```python
import torch

def _softmax(x, axis=-1):
    return torch.softmax(x, dim=axis)
def _gelu(x):
    return torch.nn.functional.gelu(x, approximate="tanh")
def _silu(x):
    return torch.nn.functional.silu(x)
def _sigmoid(x):
    return torch.sigmoid(x)
def _layernorm(x, axis=-1, eps=1e-5):
    m = x.mean(dim=axis, keepdim=True)
    v = x.var(dim=axis, keepdim=True, unbiased=False)
    return (x - m) / torch.sqrt(v + eps)
def _scatter_add(tgt, idx, src, axis=0):
    return tgt.clone().index_add_(axis, idx, src)
def _segment_sum(src, seg, n):
    out = torch.zeros((n,) + src.shape[1:], dtype=src.dtype)
    return out.index_add_(0, seg, src)
def _pad(x, pw):
    flat = tuple(v for pair in reversed(pw) for v in pair)
    return torch.nn.functional.pad(x, flat)

kernel_name = 'gated_mix__spectral_gfnet__grouped_kv_mqa__prompt'

def setup_inputs():

    _w = (lambda a: (lambda t: t.to(torch.bfloat16) if t.is_floating_point() else t)(torch.as_tensor(a)))
    def _A_setup():
        B, S, D = 1, 2048, 576
        Df = D // 2 + 1
        return {
            "x": _w((lambda *s: torch.randn(*s, dtype=torch.bfloat16) * 0.05)(B, S, D)),
            "w_r": _w((lambda *s: torch.randn(*s, dtype=torch.bfloat16) * 0.8)(S, Df) * 0.02),
            "w_i": _w((lambda *s: torch.randn(*s, dtype=torch.bfloat16) * 0.8)(S, Df) * 0.02),
        }
    _A_in = _A_setup()

    def _B_setup():
        B, S, D, H = 1, 2048, 576, 32
        Dh = D // H
        return {
            "x": _w((lambda *s: torch.randn(*s, dtype=torch.bfloat16) * 0.05)(B, S, D)),
            "wq": _w((lambda *s: torch.randn(*s, dtype=torch.bfloat16) * 0.8)(D, H * Dh)),
            "wk": _w((lambda *s: torch.randn(*s, dtype=torch.bfloat16) * 0.8)(D, Dh)),
            "wv": _w((lambda *s: torch.randn(*s, dtype=torch.bfloat16) * 0.05)(D, Dh)),
            "wo": _w((lambda *s: torch.randn(*s, dtype=torch.bfloat16) * 0.05)(H * Dh, D)),
        }
    _B_in = _B_setup()

    return {
        "A_x": _A_in["x"],
        "A_w_r": _A_in["w_r"],
        "A_w_i": _A_in["w_i"],
        "B_x": _B_in["x"],
        "B_wq": _B_in["wq"],
        "B_wk": _B_in["wk"],
        "B_wv": _B_in["wv"],
        "B_wo": _B_in["wo"],
        "gate_w": _w((lambda *s: torch.randn(*s, dtype=torch.bfloat16) * 0.05)(576) * 16.0),
    }

def reference(A_x, A_w_r, A_w_i, B_x, B_wq, B_wk, B_wv, B_wo, gate_w):
    def _A_ref(x, w_r, w_i):
        B, S, D = x.shape
        X = (lambda x, axes=(-2,-1): torch.fft.rfft2(x.float(), dim=axes))(x, axes=(-2, -1))
        W = w_r + 1j * w_i
        X = X * W
        y = (lambda x, s, axes=(-2,-1): torch.fft.irfft2(x, s=s, dim=axes).to(torch.bfloat16))(X, (S, D), axes=(-2, -1))
        return y

    def _B_ref(x, wq, wk, wv, wo):
        B, S, D = x.shape
        H = 32
        Dh = D // H
        q = (lambda x, *d: x.permute(*d))((x @ wq).reshape(B, S, H, Dh), 0, 2, 1, 3)
        k = x @ wk
        v = x @ wv
        scores = torch.einsum("bhqd,bkd->bhqk", q, k) * (Dh ** -0.5)
        p = _softmax(scores, axis=-1)
        o = torch.einsum("bhqk,bkd->bhqd", p, v)
        return (lambda x, *d: x.permute(*d))(o, 0, 2, 1, 3).reshape(B, S, H * Dh) @ wo

    x = A_x
    g = _sigmoid((x * gate_w).sum(-1, keepdims=True))
    a = _A_ref(x, A_w_r, A_w_i)
    b = _B_ref(x, B_wq, B_wk, B_wv, B_wo)
    return g * a + (1 - g) * b
```

```asm
; @launch grid=(256,1,1) block=(512,1,1) lds=163840
.amdgcn_target "amdgcn-amd-amdhsa--gfx950"
.text
.globl gated_mix__spectral_gfnet__grouped_kv_mqa__prompt_kernel
.p2align 8
.type gated_mix__spectral_gfnet__grouped_kv_mqa__prompt_kernel,@function
gated_mix__spectral_gfnet__grouped_kv_mqa__prompt_kernel:
    s_cmp_ge_u32 s2, 256
    s_cbranch_scc1 L_end
    s_load_dwordx16 s[4:19], s[0:1], 0
    s_load_dwordx8 s[20:27], s[0:1], 64
    v_lshrrev_b32 v1, 6, v0
    v_and_b32 v0, 63, v0
    v_readfirstlane_b32 s68, v1
    s_and_b32 s69, s2, 31
    s_lshr_b32 s70, s2, 5
    v_lshl_add_u32 v4, v1, 6, v0
    v_mov_b32 v2, 160768
    v_mov_b32 v3, 1
    v_lshlrev_b32 v7, 4, v0
    s_mul_i32 s94, s69, 2304
    s_mul_i32 s95, s70, 144
    s_lshl_b32 s91, s70, 2
    s_add_u32 s91, s91, s68
    s_mov_b32 s30, 2359296
    s_mov_b32 s31, 0x20000
    s_mov_b32 s72, 400000
    s_cmp_ge_u32 s68, 4
    s_waitcnt lgkmcnt(0)
    s_cbranch_scc1 L_lwave
    s_setprio 3
    s_mov_b32 s28, s4
    s_mov_b32 s29, s5
    s_and_b32 s91, s91, 31
    s_mul_i32 s90, s91, 73728
    s_mul_i32 m0, s91, 1040
    s_add_u32 s90, s90, s94
    s_add_u32 s91, s91, 4
    buffer_load_dwordx4 v7, s[28:31], s90 offen lds
    s_add_u32 m0, m0, 32128
    s_nop 0
    buffer_load_dwordx4 v7, s[28:31], s90 offen offset:1152 lds
    s_and_b32 s91, s91, 31
    s_mul_i32 s90, s91, 73728
    s_mul_i32 m0, s91, 1040
    s_add_u32 s90, s90, s94
    s_add_u32 s91, s91, 4
    buffer_load_dwordx4 v7, s[28:31], s90 offen lds
    s_add_u32 m0, m0, 32128
    s_nop 0
    buffer_load_dwordx4 v7, s[28:31], s90 offen offset:1152 lds
    s_and_b32 s91, s91, 31
    s_mul_i32 s90, s91, 73728
    s_mul_i32 m0, s91, 1040
    s_add_u32 s90, s90, s94
    s_add_u32 s91, s91, 4
    buffer_load_dwordx4 v7, s[28:31], s90 offen lds
    s_add_u32 m0, m0, 32128
    s_nop 0
    buffer_load_dwordx4 v7, s[28:31], s90 offen offset:1152 lds
    s_and_b32 s91, s91, 31
    s_mul_i32 s90, s91, 73728
    s_mul_i32 m0, s91, 1040
    s_add_u32 s90, s90, s94
    s_add_u32 s91, s91, 4
    buffer_load_dwordx4 v7, s[28:31], s90 offen lds
    s_add_u32 m0, m0, 32128
    s_nop 0
    buffer_load_dwordx4 v7, s[28:31], s90 offen offset:1152 lds
    s_and_b32 s91, s91, 31
    s_mul_i32 s90, s91, 73728
    s_mul_i32 m0, s91, 1040
    s_add_u32 s90, s90, s94
    s_add_u32 s91, s91, 4
    buffer_load_dwordx4 v7, s[28:31], s90 offen lds
    s_add_u32 m0, m0, 32128
    s_nop 0
    buffer_load_dwordx4 v7, s[28:31], s90 offen offset:1152 lds
    s_and_b32 s91, s91, 31
    s_mul_i32 s90, s91, 73728
    s_mul_i32 m0, s91, 1040
    s_add_u32 s90, s90, s94
    s_add_u32 s91, s91, 4
    buffer_load_dwordx4 v7, s[28:31], s90 offen lds
    s_add_u32 m0, m0, 32128
    s_nop 0
    buffer_load_dwordx4 v7, s[28:31], s90 offen offset:1152 lds
    s_and_b32 s91, s91, 31
    s_mul_i32 s90, s91, 73728
    s_mul_i32 m0, s91, 1040
    s_add_u32 s90, s90, s94
    s_add_u32 s91, s91, 4
    buffer_load_dwordx4 v7, s[28:31], s90 offen lds
    s_add_u32 m0, m0, 32128
    s_nop 0
    buffer_load_dwordx4 v7, s[28:31], s90 offen offset:1152 lds
    s_and_b32 s91, s91, 31
    s_mul_i32 s90, s91, 73728
    s_mul_i32 m0, s91, 1040
    s_add_u32 s90, s90, s94
    s_add_u32 s91, s91, 4
    buffer_load_dwordx4 v7, s[28:31], s90 offen lds
    s_add_u32 m0, m0, 32128
    s_nop 0
    buffer_load_dwordx4 v7, s[28:31], s90 offen offset:1152 lds
    s_barrier
    s_load_dword s71, s[26:27], 0
    v_lshrrev_b32 v20, 3, v0
    s_mov_b32 s73, 73728
    v_mul_lo_u32 v21, v20, s73
    v_lshrrev_b32 v22, 4, v0
    v_xor_b32 v22, v22, v0
    v_and_b32 v22, 7, v22
    v_lshl_add_u32 v21, v22, 4, v21
    s_and_b32 s90, s68, 1
    s_mul_i32 s90, s90, 1179648
    s_lshr_b32 s73, s68, 1
    s_mul_i32 s73, s73, 1152
    s_add_u32 s90, s90, s73
    s_add_u32 s90, s90, s94
    s_add_u32 s90, s90, 1024
    s_lshl_b32 s91, s68, 11
    s_add_u32 m0, s91, 66560
    v_xor_b32 v22, 64, v21
    buffer_load_dwordx4 v21, s[28:31], s90 offen lds
    s_add_u32 m0, s91, 67584
    s_add_u32 s90, s90, 589824
    buffer_load_dwordx4 v22, s[28:31], s90 offen lds
    s_cmp_lt_u32 s70, 4
    s_cselect_b32 s36, s14, s16
    s_cselect_b32 s37, s15, s17
    s_mov_b32 s38, 20736
    s_mov_b32 s39, 0x20000
    v_mul_u32_u24 v5, 36, v4
    v_lshlrev_b32 v6, 1, v4
    s_and_b32 s73, s70, 3
    s_lshl_b32 s92, s73, 3
    s_mov_b32 s40, s20
    s_mov_b32 s41, s21
    s_mov_b32 s42, 1152
    s_mov_b32 s43, 0x20000
    buffer_load_dwordx3 v[24:26], v5, s[36:39], s92 offen
    buffer_load_ushort v27, v6, s[40:43], 0 offen
    v_add_u32 v5, 9216, v5
    buffer_load_dwordx3 v[28:30], v5, s[36:39], s92 offen
    buffer_load_ushort v31, v6, s[40:43], 0 offen offset:512
    s_cmp_gt_u32 s68, 0
    s_cbranch_scc1 KV3_1
    v_add_u32 v5, 9216, v5
    buffer_load_dwordx3 v[40:42], v5, s[36:39], s92 offen
    buffer_load_ushort v43, v6, s[40:43], 0 offen offset:1024
KV3_1:
    s_mov_b64 exec, 1
    ds_add_u32 v2, v3 offset:2152
    s_mov_b64 exec, -1
    s_mov_b32 s44, s26
    s_mov_b32 s45, s27
    s_mov_b32 s46, 16777216
    s_mov_b32 s47, 0x20000
    v_lshrrev_b32 v7, 7, v4
    v_lshlrev_b32 v7, 7, v7
    v_lshl_add_u32 v7, v4, 4, v7
    v_add_u32 v7, 138752, v7
    v_and_b32 v14, 15, v0
    v_lshrrev_b32 v15, 4, v0
    v_and_b32 v17, 31, v0
    v_lshrrev_b32 v18, 5, v0
    v_bfe_u32 v22, v0, 2, 2
    v_lshlrev_b32 v22, 4, v22
    v_and_b32 v23, 1, v0
    v_lshl_add_u32 v22, v23, 3, v22
    v_and_b32 v16, 1, v15
    v_mul_u32_u24 v16, 2176, v16
    v_lshl_add_u32 v16, v18, 10, v16
    v_add_u32 v16, v16, v22
    v_lshl_add_u32 v12, v15, 7, v22
    v_add_u32 v12, 8704, v12
    v_add_u32 v19, 138752, v16
    v_add_u32 v10, 138752, v12
    v_add_u32 v16, 148480, v16
    v_add_u32 v12, 148480, v12
    s_lshl_b32 s73, s68, 4
    v_add_u32 v21, s73, v14
    v_mul_u32_u24 v20, 1040, v21
    v_and_b32 v22, 1, v15
    v_lshl_add_u32 v20, v22, 8, v20
    v_lshl_add_u32 v20, v18, 7, v20
    v_lshrrev_b32 v22, 1, v21
    v_xor_b32 v22, v22, v15
    v_and_b32 v22, 7, v22
    v_lshlrev_b32 v22, 4, v22
    v_lshl_add_u32 v11, v21, 7, v22
    v_add_u32 v11, 66560, v11
    v_xor_b32 v9, 64, v11
    s_lshl_b32 s90, s69, 1
    s_lshr_b32 s73, s68, 1
    s_add_u32 s90, s90, s73
    s_and_b32 s91, s68, 1
    s_mov_b32 s92, 0xbfb8aa3b
    s_lshl_b32 s99, s68, 6
    s_add_u32 s99, s99, 163072
    s_cmp_lt_u32 s70, 4
    s_cbranch_scc1 EK_2
    s_lshl_b32 s90, s90, 1
    s_add_u32 s90, s90, s91
    s_mul_i32 s90, s90, 640
    s_add_u32 s90, s90, 196608
    s_sub_u32 s73, s70, 4
    s_lshl_b32 s73, s73, 2
    v_add_u32 v36, s73, v14
    v_cmp_eq_u32 vcc, 7, v14
    v_lshrrev_b32 v37, 1, v15
    s_nop 0
    v_cndmask_b32 v36, v36, 18, vcc
    v_lshlrev_b32 v36, 5, v36
    v_lshl_add_u32 v36, v37, 3, v36
    v_and_b32 v37, 1, v15
    v_lshl_add_u32 v36, v37, 4, v36
    v_mov_b32 v37, 0x3f803f80
    v_lshl_add_u32 v38, v15, 4, s99
    s_mov_b32 s88, 0x000f000f
    s_cmp_eq_u32 s70, 7
    s_cmov_b32 s88, 0x00bf00bf
    s_waitcnt vmcnt(0)
    ds_write_b128 v7, v[24:27]
    ds_write_b128 v7, v[28:31] offset:4352
    s_cmp_gt_u32 s68, 0
    s_cbranch_scc1 KW_4
    ds_write_b128 v7, v[40:43] offset:8704
KW_4:
    s_mov_b64 exec, 1
    ds_add_u32 v2, v3 offset:2064
    s_mov_b64 exec, -1
LW_5:
    ds_read_b32 v1, v2 offset:2064
    s_waitcnt lgkmcnt(0)
    v_readfirstlane_b32 s73, v1
    s_cmp_ge_u32 s73, 4
    s_cbranch_scc1 LWD_6
    s_sub_u32 s72, s72, 1
    s_cbranch_scc0 LW_5
    s_branch L_bail
LWD_6:
    s_mul_i32 s71, s71, 0x9E3779B1
    s_add_u32 s71, s71, 0x7F4A7C15
    ds_read_b64_tr_b16 v[44:45], v19 offset:0
    ds_read_b64_tr_b16 v[46:47], v19 offset:64
    ds_read_b128 v[160:163], v20 offset:0
    ds_read_b64_tr_b16 v[48:49], v19 offset:128
    ds_read_b64_tr_b16 v[50:51], v19 offset:192
    ds_read_b128 v[164:167], v20 offset:16
    ds_read_b64_tr_b16 v[52:53], v19 offset:256
    ds_read_b64_tr_b16 v[54:55], v19 offset:320
    ds_read_b128 v[168:171], v20 offset:32
    ds_read_b64_tr_b16 v[56:57], v19 offset:384
    ds_read_b64_tr_b16 v[58:59], v19 offset:448
    ds_read_b128 v[172:175], v20 offset:48
    ds_read_b64_tr_b16 v[60:61], v19 offset:512
    ds_read_b64_tr_b16 v[62:63], v19 offset:576
    ds_read_b128 v[176:179], v20 offset:64
    s_waitcnt lgkmcnt(12)
    v_mfma_f32_16x16x32_bf16 v[252:255], v[160:163], v[44:47], 0
    ds_read_b64_tr_b16 v[44:45], v19 offset:640
    ds_read_b64_tr_b16 v[46:47], v19 offset:704
    ds_read_b128 v[180:183], v20 offset:80
    s_waitcnt lgkmcnt(12)
    v_mfma_f32_16x16x32_bf16 v[252:255], v[164:167], v[48:51], v[252:255]
    ds_read_b64_tr_b16 v[48:49], v19 offset:768
    ds_read_b64_tr_b16 v[50:51], v19 offset:832
    ds_read_b128 v[184:187], v20 offset:96
    s_waitcnt lgkmcnt(12)
    v_mfma_f32_16x16x32_bf16 v[252:255], v[168:171], v[52:55], v[252:255]
    ds_read_b64_tr_b16 v[52:53], v19 offset:896
    ds_read_b64_tr_b16 v[54:55], v19 offset:960
    ds_read_b128 v[188:191], v20 offset:112
    s_waitcnt lgkmcnt(12)
    v_mfma_f32_16x16x32_bf16 v[252:255], v[172:175], v[56:59], v[252:255]
    ds_read_b64_tr_b16 v[56:57], v19 offset:4352
    ds_read_b64_tr_b16 v[58:59], v19 offset:4416
    ds_read_b128 v[192:195], v20 offset:512
    s_waitcnt lgkmcnt(12)
    v_mfma_f32_16x16x32_bf16 v[252:255], v[176:179], v[60:63], v[252:255]
    ds_read_b64_tr_b16 v[60:61], v19 offset:4480
    ds_read_b64_tr_b16 v[62:63], v19 offset:4544
    ds_read_b128 v[196:199], v20 offset:528
    s_waitcnt lgkmcnt(12)
    v_mfma_f32_16x16x32_bf16 v[252:255], v[180:183], v[44:47], v[252:255]
    ds_read_b64_tr_b16 v[44:45], v19 offset:4608
    ds_read_b64_tr_b16 v[46:47], v19 offset:4672
    ds_read_b128 v[200:203], v20 offset:544
    s_waitcnt lgkmcnt(12)
    v_mfma_f32_16x16x32_bf16 v[252:255], v[184:187], v[48:51], v[252:255]
    ds_read_b64_tr_b16 v[48:49], v19 offset:4736
    ds_read_b64_tr_b16 v[50:51], v19 offset:4800
    ds_read_b128 v[204:207], v20 offset:560
    s_waitcnt lgkmcnt(12)
    v_mfma_f32_16x16x32_bf16 v[252:255], v[188:191], v[52:55], v[252:255]
    ds_read_b64_tr_b16 v[52:53], v19 offset:4864
    ds_read_b64_tr_b16 v[54:55], v19 offset:4928
    ds_read_b128 v[208:211], v20 offset:576
    s_waitcnt lgkmcnt(12)
    v_mfma_f32_16x16x32_bf16 v[252:255], v[192:195], v[56:59], v[252:255]
    ds_read_b64_tr_b16 v[56:57], v19 offset:4992
    ds_read_b64_tr_b16 v[58:59], v19 offset:5056
    ds_read_b128 v[212:215], v20 offset:592
    s_waitcnt lgkmcnt(12)
    v_mfma_f32_16x16x32_bf16 v[252:255], v[196:199], v[60:63], v[252:255]
    ds_read_b64_tr_b16 v[60:61], v19 offset:5120
    ds_read_b64_tr_b16 v[62:63], v19 offset:5184
    ds_read_b128 v[216:219], v20 offset:608
    s_waitcnt lgkmcnt(12)
    v_mfma_f32_16x16x32_bf16 v[252:255], v[200:203], v[44:47], v[252:255]
    ds_read_b64_tr_b16 v[44:45], v19 offset:5248
    ds_read_b64_tr_b16 v[46:47], v19 offset:5312
    ds_read_b128 v[220:223], v20 offset:624
    s_waitcnt lgkmcnt(12)
    v_mfma_f32_16x16x32_bf16 v[252:255], v[204:207], v[48:51], v[252:255]
    ds_read_b64_tr_b16 v[48:49], v10 offset:0
    ds_read_b64_tr_b16 v[50:51], v10 offset:64
    ds_read_b128 v[224:227], v11
    s_waitcnt lgkmcnt(12)
    v_mfma_f32_16x16x32_bf16 v[252:255], v[208:211], v[52:55], v[252:255]
    ds_read_b64_tr_b16 v[52:53], v10 offset:512
    ds_read_b64_tr_b16 v[54:55], v10 offset:576
    ds_read_b128 v[228:231], v9
    s_waitcnt lgkmcnt(12)
    v_mfma_f32_16x16x32_bf16 v[252:255], v[212:215], v[56:59], v[252:255]
    s_waitcnt lgkmcnt(9)
    v_mfma_f32_16x16x32_bf16 v[252:255], v[216:219], v[60:63], v[252:255]
    s_waitcnt lgkmcnt(6)
    v_mfma_f32_16x16x32_bf16 v[252:255], v[220:223], v[44:47], v[252:255]
    s_waitcnt lgkmcnt(3)
    v_mfma_f32_16x16x32_bf16 v[252:255], v[224:227], v[48:51], v[252:255]
    s_waitcnt lgkmcnt(0)
    v_mfma_f32_16x16x32_bf16 v[252:255], v[228:231], v[52:55], v[252:255]
    s_mov_b64 exec, 1
    ds_add_u32 v2, v3 offset:2068
    s_mov_b64 exec, -1
    s_nop 0
    s_nop 1
    s_nop 1
    v_cvt_pk_bf16_f32 v22, v252, v253
    v_cvt_pk_bf16_f32 v23, v254, v255
    v_cndmask_b32 v22, v22, v37, vcc
    v_cndmask_b32 v23, v23, v37, vcc
    s_mov_b32 exec_lo, s88
    s_mov_b32 exec_hi, s88
    buffer_store_dwordx2 v[22:23], v36, s[44:47], s90 offen sc1
    s_mov_b64 exec, -1
    v_mul_f32 v252, s92, v252
    v_exp_f32 v252, v252
    v_mul_f32 v253, s92, v253
    v_exp_f32 v253, v253
    v_mul_f32 v254, s92, v254
    v_exp_f32 v254, v254
    v_mul_f32 v255, s92, v255
    v_exp_f32 v255, v255
    v_add_f32 v252, 1.0, v252
    v_rcp_f32 v252, v252
    v_add_f32 v253, 1.0, v253
    v_rcp_f32 v253, v253
    v_add_f32 v254, 1.0, v254
    v_rcp_f32 v254, v254
    v_add_f32 v255, 1.0, v255
    v_rcp_f32 v255, v255
    s_mov_b32 exec_lo, 0x00400040
    s_mov_b32 exec_hi, 0x00400040
    ds_write_b128 v38, v[252:255]
    s_branch EKD_3
EK_2:
    s_lshl_b32 s91, s91, 4
    v_add_u32 v37, s91, v14
    v_lshlrev_b32 v36, 5, v37
    v_lshlrev_b32 v37, 2, v37
    v_lshl_add_u32 v38, v14, 2, s99
    s_lshl_b32 s88, s90, 10
    s_lshl_b32 s73, s70, 3
    s_add_u32 s88, s88, s73
    s_add_u32 s88, s88, 65536
    s_lshl_b32 s90, s90, 7
    s_add_u32 s90, s90, 131072
    s_cmp_lg_u32 s70, 3
    s_cmov_b32 s90, 1073741824
    s_mov_b32 s91, 0x3eae1a93
    s_waitcnt vmcnt(0)
    ds_write_b128 v7, v[24:27]
    ds_write_b128 v7, v[28:31] offset:4352
    s_cmp_gt_u32 s68, 0
    s_cbranch_scc1 KW_7
    ds_write_b128 v7, v[40:43] offset:8704
KW_7:
    s_mov_b64 exec, 1
    ds_add_u32 v2, v3 offset:2064
    s_mov_b64 exec, -1
LW_8:
    ds_read_b32 v1, v2 offset:2064
    s_waitcnt lgkmcnt(0)
    v_readfirstlane_b32 s73, v1
    s_cmp_ge_u32 s73, 4
    s_cbranch_scc1 LWD_9
    s_sub_u32 s72, s72, 1
    s_cbranch_scc0 LW_8
    s_branch L_bail
LWD_9:
    s_mul_i32 s71, s71, 0x9E3779B1
    s_add_u32 s71, s71, 0x7F4A7C15
    ds_read_b64_tr_b16 v[44:45], v19 offset:0
    ds_read_b64_tr_b16 v[46:47], v19 offset:64
    ds_read_b128 v[160:163], v20 offset:0
    ds_read_b64_tr_b16 v[48:49], v19 offset:128
    ds_read_b64_tr_b16 v[50:51], v19 offset:192
    ds_read_b128 v[164:167], v20 offset:16
    ds_read_b64_tr_b16 v[52:53], v19 offset:256
    ds_read_b64_tr_b16 v[54:55], v19 offset:320
    ds_read_b128 v[168:171], v20 offset:32
    ds_read_b64_tr_b16 v[56:57], v19 offset:384
    ds_read_b64_tr_b16 v[58:59], v19 offset:448
    ds_read_b128 v[172:175], v20 offset:48
    ds_read_b64_tr_b16 v[60:61], v19 offset:512
    ds_read_b64_tr_b16 v[62:63], v19 offset:576
    ds_read_b128 v[176:179], v20 offset:64
    s_waitcnt lgkmcnt(12)
    v_mfma_f32_16x16x32_bf16 v[252:255], v[44:47], v[160:163], 0
    ds_read_b64_tr_b16 v[44:45], v19 offset:640
    ds_read_b64_tr_b16 v[46:47], v19 offset:704
    ds_read_b128 v[180:183], v20 offset:80
    s_waitcnt lgkmcnt(12)
    v_mfma_f32_16x16x32_bf16 v[252:255], v[48:51], v[164:167], v[252:255]
    ds_read_b64_tr_b16 v[48:49], v19 offset:768
    ds_read_b64_tr_b16 v[50:51], v19 offset:832
    ds_read_b128 v[184:187], v20 offset:96
    s_waitcnt lgkmcnt(12)
    v_mfma_f32_16x16x32_bf16 v[252:255], v[52:55], v[168:171], v[252:255]
    ds_read_b64_tr_b16 v[52:53], v19 offset:896
    ds_read_b64_tr_b16 v[54:55], v19 offset:960
    ds_read_b128 v[188:191], v20 offset:112
    s_waitcnt lgkmcnt(12)
    v_mfma_f32_16x16x32_bf16 v[252:255], v[56:59], v[172:175], v[252:255]
    ds_read_b64_tr_b16 v[56:57], v19 offset:4352
    ds_read_b64_tr_b16 v[58:59], v19 offset:4416
    ds_read_b128 v[192:195], v20 offset:512
    s_waitcnt lgkmcnt(12)
    v_mfma_f32_16x16x32_bf16 v[252:255], v[60:63], v[176:179], v[252:255]
    ds_read_b64_tr_b16 v[60:61], v19 offset:4480
    ds_read_b64_tr_b16 v[62:63], v19 offset:4544
    ds_read_b128 v[196:199], v20 offset:528
    s_waitcnt lgkmcnt(12)
    v_mfma_f32_16x16x32_bf16 v[252:255], v[44:47], v[180:183], v[252:255]
    ds_read_b64_tr_b16 v[44:45], v19 offset:4608
    ds_read_b64_tr_b16 v[46:47], v19 offset:4672
    ds_read_b128 v[200:203], v20 offset:544
    s_waitcnt lgkmcnt(12)
    v_mfma_f32_16x16x32_bf16 v[252:255], v[48:51], v[184:187], v[252:255]
    ds_read_b64_tr_b16 v[48:49], v19 offset:4736
    ds_read_b64_tr_b16 v[50:51], v19 offset:4800
    ds_read_b128 v[204:207], v20 offset:560
    s_waitcnt lgkmcnt(12)
    v_mfma_f32_16x16x32_bf16 v[252:255], v[52:55], v[188:191], v[252:255]
    ds_read_b64_tr_b16 v[52:53], v19 offset:4864
    ds_read_b64_tr_b16 v[54:55], v19 offset:4928
    ds_read_b128 v[208:211], v20 offset:576
    s_waitcnt lgkmcnt(12)
    v_mfma_f32_16x16x32_bf16 v[252:255], v[56:59], v[192:195], v[252:255]
    ds_read_b64_tr_b16 v[56:57], v19 offset:4992
    ds_read_b64_tr_b16 v[58:59], v19 offset:5056
    ds_read_b128 v[212:215], v20 offset:592
    s_waitcnt lgkmcnt(12)
    v_mfma_f32_16x16x32_bf16 v[252:255], v[60:63], v[196:199], v[252:255]
    ds_read_b64_tr_b16 v[60:61], v19 offset:5120
    ds_read_b64_tr_b16 v[62:63], v19 offset:5184
    ds_read_b128 v[216:219], v20 offset:608
    s_waitcnt lgkmcnt(12)
    v_mfma_f32_16x16x32_bf16 v[252:255], v[44:47], v[200:203], v[252:255]
    ds_read_b64_tr_b16 v[44:45], v19 offset:5248
    ds_read_b64_tr_b16 v[46:47], v19 offset:5312
    ds_read_b128 v[220:223], v20 offset:624
    s_waitcnt lgkmcnt(12)
    v_mfma_f32_16x16x32_bf16 v[252:255], v[48:51], v[204:207], v[252:255]
    ds_read_b64_tr_b16 v[48:49], v10 offset:0
    ds_read_b64_tr_b16 v[50:51], v10 offset:64
    ds_read_b128 v[224:227], v11
    s_waitcnt lgkmcnt(12)
    v_mfma_f32_16x16x32_bf16 v[252:255], v[52:55], v[208:211], v[252:255]
    ds_read_b64_tr_b16 v[52:53], v10 offset:512
    ds_read_b64_tr_b16 v[54:55], v10 offset:576
    ds_read_b128 v[228:231], v9
    s_waitcnt lgkmcnt(12)
    v_mfma_f32_16x16x32_bf16 v[252:255], v[56:59], v[212:215], v[252:255]
    s_waitcnt lgkmcnt(9)
    v_mfma_f32_16x16x32_bf16 v[252:255], v[60:63], v[216:219], v[252:255]
    s_waitcnt lgkmcnt(6)
    v_mfma_f32_16x16x32_bf16 v[252:255], v[44:47], v[220:223], v[252:255]
    s_waitcnt lgkmcnt(3)
    v_mfma_f32_16x16x32_bf16 v[252:255], v[48:51], v[224:227], v[252:255]
    s_waitcnt lgkmcnt(0)
    v_mfma_f32_16x16x32_bf16 v[252:255], v[52:55], v[228:231], v[252:255]
    s_mov_b64 exec, 1
    ds_add_u32 v2, v3 offset:2068
    s_mov_b64 exec, -1
    s_nop 0
    s_nop 1
    s_nop 1
    v_mul_f32 v39, s92, v254
    v_mul_f32 v252, s91, v252
    v_mul_f32 v253, s91, v253
    v_mul_f32 v254, s91, v254
    v_mul_f32 v255, s91, v255
    v_cvt_pk_bf16_f32 v22, v252, v253
    v_cvt_pk_bf16_f32 v23, v254, v255
    s_mov_b64 exec, 0xffff
    buffer_store_dwordx2 v[22:23], v36, s[44:47], s88 offen sc1
    s_mov_b32 exec_lo, 0xffff0000
    buffer_store_dword v22, v37, s[44:47], s90 offen sc1
    v_exp_f32 v39, v39
    s_nop 0
    v_add_f32 v39, 1.0, v39
    v_rcp_f32 v39, v39
    s_nop 0
    ds_write_b32 v38, v39
EKD_3:
    s_mov_b64 exec, -1
    s_lshl_b32 s73, s69, 3
    s_add_u32 s73, s73, s70
    s_lshl_b32 s73, s73, 4
    s_add_u32 s91, s73, 327680
    v_bfe_u32 v22, v0, 2, 2
    v_lshl_add_u32 v19, v18, 3, v22
    v_lshlrev_b32 v19, 6, v19
    v_bfe_u32 v22, v0, 4, 1
    v_lshl_add_u32 v19, v22, 5, v19
    v_and_b32 v22, 3, v0
    v_lshl_add_u32 v19, v22, 3, v19
    s_and_b32 s73, s68, 1
    s_mul_i32 s73, s73, 36864
    s_add_u32 s73, s73, 74752
    v_add_u32 v19, s73, v19
    s_lshr_b32 s73, s68, 1
    s_lshl_b32 s73, s73, 5
    v_add_u32 v21, s73, v17
    v_mul_u32_u24 v13, 1040, v21
    v_lshl_add_u32 v13, v18, 4, v13
    v_mul_u32_u24 v26, 48, v4
    v_add_u32 v26, 74788, v26
    v_lshrrev_b32 v22, 1, v21
    v_xor_b32 v22, v22, v18
    v_and_b32 v22, 7, v22
    v_lshlrev_b32 v22, 4, v22
    v_lshl_add_u32 v6, v21, 7, v22
    v_add_u32 v6, 66560, v6
    v_xor_b32 v7, 32, v6
    v_xor_b32 v8, 64, v6
    v_xor_b32 v9, 0x60, v6
    v_mul_u32_u24 v22, 48, v21
    v_add_u32 v22, 74752, v22
    v_lshl_add_u32 v23, v18, 3, v22
    v_mul_u32_u24 v24, 3044, v18
    v_add_u32 v24, v24, v22
    s_lshl_b32 s73, s68, 4
    v_add_u32 v25, s73, v14
    v_mul_u32_u24 v25, 48, v25
    v_lshl_add_u32 v25, v15, 3, v25
    v_add_u32 v25, 83988, v25
    v_mov_b32 v27, 0
    v_lshlrev_b32 v28, 4, v0
    s_lshl_b32 s93, s68, 10
    s_add_u32 s93, s93, 327680
    v_and_b32 v84, 31, v0
    v_lshrrev_b32 v85, 5, v0
    v_lshlrev_b32 v82, 5, v84
    v_lshl_add_u32 v82, v85, 4, v82
    v_mov_b32 v86, 1073741824
    v_lshlrev_b32 v83, 2, v0
    v_subrev_u32 v87, 64, v82
    v_cmp_eq_u32 vcc, 20, v84
    s_and_b32 s73, s68, 3
    s_nop 0
    v_cndmask_b32 v87, v86, v87, vcc
    v_cmp_gt_u32 vcc, 18, v84
    s_lshl_b32 s96, s73, 14
    s_nop 0
    v_cndmask_b32 v4, v87, v82, vcc
    s_add_u32 s96, s96, 65536
    s_lshl_b32 s97, s73, 11
    s_add_u32 s97, s97, 131072
    s_mul_i32 s98, s73, 20480
    s_add_u32 s98, s98, 196608
    ds_read_b128 v[88:91], v13 offset:448
    ds_read_b128 v[92:95], v13 offset:480
    ds_read_b128 v[96:99], v13 offset:512
    ds_read_b128 v[100:103], v13 offset:544
    ds_read_b128 v[104:107], v13 offset:576
    ds_read_b128 v[108:111], v13 offset:608
    s_waitcnt lgkmcnt(6)
    ds_read_b128 v[112:115], v13 offset:640
    ds_read_b128 v[116:119], v13 offset:672
    ds_read_b128 v[120:123], v13 offset:704
    ds_read_b128 v[124:127], v13 offset:736
    ds_read_b128 v[128:131], v13 offset:768
    ds_read_b128 v[132:135], v13 offset:800
    s_waitcnt lgkmcnt(6)
    ds_read_b128 v[136:139], v13 offset:832
    ds_read_b128 v[140:143], v13 offset:864
    ds_read_b128 v[144:147], v13 offset:896
    ds_read_b128 v[148:151], v13 offset:928
    ds_read_b128 v[152:155], v13 offset:960
    ds_read_b128 v[156:159], v13 offset:992
    s_waitcnt lgkmcnt(6)
    s_waitcnt vmcnt(0)
    s_mov_b64 exec, 1
    ds_add_rtn_u32 v1, v2, v3 offset:2104
    s_mov_b64 exec, -1
    s_waitcnt lgkmcnt(0)
    v_readfirstlane_b32 s73, v1
    s_cmp_lg_u32 s73, 3
    s_cbranch_scc1 NF_10
    v_mov_b32 v1, s71
    s_mov_b64 exec, 1
    buffer_store_dword v1, off, s[44:47], s91 sc1
    s_mov_b64 exec, -1
NF_10:
LW_11:
    ds_read_b32 v1, v2 offset:2048
    s_waitcnt lgkmcnt(0)
    v_readfirstlane_b32 s73, v1
    s_cmp_ge_u32 s73, 2
    s_cbranch_scc1 LWD_12
    s_sub_u32 s72, s72, 1
    s_cbranch_scc0 LW_11
    s_branch L_bail
LWD_12:
    ds_read_b64_tr_b16 v[32:33], v19 offset:0
    ds_read_b64_tr_b16 v[34:35], v19 offset:256
    ds_read_b128 v[36:39], v13 offset:0
    ds_read_b64_tr_b16 v[40:41], v19 offset:1024
    ds_read_b64_tr_b16 v[42:43], v19 offset:1280
    ds_read_b128 v[44:47], v13 offset:32
    ds_read_b64_tr_b16 v[48:49], v19 offset:2048
    ds_read_b64_tr_b16 v[50:51], v19 offset:2304
    ds_read_b128 v[52:55], v13 offset:64
    s_waitcnt lgkmcnt(6)
    v_mfma_f32_32x32x16_bf16 v[232:247], v[32:35], v[36:39], 0
    ds_read_b64_tr_b16 v[56:57], v19 offset:3072
    ds_read_b64_tr_b16 v[58:59], v19 offset:3328
    ds_read_b128 v[60:63], v13 offset:96
    s_waitcnt lgkmcnt(6)
    v_mfma_f32_32x32x16_bf16 v[232:247], v[40:43], v[44:47], v[232:247]
    ds_read_b64_tr_b16 v[32:33], v19 offset:4096
    ds_read_b64_tr_b16 v[34:35], v19 offset:4352
    ds_read_b128 v[36:39], v13 offset:128
    s_waitcnt lgkmcnt(6)
    v_mfma_f32_32x32x16_bf16 v[232:247], v[48:51], v[52:55], v[232:247]
    ds_read_b64_tr_b16 v[40:41], v19 offset:5120
    ds_read_b64_tr_b16 v[42:43], v19 offset:5376
    ds_read_b128 v[44:47], v13 offset:160
    s_waitcnt lgkmcnt(6)
    v_mfma_f32_32x32x16_bf16 v[232:247], v[56:59], v[60:63], v[232:247]
    ds_read_b64_tr_b16 v[48:49], v19 offset:6144
    ds_read_b64_tr_b16 v[50:51], v19 offset:6400
    ds_read_b128 v[52:55], v13 offset:192
    s_waitcnt lgkmcnt(6)
    v_mfma_f32_32x32x16_bf16 v[232:247], v[32:35], v[36:39], v[232:247]
    ds_read_b64_tr_b16 v[56:57], v19 offset:7168
    ds_read_b64_tr_b16 v[58:59], v19 offset:7424
    ds_read_b128 v[60:63], v13 offset:224
    s_waitcnt lgkmcnt(6)
    v_mfma_f32_32x32x16_bf16 v[232:247], v[40:43], v[44:47], v[232:247]
    ds_read_b64_tr_b16 v[32:33], v19 offset:8192
    ds_read_b64_tr_b16 v[34:35], v19 offset:8448
    ds_read_b128 v[36:39], v13 offset:256
    s_waitcnt lgkmcnt(6)
    v_mfma_f32_32x32x16_bf16 v[232:247], v[48:51], v[52:55], v[232:247]
    ds_read_b64_tr_b16 v[40:41], v19 offset:9216
    ds_read_b64_tr_b16 v[42:43], v19 offset:9472
    ds_read_b128 v[44:47], v13 offset:288
    s_waitcnt lgkmcnt(6)
    v_mfma_f32_32x32x16_bf16 v[232:247], v[56:59], v[60:63], v[232:247]
    ds_read_b64_tr_b16 v[48:49], v19 offset:10240
    ds_read_b64_tr_b16 v[50:51], v19 offset:10496
    ds_read_b128 v[52:55], v13 offset:320
    s_waitcnt lgkmcnt(6)
    v_mfma_f32_32x32x16_bf16 v[232:247], v[32:35], v[36:39], v[232:247]
    ds_read_b64_tr_b16 v[56:57], v19 offset:11264
    ds_read_b64_tr_b16 v[58:59], v19 offset:11520
    ds_read_b128 v[60:63], v13 offset:352
    s_waitcnt lgkmcnt(6)
    v_mfma_f32_32x32x16_bf16 v[232:247], v[40:43], v[44:47], v[232:247]
    s_waitcnt lgkmcnt(3)
    v_mfma_f32_32x32x16_bf16 v[232:247], v[48:51], v[52:55], v[232:247]
    s_waitcnt lgkmcnt(0)
    v_mfma_f32_32x32x16_bf16 v[232:247], v[56:59], v[60:63], v[232:247]
    s_mov_b64 exec, 1
    ds_add_u32 v2, v3 offset:2072
    s_mov_b64 exec, -1
LW_13:
    ds_read_b32 v1, v2 offset:2052
    s_waitcnt lgkmcnt(0)
    v_readfirstlane_b32 s73, v1
    s_cmp_ge_u32 s73, 2
    s_cbranch_scc1 LWD_14
    s_sub_u32 s72, s72, 1
    s_cbranch_scc0 LW_13
    s_branch L_bail
LWD_14:
    ds_read_b64_tr_b16 v[32:33], v19 offset:12288
    ds_read_b64_tr_b16 v[34:35], v19 offset:12544
    ds_read_b128 v[36:39], v13 offset:384
    ds_read_b64_tr_b16 v[64:65], v16 offset:0
    ds_read_b64_tr_b16 v[66:67], v16 offset:64
    ds_read_b64_tr_b16 v[40:41], v19 offset:13312
    ds_read_b64_tr_b16 v[42:43], v19 offset:13568
    ds_read_b128 v[44:47], v13 offset:416
    s_waitcnt lgkmcnt(5)
    v_mfma_f32_32x32x16_bf16 v[232:247], v[32:35], v[36:39], v[232:247]
    ds_read_b64_tr_b16 v[68:69], v16 offset:128
    ds_read_b64_tr_b16 v[70:71], v16 offset:192
    s_waitcnt lgkmcnt(5)
    v_mfma_f32_16x16x32_bf16 v[248:251], v[64:67], v[160:163], 0
    ds_read_b64_tr_b16 v[48:49], v19 offset:14336
    ds_read_b64_tr_b16 v[50:51], v19 offset:14592
    s_waitcnt lgkmcnt(4)
    v_mfma_f32_32x32x16_bf16 v[232:247], v[40:43], v[44:47], v[232:247]
    ds_read_b64_tr_b16 v[72:73], v16 offset:256
    ds_read_b64_tr_b16 v[74:75], v16 offset:320
    s_waitcnt lgkmcnt(4)
    v_mfma_f32_16x16x32_bf16 v[248:251], v[68:71], v[164:167], v[248:251]
    ds_read_b64_tr_b16 v[56:57], v19 offset:15360
    ds_read_b64_tr_b16 v[58:59], v19 offset:15616
    s_waitcnt lgkmcnt(4)
    v_mfma_f32_32x32x16_bf16 v[232:247], v[48:51], v[88:91], v[232:247]
    ds_read_b64_tr_b16 v[64:65], v16 offset:384
    ds_read_b64_tr_b16 v[66:67], v16 offset:448
    s_waitcnt lgkmcnt(4)
    v_mfma_f32_16x16x32_bf16 v[248:251], v[72:75], v[168:171], v[248:251]
    ds_read_b64_tr_b16 v[32:33], v19 offset:16384
    ds_read_b64_tr_b16 v[34:35], v19 offset:16640
    s_waitcnt lgkmcnt(4)
    v_mfma_f32_32x32x16_bf16 v[232:247], v[56:59], v[92:95], v[232:247]
    ds_read_b64_tr_b16 v[68:69], v16 offset:512
    ds_read_b64_tr_b16 v[70:71], v16 offset:576
    s_waitcnt lgkmcnt(4)
    v_mfma_f32_16x16x32_bf16 v[248:251], v[64:67], v[172:175], v[248:251]
    ds_read_b64_tr_b16 v[40:41], v19 offset:17408
    ds_read_b64_tr_b16 v[42:43], v19 offset:17664
    s_waitcnt lgkmcnt(4)
    v_mfma_f32_32x32x16_bf16 v[232:247], v[32:35], v[96:99], v[232:247]
    ds_read_b64_tr_b16 v[72:73], v16 offset:640
    ds_read_b64_tr_b16 v[74:75], v16 offset:704
    s_waitcnt lgkmcnt(4)
    v_mfma_f32_16x16x32_bf16 v[248:251], v[68:71], v[176:179], v[248:251]
    ds_read_b64_tr_b16 v[48:49], v19 offset:18432
    ds_read_b64_tr_b16 v[50:51], v19 offset:18688
    s_waitcnt lgkmcnt(4)
    v_mfma_f32_32x32x16_bf16 v[232:247], v[40:43], v[100:103], v[232:247]
    ds_read_b64_tr_b16 v[64:65], v16 offset:768
    ds_read_b64_tr_b16 v[66:67], v16 offset:832
    s_waitcnt lgkmcnt(4)
    v_mfma_f32_16x16x32_bf16 v[248:251], v[72:75], v[180:183], v[248:251]
    ds_read_b64_tr_b16 v[56:57], v19 offset:19456
    ds_read_b64_tr_b16 v[58:59], v19 offset:19712
    s_waitcnt lgkmcnt(4)
    v_mfma_f32_32x32x16_bf16 v[232:247], v[48:51], v[104:107], v[232:247]
    ds_read_b64_tr_b16 v[68:69], v16 offset:896
    ds_read_b64_tr_b16 v[70:71], v16 offset:960
    s_waitcnt lgkmcnt(4)
    v_mfma_f32_16x16x32_bf16 v[248:251], v[64:67], v[184:187], v[248:251]
    s_waitcnt lgkmcnt(2)
    v_mfma_f32_32x32x16_bf16 v[232:247], v[56:59], v[108:111], v[232:247]
    s_waitcnt lgkmcnt(0)
    v_mfma_f32_16x16x32_bf16 v[248:251], v[68:71], v[188:191], v[248:251]
LW_15:
    ds_read_b32 v1, v2 offset:2120
    s_waitcnt lgkmcnt(0)
    v_readfirstlane_b32 s73, v1
    s_cmp_ge_u32 s73, 2
    s_cbranch_scc1 LWD_16
    s_sub_u32 s72, s72, 1
    s_cbranch_scc0 LW_15
    s_branch L_bail
LWD_16:
    ds_read_b64_tr_b16 v[32:33], v19 offset:20480
    ds_read_b64_tr_b16 v[34:35], v19 offset:20736
    ds_read_b64_tr_b16 v[72:73], v16 offset:4352
    ds_read_b64_tr_b16 v[74:75], v16 offset:4416
    ds_read_b64_tr_b16 v[40:41], v19 offset:21504
    ds_read_b64_tr_b16 v[42:43], v19 offset:21760
    s_waitcnt lgkmcnt(4)
    v_mfma_f32_32x32x16_bf16 v[232:247], v[32:35], v[112:115], v[232:247]
    ds_read_b64_tr_b16 v[64:65], v16 offset:4480
    ds_read_b64_tr_b16 v[66:67], v16 offset:4544
    buffer_load_dword v84, v28, s[44:47], s93 offen sc1
    s_waitcnt lgkmcnt(4)
    v_mfma_f32_16x16x32_bf16 v[248:251], v[72:75], v[192:195], v[248:251]
    ds_read_b64_tr_b16 v[48:49], v19 offset:22528
    ds_read_b64_tr_b16 v[50:51], v19 offset:22784
    s_waitcnt lgkmcnt(4)
    v_mfma_f32_32x32x16_bf16 v[232:247], v[40:43], v[116:119], v[232:247]
    ds_read_b64_tr_b16 v[68:69], v16 offset:4608
    ds_read_b64_tr_b16 v[70:71], v16 offset:4672
    s_waitcnt lgkmcnt(4)
    v_mfma_f32_16x16x32_bf16 v[248:251], v[64:67], v[196:199], v[248:251]
    ds_read_b64_tr_b16 v[56:57], v19 offset:23552
    ds_read_b64_tr_b16 v[58:59], v19 offset:23808
    s_waitcnt lgkmcnt(4)
    v_mfma_f32_32x32x16_bf16 v[232:247], v[48:51], v[120:123], v[232:247]
    ds_read_b64_tr_b16 v[72:73], v16 offset:4736
    ds_read_b64_tr_b16 v[74:75], v16 offset:4800
    s_waitcnt lgkmcnt(4)
    v_mfma_f32_16x16x32_bf16 v[248:251], v[68:71], v[200:203], v[248:251]
    ds_read_b64_tr_b16 v[32:33], v19 offset:24576
    ds_read_b64_tr_b16 v[34:35], v19 offset:24832
    s_waitcnt lgkmcnt(4)
    v_mfma_f32_32x32x16_bf16 v[232:247], v[56:59], v[124:127], v[232:247]
    ds_read_b64_tr_b16 v[64:65], v16 offset:4864
    ds_read_b64_tr_b16 v[66:67], v16 offset:4928
    s_waitcnt lgkmcnt(4)
    v_mfma_f32_16x16x32_bf16 v[248:251], v[72:75], v[204:207], v[248:251]
    ds_read_b64_tr_b16 v[40:41], v19 offset:25600
    ds_read_b64_tr_b16 v[42:43], v19 offset:25856
    s_waitcnt lgkmcnt(4)
    v_mfma_f32_32x32x16_bf16 v[232:247], v[32:35], v[128:131], v[232:247]
    ds_read_b64_tr_b16 v[68:69], v16 offset:4992
    ds_read_b64_tr_b16 v[70:71], v16 offset:5056
    s_waitcnt lgkmcnt(4)
    v_mfma_f32_16x16x32_bf16 v[248:251], v[64:67], v[208:211], v[248:251]
    ds_read_b64_tr_b16 v[48:49], v19 offset:26624
    ds_read_b64_tr_b16 v[50:51], v19 offset:26880
    s_waitcnt lgkmcnt(4)
    v_mfma_f32_32x32x16_bf16 v[232:247], v[40:43], v[132:135], v[232:247]
    ds_read_b64_tr_b16 v[72:73], v16 offset:5120
    ds_read_b64_tr_b16 v[74:75], v16 offset:5184
    s_waitcnt lgkmcnt(4)
    v_mfma_f32_16x16x32_bf16 v[248:251], v[68:71], v[212:215], v[248:251]
    ds_read_b64_tr_b16 v[56:57], v19 offset:27648
    ds_read_b64_tr_b16 v[58:59], v19 offset:27904
    s_waitcnt lgkmcnt(4)
    v_mfma_f32_32x32x16_bf16 v[232:247], v[48:51], v[136:139], v[232:247]
    ds_read_b64_tr_b16 v[64:65], v16 offset:5248
    ds_read_b64_tr_b16 v[66:67], v16 offset:5312
    s_waitcnt lgkmcnt(4)
    v_mfma_f32_16x16x32_bf16 v[248:251], v[72:75], v[216:219], v[248:251]
    ds_read_b64_tr_b16 v[32:33], v19 offset:28672
    ds_read_b64_tr_b16 v[34:35], v19 offset:28928
    s_waitcnt lgkmcnt(4)
    v_mfma_f32_32x32x16_bf16 v[232:247], v[56:59], v[140:143], v[232:247]
    ds_read_b64_tr_b16 v[40:41], v19 offset:29696
    ds_read_b64_tr_b16 v[42:43], v19 offset:29952
    s_waitcnt lgkmcnt(4)
    v_mfma_f32_16x16x32_bf16 v[248:251], v[64:67], v[220:223], v[248:251]
    ds_read_b64_tr_b16 v[48:49], v19 offset:30720
    ds_read_b64_tr_b16 v[50:51], v19 offset:30976
    s_waitcnt lgkmcnt(4)
    v_mfma_f32_32x32x16_bf16 v[232:247], v[32:35], v[144:147], v[232:247]
    ds_read_b64_tr_b16 v[56:57], v19 offset:31744
    ds_read_b64_tr_b16 v[58:59], v19 offset:32000
    s_waitcnt lgkmcnt(4)
    v_mfma_f32_32x32x16_bf16 v[232:247], v[40:43], v[148:151], v[232:247]
    s_waitcnt lgkmcnt(2)
    v_mfma_f32_32x32x16_bf16 v[232:247], v[48:51], v[152:155], v[232:247]
    s_waitcnt lgkmcnt(0)
    v_mfma_f32_32x32x16_bf16 v[232:247], v[56:59], v[156:159], v[232:247]
    ds_read_b32 v31, v2 offset:2072
LW_17:
    ds_read_b32 v1, v2 offset:2056
    s_waitcnt lgkmcnt(0)
    v_readfirstlane_b32 s73, v1
    s_cmp_ge_u32 s73, 2
    s_cbranch_scc1 LWD_18
    s_sub_u32 s72, s72, 1
    s_cbranch_scc0 LW_17
    s_branch L_bail
LWD_18:
    ds_read_b64_tr_b16 v[32:33], v19 offset:32768
    ds_read_b64_tr_b16 v[34:35], v19 offset:33024
    ds_read_b128 v[36:39], v6
    ds_read_b64_tr_b16 v[68:69], v12 offset:0
    ds_read_b64_tr_b16 v[70:71], v12 offset:64
    ds_read_b64_tr_b16 v[40:41], v19 offset:33792
    ds_read_b64_tr_b16 v[42:43], v19 offset:34048
    ds_read_b128 v[44:47], v7
    s_waitcnt lgkmcnt(5)
    v_mfma_f32_32x32x16_bf16 v[232:247], v[32:35], v[36:39], v[232:247]
    ds_read_b64_tr_b16 v[72:73], v12 offset:512
    ds_read_b64_tr_b16 v[74:75], v12 offset:576
    s_waitcnt lgkmcnt(5)
    v_mfma_f32_16x16x32_bf16 v[248:251], v[68:71], v[224:227], v[248:251]
    ds_read_b64_tr_b16 v[48:49], v19 offset:34816
    ds_read_b64_tr_b16 v[50:51], v19 offset:35072
    ds_read_b128 v[52:55], v8
    s_waitcnt lgkmcnt(5)
    v_mfma_f32_32x32x16_bf16 v[232:247], v[40:43], v[44:47], v[232:247]
    ds_read_b64_tr_b16 v[56:57], v19 offset:35840
    ds_read_b64_tr_b16 v[58:59], v19 offset:36096
    ds_read_b128 v[60:63], v9
    s_waitcnt lgkmcnt(6)
    v_mfma_f32_16x16x32_bf16 v[248:251], v[72:75], v[228:231], v[248:251]
    s_waitcnt lgkmcnt(3)
    v_mfma_f32_32x32x16_bf16 v[232:247], v[48:51], v[52:55], v[232:247]
    s_waitcnt lgkmcnt(0)
    v_mfma_f32_32x32x16_bf16 v[232:247], v[56:59], v[60:63], v[232:247]
    s_waitcnt vmcnt(0)
    v_cmp_ne_u32 vcc, s71, v84
    s_cmp_eq_u64 vcc, 0
    s_cselect_b32 s89, 1, 0
    s_cbranch_scc0 KM_19
    buffer_load_dword v120, v83, s[44:47], s97 offen offset:0 sc1
    buffer_load_dword v121, v83, s[44:47], s97 offen offset:256 sc1
    buffer_load_dword v122, v83, s[44:47], s97 offen offset:512 sc1
    buffer_load_dword v123, v83, s[44:47], s97 offen offset:768 sc1
    buffer_load_dwordx4 v[88:91], v82, s[44:47], s96 offen offset:0 sc1
    buffer_load_dwordx4 v[128:131], v4, s[44:47], s98 offen offset:0 sc1
    buffer_load_dwordx4 v[132:135], v4, s[44:47], s98 offen offset:640 sc1
    buffer_load_dwordx4 v[92:95], v82, s[44:47], s96 offen offset:1024 sc1
    buffer_load_dwordx4 v[136:139], v4, s[44:47], s98 offen offset:1280 sc1
    buffer_load_dwordx4 v[140:143], v4, s[44:47], s98 offen offset:1920 sc1
    s_add_u32 s98, s98, 2560
KM_19:
    v_readfirstlane_b32 s73, v31
    s_cmp_ge_u32 s73, 4
    s_cbranch_scc1 CEOK_20
LW_21:
    ds_read_b32 v1, v2 offset:2072
    s_waitcnt lgkmcnt(0)
    v_readfirstlane_b32 s73, v1
    s_cmp_ge_u32 s73, 4
    s_cbranch_scc1 LWD_22
    s_sub_u32 s72, s72, 1
    s_cbranch_scc0 LW_21
    s_branch L_bail
LWD_22:
CEOK_20:
    ds_write_b32 v26, v27
    v_cvt_pk_bf16_f32 v248, v248, v249
    v_cvt_pk_bf16_f32 v249, v250, v251
    s_mov_b32 exec_hi, 0
    ds_write2_b32 v25, v248, v249 offset0:0 offset1:1
    s_mov_b64 exec, -1
    s_bitcmp1_b32 s68, 0
    s_cbranch_scc1 QM1_23
    v_cvt_pk_bf16_f32 v232, v232, v233
    ds_write_b32 v23, v232 offset:0
    v_cvt_pk_bf16_f32 v233, v234, v235
    ds_write_b32 v23, v233 offset:4
    v_cvt_pk_bf16_f32 v234, v236, v237
    ds_write_b32 v23, v234 offset:16
    v_cvt_pk_bf16_f32 v235, v238, v239
    ds_write_b32 v23, v235 offset:20
    v_cvt_pk_bf16_f32 v236, v240, v241
    ds_write_b32 v24, v236 offset:32
    v_cvt_pk_bf16_f32 v237, v242, v243
    ds_write_b32 v23, v237 offset:3072
    v_cvt_pk_bf16_f32 v238, v244, v245
    ds_write_b32 v23, v238 offset:3084
    v_cvt_pk_bf16_f32 v239, v246, v247
    ds_write_b32 v23, v239 offset:3088
    s_branch QMD_24
QM1_23:
    v_cvt_pk_bf16_f32 v232, v232, v233
    ds_write_b32 v24, v232 offset:3100
    v_cvt_pk_bf16_f32 v233, v234, v235
    ds_write_b32 v24, v233 offset:3104
    v_cvt_pk_bf16_f32 v234, v236, v237
    ds_write_b32 v23, v234 offset:6152
    v_cvt_pk_bf16_f32 v235, v238, v239
    ds_write_b32 v23, v235 offset:6156
    v_cvt_pk_bf16_f32 v236, v240, v241
    ds_write_b32 v23, v236 offset:6168
    v_cvt_pk_bf16_f32 v237, v242, v243
    ds_write_b32 v24, v237 offset:6172
    v_cvt_pk_bf16_f32 v238, v244, v245
    ds_write_b32 v23, v238 offset:9220
    v_cvt_pk_bf16_f32 v239, v246, v247
    ds_write_b32 v23, v239 offset:9224
QMD_24:
    s_mov_b64 exec, 1
    ds_add_u32 v2, v3 offset:2060
    s_mov_b64 exec, -1
    s_cmp_eq_u32 s89, 1
    s_cbranch_scc1 KH_25
PL_26:
    buffer_load_dword v84, v28, s[44:47], s93 offen sc1
    s_waitcnt vmcnt(0)
    v_cmp_ne_u32 vcc, s71, v84
    s_cmp_eq_u64 vcc, 0
    s_cbranch_scc1 PD_27
    s_sleep 12
    s_sub_u32 s72, s72, 1
    s_cbranch_scc0 PL_26
    s_branch L_bail
PD_27:
    buffer_load_dword v120, v83, s[44:47], s97 offen offset:0 sc1
    buffer_load_dword v121, v83, s[44:47], s97 offen offset:256 sc1
    buffer_load_dword v122, v83, s[44:47], s97 offen offset:512 sc1
    buffer_load_dword v123, v83, s[44:47], s97 offen offset:768 sc1
    buffer_load_dwordx4 v[88:91], v82, s[44:47], s96 offen offset:0 sc1
    buffer_load_dwordx4 v[128:131], v4, s[44:47], s98 offen offset:0 sc1
    buffer_load_dwordx4 v[132:135], v4, s[44:47], s98 offen offset:640 sc1
    buffer_load_dwordx4 v[92:95], v82, s[44:47], s96 offen offset:1024 sc1
    buffer_load_dwordx4 v[136:139], v4, s[44:47], s98 offen offset:1280 sc1
    buffer_load_dwordx4 v[140:143], v4, s[44:47], s98 offen offset:1920 sc1
    s_add_u32 s98, s98, 2560
KH_25:
    buffer_load_dwordx4 v[96:99], v82, s[44:47], s96 offen offset:2048 sc1
    buffer_load_dwordx4 v[144:147], v4, s[44:47], s98 offen offset:0 sc1
    buffer_load_dwordx4 v[148:151], v4, s[44:47], s98 offen offset:640 sc1
    buffer_load_dwordx4 v[100:103], v82, s[44:47], s96 offen offset:3072 sc1
    s_add_u32 s96, s96, 4096
    buffer_load_dwordx4 v[152:155], v4, s[44:47], s98 offen offset:1280 sc1
    buffer_load_dwordx4 v[156:159], v4, s[44:47], s98 offen offset:1920 sc1
    s_add_u32 s98, s98, 2560
    s_setprio 2
    s_mov_b32 s99, 1073741824
    v_mov_b32 v7, v2
L_attn:
    v_and_b32 v84, 31, v0
    v_lshrrev_b32 v85, 5, v0
    s_lshr_b32 s88, s68, 2
    s_mul_i32 s73, s88, 6144
    s_add_u32 s73, s73, 74752
    v_mul_u32_u24 v78, 48, v84
    v_add_u32 v78, s73, v78
    v_add_u32 v79, 32, v78
    v_lshl_add_u32 v78, v85, 4, v78
    s_and_b32 s73, s68, 3
    s_mul_i32 s73, s73, 2560
    s_add_u32 s73, s73, 87040
    v_lshl_add_u32 v80, v0, 4, s73
    s_add_u32 s73, s73, 2048
    v_lshl_add_u32 v81, v0, 3, s73
    s_lshl_b32 s73, s88, 10
    s_add_u32 s73, s73, 160768
    v_lshl_add_u32 v84, v0, 2, s73
    s_mul_i32 s73, s88, 36
    v_add_u32 v86, s73, v2
    v_mov_b32 v29, 0
    v_mov_b32 v30, 0
LW_28:
    ds_read_b32 v1, v2 offset:2060
    s_waitcnt lgkmcnt(0)
    v_readfirstlane_b32 s73, v1
    s_cmp_ge_u32 s73, 4
    s_cbranch_scc1 LWD_29
    s_sub_u32 s72, s72, 1
    s_cbranch_scc0 LW_28
    s_branch L_bail
LWD_29:
    ds_read_b128 v[24:27], v78 offset:0
    ds_read_b32 v28, v79 offset:0
    ds_read_b32 v31, v79 offset:0
    s_lshr_b32 s88, s68, 1
    s_and_b32 s89, s68, 1
    v_lshrrev_b32 v32, 5, v0
    v_and_b32 v33, 15, v0
    v_lshrrev_b32 v34, 4, v0
    v_bfe_u32 v35, v0, 2, 2
    v_and_b32 v36, 3, v0
    v_and_b32 v37, 1, v34
    v_and_b32 v38, 1, v0
    v_lshlrev_b32 v39, 2, v38
    v_lshl_add_u32 v39, v37, 1, v39
    v_lshrrev_b32 v40, 1, v36
    v_add_u32 v39, v39, v40
    s_mul_i32 s73, s88, 36864
    v_lshl_add_u32 v39, v39, 3, s73
    v_lshl_add_u32 v6, v32, 2, v35
    v_lshl_add_u32 v6, v6, 6, v39
    v_lshrrev_b32 v40, 1, v35
    v_mul_u32_u24 v40, 72, v40
    v_and_b32 v41, 1, v35
    v_add3_u32 v40, v40, v41, 16
    v_lshl_add_u32 v9, v40, 6, v39
    v_mul_u32_u24 v41, 18432, v32
    v_add_u32 v9, v9, v41
    s_waitcnt vmcnt(12)
    s_waitcnt lgkmcnt(0)
    v_mfma_f32_32x32x4_2b_bf16 v[192:223], v[120:121], v[28:29], 0
    s_mov_b32 s73, 128000
    v_lshl_add_u32 v38, v38, 3, s73
    v_mul_u32_u24 v11, 288, v37
    v_add_u32 v11, v11, v40
    v_lshl_add_u32 v11, v11, 4, v38
    v_mul_u32_u24 v10, 72, v32
    v_lshl_add_u32 v10, v37, 2, v10
    v_add_u32 v10, v10, v35
    v_lshl_add_u32 v10, v10, 4, v38
    v_lshlrev_b32 v12, 4, v33
    v_lshl_add_u32 v12, v37, 9, v12
    v_lshl_add_u32 v14, v32, 10, v12
    v_cmp_gt_u32 vcc, 32, v0
    v_mov_b32 v40, 1073741824
    s_lshl_b32 s73, s88, 8
    v_add_u32 v12, s73, v14
    v_cndmask_b32 v13, v40, v12, vcc
    v_cmp_gt_u32 vcc, 8, v33
    v_lshrrev_b32 v15, 3, v0
    v_mul_u32_u24 v15, 4224, v15
    v_cndmask_b32 v14, v40, v14, vcc
    s_waitcnt vmcnt(8)
    v_mfma_f32_32x32x16_bf16 v[192:207], v[88:91], v[24:27], v[192:207]
    v_mfma_f32_32x32x16_bf16 v[208:223], v[92:95], v[24:27], v[208:223]
    v_lshlrev_b32 v40, 2, v37
    v_xor_b32 v40, v40, v0
    v_and_b32 v40, 7, v40
    v_lshl_add_u32 v15, v40, 4, v15
    v_bfe_u32 v40, v0, 3, 1
    v_xor_b32 v40, s89, v40
    v_lshlrev_b32 v40, 6, v40
    v_lshl_add_u32 v40, v36, 3, v40
    v_lshl_add_u32 v40, v35, 7, v40
    v_lshl_add_u32 v16, v32, 10, v40
    v_lshl_add_u32 v16, v37, 5, v16
    v_lshl_add_u32 v17, v34, 10, v40
    s_lshl_b32 s73, s88, 5
    v_add_u32 v17, s73, v17
    s_mov_b32 s73, 73728
    v_and_b32 v40, 31, v0
    v_mul_lo_u32 v18, v40, s73
    v_lshl_add_u32 v18, v32, 5, v18
    v_mul_lo_u32 v19, v33, s73
    v_lshl_add_u32 v19, v34, 3, v19
    v_exp_f32 v192, v192
    v_exp_f32 v193, v193
    buffer_load_dwordx4 v[104:107], v82, s[44:47], s96 offen offset:0 sc1
    v_exp_f32 v194, v194
    v_exp_f32 v195, v195
    v_cvt_pk_bf16_f32 v192, v192, v193
    v_exp_f32 v196, v196
    v_cvt_pk_bf16_f32 v193, v194, v195
    v_exp_f32 v197, v197
    v_mfma_f32_32x32x4_2b_bf16 v[224:255], v[120:121], v[30:31], 0
    buffer_load_dwordx4 v[160:163], v4, s[44:47], s98 offen offset:0 sc1
    v_exp_f32 v198, v198
    v_exp_f32 v199, v199
    v_cvt_pk_bf16_f32 v194, v196, v197
    v_exp_f32 v200, v200
    v_cvt_pk_bf16_f32 v195, v198, v199
    v_exp_f32 v201, v201
    v_exp_f32 v202, v202
    v_exp_f32 v203, v203
    v_cvt_pk_bf16_f32 v196, v200, v201
    v_exp_f32 v204, v204
    v_cvt_pk_bf16_f32 v197, v202, v203
    v_exp_f32 v205, v205
    v_mfma_f32_32x32x16_bf16 v[32:47], v[128:131], v[192:195], 0
    buffer_load_dwordx4 v[164:167], v4, s[44:47], s98 offen offset:640 sc1
    v_exp_f32 v206, v206
    v_exp_f32 v207, v207
    v_cvt_pk_bf16_f32 v198, v204, v205
    v_cvt_pk_bf16_f32 v199, v206, v207
    v_exp_f32 v208, v208
    v_exp_f32 v209, v209
    v_mfma_f32_32x32x16_bf16 v[32:47], v[132:135], v[196:199], v[32:47]
    buffer_load_dwordx4 v[108:111], v82, s[44:47], s96 offen offset:1024 sc1
    s_waitcnt vmcnt(6)
    v_exp_f32 v210, v210
    v_exp_f32 v211, v211
    v_cvt_pk_bf16_f32 v208, v208, v209
    v_exp_f32 v212, v212
    v_cvt_pk_bf16_f32 v209, v210, v211
    v_mfma_f32_32x32x16_bf16 v[224:239], v[96:99], v[24:27], v[224:239]
    buffer_load_dwordx4 v[168:171], v4, s[44:47], s98 offen offset:1280 sc1
    v_exp_f32 v213, v213
    v_exp_f32 v214, v214
    v_exp_f32 v215, v215
    v_cvt_pk_bf16_f32 v210, v212, v213
    v_exp_f32 v216, v216
    v_cvt_pk_bf16_f32 v211, v214, v215
    v_mfma_f32_32x32x16_bf16 v[240:255], v[100:103], v[24:27], v[240:255]
    s_cmp_eq_u32 s99, 1073741824
    s_cbranch_scc1 NYF_31
    s_waitcnt vmcnt(5)
    s_mov_b64 exec, 1
    ds_add_rtn_u32 v8, v7, v3 offset:2136
    v_mov_b32 v1, s71
    s_waitcnt lgkmcnt(0)
    v_readfirstlane_b32 s73, v8
    s_cmp_lg_u32 s73, 1
    s_cmov_b32 s99, 1073741824
    buffer_store_dword v1, off, s[44:47], s99 sc1
    s_mov_b64 exec, -1
NYF_31:
    v_exp_f32 v217, v217
    v_exp_f32 v218, v218
    v_exp_f32 v219, v219
    v_cvt_pk_bf16_f32 v212, v216, v217
    v_exp_f32 v220, v220
    v_cvt_pk_bf16_f32 v213, v218, v219
    v_mfma_f32_32x32x16_bf16 v[32:47], v[136:139], v[208:211], v[32:47]
    buffer_load_dwordx4 v[172:175], v4, s[44:47], s98 offen offset:1920 sc1
    s_add_u32 s98, s98, 2560
    v_exp_f32 v221, v221
    v_exp_f32 v222, v222
    v_exp_f32 v223, v223
    v_cvt_pk_bf16_f32 v214, v220, v221
    v_cvt_pk_bf16_f32 v215, v222, v223
    v_exp_f32 v224, v224
    v_exp_f32 v225, v225
    v_mfma_f32_32x32x16_bf16 v[32:47], v[140:143], v[212:215], v[32:47]
    buffer_load_dwordx4 v[112:115], v82, s[44:47], s96 offen offset:2048 sc1
    v_exp_f32 v226, v226
    v_exp_f32 v227, v227
    v_cvt_pk_bf16_f32 v224, v224, v225
    v_exp_f32 v228, v228
    v_cvt_pk_bf16_f32 v225, v226, v227
    v_exp_f32 v229, v229
    v_mfma_f32_32x32x4_2b_bf16 v[192:223], v[122:123], v[28:29], 0
    buffer_load_dwordx4 v[176:179], v4, s[44:47], s98 offen offset:0 sc1
    v_exp_f32 v230, v230
    v_exp_f32 v231, v231
    v_cvt_pk_bf16_f32 v226, v228, v229
    v_exp_f32 v232, v232
    v_cvt_pk_bf16_f32 v227, v230, v231
    v_exp_f32 v233, v233
    v_exp_f32 v234, v234
    v_exp_f32 v235, v235
    v_cvt_pk_bf16_f32 v228, v232, v233
    v_exp_f32 v236, v236
    v_cvt_pk_bf16_f32 v229, v234, v235
    v_exp_f32 v237, v237
    v_mfma_f32_32x32x16_bf16 v[32:47], v[144:147], v[224:227], v[32:47]
    buffer_load_dwordx4 v[180:183], v4, s[44:47], s98 offen offset:640 sc1
    v_exp_f32 v238, v238
    v_exp_f32 v239, v239
    v_cvt_pk_bf16_f32 v230, v236, v237
    v_cvt_pk_bf16_f32 v231, v238, v239
    v_exp_f32 v240, v240
    v_exp_f32 v241, v241
    v_mfma_f32_32x32x16_bf16 v[32:47], v[148:151], v[228:231], v[32:47]
    buffer_load_dwordx4 v[116:119], v82, s[44:47], s96 offen offset:3072 sc1
    s_add_u32 s96, s96, 4096
    s_waitcnt vmcnt(6)
    v_exp_f32 v242, v242
    v_exp_f32 v243, v243
    v_cvt_pk_bf16_f32 v240, v240, v241
    v_exp_f32 v244, v244
    v_cvt_pk_bf16_f32 v241, v242, v243
    v_mfma_f32_32x32x16_bf16 v[192:207], v[104:107], v[24:27], v[192:207]
    buffer_load_dwordx4 v[184:187], v4, s[44:47], s98 offen offset:1280 sc1
    v_exp_f32 v245, v245
    v_exp_f32 v246, v246
    v_exp_f32 v247, v247
    v_cvt_pk_bf16_f32 v242, v244, v245
    v_exp_f32 v248, v248
    v_cvt_pk_bf16_f32 v243, v246, v247
    v_mfma_f32_32x32x16_bf16 v[208:223], v[108:111], v[24:27], v[208:223]
    v_exp_f32 v249, v249
    v_exp_f32 v250, v250
    v_exp_f32 v251, v251
    v_cvt_pk_bf16_f32 v244, v248, v249
    v_exp_f32 v252, v252
    v_cvt_pk_bf16_f32 v245, v250, v251
    v_mfma_f32_32x32x16_bf16 v[32:47], v[152:155], v[240:243], v[32:47]
    buffer_load_dwordx4 v[188:191], v4, s[44:47], s98 offen offset:1920 sc1
    s_add_u32 s98, s98, 2560
    s_mov_b64 exec, 1
    ds_add_u32 v2, v3 offset:2076
    s_mov_b64 exec, -1
    s_cmp_lt_u32 s68, 4
    s_cbranch_scc1 PHI_30
    s_setprio 1
PHI_30:
    v_exp_f32 v253, v253
    v_exp_f32 v254, v254
    v_exp_f32 v255, v255
    v_cvt_pk_bf16_f32 v246, v252, v253
    v_cvt_pk_bf16_f32 v247, v254, v255
    v_exp_f32 v192, v192
    v_exp_f32 v193, v193
    v_mfma_f32_32x32x16_bf16 v[32:47], v[156:159], v[244:247], v[32:47]
    v_exp_f32 v194, v194
    v_exp_f32 v195, v195
    v_cvt_pk_bf16_f32 v192, v192, v193
    v_exp_f32 v196, v196
    v_cvt_pk_bf16_f32 v193, v194, v195
    v_exp_f32 v197, v197
    v_mfma_f32_32x32x4_2b_bf16 v[224:255], v[122:123], v[30:31], 0
    v_exp_f32 v198, v198
    v_exp_f32 v199, v199
    v_cvt_pk_bf16_f32 v194, v196, v197
    v_exp_f32 v200, v200
    v_cvt_pk_bf16_f32 v195, v198, v199
    v_exp_f32 v201, v201
    v_exp_f32 v202, v202
    v_exp_f32 v203, v203
    v_cvt_pk_bf16_f32 v196, v200, v201
    v_exp_f32 v204, v204
    v_cvt_pk_bf16_f32 v197, v202, v203
    v_exp_f32 v205, v205
    v_mfma_f32_32x32x16_bf16 v[32:47], v[160:163], v[192:195], v[32:47]
    ds_read_b32 v28, v79 offset:1536
    v_exp_f32 v206, v206
    v_exp_f32 v207, v207
    v_cvt_pk_bf16_f32 v198, v204, v205
    v_cvt_pk_bf16_f32 v199, v206, v207
    v_exp_f32 v208, v208
    v_exp_f32 v209, v209
    v_mfma_f32_32x32x16_bf16 v[32:47], v[164:167], v[196:199], v[32:47]
    ds_read_b32 v31, v79 offset:1536
    s_waitcnt vmcnt(2)
    v_exp_f32 v210, v210
    v_exp_f32 v211, v211
    v_cvt_pk_bf16_f32 v208, v208, v209
    v_exp_f32 v212, v212
    v_cvt_pk_bf16_f32 v209, v210, v211
    v_mfma_f32_32x32x16_bf16 v[224:239], v[112:115], v[24:27], v[224:239]
    v_exp_f32 v213, v213
    v_exp_f32 v214, v214
    v_exp_f32 v215, v215
    v_cvt_pk_bf16_f32 v210, v212, v213
    v_exp_f32 v216, v216
    v_cvt_pk_bf16_f32 v211, v214, v215
    v_mfma_f32_32x32x16_bf16 v[240:255], v[116:119], v[24:27], v[240:255]
    v_exp_f32 v217, v217
    v_exp_f32 v218, v218
    v_exp_f32 v219, v219
    v_cvt_pk_bf16_f32 v212, v216, v217
    v_exp_f32 v220, v220
    v_cvt_pk_bf16_f32 v213, v218, v219
    v_mfma_f32_32x32x16_bf16 v[32:47], v[168:171], v[208:211], v[32:47]
    ds_read_b128 v[24:27], v78 offset:1536
    v_exp_f32 v221, v221
    v_exp_f32 v222, v222
    v_exp_f32 v223, v223
    v_cvt_pk_bf16_f32 v214, v220, v221
    v_cvt_pk_bf16_f32 v215, v222, v223
    v_exp_f32 v224, v224
    v_exp_f32 v225, v225
    v_mfma_f32_32x32x16_bf16 v[32:47], v[172:175], v[212:215], v[32:47]
    s_waitcnt lgkmcnt(2)
    v_exp_f32 v226, v226
    v_exp_f32 v227, v227
    v_cvt_pk_bf16_f32 v224, v224, v225
    v_exp_f32 v228, v228
    v_cvt_pk_bf16_f32 v225, v226, v227
    v_exp_f32 v229, v229
    v_mfma_f32_32x32x4_2b_bf16 v[192:223], v[120:121], v[28:29], 0
    v_exp_f32 v230, v230
    v_exp_f32 v231, v231
    v_cvt_pk_bf16_f32 v226, v228, v229
    v_exp_f32 v232, v232
    v_cvt_pk_bf16_f32 v227, v230, v231
    v_exp_f32 v233, v233
    v_exp_f32 v234, v234
    v_exp_f32 v235, v235
    v_cvt_pk_bf16_f32 v228, v232, v233
    v_exp_f32 v236, v236
    v_cvt_pk_bf16_f32 v229, v234, v235
    v_exp_f32 v237, v237
    v_mfma_f32_32x32x16_bf16 v[32:47], v[176:179], v[224:227], v[32:47]
    v_exp_f32 v238, v238
    v_exp_f32 v239, v239
    v_cvt_pk_bf16_f32 v230, v236, v237
    v_cvt_pk_bf16_f32 v231, v238, v239
    v_exp_f32 v240, v240
    v_exp_f32 v241, v241
    v_mfma_f32_32x32x16_bf16 v[32:47], v[180:183], v[228:231], v[32:47]
    s_waitcnt lgkmcnt(0)
    v_exp_f32 v242, v242
    v_exp_f32 v243, v243
    v_cvt_pk_bf16_f32 v240, v240, v241
    v_exp_f32 v244, v244
    v_cvt_pk_bf16_f32 v241, v242, v243
    v_mfma_f32_32x32x16_bf16 v[192:207], v[88:91], v[24:27], v[192:207]
    v_exp_f32 v245, v245
    v_exp_f32 v246, v246
    v_exp_f32 v247, v247
    v_cvt_pk_bf16_f32 v242, v244, v245
    v_exp_f32 v248, v248
    v_cvt_pk_bf16_f32 v243, v246, v247
    v_mfma_f32_32x32x16_bf16 v[208:223], v[92:95], v[24:27], v[208:223]
    s_waitcnt vmcnt(0)
    v_exp_f32 v249, v249
    v_exp_f32 v250, v250
    v_exp_f32 v251, v251
    v_cvt_pk_bf16_f32 v244, v248, v249
    v_exp_f32 v252, v252
    v_cvt_pk_bf16_f32 v245, v250, v251
    v_mfma_f32_32x32x16_bf16 v[32:47], v[184:187], v[240:243], v[32:47]
    v_exp_f32 v253, v253
    v_exp_f32 v254, v254
    v_exp_f32 v255, v255
    v_cvt_pk_bf16_f32 v246, v252, v253
    v_cvt_pk_bf16_f32 v247, v254, v255
    v_exp_f32 v192, v192
    v_exp_f32 v193, v193
    v_mfma_f32_32x32x16_bf16 v[32:47], v[188:191], v[244:247], v[32:47]
    v_exp_f32 v194, v194
    v_exp_f32 v195, v195
    v_cvt_pk_bf16_f32 v192, v192, v193
    v_exp_f32 v196, v196
    v_cvt_pk_bf16_f32 v193, v194, v195
    v_exp_f32 v197, v197
    v_mfma_f32_32x32x4_2b_bf16 v[224:255], v[120:121], v[30:31], 0
    v_exp_f32 v198, v198
    v_exp_f32 v199, v199
    v_cvt_pk_bf16_f32 v194, v196, v197
    v_exp_f32 v200, v200
    v_cvt_pk_bf16_f32 v195, v198, v199
    v_exp_f32 v201, v201
    v_exp_f32 v202, v202
    v_exp_f32 v203, v203
    v_cvt_pk_bf16_f32 v196, v200, v201
    v_exp_f32 v204, v204
    v_cvt_pk_bf16_f32 v197, v202, v203
    v_exp_f32 v205, v205
    v_mfma_f32_32x32x16_bf16 v[42:57], v[128:131], v[192:195], 0
    v_exp_f32 v206, v206
    v_exp_f32 v207, v207
    v_cvt_pk_bf16_f32 v198, v204, v205
    v_cvt_pk_bf16_f32 v199, v206, v207
    v_exp_f32 v208, v208
    v_exp_f32 v209, v209
    v_mfma_f32_32x32x16_bf16 v[42:57], v[132:135], v[196:199], v[42:57]
    v_exp_f32 v210, v210
    v_exp_f32 v211, v211
    v_cvt_pk_bf16_f32 v208, v208, v209
    v_exp_f32 v212, v212
    v_cvt_pk_bf16_f32 v209, v210, v211
    v_mfma_f32_32x32x16_bf16 v[224:239], v[96:99], v[24:27], v[224:239]
    v_exp_f32 v213, v213
    v_exp_f32 v214, v214
    v_exp_f32 v215, v215
    v_cvt_pk_bf16_f32 v210, v212, v213
    v_exp_f32 v216, v216
    v_cvt_pk_bf16_f32 v211, v214, v215
    v_mfma_f32_32x32x16_bf16 v[240:255], v[100:103], v[24:27], v[240:255]
    v_exp_f32 v217, v217
    v_exp_f32 v218, v218
    v_exp_f32 v219, v219
    v_cvt_pk_bf16_f32 v212, v216, v217
    v_exp_f32 v220, v220
    v_cvt_pk_bf16_f32 v213, v218, v219
    v_mfma_f32_32x32x16_bf16 v[42:57], v[136:139], v[208:211], v[42:57]
    v_exp_f32 v221, v221
    v_exp_f32 v222, v222
    v_exp_f32 v223, v223
    v_cvt_pk_bf16_f32 v214, v220, v221
    v_cvt_pk_bf16_f32 v215, v222, v223
    v_exp_f32 v224, v224
    v_exp_f32 v225, v225
    v_mfma_f32_32x32x16_bf16 v[42:57], v[140:143], v[212:215], v[42:57]
    v_exp_f32 v226, v226
    v_exp_f32 v227, v227
    v_cvt_pk_bf16_f32 v224, v224, v225
    v_exp_f32 v228, v228
    v_cvt_pk_bf16_f32 v225, v226, v227
    v_exp_f32 v229, v229
    v_mfma_f32_32x32x4_2b_bf16 v[192:223], v[122:123], v[28:29], 0
    v_exp_f32 v230, v230
    v_exp_f32 v231, v231
    v_cvt_pk_bf16_f32 v226, v228, v229
    v_exp_f32 v232, v232
    v_cvt_pk_bf16_f32 v227, v230, v231
    v_exp_f32 v233, v233
    v_exp_f32 v234, v234
    v_exp_f32 v235, v235
    v_cvt_pk_bf16_f32 v228, v232, v233
    v_exp_f32 v236, v236
    v_cvt_pk_bf16_f32 v229, v234, v235
    v_exp_f32 v237, v237
    v_mfma_f32_32x32x16_bf16 v[42:57], v[144:147], v[224:227], v[42:57]
    v_exp_f32 v238, v238
    v_exp_f32 v239, v239
    v_cvt_pk_bf16_f32 v230, v236, v237
    v_cvt_pk_bf16_f32 v231, v238, v239
    v_exp_f32 v240, v240
    v_exp_f32 v241, v241
    v_mfma_f32_32x32x16_bf16 v[42:57], v[148:151], v[228:231], v[42:57]
    v_exp_f32 v242, v242
    v_exp_f32 v243, v243
    v_cvt_pk_bf16_f32 v240, v240, v241
    v_exp_f32 v244, v244
    v_cvt_pk_bf16_f32 v241, v242, v243
    v_mfma_f32_32x32x16_bf16 v[192:207], v[104:107], v[24:27], v[192:207]
    v_exp_f32 v245, v245
    v_exp_f32 v246, v246
    v_exp_f32 v247, v247
    v_cvt_pk_bf16_f32 v242, v244, v245
    v_exp_f32 v248, v248
    v_cvt_pk_bf16_f32 v243, v246, v247
    v_mfma_f32_32x32x16_bf16 v[208:223], v[108:111], v[24:27], v[208:223]
    v_exp_f32 v249, v249
    v_exp_f32 v250, v250
    v_exp_f32 v251, v251
    v_cvt_pk_bf16_f32 v244, v248, v249
    v_exp_f32 v252, v252
    v_cvt_pk_bf16_f32 v245, v250, v251
    v_mfma_f32_32x32x16_bf16 v[42:57], v[152:155], v[240:243], v[42:57]
    v_exp_f32 v253, v253
    v_exp_f32 v254, v254
    v_exp_f32 v255, v255
    v_cvt_pk_bf16_f32 v246, v252, v253
    v_cvt_pk_bf16_f32 v247, v254, v255
    v_exp_f32 v192, v192
    v_exp_f32 v193, v193
    v_mfma_f32_32x32x16_bf16 v[42:57], v[156:159], v[244:247], v[42:57]
    v_exp_f32 v194, v194
    v_exp_f32 v195, v195
    v_cvt_pk_bf16_f32 v192, v192, v193
    v_exp_f32 v196, v196
    v_cvt_pk_bf16_f32 v193, v194, v195
    v_exp_f32 v197, v197
    v_mfma_f32_32x32x4_2b_bf16 v[224:255], v[122:123], v[30:31], 0
    v_exp_f32 v198, v198
    v_exp_f32 v199, v199
    v_cvt_pk_bf16_f32 v194, v196, v197
    v_exp_f32 v200, v200
    v_cvt_pk_bf16_f32 v195, v198, v199
    v_exp_f32 v201, v201
    v_exp_f32 v202, v202
    v_exp_f32 v203, v203
    v_cvt_pk_bf16_f32 v196, v200, v201
    v_exp_f32 v204, v204
    v_cvt_pk_bf16_f32 v197, v202, v203
    v_exp_f32 v205, v205
    v_mfma_f32_32x32x16_bf16 v[42:57], v[160:163], v[192:195], v[42:57]
    ds_read_b32 v28, v79 offset:3072
    v_exp_f32 v206, v206
    v_exp_f32 v207, v207
    v_cvt_pk_bf16_f32 v198, v204, v205
    v_cvt_pk_bf16_f32 v199, v206, v207
    v_exp_f32 v208, v208
    v_exp_f32 v209, v209
    v_mfma_f32_32x32x16_bf16 v[42:57], v[164:167], v[196:199], v[42:57]
    ds_read_b32 v31, v79 offset:3072
    v_exp_f32 v210, v210
    v_exp_f32 v211, v211
    v_cvt_pk_bf16_f32 v208, v208, v209
    v_exp_f32 v212, v212
    v_cvt_pk_bf16_f32 v209, v210, v211
    v_mfma_f32_32x32x16_bf16 v[224:239], v[112:115], v[24:27], v[224:239]
    v_exp_f32 v213, v213
    v_exp_f32 v214, v214
    v_exp_f32 v215, v215
    v_cvt_pk_bf16_f32 v210, v212, v213
    v_exp_f32 v216, v216
    v_cvt_pk_bf16_f32 v211, v214, v215
    v_mfma_f32_32x32x16_bf16 v[240:255], v[116:119], v[24:27], v[240:255]
    v_exp_f32 v217, v217
    v_exp_f32 v218, v218
    v_exp_f32 v219, v219
    v_cvt_pk_bf16_f32 v212, v216, v217
    v_exp_f32 v220, v220
    v_cvt_pk_bf16_f32 v213, v218, v219
    v_mfma_f32_32x32x16_bf16 v[42:57], v[168:171], v[208:211], v[42:57]
    ds_read_b128 v[24:27], v78 offset:3072
    v_exp_f32 v221, v221
    v_exp_f32 v222, v222
    v_exp_f32 v223, v223
    v_cvt_pk_bf16_f32 v214, v220, v221
    v_cvt_pk_bf16_f32 v215, v222, v223
    v_exp_f32 v224, v224
    v_exp_f32 v225, v225
    v_mfma_f32_32x32x16_bf16 v[42:57], v[172:175], v[212:215], v[42:57]
    s_waitcnt lgkmcnt(2)
    v_exp_f32 v226, v226
    v_exp_f32 v227, v227
    v_cvt_pk_bf16_f32 v224, v224, v225
    v_exp_f32 v228, v228
    v_cvt_pk_bf16_f32 v225, v226, v227
    v_exp_f32 v229, v229
    v_mfma_f32_32x32x4_2b_bf16 v[192:223], v[120:121], v[28:29], 0
    v_exp_f32 v230, v230
    v_exp_f32 v231, v231
    v_cvt_pk_bf16_f32 v226, v228, v229
    v_exp_f32 v232, v232
    v_cvt_pk_bf16_f32 v227, v230, v231
    v_exp_f32 v233, v233
    v_exp_f32 v234, v234
    v_exp_f32 v235, v235
    v_cvt_pk_bf16_f32 v228, v232, v233
    v_exp_f32 v236, v236
    v_cvt_pk_bf16_f32 v229, v234, v235
    v_exp_f32 v237, v237
    v_mfma_f32_32x32x16_bf16 v[42:57], v[176:179], v[224:227], v[42:57]
    v_exp_f32 v238, v238
    v_exp_f32 v239, v239
    v_cvt_pk_bf16_f32 v230, v236, v237
    v_cvt_pk_bf16_f32 v231, v238, v239
    v_exp_f32 v240, v240
    v_exp_f32 v241, v241
    v_mfma_f32_32x32x16_bf16 v[42:57], v[180:183], v[228:231], v[42:57]
    s_waitcnt lgkmcnt(0)
    v_exp_f32 v242, v242
    v_exp_f32 v243, v243
    v_cvt_pk_bf16_f32 v240, v240, v241
    v_exp_f32 v244, v244
    v_cvt_pk_bf16_f32 v241, v242, v243
    v_mfma_f32_32x32x16_bf16 v[192:207], v[88:91], v[24:27], v[192:207]
    v_exp_f32 v245, v245
    v_exp_f32 v246, v246
    v_exp_f32 v247, v247
    v_cvt_pk_bf16_f32 v242, v244, v245
    v_exp_f32 v248, v248
    v_cvt_pk_bf16_f32 v243, v246, v247
    v_mfma_f32_32x32x16_bf16 v[208:223], v[92:95], v[24:27], v[208:223]
    v_exp_f32 v249, v249
    v_exp_f32 v250, v250
    v_exp_f32 v251, v251
    v_cvt_pk_bf16_f32 v244, v248, v249
    v_exp_f32 v252, v252
    v_cvt_pk_bf16_f32 v245, v250, v251
    v_mfma_f32_32x32x16_bf16 v[42:57], v[184:187], v[240:243], v[42:57]
    v_exp_f32 v253, v253
    v_exp_f32 v254, v254
    v_exp_f32 v255, v255
    v_cvt_pk_bf16_f32 v246, v252, v253
    v_cvt_pk_bf16_f32 v247, v254, v255
    v_exp_f32 v192, v192
    v_exp_f32 v193, v193
    v_mfma_f32_32x32x16_bf16 v[42:57], v[188:191], v[244:247], v[42:57]
    v_exp_f32 v194, v194
    v_exp_f32 v195, v195
    v_cvt_pk_bf16_f32 v192, v192, v193
    v_exp_f32 v196, v196
    v_cvt_pk_bf16_f32 v193, v194, v195
    v_exp_f32 v197, v197
    v_mfma_f32_32x32x4_2b_bf16 v[224:255], v[120:121], v[30:31], 0
    v_exp_f32 v198, v198
    v_exp_f32 v199, v199
    v_cvt_pk_bf16_f32 v194, v196, v197
    v_exp_f32 v200, v200
    v_cvt_pk_bf16_f32 v195, v198, v199
    v_exp_f32 v201, v201
    v_exp_f32 v202, v202
    v_exp_f32 v203, v203
    v_cvt_pk_bf16_f32 v196, v200, v201
    v_exp_f32 v204, v204
    v_cvt_pk_bf16_f32 v197, v202, v203
    v_exp_f32 v205, v205
    v_mfma_f32_32x32x16_bf16 v[52:67], v[128:131], v[192:195], 0
    v_exp_f32 v206, v206
    v_exp_f32 v207, v207
    v_cvt_pk_bf16_f32 v198, v204, v205
    v_cvt_pk_bf16_f32 v199, v206, v207
    v_exp_f32 v208, v208
    v_exp_f32 v209, v209
    v_mfma_f32_32x32x16_bf16 v[52:67], v[132:135], v[196:199], v[52:67]
    v_exp_f32 v210, v210
    v_exp_f32 v211, v211
    v_cvt_pk_bf16_f32 v208, v208, v209
    v_exp_f32 v212, v212
    v_cvt_pk_bf16_f32 v209, v210, v211
    v_mfma_f32_32x32x16_bf16 v[224:239], v[96:99], v[24:27], v[224:239]
    v_exp_f32 v213, v213
    v_exp_f32 v214, v214
    v_exp_f32 v215, v215
    v_cvt_pk_bf16_f32 v210, v212, v213
    v_exp_f32 v216, v216
    v_cvt_pk_bf16_f32 v211, v214, v215
    v_mfma_f32_32x32x16_bf16 v[240:255], v[100:103], v[24:27], v[240:255]
    v_exp_f32 v217, v217
    v_exp_f32 v218, v218
    v_exp_f32 v219, v219
    v_cvt_pk_bf16_f32 v212, v216, v217
    v_exp_f32 v220, v220
    v_cvt_pk_bf16_f32 v213, v218, v219
    v_mfma_f32_32x32x16_bf16 v[52:67], v[136:139], v[208:211], v[52:67]
    v_exp_f32 v221, v221
    v_exp_f32 v222, v222
    v_exp_f32 v223, v223
    v_cvt_pk_bf16_f32 v214, v220, v221
    v_cvt_pk_bf16_f32 v215, v222, v223
    v_exp_f32 v224, v224
    v_exp_f32 v225, v225
    v_mfma_f32_32x32x16_bf16 v[52:67], v[140:143], v[212:215], v[52:67]
    v_exp_f32 v226, v226
    v_exp_f32 v227, v227
    v_cvt_pk_bf16_f32 v224, v224, v225
    v_exp_f32 v228, v228
    v_cvt_pk_bf16_f32 v225, v226, v227
    v_exp_f32 v229, v229
    v_mfma_f32_32x32x4_2b_bf16 v[192:223], v[122:123], v[28:29], 0
    v_exp_f32 v230, v230
    v_exp_f32 v231, v231
    v_cvt_pk_bf16_f32 v226, v228, v229
    v_exp_f32 v232, v232
    v_cvt_pk_bf16_f32 v227, v230, v231
    v_exp_f32 v233, v233
    v_exp_f32 v234, v234
    v_exp_f32 v235, v235
    v_cvt_pk_bf16_f32 v228, v232, v233
    v_exp_f32 v236, v236
    v_cvt_pk_bf16_f32 v229, v234, v235
    v_exp_f32 v237, v237
    v_mfma_f32_32x32x16_bf16 v[52:67], v[144:147], v[224:227], v[52:67]
    v_exp_f32 v238, v238
    v_exp_f32 v239, v239
    v_cvt_pk_bf16_f32 v230, v236, v237
    v_cvt_pk_bf16_f32 v231, v238, v239
    v_exp_f32 v240, v240
    v_exp_f32 v241, v241
    v_mfma_f32_32x32x16_bf16 v[52:67], v[148:151], v[228:231], v[52:67]
    v_exp_f32 v242, v242
    v_exp_f32 v243, v243
    v_cvt_pk_bf16_f32 v240, v240, v241
    v_exp_f32 v244, v244
    v_cvt_pk_bf16_f32 v241, v242, v243
    v_mfma_f32_32x32x16_bf16 v[192:207], v[104:107], v[24:27], v[192:207]
    v_exp_f32 v245, v245
    v_exp_f32 v246, v246
    v_exp_f32 v247, v247
    v_cvt_pk_bf16_f32 v242, v244, v245
    v_exp_f32 v248, v248
    v_cvt_pk_bf16_f32 v243, v246, v247
    v_mfma_f32_32x32x16_bf16 v[208:223], v[108:111], v[24:27], v[208:223]
    v_exp_f32 v249, v249
    v_exp_f32 v250, v250
    v_exp_f32 v251, v251
    v_cvt_pk_bf16_f32 v244, v248, v249
    v_exp_f32 v252, v252
    v_cvt_pk_bf16_f32 v245, v250, v251
    v_mfma_f32_32x32x16_bf16 v[52:67], v[152:155], v[240:243], v[52:67]
    v_exp_f32 v253, v253
    v_exp_f32 v254, v254
    v_exp_f32 v255, v255
    v_cvt_pk_bf16_f32 v246, v252, v253
    v_cvt_pk_bf16_f32 v247, v254, v255
    v_exp_f32 v192, v192
    v_exp_f32 v193, v193
    v_mfma_f32_32x32x16_bf16 v[52:67], v[156:159], v[244:247], v[52:67]
    v_exp_f32 v194, v194
    v_exp_f32 v195, v195
    v_cvt_pk_bf16_f32 v192, v192, v193
    v_exp_f32 v196, v196
    v_cvt_pk_bf16_f32 v193, v194, v195
    v_exp_f32 v197, v197
    v_mfma_f32_32x32x4_2b_bf16 v[224:255], v[122:123], v[30:31], 0
    v_exp_f32 v198, v198
    v_exp_f32 v199, v199
    v_cvt_pk_bf16_f32 v194, v196, v197
    v_exp_f32 v200, v200
    v_cvt_pk_bf16_f32 v195, v198, v199
    v_exp_f32 v201, v201
    v_exp_f32 v202, v202
    v_exp_f32 v203, v203
    v_cvt_pk_bf16_f32 v196, v200, v201
    v_exp_f32 v204, v204
    v_cvt_pk_bf16_f32 v197, v202, v203
    v_exp_f32 v205, v205
    v_mfma_f32_32x32x16_bf16 v[52:67], v[160:163], v[192:195], v[52:67]
    ds_read_b32 v28, v79 offset:4608
    v_exp_f32 v206, v206
    v_exp_f32 v207, v207
    v_cvt_pk_bf16_f32 v198, v204, v205
    v_cvt_pk_bf16_f32 v199, v206, v207
    v_exp_f32 v208, v208
    v_exp_f32 v209, v209
    v_mfma_f32_32x32x16_bf16 v[52:67], v[164:167], v[196:199], v[52:67]
    ds_read_b32 v31, v79 offset:4608
    v_exp_f32 v210, v210
    v_exp_f32 v211, v211
    v_cvt_pk_bf16_f32 v208, v208, v209
    v_exp_f32 v212, v212
    v_cvt_pk_bf16_f32 v209, v210, v211
    v_mfma_f32_32x32x16_bf16 v[224:239], v[112:115], v[24:27], v[224:239]
    v_exp_f32 v213, v213
    v_exp_f32 v214, v214
    v_exp_f32 v215, v215
    v_cvt_pk_bf16_f32 v210, v212, v213
    v_exp_f32 v216, v216
    v_cvt_pk_bf16_f32 v211, v214, v215
    v_mfma_f32_32x32x16_bf16 v[240:255], v[116:119], v[24:27], v[240:255]
    v_exp_f32 v217, v217
    v_exp_f32 v218, v218
    v_exp_f32 v219, v219
    v_cvt_pk_bf16_f32 v212, v216, v217
    v_exp_f32 v220, v220
    v_cvt_pk_bf16_f32 v213, v218, v219
    v_mfma_f32_32x32x16_bf16 v[52:67], v[168:171], v[208:211], v[52:67]
    ds_read_b128 v[24:27], v78 offset:4608
    v_exp_f32 v221, v221
    v_exp_f32 v222, v222
    v_exp_f32 v223, v223
    v_cvt_pk_bf16_f32 v214, v220, v221
    v_cvt_pk_bf16_f32 v215, v222, v223
    v_exp_f32 v224, v224
    v_exp_f32 v225, v225
    v_mfma_f32_32x32x16_bf16 v[52:67], v[172:175], v[212:215], v[52:67]
    s_waitcnt lgkmcnt(2)
    v_exp_f32 v226, v226
    v_exp_f32 v227, v227
    v_cvt_pk_bf16_f32 v224, v224, v225
    v_exp_f32 v228, v228
    v_cvt_pk_bf16_f32 v225, v226, v227
    v_exp_f32 v229, v229
    v_mfma_f32_32x32x4_2b_bf16 v[192:223], v[120:121], v[28:29], 0
    v_exp_f32 v230, v230
    v_exp_f32 v231, v231
    v_cvt_pk_bf16_f32 v226, v228, v229
    v_exp_f32 v232, v232
    v_cvt_pk_bf16_f32 v227, v230, v231
    v_exp_f32 v233, v233
    v_exp_f32 v234, v234
    v_exp_f32 v235, v235
    v_cvt_pk_bf16_f32 v228, v232, v233
    v_exp_f32 v236, v236
    v_cvt_pk_bf16_f32 v229, v234, v235
    v_exp_f32 v237, v237
    v_mfma_f32_32x32x16_bf16 v[52:67], v[176:179], v[224:227], v[52:67]
    v_exp_f32 v238, v238
    v_exp_f32 v239, v239
    v_cvt_pk_bf16_f32 v230, v236, v237
    v_cvt_pk_bf16_f32 v231, v238, v239
    v_exp_f32 v240, v240
    v_exp_f32 v241, v241
    v_mfma_f32_32x32x16_bf16 v[52:67], v[180:183], v[228:231], v[52:67]
    s_waitcnt lgkmcnt(0)
    v_exp_f32 v242, v242
    v_exp_f32 v243, v243
    v_cvt_pk_bf16_f32 v240, v240, v241
    v_exp_f32 v244, v244
    v_cvt_pk_bf16_f32 v241, v242, v243
    v_mfma_f32_32x32x16_bf16 v[192:207], v[88:91], v[24:27], v[192:207]
    v_exp_f32 v245, v245
    v_exp_f32 v246, v246
    v_exp_f32 v247, v247
    v_cvt_pk_bf16_f32 v242, v244, v245
    v_exp_f32 v248, v248
    v_cvt_pk_bf16_f32 v243, v246, v247
    v_mfma_f32_32x32x16_bf16 v[208:223], v[92:95], v[24:27], v[208:223]
    v_exp_f32 v249, v249
    v_exp_f32 v250, v250
    v_exp_f32 v251, v251
    v_cvt_pk_bf16_f32 v244, v248, v249
    v_exp_f32 v252, v252
    v_cvt_pk_bf16_f32 v245, v250, v251
    v_mfma_f32_32x32x16_bf16 v[52:67], v[184:187], v[240:243], v[52:67]
    s_setprio 3
    v_exp_f32 v253, v253
    v_exp_f32 v254, v254
    v_exp_f32 v255, v255
    v_cvt_pk_bf16_f32 v246, v252, v253
    v_cvt_pk_bf16_f32 v247, v254, v255
    v_exp_f32 v192, v192
    v_exp_f32 v193, v193
    v_mfma_f32_32x32x16_bf16 v[52:67], v[188:191], v[244:247], v[52:67]
    v_exp_f32 v194, v194
    v_exp_f32 v195, v195
    v_cvt_pk_bf16_f32 v192, v192, v193
    v_exp_f32 v196, v196
    v_cvt_pk_bf16_f32 v193, v194, v195
    v_exp_f32 v197, v197
    v_mfma_f32_32x32x4_2b_bf16 v[224:255], v[120:121], v[30:31], 0
    buffer_load_dword v120, v83, s[44:47], s97 offen offset:1024 sc1
    v_exp_f32 v198, v198
    v_exp_f32 v199, v199
    v_cvt_pk_bf16_f32 v194, v196, v197
    v_exp_f32 v200, v200
    v_cvt_pk_bf16_f32 v195, v198, v199
    v_exp_f32 v201, v201
    v_exp_f32 v202, v202
    v_exp_f32 v203, v203
    v_cvt_pk_bf16_f32 v196, v200, v201
    v_exp_f32 v204, v204
    v_cvt_pk_bf16_f32 v197, v202, v203
    v_exp_f32 v205, v205
    v_mfma_f32_32x32x16_bf16 v[62:77], v[128:131], v[192:195], 0
    buffer_load_dwordx4 v[88:91], v82, s[44:47], s96 offen offset:0 sc1
    v_exp_f32 v206, v206
    v_exp_f32 v207, v207
    v_cvt_pk_bf16_f32 v198, v204, v205
    v_cvt_pk_bf16_f32 v199, v206, v207
    v_exp_f32 v208, v208
    v_exp_f32 v209, v209
    v_mfma_f32_32x32x16_bf16 v[62:77], v[132:135], v[196:199], v[62:77]
    buffer_load_dwordx4 v[128:131], v4, s[44:47], s98 offen offset:0 sc1
    v_exp_f32 v210, v210
    v_exp_f32 v211, v211
    v_cvt_pk_bf16_f32 v208, v208, v209
    v_exp_f32 v212, v212
    v_cvt_pk_bf16_f32 v209, v210, v211
    v_mfma_f32_32x32x16_bf16 v[224:239], v[96:99], v[24:27], v[224:239]
    buffer_load_dwordx4 v[132:135], v4, s[44:47], s98 offen offset:640 sc1
    v_exp_f32 v213, v213
    v_exp_f32 v214, v214
    v_exp_f32 v215, v215
    v_cvt_pk_bf16_f32 v210, v212, v213
    v_exp_f32 v216, v216
    v_cvt_pk_bf16_f32 v211, v214, v215
    v_mfma_f32_32x32x16_bf16 v[240:255], v[100:103], v[24:27], v[240:255]
    v_exp_f32 v217, v217
    v_exp_f32 v218, v218
    v_exp_f32 v219, v219
    v_cvt_pk_bf16_f32 v212, v216, v217
    v_exp_f32 v220, v220
    v_cvt_pk_bf16_f32 v213, v218, v219
    v_mfma_f32_32x32x16_bf16 v[62:77], v[136:139], v[208:211], v[62:77]
    buffer_load_dwordx4 v[92:95], v82, s[44:47], s96 offen offset:1024 sc1
    v_exp_f32 v221, v221
    v_exp_f32 v222, v222
    v_exp_f32 v223, v223
    v_cvt_pk_bf16_f32 v214, v220, v221
    v_cvt_pk_bf16_f32 v215, v222, v223
    v_exp_f32 v224, v224
    v_exp_f32 v225, v225
    v_mfma_f32_32x32x16_bf16 v[62:77], v[140:143], v[212:215], v[62:77]
    buffer_load_dwordx4 v[136:139], v4, s[44:47], s98 offen offset:1280 sc1
    v_exp_f32 v226, v226
    v_exp_f32 v227, v227
    v_cvt_pk_bf16_f32 v224, v224, v225
    v_exp_f32 v228, v228
    v_cvt_pk_bf16_f32 v225, v226, v227
    v_exp_f32 v229, v229
    v_mfma_f32_32x32x4_2b_bf16 v[192:223], v[122:123], v[28:29], 0
    buffer_load_dwordx4 v[140:143], v4, s[44:47], s98 offen offset:1920 sc1
    s_add_u32 s98, s98, 2560
    v_exp_f32 v230, v230
    v_exp_f32 v231, v231
    v_cvt_pk_bf16_f32 v226, v228, v229
    v_exp_f32 v232, v232
    v_cvt_pk_bf16_f32 v227, v230, v231
    v_exp_f32 v233, v233
    v_exp_f32 v234, v234
    v_exp_f32 v235, v235
    v_cvt_pk_bf16_f32 v228, v232, v233
    v_exp_f32 v236, v236
    v_cvt_pk_bf16_f32 v229, v234, v235
    v_exp_f32 v237, v237
    v_mfma_f32_32x32x16_bf16 v[62:77], v[144:147], v[224:227], v[62:77]
    v_exp_f32 v238, v238
    v_exp_f32 v239, v239
    v_cvt_pk_bf16_f32 v230, v236, v237
    v_cvt_pk_bf16_f32 v231, v238, v239
    v_exp_f32 v240, v240
    v_exp_f32 v241, v241
    v_mfma_f32_32x32x16_bf16 v[62:77], v[148:151], v[228:231], v[62:77]
    v_exp_f32 v242, v242
    v_exp_f32 v243, v243
    v_cvt_pk_bf16_f32 v240, v240, v241
    v_exp_f32 v244, v244
    v_cvt_pk_bf16_f32 v241, v242, v243
    v_mfma_f32_32x32x16_bf16 v[192:207], v[104:107], v[24:27], v[192:207]
    buffer_load_dword v121, v83, s[44:47], s97 offen offset:1280 sc1
    v_exp_f32 v245, v245
    v_exp_f32 v246, v246
    v_exp_f32 v247, v247
    v_cvt_pk_bf16_f32 v242, v244, v245
    v_exp_f32 v248, v248
    v_cvt_pk_bf16_f32 v243, v246, v247
    v_mfma_f32_32x32x16_bf16 v[208:223], v[108:111], v[24:27], v[208:223]
    v_exp_f32 v249, v249
    v_exp_f32 v250, v250
    v_exp_f32 v251, v251
    v_cvt_pk_bf16_f32 v244, v248, v249
    v_exp_f32 v252, v252
    v_cvt_pk_bf16_f32 v245, v250, v251
    v_mfma_f32_32x32x16_bf16 v[62:77], v[152:155], v[240:243], v[62:77]
    buffer_load_dwordx4 v[96:99], v82, s[44:47], s96 offen offset:2048 sc1
    v_exp_f32 v253, v253
    v_exp_f32 v254, v254
    v_exp_f32 v255, v255
    v_cvt_pk_bf16_f32 v246, v252, v253
    v_cvt_pk_bf16_f32 v247, v254, v255
    v_exp_f32 v192, v192
    v_exp_f32 v193, v193
    v_mfma_f32_32x32x16_bf16 v[62:77], v[156:159], v[244:247], v[62:77]
    buffer_load_dwordx4 v[144:147], v4, s[44:47], s98 offen offset:0 sc1
    v_exp_f32 v194, v194
    v_exp_f32 v195, v195
    v_cvt_pk_bf16_f32 v192, v192, v193
    v_exp_f32 v196, v196
    v_cvt_pk_bf16_f32 v193, v194, v195
    v_exp_f32 v197, v197
    v_mfma_f32_32x32x4_2b_bf16 v[224:255], v[122:123], v[30:31], 0
    buffer_load_dwordx4 v[148:151], v4, s[44:47], s98 offen offset:640 sc1
    v_exp_f32 v198, v198
    v_exp_f32 v199, v199
    v_cvt_pk_bf16_f32 v194, v196, v197
    v_exp_f32 v200, v200
    v_cvt_pk_bf16_f32 v195, v198, v199
    v_exp_f32 v201, v201
    v_exp_f32 v202, v202
    v_exp_f32 v203, v203
    v_cvt_pk_bf16_f32 v196, v200, v201
    v_exp_f32 v204, v204
    v_cvt_pk_bf16_f32 v197, v202, v203
    v_exp_f32 v205, v205
    v_mfma_f32_32x32x16_bf16 v[62:77], v[160:163], v[192:195], v[62:77]
    buffer_load_dwordx4 v[100:103], v82, s[44:47], s96 offen offset:3072 sc1
    s_add_u32 s96, s96, 4096
    ds_read_b32 v28, v79 offset:0
    v_exp_f32 v206, v206
    v_exp_f32 v207, v207
    v_cvt_pk_bf16_f32 v198, v204, v205
    v_cvt_pk_bf16_f32 v199, v206, v207
    v_exp_f32 v208, v208
    v_exp_f32 v209, v209
    v_mfma_f32_32x32x16_bf16 v[62:77], v[164:167], v[196:199], v[62:77]
    buffer_load_dwordx4 v[152:155], v4, s[44:47], s98 offen offset:1280 sc1
    ds_read_b32 v31, v79 offset:0
    v_exp_f32 v210, v210
    v_exp_f32 v211, v211
    v_cvt_pk_bf16_f32 v208, v208, v209
    v_exp_f32 v212, v212
    v_cvt_pk_bf16_f32 v209, v210, v211
    v_mfma_f32_32x32x16_bf16 v[224:239], v[112:115], v[24:27], v[224:239]
    buffer_load_dwordx4 v[156:159], v4, s[44:47], s98 offen offset:1920 sc1
    s_add_u32 s98, s98, 2560
    v_exp_f32 v213, v213
    v_exp_f32 v214, v214
    v_exp_f32 v215, v215
    v_cvt_pk_bf16_f32 v210, v212, v213
    v_exp_f32 v216, v216
    v_cvt_pk_bf16_f32 v211, v214, v215
    v_mfma_f32_32x32x16_bf16 v[240:255], v[116:119], v[24:27], v[240:255]
    v_exp_f32 v217, v217
    v_exp_f32 v218, v218
    v_exp_f32 v219, v219
    v_cvt_pk_bf16_f32 v212, v216, v217
    v_exp_f32 v220, v220
    v_cvt_pk_bf16_f32 v213, v218, v219
    v_mfma_f32_32x32x16_bf16 v[62:77], v[168:171], v[208:211], v[62:77]
    ds_read_b128 v[24:27], v78 offset:0
    v_exp_f32 v221, v221
    v_exp_f32 v222, v222
    v_exp_f32 v223, v223
    v_cvt_pk_bf16_f32 v214, v220, v221
    v_cvt_pk_bf16_f32 v215, v222, v223
    v_exp_f32 v224, v224
    v_exp_f32 v225, v225
    v_mfma_f32_32x32x16_bf16 v[62:77], v[172:175], v[212:215], v[62:77]
    s_waitcnt vmcnt(13) lgkmcnt(2)
    v_exp_f32 v226, v226
    v_exp_f32 v227, v227
    v_cvt_pk_bf16_f32 v224, v224, v225
    v_exp_f32 v228, v228
    v_cvt_pk_bf16_f32 v225, v226, v227
    v_exp_f32 v229, v229
    v_mfma_f32_32x32x4_2b_bf16 v[192:223], v[120:121], v[28:29], 0
    buffer_load_dword v122, v83, s[44:47], s97 offen offset:1536 sc1
    v_exp_f32 v230, v230
    v_exp_f32 v231, v231
    v_cvt_pk_bf16_f32 v226, v228, v229
    v_exp_f32 v232, v232
    v_cvt_pk_bf16_f32 v227, v230, v231
    v_exp_f32 v233, v233
    v_exp_f32 v234, v234
    v_exp_f32 v235, v235
    v_cvt_pk_bf16_f32 v228, v232, v233
    v_exp_f32 v236, v236
    v_cvt_pk_bf16_f32 v229, v234, v235
    v_exp_f32 v237, v237
    v_mfma_f32_32x32x16_bf16 v[62:77], v[176:179], v[224:227], v[62:77]
    buffer_load_dwordx4 v[104:107], v82, s[44:47], s96 offen offset:0 sc1
    v_exp_f32 v238, v238
    v_exp_f32 v239, v239
    v_cvt_pk_bf16_f32 v230, v236, v237
    v_cvt_pk_bf16_f32 v231, v238, v239
    v_exp_f32 v240, v240
    v_exp_f32 v241, v241
    v_mfma_f32_32x32x16_bf16 v[62:77], v[180:183], v[228:231], v[62:77]
    buffer_load_dwordx4 v[160:163], v4, s[44:47], s98 offen offset:0 sc1
    s_waitcnt vmcnt(12) lgkmcnt(0)
    v_exp_f32 v242, v242
    v_exp_f32 v243, v243
    v_cvt_pk_bf16_f32 v240, v240, v241
    v_exp_f32 v244, v244
    v_cvt_pk_bf16_f32 v241, v242, v243
    v_mfma_f32_32x32x16_bf16 v[192:207], v[88:91], v[24:27], v[192:207]
    buffer_load_dwordx4 v[164:167], v4, s[44:47], s98 offen offset:640 sc1
    v_exp_f32 v245, v245
    v_exp_f32 v246, v246
    v_exp_f32 v247, v247
    v_cvt_pk_bf16_f32 v242, v244, v245
    v_exp_f32 v248, v248
    v_cvt_pk_bf16_f32 v243, v246, v247
    v_mfma_f32_32x32x16_bf16 v[208:223], v[92:95], v[24:27], v[208:223]
    v_exp_f32 v249, v249
    v_exp_f32 v250, v250
    v_exp_f32 v251, v251
    v_cvt_pk_bf16_f32 v244, v248, v249
    v_exp_f32 v252, v252
    v_cvt_pk_bf16_f32 v245, v250, v251
    v_mfma_f32_32x32x16_bf16 v[62:77], v[184:187], v[240:243], v[62:77]
    buffer_load_dwordx4 v[108:111], v82, s[44:47], s96 offen offset:1024 sc1
    s_mov_b64 exec, 1
    ds_add_u32 v2, v3 offset:2144
    s_mov_b64 exec, -1
    v_exp_f32 v253, v253
    v_exp_f32 v254, v254
    v_exp_f32 v255, v255
    v_cvt_pk_bf16_f32 v246, v252, v253
    v_cvt_pk_bf16_f32 v247, v254, v255
    v_exp_f32 v192, v192
    v_exp_f32 v193, v193
    v_mfma_f32_32x32x16_bf16 v[62:77], v[188:191], v[244:247], v[62:77]
    buffer_load_dwordx4 v[168:171], v4, s[44:47], s98 offen offset:1280 sc1
    s_waitcnt vmcnt(12)
    v_exp_f32 v194, v194
    v_exp_f32 v195, v195
    v_cvt_pk_bf16_f32 v192, v192, v193
    v_exp_f32 v196, v196
    v_cvt_pk_bf16_f32 v193, v194, v195
    v_exp_f32 v197, v197
    v_mfma_f32_32x32x4_2b_bf16 v[224:255], v[120:121], v[30:31], 0
    buffer_load_dwordx4 v[172:175], v4, s[44:47], s98 offen offset:1920 sc1
    s_add_u32 s98, s98, 2560
    v_exp_f32 v198, v198
    v_exp_f32 v199, v199
    v_cvt_pk_bf16_f32 v194, v196, v197
    v_exp_f32 v200, v200
    v_cvt_pk_bf16_f32 v195, v198, v199
    v_exp_f32 v201, v201
    v_exp_f32 v202, v202
    v_exp_f32 v203, v203
    v_cvt_pk_bf16_f32 v196, v200, v201
    v_exp_f32 v204, v204
    v_cvt_pk_bf16_f32 v197, v202, v203
    v_exp_f32 v205, v205
    v_mfma_f32_32x32x16_bf16 v[32:47], v[128:131], v[192:195], v[32:47]
    v_exp_f32 v206, v206
    v_exp_f32 v207, v207
    v_cvt_pk_bf16_f32 v198, v204, v205
    v_cvt_pk_bf16_f32 v199, v206, v207
    v_exp_f32 v208, v208
    v_exp_f32 v209, v209
    v_mfma_f32_32x32x16_bf16 v[32:47], v[132:135], v[196:199], v[32:47]
    s_waitcnt vmcnt(9)
    v_exp_f32 v210, v210
    v_exp_f32 v211, v211
    v_cvt_pk_bf16_f32 v208, v208, v209
    v_exp_f32 v212, v212
    v_cvt_pk_bf16_f32 v209, v210, v211
    v_mfma_f32_32x32x16_bf16 v[224:239], v[96:99], v[24:27], v[224:239]
    buffer_load_dword v123, v83, s[44:47], s97 offen offset:1792 sc1
    v_exp_f32 v213, v213
    v_exp_f32 v214, v214
    v_exp_f32 v215, v215
    v_cvt_pk_bf16_f32 v210, v212, v213
    v_exp_f32 v216, v216
    v_cvt_pk_bf16_f32 v211, v214, v215
    v_mfma_f32_32x32x16_bf16 v[240:255], v[100:103], v[24:27], v[240:255]
    v_exp_f32 v217, v217
    v_exp_f32 v218, v218
    v_exp_f32 v219, v219
    v_cvt_pk_bf16_f32 v212, v216, v217
    v_exp_f32 v220, v220
    v_cvt_pk_bf16_f32 v213, v218, v219
    v_mfma_f32_32x32x16_bf16 v[32:47], v[136:139], v[208:211], v[32:47]
    buffer_load_dwordx4 v[112:115], v82, s[44:47], s96 offen offset:2048 sc1
    v_exp_f32 v221, v221
    v_exp_f32 v222, v222
    v_exp_f32 v223, v223
    v_cvt_pk_bf16_f32 v214, v220, v221
    v_cvt_pk_bf16_f32 v215, v222, v223
    v_exp_f32 v224, v224
    v_exp_f32 v225, v225
    v_mfma_f32_32x32x16_bf16 v[32:47], v[140:143], v[212:215], v[32:47]
    buffer_load_dwordx4 v[176:179], v4, s[44:47], s98 offen offset:0 sc1
    s_waitcnt vmcnt(9)
    v_exp_f32 v226, v226
    v_exp_f32 v227, v227
    v_cvt_pk_bf16_f32 v224, v224, v225
    v_exp_f32 v228, v228
    v_cvt_pk_bf16_f32 v225, v226, v227
    v_exp_f32 v229, v229
    v_mfma_f32_32x32x4_2b_bf16 v[192:223], v[122:123], v[28:29], 0
    buffer_load_dwordx4 v[180:183], v4, s[44:47], s98 offen offset:640 sc1
    v_exp_f32 v230, v230
    v_exp_f32 v231, v231
    v_cvt_pk_bf16_f32 v226, v228, v229
    v_exp_f32 v232, v232
    v_cvt_pk_bf16_f32 v227, v230, v231
    v_exp_f32 v233, v233
    v_exp_f32 v234, v234
    v_exp_f32 v235, v235
    v_cvt_pk_bf16_f32 v228, v232, v233
    v_exp_f32 v236, v236
    v_cvt_pk_bf16_f32 v229, v234, v235
    v_exp_f32 v237, v237
    v_mfma_f32_32x32x16_bf16 v[32:47], v[144:147], v[224:227], v[32:47]
    buffer_load_dwordx4 v[116:119], v82, s[44:47], s96 offen offset:3072 sc1
    s_add_u32 s96, s96, 4096
    v_exp_f32 v238, v238
    v_exp_f32 v239, v239
    v_cvt_pk_bf16_f32 v230, v236, v237
    v_cvt_pk_bf16_f32 v231, v238, v239
    v_exp_f32 v240, v240
    v_exp_f32 v241, v241
    v_mfma_f32_32x32x16_bf16 v[32:47], v[148:151], v[228:231], v[32:47]
    buffer_load_dwordx4 v[184:187], v4, s[44:47], s98 offen offset:1280 sc1
    s_waitcnt vmcnt(8)
    v_exp_f32 v242, v242
    v_exp_f32 v243, v243
    v_cvt_pk_bf16_f32 v240, v240, v241
    v_exp_f32 v244, v244
    v_cvt_pk_bf16_f32 v241, v242, v243
    v_mfma_f32_32x32x16_bf16 v[192:207], v[104:107], v[24:27], v[192:207]
    buffer_load_dwordx4 v[188:191], v4, s[44:47], s98 offen offset:1920 sc1
    s_add_u32 s98, s98, 2560
    v_exp_f32 v245, v245
    v_exp_f32 v246, v246
    v_exp_f32 v247, v247
    v_cvt_pk_bf16_f32 v242, v244, v245
    v_exp_f32 v248, v248
    v_cvt_pk_bf16_f32 v243, v246, v247
    v_mfma_f32_32x32x16_bf16 v[208:223], v[108:111], v[24:27], v[208:223]
    v_exp_f32 v249, v249
    v_exp_f32 v250, v250
    v_exp_f32 v251, v251
    v_cvt_pk_bf16_f32 v244, v248, v249
    v_exp_f32 v252, v252
    v_cvt_pk_bf16_f32 v245, v250, v251
    v_mfma_f32_32x32x16_bf16 v[32:47], v[152:155], v[240:243], v[32:47]
    v_exp_f32 v253, v253
    v_exp_f32 v254, v254
    v_exp_f32 v255, v255
    v_cvt_pk_bf16_f32 v246, v252, v253
    v_cvt_pk_bf16_f32 v247, v254, v255
    v_exp_f32 v192, v192
    v_exp_f32 v193, v193
    v_mfma_f32_32x32x16_bf16 v[32:47], v[156:159], v[244:247], v[32:47]
    s_setprio 1
    s_cmp_ge_u32 s68, 4
    s_cbranch_scc1 PLO_32
    s_setprio 2
PLO_32:
    s_waitcnt vmcnt(6)
    v_exp_f32 v194, v194
    v_exp_f32 v195, v195
    v_cvt_pk_bf16_f32 v192, v192, v193
    v_exp_f32 v196, v196
    v_cvt_pk_bf16_f32 v193, v194, v195
    v_exp_f32 v197, v197
    v_mfma_f32_32x32x4_2b_bf16 v[224:255], v[122:123], v[30:31], 0
    v_exp_f32 v198, v198
    v_exp_f32 v199, v199
    v_cvt_pk_bf16_f32 v194, v196, v197
    v_exp_f32 v200, v200
    v_cvt_pk_bf16_f32 v195, v198, v199
    v_exp_f32 v201, v201
    v_exp_f32 v202, v202
    v_exp_f32 v203, v203
    v_cvt_pk_bf16_f32 v196, v200, v201
    v_exp_f32 v204, v204
    v_cvt_pk_bf16_f32 v197, v202, v203
    v_exp_f32 v205, v205
    v_mfma_f32_32x32x16_bf16 v[32:47], v[160:163], v[192:195], v[32:47]
    ds_read_b32 v28, v79 offset:1536
    ds_read_b32 v87, v86 offset:2060
    v_exp_f32 v206, v206
    v_exp_f32 v207, v207
    v_cvt_pk_bf16_f32 v198, v204, v205
    v_cvt_pk_bf16_f32 v199, v206, v207
    v_exp_f32 v208, v208
    v_exp_f32 v209, v209
    v_mfma_f32_32x32x16_bf16 v[32:47], v[164:167], v[196:199], v[32:47]
    ds_read_b32 v31, v79 offset:1536
    s_waitcnt vmcnt(2)
    v_exp_f32 v210, v210
    v_exp_f32 v211, v211
    v_cvt_pk_bf16_f32 v208, v208, v209
    v_exp_f32 v212, v212
    v_cvt_pk_bf16_f32 v209, v210, v211
    v_mfma_f32_32x32x16_bf16 v[224:239], v[112:115], v[24:27], v[224:239]
    v_exp_f32 v213, v213
    v_exp_f32 v214, v214
    v_exp_f32 v215, v215
    v_cvt_pk_bf16_f32 v210, v212, v213
    v_exp_f32 v216, v216
    v_cvt_pk_bf16_f32 v211, v214, v215
    v_mfma_f32_32x32x16_bf16 v[240:255], v[116:119], v[24:27], v[240:255]
    v_exp_f32 v217, v217
    v_exp_f32 v218, v218
    v_exp_f32 v219, v219
    v_cvt_pk_bf16_f32 v212, v216, v217
    v_exp_f32 v220, v220
    v_cvt_pk_bf16_f32 v213, v218, v219
    v_mfma_f32_32x32x16_bf16 v[32:47], v[168:171], v[208:211], v[32:47]
    ds_read_b128 v[24:27], v78 offset:1536
    v_exp_f32 v221, v221
    v_exp_f32 v222, v222
    v_exp_f32 v223, v223
    v_cvt_pk_bf16_f32 v214, v220, v221
    v_cvt_pk_bf16_f32 v215, v222, v223
    v_exp_f32 v224, v224
    v_exp_f32 v225, v225
    v_mfma_f32_32x32x16_bf16 v[32:47], v[172:175], v[212:215], v[32:47]
    s_waitcnt lgkmcnt(2)
    v_exp_f32 v226, v226
    v_exp_f32 v227, v227
    v_cvt_pk_bf16_f32 v224, v224, v225
    v_exp_f32 v228, v228
    v_cvt_pk_bf16_f32 v225, v226, v227
    v_exp_f32 v229, v229
    v_mfma_f32_32x32x4_2b_bf16 v[192:223], v[120:121], v[28:29], 0
    v_exp_f32 v230, v230
    v_exp_f32 v231, v231
    v_cvt_pk_bf16_f32 v226, v228, v229
    v_exp_f32 v232, v232
    v_cvt_pk_bf16_f32 v227, v230, v231
    v_exp_f32 v233, v233
    v_exp_f32 v234, v234
    v_exp_f32 v235, v235
    v_cvt_pk_bf16_f32 v228, v232, v233
    v_exp_f32 v236, v236
    v_cvt_pk_bf16_f32 v229, v234, v235
    v_exp_f32 v237, v237
    v_mfma_f32_32x32x16_bf16 v[32:47], v[176:179], v[224:227], v[32:47]
    v_exp_f32 v238, v238
    v_exp_f32 v239, v239
    v_cvt_pk_bf16_f32 v230, v236, v237
    v_cvt_pk_bf16_f32 v231, v238, v239
    v_exp_f32 v240, v240
    v_exp_f32 v241, v241
    v_mfma_f32_32x32x16_bf16 v[32:47], v[180:183], v[228:231], v[32:47]
    s_waitcnt lgkmcnt(0)
    v_exp_f32 v242, v242
    v_exp_f32 v243, v243
    v_cvt_pk_bf16_f32 v240, v240, v241
    v_exp_f32 v244, v244
    v_cvt_pk_bf16_f32 v241, v242, v243
    v_mfma_f32_32x32x16_bf16 v[192:207], v[88:91], v[24:27], v[192:207]
    v_exp_f32 v245, v245
    v_exp_f32 v246, v246
    v_exp_f32 v247, v247
    v_cvt_pk_bf16_f32 v242, v244, v245
    v_exp_f32 v248, v248
    v_cvt_pk_bf16_f32 v243, v246, v247
    v_mfma_f32_32x32x16_bf16 v[208:223], v[92:95], v[24:27], v[208:223]
    s_waitcnt vmcnt(0)
    v_exp_f32 v249, v249
    v_exp_f32 v250, v250
    v_exp_f32 v251, v251
    v_cvt_pk_bf16_f32 v244, v248, v249
    v_exp_f32 v252, v252
    v_cvt_pk_bf16_f32 v245, v250, v251
    v_mfma_f32_32x32x16_bf16 v[32:47], v[184:187], v[240:243], v[32:47]
    v_exp_f32 v253, v253
    v_exp_f32 v254, v254
    v_exp_f32 v255, v255
    v_cvt_pk_bf16_f32 v246, v252, v253
    v_cvt_pk_bf16_f32 v247, v254, v255
    v_readfirstlane_b32 s73, v87
    s_cmp_ge_u32 s73, 4
    s_cbranch_scc1 CNOK_33
LW_34:
    ds_read_b32 v1, v86 offset:2060
    s_waitcnt lgkmcnt(0)
    v_readfirstlane_b32 s73, v1
    s_cmp_ge_u32 s73, 4
    s_cbranch_scc1 LWD_35
    s_sleep 2
    s_sub_u32 s72, s72, 1
    s_cbranch_scc0 LW_34
    s_branch L_bail
LWD_35:
CNOK_33:
    v_exp_f32 v192, v192
    v_exp_f32 v193, v193
    v_mfma_f32_32x32x16_bf16 v[32:47], v[188:191], v[244:247], v[32:47]
    v_exp_f32 v194, v194
    v_exp_f32 v195, v195
    v_cvt_pk_bf16_f32 v192, v192, v193
    v_exp_f32 v196, v196
    v_cvt_pk_bf16_f32 v193, v194, v195
    v_exp_f32 v197, v197
    v_mfma_f32_32x32x4_2b_bf16 v[224:255], v[120:121], v[30:31], 0
    v_exp_f32 v198, v198
    v_exp_f32 v199, v199
    v_cvt_pk_bf16_f32 v194, v196, v197
    v_exp_f32 v200, v200
    v_cvt_pk_bf16_f32 v195, v198, v199
    v_exp_f32 v201, v201
    v_exp_f32 v202, v202
    v_exp_f32 v203, v203
    v_cvt_pk_bf16_f32 v196, v200, v201
    v_exp_f32 v204, v204
    v_cvt_pk_bf16_f32 v197, v202, v203
    v_exp_f32 v205, v205
    v_mfma_f32_32x32x16_bf16 v[42:57], v[128:131], v[192:195], v[42:57]
    ds_write_b128 v80, v[32:35] offset:0
    v_exp_f32 v206, v206
    v_exp_f32 v207, v207
    v_cvt_pk_bf16_f32 v198, v204, v205
    v_cvt_pk_bf16_f32 v199, v206, v207
    v_exp_f32 v208, v208
    v_exp_f32 v209, v209
    v_mfma_f32_32x32x16_bf16 v[42:57], v[132:135], v[196:199], v[42:57]
    ds_write_b128 v80, v[36:39] offset:1024
    v_exp_f32 v210, v210
    v_exp_f32 v211, v211
    v_cvt_pk_bf16_f32 v208, v208, v209
    v_exp_f32 v212, v212
    v_cvt_pk_bf16_f32 v209, v210, v211
    v_mfma_f32_32x32x16_bf16 v[224:239], v[96:99], v[24:27], v[224:239]
    ds_write_b64 v81, v[40:41] offset:0
    v_exp_f32 v213, v213
    v_exp_f32 v214, v214
    v_exp_f32 v215, v215
    v_cvt_pk_bf16_f32 v210, v212, v213
    v_exp_f32 v216, v216
    v_cvt_pk_bf16_f32 v211, v214, v215
    v_mfma_f32_32x32x16_bf16 v[240:255], v[100:103], v[24:27], v[240:255]
    ds_add_u32 v84, v3 offset:0
    v_exp_f32 v217, v217
    v_exp_f32 v218, v218
    v_exp_f32 v219, v219
    v_cvt_pk_bf16_f32 v212, v216, v217
    v_exp_f32 v220, v220
    v_cvt_pk_bf16_f32 v213, v218, v219
    v_mfma_f32_32x32x16_bf16 v[42:57], v[136:139], v[208:211], v[42:57]
    v_exp_f32 v221, v221
    v_exp_f32 v222, v222
    v_exp_f32 v223, v223
    v_cvt_pk_bf16_f32 v214, v220, v221
    v_cvt_pk_bf16_f32 v215, v222, v223
    v_exp_f32 v224, v224
    v_exp_f32 v225, v225
    v_mfma_f32_32x32x16_bf16 v[42:57], v[140:143], v[212:215], v[42:57]
    v_exp_f32 v226, v226
    v_exp_f32 v227, v227
    v_cvt_pk_bf16_f32 v224, v224, v225
    v_exp_f32 v228, v228
    v_cvt_pk_bf16_f32 v225, v226, v227
    v_exp_f32 v229, v229
    v_mfma_f32_32x32x4_2b_bf16 v[192:223], v[122:123], v[28:29], 0
    v_exp_f32 v230, v230
    v_exp_f32 v231, v231
    v_cvt_pk_bf16_f32 v226, v228, v229
    v_exp_f32 v232, v232
    v_cvt_pk_bf16_f32 v227, v230, v231
    v_exp_f32 v233, v233
    v_exp_f32 v234, v234
    v_exp_f32 v235, v235
    v_cvt_pk_bf16_f32 v228, v232, v233
    v_exp_f32 v236, v236
    v_cvt_pk_bf16_f32 v229, v234, v235
    v_exp_f32 v237, v237
    v_mfma_f32_32x32x16_bf16 v[42:57], v[144:147], v[224:227], v[42:57]
    v_exp_f32 v238, v238
    v_exp_f32 v239, v239
    v_cvt_pk_bf16_f32 v230, v236, v237
    v_cvt_pk_bf16_f32 v231, v238, v239
    v_exp_f32 v240, v240
    v_exp_f32 v241, v241
    v_mfma_f32_32x32x16_bf16 v[42:57], v[148:151], v[228:231], v[42:57]
    v_exp_f32 v242, v242
    v_exp_f32 v243, v243
    v_cvt_pk_bf16_f32 v240, v240, v241
    v_exp_f32 v244, v244
    v_cvt_pk_bf16_f32 v241, v242, v243
    v_mfma_f32_32x32x16_bf16 v[192:207], v[104:107], v[24:27], v[192:207]
    v_exp_f32 v245, v245
    v_exp_f32 v246, v246
    v_exp_f32 v247, v247
    v_cvt_pk_bf16_f32 v242, v244, v245
    v_exp_f32 v248, v248
    v_cvt_pk_bf16_f32 v243, v246, v247
    v_mfma_f32_32x32x16_bf16 v[208:223], v[108:111], v[24:27], v[208:223]
    v_exp_f32 v249, v249
    v_exp_f32 v250, v250
    v_exp_f32 v251, v251
    v_cvt_pk_bf16_f32 v244, v248, v249
    v_exp_f32 v252, v252
    v_cvt_pk_bf16_f32 v245, v250, v251
    v_mfma_f32_32x32x16_bf16 v[42:57], v[152:155], v[240:243], v[42:57]
    v_exp_f32 v253, v253
    v_exp_f32 v254, v254
    v_exp_f32 v255, v255
    v_cvt_pk_bf16_f32 v246, v252, v253
    v_cvt_pk_bf16_f32 v247, v254, v255
    v_exp_f32 v192, v192
    v_exp_f32 v193, v193
    v_mfma_f32_32x32x16_bf16 v[42:57], v[156:159], v[244:247], v[42:57]
    v_exp_f32 v194, v194
    v_exp_f32 v195, v195
    v_cvt_pk_bf16_f32 v192, v192, v193
    v_exp_f32 v196, v196
    v_cvt_pk_bf16_f32 v193, v194, v195
    v_exp_f32 v197, v197
    v_mfma_f32_32x32x4_2b_bf16 v[224:255], v[122:123], v[30:31], 0
    v_exp_f32 v198, v198
    v_exp_f32 v199, v199
    v_cvt_pk_bf16_f32 v194, v196, v197
    v_exp_f32 v200, v200
    v_cvt_pk_bf16_f32 v195, v198, v199
    v_exp_f32 v201, v201
    v_exp_f32 v202, v202
    v_exp_f32 v203, v203
    v_cvt_pk_bf16_f32 v196, v200, v201
    v_exp_f32 v204, v204
    v_cvt_pk_bf16_f32 v197, v202, v203
    v_exp_f32 v205, v205
    v_mfma_f32_32x32x16_bf16 v[42:57], v[160:163], v[192:195], v[42:57]
    ds_read_b32 v28, v79 offset:3072
    v_exp_f32 v206, v206
    v_exp_f32 v207, v207
    v_cvt_pk_bf16_f32 v198, v204, v205
    v_cvt_pk_bf16_f32 v199, v206, v207
    v_exp_f32 v208, v208
    v_exp_f32 v209, v209
    v_mfma_f32_32x32x16_bf16 v[42:57], v[164:167], v[196:199], v[42:57]
    ds_read_b32 v31, v79 offset:3072
    v_exp_f32 v210, v210
    v_exp_f32 v211, v211
    v_cvt_pk_bf16_f32 v208, v208, v209
    v_exp_f32 v212, v212
    v_cvt_pk_bf16_f32 v209, v210, v211
    v_mfma_f32_32x32x16_bf16 v[224:239], v[112:115], v[24:27], v[224:239]
    v_exp_f32 v213, v213
    v_exp_f32 v214, v214
    v_exp_f32 v215, v215
    v_cvt_pk_bf16_f32 v210, v212, v213
    v_exp_f32 v216, v216
    v_cvt_pk_bf16_f32 v211, v214, v215
    v_mfma_f32_32x32x16_bf16 v[240:255], v[116:119], v[24:27], v[240:255]
    v_exp_f32 v217, v217
    v_exp_f32 v218, v218
    v_exp_f32 v219, v219
    v_cvt_pk_bf16_f32 v212, v216, v217
    v_exp_f32 v220, v220
    v_cvt_pk_bf16_f32 v213, v218, v219
    v_mfma_f32_32x32x16_bf16 v[42:57], v[168:171], v[208:211], v[42:57]
    ds_read_b128 v[24:27], v78 offset:3072
    v_exp_f32 v221, v221
    v_exp_f32 v222, v222
    v_exp_f32 v223, v223
    v_cvt_pk_bf16_f32 v214, v220, v221
    v_cvt_pk_bf16_f32 v215, v222, v223
    v_exp_f32 v224, v224
    v_exp_f32 v225, v225
    v_mfma_f32_32x32x16_bf16 v[42:57], v[172:175], v[212:215], v[42:57]
    s_waitcnt lgkmcnt(2)
    v_exp_f32 v226, v226
    v_exp_f32 v227, v227
    v_cvt_pk_bf16_f32 v224, v224, v225
    v_exp_f32 v228, v228
    v_cvt_pk_bf16_f32 v225, v226, v227
    v_exp_f32 v229, v229
    v_mfma_f32_32x32x4_2b_bf16 v[192:223], v[120:121], v[28:29], 0
    v_exp_f32 v230, v230
    v_exp_f32 v231, v231
    v_cvt_pk_bf16_f32 v226, v228, v229
    v_exp_f32 v232, v232
    v_cvt_pk_bf16_f32 v227, v230, v231
    v_exp_f32 v233, v233
    v_exp_f32 v234, v234
    v_exp_f32 v235, v235
    v_cvt_pk_bf16_f32 v228, v232, v233
    v_exp_f32 v236, v236
    v_cvt_pk_bf16_f32 v229, v234, v235
    v_exp_f32 v237, v237
    v_mfma_f32_32x32x16_bf16 v[42:57], v[176:179], v[224:227], v[42:57]
    v_exp_f32 v238, v238
    v_exp_f32 v239, v239
    v_cvt_pk_bf16_f32 v230, v236, v237
    v_cvt_pk_bf16_f32 v231, v238, v239
    v_exp_f32 v240, v240
    v_exp_f32 v241, v241
    v_mfma_f32_32x32x16_bf16 v[42:57], v[180:183], v[228:231], v[42:57]
    s_waitcnt lgkmcnt(0)
    v_exp_f32 v242, v242
    v_exp_f32 v243, v243
    v_cvt_pk_bf16_f32 v240, v240, v241
    v_exp_f32 v244, v244
    v_cvt_pk_bf16_f32 v241, v242, v243
    v_mfma_f32_32x32x16_bf16 v[192:207], v[88:91], v[24:27], v[192:207]
    v_exp_f32 v245, v245
    v_exp_f32 v246, v246
    v_exp_f32 v247, v247
    v_cvt_pk_bf16_f32 v242, v244, v245
    v_exp_f32 v248, v248
    v_cvt_pk_bf16_f32 v243, v246, v247
    v_mfma_f32_32x32x16_bf16 v[208:223], v[92:95], v[24:27], v[208:223]
    v_exp_f32 v249, v249
    v_exp_f32 v250, v250
    v_exp_f32 v251, v251
    v_cvt_pk_bf16_f32 v244, v248, v249
    v_exp_f32 v252, v252
    v_cvt_pk_bf16_f32 v245, v250, v251
    v_mfma_f32_32x32x16_bf16 v[42:57], v[184:187], v[240:243], v[42:57]
    v_exp_f32 v253, v253
    v_exp_f32 v254, v254
    v_exp_f32 v255, v255
    v_cvt_pk_bf16_f32 v246, v252, v253
    v_cvt_pk_bf16_f32 v247, v254, v255
    v_exp_f32 v192, v192
    v_exp_f32 v193, v193
    v_mfma_f32_32x32x16_bf16 v[42:57], v[188:191], v[244:247], v[42:57]
    v_exp_f32 v194, v194
    v_exp_f32 v195, v195
    v_cvt_pk_bf16_f32 v192, v192, v193
    v_exp_f32 v196, v196
    v_cvt_pk_bf16_f32 v193, v194, v195
    v_exp_f32 v197, v197
    v_mfma_f32_32x32x4_2b_bf16 v[224:255], v[120:121], v[30:31], 0
    v_exp_f32 v198, v198
    v_exp_f32 v199, v199
    v_cvt_pk_bf16_f32 v194, v196, v197
    v_exp_f32 v200, v200
    v_cvt_pk_bf16_f32 v195, v198, v199
    v_exp_f32 v201, v201
    v_exp_f32 v202, v202
    v_exp_f32 v203, v203
    v_cvt_pk_bf16_f32 v196, v200, v201
    v_exp_f32 v204, v204
    v_cvt_pk_bf16_f32 v197, v202, v203
    v_exp_f32 v205, v205
    v_mfma_f32_32x32x16_bf16 v[52:67], v[128:131], v[192:195], v[52:67]
    ds_write_b128 v80, v[42:45] offset:10240
    v_exp_f32 v206, v206
    v_exp_f32 v207, v207
    v_cvt_pk_bf16_f32 v198, v204, v205
    v_cvt_pk_bf16_f32 v199, v206, v207
    v_exp_f32 v208, v208
    v_exp_f32 v209, v209
    v_mfma_f32_32x32x16_bf16 v[52:67], v[132:135], v[196:199], v[52:67]
    ds_write_b128 v80, v[46:49] offset:11264
    v_exp_f32 v210, v210
    v_exp_f32 v211, v211
    v_cvt_pk_bf16_f32 v208, v208, v209
    v_exp_f32 v212, v212
    v_cvt_pk_bf16_f32 v209, v210, v211
    v_mfma_f32_32x32x16_bf16 v[224:239], v[96:99], v[24:27], v[224:239]
    ds_write_b64 v81, v[50:51] offset:10240
    v_exp_f32 v213, v213
    v_exp_f32 v214, v214
    v_exp_f32 v215, v215
    v_cvt_pk_bf16_f32 v210, v212, v213
    v_exp_f32 v216, v216
    v_cvt_pk_bf16_f32 v211, v214, v215
    v_mfma_f32_32x32x16_bf16 v[240:255], v[100:103], v[24:27], v[240:255]
    ds_add_u32 v84, v3 offset:256
    v_exp_f32 v217, v217
    v_exp_f32 v218, v218
    v_exp_f32 v219, v219
    v_cvt_pk_bf16_f32 v212, v216, v217
    v_exp_f32 v220, v220
    v_cvt_pk_bf16_f32 v213, v218, v219
    v_mfma_f32_32x32x16_bf16 v[52:67], v[136:139], v[208:211], v[52:67]
    v_exp_f32 v221, v221
    v_exp_f32 v222, v222
    v_exp_f32 v223, v223
    v_cvt_pk_bf16_f32 v214, v220, v221
    v_cvt_pk_bf16_f32 v215, v222, v223
    v_exp_f32 v224, v224
    v_exp_f32 v225, v225
    v_mfma_f32_32x32x16_bf16 v[52:67], v[140:143], v[212:215], v[52:67]
    v_exp_f32 v226, v226
    v_exp_f32 v227, v227
    v_cvt_pk_bf16_f32 v224, v224, v225
    v_exp_f32 v228, v228
    v_cvt_pk_bf16_f32 v225, v226, v227
    v_exp_f32 v229, v229
    v_mfma_f32_32x32x4_2b_bf16 v[192:223], v[122:123], v[28:29], 0
    v_exp_f32 v230, v230
    v_exp_f32 v231, v231
    v_cvt_pk_bf16_f32 v226, v228, v229
    v_exp_f32 v232, v232
    v_cvt_pk_bf16_f32 v227, v230, v231
    v_exp_f32 v233, v233
    v_exp_f32 v234, v234
    v_exp_f32 v235, v235
    v_cvt_pk_bf16_f32 v228, v232, v233
    v_exp_f32 v236, v236
    v_cvt_pk_bf16_f32 v229, v234, v235
    v_exp_f32 v237, v237
    v_mfma_f32_32x32x16_bf16 v[52:67], v[144:147], v[224:227], v[52:67]
    v_exp_f32 v238, v238
    v_exp_f32 v239, v239
    v_cvt_pk_bf16_f32 v230, v236, v237
    v_cvt_pk_bf16_f32 v231, v238, v239
    v_exp_f32 v240, v240
    v_exp_f32 v241, v241
    v_mfma_f32_32x32x16_bf16 v[52:67], v[148:151], v[228:231], v[52:67]
    v_exp_f32 v242, v242
    v_exp_f32 v243, v243
    v_cvt_pk_bf16_f32 v240, v240, v241
    v_exp_f32 v244, v244
    v_cvt_pk_bf16_f32 v241, v242, v243
    v_mfma_f32_32x32x16_bf16 v[192:207], v[104:107], v[24:27], v[192:207]
    v_exp_f32 v245, v245
    v_exp_f32 v246, v246
    v_exp_f32 v247, v247
    v_cvt_pk_bf16_f32 v242, v244, v245
    v_exp_f32 v248, v248
    v_cvt_pk_bf16_f32 v243, v246, v247
    v_mfma_f32_32x32x16_bf16 v[208:223], v[108:111], v[24:27], v[208:223]
    v_exp_f32 v249, v249
    v_exp_f32 v250, v250
    v_exp_f32 v251, v251
    v_cvt_pk_bf16_f32 v244, v248, v249
    v_exp_f32 v252, v252
    v_cvt_pk_bf16_f32 v245, v250, v251
    v_mfma_f32_32x32x16_bf16 v[52:67], v[152:155], v[240:243], v[52:67]
    v_exp_f32 v253, v253
    v_exp_f32 v254, v254
    v_exp_f32 v255, v255
    v_cvt_pk_bf16_f32 v246, v252, v253
    v_cvt_pk_bf16_f32 v247, v254, v255
    v_exp_f32 v192, v192
    v_exp_f32 v193, v193
    v_mfma_f32_32x32x16_bf16 v[52:67], v[156:159], v[244:247], v[52:67]
    v_exp_f32 v194, v194
    v_exp_f32 v195, v195
    v_cvt_pk_bf16_f32 v192, v192, v193
    v_exp_f32 v196, v196
    v_cvt_pk_bf16_f32 v193, v194, v195
    v_exp_f32 v197, v197
    v_mfma_f32_32x32x4_2b_bf16 v[224:255], v[122:123], v[30:31], 0
    v_exp_f32 v198, v198
    v_exp_f32 v199, v199
    v_cvt_pk_bf16_f32 v194, v196, v197
    v_exp_f32 v200, v200
    v_cvt_pk_bf16_f32 v195, v198, v199
    v_exp_f32 v201, v201
    v_exp_f32 v202, v202
    v_exp_f32 v203, v203
    v_cvt_pk_bf16_f32 v196, v200, v201
    v_exp_f32 v204, v204
    v_cvt_pk_bf16_f32 v197, v202, v203
    v_exp_f32 v205, v205
    v_mfma_f32_32x32x16_bf16 v[52:67], v[160:163], v[192:195], v[52:67]
    ds_read_b32 v28, v79 offset:4608
    v_exp_f32 v206, v206
    v_exp_f32 v207, v207
    v_cvt_pk_bf16_f32 v198, v204, v205
    v_cvt_pk_bf16_f32 v199, v206, v207
    v_exp_f32 v208, v208
    v_exp_f32 v209, v209
    v_mfma_f32_32x32x16_bf16 v[52:67], v[164:167], v[196:199], v[52:67]
    ds_read_b32 v31, v79 offset:4608
    v_exp_f32 v210, v210
    v_exp_f32 v211, v211
    v_cvt_pk_bf16_f32 v208, v208, v209
    v_exp_f32 v212, v212
    v_cvt_pk_bf16_f32 v209, v210, v211
    v_mfma_f32_32x32x16_bf16 v[224:239], v[112:115], v[24:27], v[224:239]
    v_exp_f32 v213, v213
    v_exp_f32 v214, v214
    v_exp_f32 v215, v215
    v_cvt_pk_bf16_f32 v210, v212, v213
    v_exp_f32 v216, v216
    v_cvt_pk_bf16_f32 v211, v214, v215
    v_mfma_f32_32x32x16_bf16 v[240:255], v[116:119], v[24:27], v[240:255]
    v_exp_f32 v217, v217
    v_exp_f32 v218, v218
    v_exp_f32 v219, v219
    v_cvt_pk_bf16_f32 v212, v216, v217
    v_exp_f32 v220, v220
    v_cvt_pk_bf16_f32 v213, v218, v219
    v_mfma_f32_32x32x16_bf16 v[52:67], v[168:171], v[208:211], v[52:67]
    ds_read_b128 v[24:27], v78 offset:4608
    v_exp_f32 v221, v221
    v_exp_f32 v222, v222
    v_exp_f32 v223, v223
    v_cvt_pk_bf16_f32 v214, v220, v221
    v_cvt_pk_bf16_f32 v215, v222, v223
    v_exp_f32 v224, v224
    v_exp_f32 v225, v225
    v_mfma_f32_32x32x16_bf16 v[52:67], v[172:175], v[212:215], v[52:67]
    s_waitcnt lgkmcnt(2)
    v_exp_f32 v226, v226
    v_exp_f32 v227, v227
    v_cvt_pk_bf16_f32 v224, v224, v225
    v_exp_f32 v228, v228
    v_cvt_pk_bf16_f32 v225, v226, v227
    v_exp_f32 v229, v229
    v_mfma_f32_32x32x4_2b_bf16 v[192:223], v[120:121], v[28:29], 0
    v_exp_f32 v230, v230
    v_exp_f32 v231, v231
    v_cvt_pk_bf16_f32 v226, v228, v229
    v_exp_f32 v232, v232
    v_cvt_pk_bf16_f32 v227, v230, v231
    v_exp_f32 v233, v233
    v_exp_f32 v234, v234
    v_exp_f32 v235, v235
    v_cvt_pk_bf16_f32 v228, v232, v233
    v_exp_f32 v236, v236
    v_cvt_pk_bf16_f32 v229, v234, v235
    v_exp_f32 v237, v237
    v_mfma_f32_32x32x16_bf16 v[52:67], v[176:179], v[224:227], v[52:67]
    v_exp_f32 v238, v238
    v_exp_f32 v239, v239
    v_cvt_pk_bf16_f32 v230, v236, v237
    v_cvt_pk_bf16_f32 v231, v238, v239
    v_exp_f32 v240, v240
    v_exp_f32 v241, v241
    v_mfma_f32_32x32x16_bf16 v[52:67], v[180:183], v[228:231], v[52:67]
    s_waitcnt lgkmcnt(0)
    v_exp_f32 v242, v242
    v_exp_f32 v243, v243
    v_cvt_pk_bf16_f32 v240, v240, v241
    v_exp_f32 v244, v244
    v_cvt_pk_bf16_f32 v241, v242, v243
    v_mfma_f32_32x32x16_bf16 v[192:207], v[88:91], v[24:27], v[192:207]
    v_exp_f32 v245, v245
    v_exp_f32 v246, v246
    v_exp_f32 v247, v247
    v_cvt_pk_bf16_f32 v242, v244, v245
    v_exp_f32 v248, v248
    v_cvt_pk_bf16_f32 v243, v246, v247
    v_mfma_f32_32x32x16_bf16 v[208:223], v[92:95], v[24:27], v[208:223]
    v_exp_f32 v249, v249
    v_exp_f32 v250, v250
    v_exp_f32 v251, v251
    v_cvt_pk_bf16_f32 v244, v248, v249
    v_exp_f32 v252, v252
    v_cvt_pk_bf16_f32 v245, v250, v251
    v_mfma_f32_32x32x16_bf16 v[52:67], v[184:187], v[240:243], v[52:67]
    v_exp_f32 v253, v253
    v_exp_f32 v254, v254
    v_exp_f32 v255, v255
    v_cvt_pk_bf16_f32 v246, v252, v253
    v_cvt_pk_bf16_f32 v247, v254, v255
    v_exp_f32 v192, v192
    v_exp_f32 v193, v193
    v_mfma_f32_32x32x16_bf16 v[52:67], v[188:191], v[244:247], v[52:67]
    v_exp_f32 v194, v194
    v_exp_f32 v195, v195
    v_cvt_pk_bf16_f32 v192, v192, v193
    v_exp_f32 v196, v196
    v_cvt_pk_bf16_f32 v193, v194, v195
    v_exp_f32 v197, v197
    v_mfma_f32_32x32x4_2b_bf16 v[224:255], v[120:121], v[30:31], 0
    v_exp_f32 v198, v198
    v_exp_f32 v199, v199
    v_cvt_pk_bf16_f32 v194, v196, v197
    v_exp_f32 v200, v200
    v_cvt_pk_bf16_f32 v195, v198, v199
    v_exp_f32 v201, v201
    v_exp_f32 v202, v202
    v_exp_f32 v203, v203
    v_cvt_pk_bf16_f32 v196, v200, v201
    v_exp_f32 v204, v204
    v_cvt_pk_bf16_f32 v197, v202, v203
    v_exp_f32 v205, v205
    v_mfma_f32_32x32x16_bf16 v[62:77], v[128:131], v[192:195], v[62:77]
    ds_write_b128 v80, v[52:55] offset:20480
    v_exp_f32 v206, v206
    v_exp_f32 v207, v207
    v_cvt_pk_bf16_f32 v198, v204, v205
    v_cvt_pk_bf16_f32 v199, v206, v207
    v_exp_f32 v208, v208
    v_exp_f32 v209, v209
    v_mfma_f32_32x32x16_bf16 v[62:77], v[132:135], v[196:199], v[62:77]
    ds_write_b128 v80, v[56:59] offset:21504
    v_exp_f32 v210, v210
    v_exp_f32 v211, v211
    v_cvt_pk_bf16_f32 v208, v208, v209
    v_exp_f32 v212, v212
    v_cvt_pk_bf16_f32 v209, v210, v211
    v_mfma_f32_32x32x16_bf16 v[224:239], v[96:99], v[24:27], v[224:239]
    ds_write_b64 v81, v[60:61] offset:20480
    v_exp_f32 v213, v213
    v_exp_f32 v214, v214
    v_exp_f32 v215, v215
    v_cvt_pk_bf16_f32 v210, v212, v213
    v_exp_f32 v216, v216
    v_cvt_pk_bf16_f32 v211, v214, v215
    v_mfma_f32_32x32x16_bf16 v[240:255], v[100:103], v[24:27], v[240:255]
    ds_add_u32 v84, v3 offset:512
    v_exp_f32 v217, v217
    v_exp_f32 v218, v218
    v_exp_f32 v219, v219
    v_cvt_pk_bf16_f32 v212, v216, v217
    v_exp_f32 v220, v220
    v_cvt_pk_bf16_f32 v213, v218, v219
    v_mfma_f32_32x32x16_bf16 v[62:77], v[136:139], v[208:211], v[62:77]
    v_exp_f32 v221, v221
    v_exp_f32 v222, v222
    v_exp_f32 v223, v223
    v_cvt_pk_bf16_f32 v214, v220, v221
    v_cvt_pk_bf16_f32 v215, v222, v223
    v_exp_f32 v224, v224
    v_exp_f32 v225, v225
    v_mfma_f32_32x32x16_bf16 v[62:77], v[140:143], v[212:215], v[62:77]
    v_exp_f32 v226, v226
    v_exp_f32 v227, v227
    v_cvt_pk_bf16_f32 v224, v224, v225
    v_exp_f32 v228, v228
    v_cvt_pk_bf16_f32 v225, v226, v227
    v_exp_f32 v229, v229
    v_mfma_f32_32x32x4_2b_bf16 v[192:223], v[122:123], v[28:29], 0
    v_exp_f32 v230, v230
    v_exp_f32 v231, v231
    v_cvt_pk_bf16_f32 v226, v228, v229
    v_exp_f32 v232, v232
    v_cvt_pk_bf16_f32 v227, v230, v231
    v_exp_f32 v233, v233
    v_exp_f32 v234, v234
    v_exp_f32 v235, v235
    v_cvt_pk_bf16_f32 v228, v232, v233
    v_exp_f32 v236, v236
    v_cvt_pk_bf16_f32 v229, v234, v235
    v_exp_f32 v237, v237
    v_mfma_f32_32x32x16_bf16 v[62:77], v[144:147], v[224:227], v[62:77]
    v_exp_f32 v238, v238
    v_exp_f32 v239, v239
    v_cvt_pk_bf16_f32 v230, v236, v237
    v_cvt_pk_bf16_f32 v231, v238, v239
    v_exp_f32 v240, v240
    v_exp_f32 v241, v241
    v_mfma_f32_32x32x16_bf16 v[62:77], v[148:151], v[228:231], v[62:77]
    v_exp_f32 v242, v242
    v_exp_f32 v243, v243
    v_cvt_pk_bf16_f32 v240, v240, v241
    v_exp_f32 v244, v244
    v_cvt_pk_bf16_f32 v241, v242, v243
    v_mfma_f32_32x32x16_bf16 v[192:207], v[104:107], v[24:27], v[192:207]
    v_exp_f32 v245, v245
    v_exp_f32 v246, v246
    v_exp_f32 v247, v247
    v_cvt_pk_bf16_f32 v242, v244, v245
    v_exp_f32 v248, v248
    v_cvt_pk_bf16_f32 v243, v246, v247
    v_mfma_f32_32x32x16_bf16 v[208:223], v[108:111], v[24:27], v[208:223]
    v_exp_f32 v249, v249
    v_exp_f32 v250, v250
    v_exp_f32 v251, v251
    v_cvt_pk_bf16_f32 v244, v248, v249
    v_exp_f32 v252, v252
    v_cvt_pk_bf16_f32 v245, v250, v251
    v_mfma_f32_32x32x16_bf16 v[62:77], v[152:155], v[240:243], v[62:77]
    v_exp_f32 v253, v253
    v_exp_f32 v254, v254
    v_exp_f32 v255, v255
    v_cvt_pk_bf16_f32 v246, v252, v253
    v_cvt_pk_bf16_f32 v247, v254, v255
    v_exp_f32 v192, v192
    v_exp_f32 v193, v193
    v_mfma_f32_32x32x16_bf16 v[62:77], v[156:159], v[244:247], v[62:77]
    v_exp_f32 v194, v194
    v_exp_f32 v195, v195
    v_cvt_pk_bf16_f32 v192, v192, v193
    v_exp_f32 v196, v196
    v_cvt_pk_bf16_f32 v193, v194, v195
    v_exp_f32 v197, v197
    v_mfma_f32_32x32x4_2b_bf16 v[224:255], v[122:123], v[30:31], 0
    v_exp_f32 v198, v198
    v_exp_f32 v199, v199
    v_cvt_pk_bf16_f32 v194, v196, v197
    v_exp_f32 v200, v200
    v_cvt_pk_bf16_f32 v195, v198, v199
    v_exp_f32 v201, v201
    v_exp_f32 v202, v202
    v_exp_f32 v203, v203
    v_cvt_pk_bf16_f32 v196, v200, v201
    v_exp_f32 v204, v204
    v_cvt_pk_bf16_f32 v197, v202, v203
    v_exp_f32 v205, v205
    v_mfma_f32_32x32x16_bf16 v[62:77], v[160:163], v[192:195], v[62:77]
    v_exp_f32 v206, v206
    v_exp_f32 v207, v207
    v_cvt_pk_bf16_f32 v198, v204, v205
    v_cvt_pk_bf16_f32 v199, v206, v207
    v_exp_f32 v208, v208
    v_exp_f32 v209, v209
    v_mfma_f32_32x32x16_bf16 v[62:77], v[164:167], v[196:199], v[62:77]
    v_exp_f32 v210, v210
    v_exp_f32 v211, v211
    v_cvt_pk_bf16_f32 v208, v208, v209
    v_exp_f32 v212, v212
    v_cvt_pk_bf16_f32 v209, v210, v211
    v_mfma_f32_32x32x16_bf16 v[224:239], v[112:115], v[24:27], v[224:239]
    v_exp_f32 v213, v213
    v_exp_f32 v214, v214
    v_exp_f32 v215, v215
    v_cvt_pk_bf16_f32 v210, v212, v213
    v_exp_f32 v216, v216
    v_cvt_pk_bf16_f32 v211, v214, v215
    v_mfma_f32_32x32x16_bf16 v[240:255], v[116:119], v[24:27], v[240:255]
    v_exp_f32 v217, v217
    v_exp_f32 v218, v218
    v_exp_f32 v219, v219
    v_cvt_pk_bf16_f32 v212, v216, v217
    v_exp_f32 v220, v220
    v_cvt_pk_bf16_f32 v213, v218, v219
    v_mfma_f32_32x32x16_bf16 v[62:77], v[168:171], v[208:211], v[62:77]
    v_exp_f32 v221, v221
    v_exp_f32 v222, v222
    v_exp_f32 v223, v223
    v_cvt_pk_bf16_f32 v214, v220, v221
    v_cvt_pk_bf16_f32 v215, v222, v223
    v_exp_f32 v224, v224
    v_exp_f32 v225, v225
    v_mfma_f32_32x32x16_bf16 v[62:77], v[172:175], v[212:215], v[62:77]
    v_exp_f32 v226, v226
    v_exp_f32 v227, v227
    v_cvt_pk_bf16_f32 v224, v224, v225
    v_exp_f32 v228, v228
    v_cvt_pk_bf16_f32 v225, v226, v227
    v_exp_f32 v229, v229
    v_exp_f32 v230, v230
    v_exp_f32 v231, v231
    v_cvt_pk_bf16_f32 v226, v228, v229
    v_exp_f32 v232, v232
    v_cvt_pk_bf16_f32 v227, v230, v231
    v_exp_f32 v233, v233
    v_exp_f32 v234, v234
    v_exp_f32 v235, v235
    v_cvt_pk_bf16_f32 v228, v232, v233
    v_exp_f32 v236, v236
    v_cvt_pk_bf16_f32 v229, v234, v235
    v_exp_f32 v237, v237
    v_mfma_f32_32x32x16_bf16 v[62:77], v[176:179], v[224:227], v[62:77]
    v_exp_f32 v238, v238
    v_exp_f32 v239, v239
    v_cvt_pk_bf16_f32 v230, v236, v237
    v_cvt_pk_bf16_f32 v231, v238, v239
    v_exp_f32 v240, v240
    v_exp_f32 v241, v241
    v_mfma_f32_32x32x16_bf16 v[62:77], v[180:183], v[228:231], v[62:77]
    v_exp_f32 v242, v242
    v_exp_f32 v243, v243
    v_cvt_pk_bf16_f32 v240, v240, v241
    v_exp_f32 v244, v244
    v_cvt_pk_bf16_f32 v241, v242, v243
    v_exp_f32 v245, v245
    v_exp_f32 v246, v246
    v_exp_f32 v247, v247
    v_cvt_pk_bf16_f32 v242, v244, v245
    v_exp_f32 v248, v248
    v_cvt_pk_bf16_f32 v243, v246, v247
    v_exp_f32 v249, v249
    v_exp_f32 v250, v250
    v_exp_f32 v251, v251
    v_cvt_pk_bf16_f32 v244, v248, v249
    v_exp_f32 v252, v252
    v_cvt_pk_bf16_f32 v245, v250, v251
    v_mfma_f32_32x32x16_bf16 v[62:77], v[184:187], v[240:243], v[62:77]
    v_exp_f32 v253, v253
    v_exp_f32 v254, v254
    v_exp_f32 v255, v255
    v_cvt_pk_bf16_f32 v246, v252, v253
    v_cvt_pk_bf16_f32 v247, v254, v255
    s_nop 0
    s_nop 0
    v_mfma_f32_32x32x16_bf16 v[62:77], v[188:191], v[244:247], v[62:77]
    v_lshlrev_b32 v5, 4, v0
    v_and_b32 v23, 31, v0
    v_add_u32 v20, 87040, v5
    v_lshlrev_b32 v21, 3, v0
    v_add_u32 v21, 89088, v21
    v_lshlrev_b32 v22, 3, v23
    v_add_u32 v22, 89344, v22
    v_lshl_add_u32 v23, v23, 2, v2
    ds_read_b32 v4, v23 offset:2432
    s_mul_i32 s94, s69, 73728
    s_add_u32 s94, s94, 8388608
    s_lshl_b32 s96, s70, 10
    s_add_u32 s96, s96, s94
    s_lshr_b32 s97, s70, 2
    s_lshl_b32 s97, s97, 9
    s_and_b32 s73, s70, 3
    s_lshl_b32 s73, s73, 2
    s_add_u32 s97, s97, s73
    s_add_u32 s97, s97, s94
    s_add_u32 s97, s97, 8192
    ds_write_b128 v80, v[62:65] offset:30720
    ds_write_b128 v80, v[66:69] offset:31744
    ds_write_b64 v81, v[70:71] offset:30720
    ds_add_rtn_u32 v1, v84, v3 offset:768
    s_cmp_ge_u32 s68, 4
    s_cbranch_scc1 L_last
    s_cmp_eq_u32 s68, 1
    s_cbranch_scc1 TL_37
    s_cmp_eq_u32 s68, 2
    s_cbranch_scc1 TL_38
    s_cmp_eq_u32 s68, 3
    s_cbranch_scc1 TL_39
TL_36:
    s_setprio 2
    ds_read_b32 v4, v23 offset:2432
    ds_read_b32 v45, v23 offset:2304
    v_and_b32 v7, 15, v0
    v_lshl_add_u32 v7, v7, 2, v2
    ds_read_b32 v46, v7 offset:2304
    v_add_u32 v7, 36864, v16
    v_add_u32 v8, 36864, v17
    s_waitcnt lgkmcnt(0)
    v_sub_f32 v4, 1.0, v4
LW_40:
    ds_read_b32 v1, v2 offset:256
    s_waitcnt lgkmcnt(0)
    v_readfirstlane_b32 s73, v1
    s_cmp_ge_u32 s73, 4
    s_cbranch_scc1 LWD_41
    s_sleep 4
    s_sub_u32 s72, s72, 1
    s_cbranch_scc0 LW_40
    s_branch L_bail
LWD_41:
    ds_read_b128 v[192:195], v20 offset:10240
    ds_read_b128 v[196:199], v20 offset:11264
    ds_read_b64 v[200:201], v21 offset:10240
    ds_read_b32 v202, v22 offset:10240
    ds_read_b128 v[204:207], v20 offset:12800
    ds_read_b128 v[208:211], v20 offset:13824
    ds_read_b64 v[212:213], v21 offset:12800
    ds_read_b32 v214, v22 offset:12800
    s_add_u32 s90, s96, 9216
    s_add_u32 s91, s97, 9216
    s_movk_i32 s89, 1
    ds_read_b128 v[216:219], v20 offset:15360
    ds_read_b128 v[220:223], v20 offset:16384
    ds_read_b64 v[224:225], v21 offset:15360
    ds_read_b32 v226, v22 offset:15360
    s_waitcnt lgkmcnt(4)
    ds_read_b128 v[228:231], v20 offset:17920
    ds_read_b128 v[232:235], v20 offset:18944
    ds_read_b64 v[236:237], v21 offset:17920
    ds_read_b32 v238, v22 offset:17920
    v_pk_add_f32 v[192:193], v[192:193], v[204:205]
    v_pk_add_f32 v[194:195], v[194:195], v[206:207]
    v_pk_add_f32 v[196:197], v[196:197], v[208:209]
    v_pk_add_f32 v[198:199], v[198:199], v[210:211]
    v_pk_add_f32 v[200:201], v[200:201], v[212:213]
    v_add_f32 v202, v202, v214
    s_waitcnt lgkmcnt(4)
    v_pk_add_f32 v[192:193], v[192:193], v[216:217]
    v_pk_add_f32 v[194:195], v[194:195], v[218:219]
    v_pk_add_f32 v[196:197], v[196:197], v[220:221]
    v_pk_add_f32 v[198:199], v[198:199], v[222:223]
    v_pk_add_f32 v[200:201], v[200:201], v[224:225]
    v_add_f32 v202, v202, v226
    s_waitcnt lgkmcnt(0)
    v_pk_add_f32 v[192:193], v[192:193], v[228:229]
    v_pk_add_f32 v[194:195], v[194:195], v[230:231]
    v_pk_add_f32 v[196:197], v[196:197], v[232:233]
    v_pk_add_f32 v[198:199], v[198:199], v[234:235]
    v_pk_add_f32 v[200:201], v[200:201], v[236:237]
    v_add_f32 v202, v202, v238
LW_42:
    ds_read_b32 v1, v2 offset:2112
    s_waitcnt lgkmcnt(0)
    v_readfirstlane_b32 s73, v1
    s_cmp_ge_u32 s73, 1
    s_cbranch_scc1 LWD_43
    s_sleep 2
    s_sub_u32 s72, s72, 1
    s_cbranch_scc0 LW_42
    s_branch L_bail
LWD_43:
    s_mov_b64 exec, 1
    ds_add_u32 v2, v3 offset:2096
    s_mov_b64 exec, -1
    v_pk_mul_f32 v[204:205], v[192:193], 0 op_sel_hi:[1,0]
    v_pk_fma_f32 v[204:205], v[194:195], 0, v[204:205] op_sel_hi:[1,0,1]
    v_pk_fma_f32 v[204:205], v[196:197], 0, v[204:205] op_sel_hi:[1,0,1]
    v_pk_fma_f32 v[204:205], v[198:199], 0, v[204:205] op_sel_hi:[1,0,1]
    v_pk_fma_f32 v[204:205], v[200:201], 0, v[204:205] op_sel_hi:[1,0,1]
    v_add_f32 v204, v204, v205
    v_subrev_u32 v205, 0x21800000, v202
    v_cmp_u_f32 vcc, v204, v204
    s_mov_b32 s73, 0x3e000000
    v_cmp_lt_u32 s[74:75], s73, v205
    s_or_b64 vcc, vcc, s[74:75]
    s_cmp_eq_u64 vcc, 0
    s_cbranch_scc1 SOK_44
    s_call_b64 s[86:87], L_fallback
SOK_44:
    v_rcp_f32 v202, v202
    s_nop 0
    v_mul_f32 v202, v4, v202
    v_pk_mul_f32 v[192:193], v[192:193], v[202:203] op_sel_hi:[1,0]
    v_pk_mul_f32 v[194:195], v[194:195], v[202:203] op_sel_hi:[1,0]
    v_pk_mul_f32 v[196:197], v[196:197], v[202:203] op_sel_hi:[1,0]
    v_pk_mul_f32 v[198:199], v[198:199], v[202:203] op_sel_hi:[1,0]
    v_pk_mul_f32 v[200:201], v[200:201], v[202:203] op_sel_hi:[1,0]
    v_cvt_pk_bf16_f32 v204, v192, v193
    v_cvt_pk_bf16_f32 v205, v194, v195
    v_cvt_pk_bf16_f32 v206, v196, v197
    v_cvt_pk_bf16_f32 v207, v198, v199
    v_cvt_pk_bf16_f32 v208, v200, v201
    v_min_u32 v204, -2, v204
    v_min_u32 v208, -2, v208
    buffer_store_dwordx4 v[204:207], v5, s[44:47], s90 offen sc1
    s_mov_b32 exec_hi, 0
    buffer_store_dword v208, v5, s[44:47], s91 offen sc1
    s_mov_b64 exec, -1
    s_mov_b32 s48, s18
    s_mov_b32 s49, s19
    s_mov_b32 s50, 663552
    s_mov_b32 s51, 0x20000
    v_lshrrev_b32 v48, 2, v0
    v_mul_u32_u24 v48, 1152, v48
    v_and_b32 v49, 3, v0
    v_lshl_add_u32 v48, v49, 4, v48
    v_mul_u32_u24 v49, 1152, v0
    s_and_b32 s73, s68, 1
    s_mul_i32 s84, s73, 18432
    s_add_u32 s84, s84, s95
    s_lshl_b32 s85, s73, 10
    s_mul_i32 s93, s70, 110592
    s_add_u32 s98, s93, 1122304
    s_add_u32 s93, s93, 1048576
LW_45:
    ds_read_b32 v1, v2 offset:2076
    s_waitcnt lgkmcnt(0)
    v_readfirstlane_b32 s73, v1
    s_cmp_ge_u32 s73, 8
    s_cbranch_scc1 LWD_46
    s_sleep 3
    s_sub_u32 s72, s72, 1
    s_cbranch_scc0 LW_45
    s_branch L_bail
LWD_46:
    s_lshr_b32 s73, s69, 3
    s_mul_i32 s82, s73, 8192
    s_add_u32 s85, s85, s82
    s_mul_i32 s82, s73, 147456
    s_add_u32 s84, s84, s82
    s_mov_b32 s88, 17
PNL_47:
    s_add_u32 m0, s85, 0
    s_add_u32 s83, s84, 128
    buffer_load_dwordx4 v48, s[48:51], s84 offen lds
    s_add_u32 m0, s85, 36800
    s_lshr_b32 s82, s85, 2
    buffer_load_dwordx4 v48, s[48:51], s84 offen offset:64 lds
    s_add_u32 m0, s82, 128000
    s_mov_b64 exec, 0xffff
    buffer_load_dwordx4 v49, s[48:51], s83 offen lds
    s_mov_b64 exec, -1
    s_add_u32 s85, s85, 2048
    s_add_u32 s84, s84, 36864
    s_cmp_lt_u32 s85, 36864
    s_cselect_b32 s82, 0, 36864
    s_cselect_b32 s83, 0, 663552
    s_sub_u32 s85, s85, s82
    s_sub_u32 s84, s84, s83
    s_sub_u32 s88, s88, 1
    s_cbranch_scc0 PNL_47
    buffer_load_dwordx4 v[192:195], v5, s[44:47], s93 offen offset:0 sc1
    buffer_load_dwordx4 v[196:199], v5, s[44:47], s93 offen offset:1024 sc1
    buffer_load_dwordx4 v[224:227], v14, s[44:47], s98 offen offset:0 sc1
    buffer_load_dwordx4 v[200:203], v5, s[44:47], s93 offen offset:2048 sc1
    buffer_load_dwordx4 v[204:207], v5, s[44:47], s93 offen offset:3072 sc1
    s_add_u32 s93, s93, 4096
    buffer_load_dwordx4 v[228:231], v14, s[44:47], s98 offen offset:2048 sc1
    s_add_u32 s98, s98, 4096
    buffer_load_dwordx4 v[208:211], v5, s[44:47], s93 offen offset:0 sc1
    buffer_load_dwordx4 v[212:215], v5, s[44:47], s93 offen offset:1024 sc1
    buffer_load_dwordx4 v[232:235], v14, s[44:47], s98 offen offset:0 sc1
    buffer_load_dwordx4 v[216:219], v5, s[44:47], s93 offen offset:2048 sc1
    buffer_load_dwordx4 v[220:223], v5, s[44:47], s93 offen offset:3072 sc1
    s_add_u32 s93, s93, 4096
    v_lshlrev_b32 v236, 7, v0
    v_min_u32 v237, 896, v236
    s_mov_b32 s99, 393216
    s_mov_b32 s92, 401408
    s_mov_b32 s88, 402432
    buffer_load_dwordx4 v[238:241], v236, s[44:47], s99 offen sc1
    buffer_load_dwordx4 v[242:245], v237, s[44:47], s92 offen sc1
    buffer_load_dword v246, off, s[44:47], s88 sc1
    s_waitcnt vmcnt(14)
    s_mov_b64 exec, 1
    ds_add_u32 v2, v3 offset:2092
    s_mov_b64 exec, -1
LW_48:
    ds_read_b32 v1, v2 offset:2092
    s_waitcnt lgkmcnt(0)
    v_readfirstlane_b32 s73, v1
    s_cmp_ge_u32 s73, 2
    s_cbranch_scc1 LWD_49
    s_sleep 1
    s_sub_u32 s72, s72, 1
    s_cbranch_scc0 LW_48
    s_branch L_bail
LWD_49:
    ds_read_b64_tr_b16 v[48:49], v6 offset:0
    ds_read_b64_tr_b16 v[50:51], v6 offset:512
    ds_read_b64_tr_b16 v[52:53], v6 offset:4608
    ds_read_b64_tr_b16 v[54:55], v6 offset:5120
    ds_read_b64_tr_b16 v[56:57], v6 offset:9216
    ds_read_b64_tr_b16 v[58:59], v6 offset:9728
    s_waitcnt lgkmcnt(6)
    ds_read_b64_tr_b16 v[60:61], v6 offset:13824
    ds_read_b64_tr_b16 v[62:63], v6 offset:14336
    ds_read_b64_tr_b16 v[64:65], v6 offset:18432
    ds_read_b64_tr_b16 v[66:67], v6 offset:18944
    ds_read_b64_tr_b16 v[68:69], v6 offset:23040
    ds_read_b64_tr_b16 v[70:71], v6 offset:23552
    s_waitcnt lgkmcnt(6)
    ds_read_b64_tr_b16 v[72:73], v6 offset:27648
    ds_read_b64_tr_b16 v[74:75], v6 offset:28160
    ds_read_b64_tr_b16 v[76:77], v6 offset:32256
    ds_read_b64_tr_b16 v[78:79], v6 offset:32768
    ds_read_b64_tr_b16 v[80:81], v9 offset:0
    ds_read_b64_tr_b16 v[82:83], v9 offset:9216
    s_waitcnt lgkmcnt(6)
    ds_read_b64_tr_b16 v[84:85], v6 offset:1152
    ds_read_b64_tr_b16 v[86:87], v6 offset:1664
    ds_read_b64_tr_b16 v[88:89], v6 offset:5760
    ds_read_b64_tr_b16 v[90:91], v6 offset:6272
    ds_read_b64_tr_b16 v[92:93], v6 offset:10368
    ds_read_b64_tr_b16 v[94:95], v6 offset:10880
    s_waitcnt lgkmcnt(6)
    ds_read_b64_tr_b16 v[96:97], v6 offset:14976
    ds_read_b64_tr_b16 v[98:99], v6 offset:15488
    ds_read_b64_tr_b16 v[100:101], v6 offset:19584
    ds_read_b64_tr_b16 v[102:103], v6 offset:20096
    ds_read_b64_tr_b16 v[104:105], v6 offset:24192
    ds_read_b64_tr_b16 v[106:107], v6 offset:24704
    s_waitcnt lgkmcnt(6)
    ds_read_b64_tr_b16 v[108:109], v6 offset:28800
    ds_read_b64_tr_b16 v[110:111], v6 offset:29312
    ds_read_b64_tr_b16 v[112:113], v6 offset:33408
    ds_read_b64_tr_b16 v[114:115], v6 offset:33920
    ds_read_b64_tr_b16 v[116:117], v9 offset:1152
    ds_read_b64_tr_b16 v[118:119], v9 offset:10368
    s_waitcnt lgkmcnt(6)
    ds_read_b64_tr_b16 v[120:121], v6 offset:2304
    ds_read_b64_tr_b16 v[122:123], v6 offset:2816
    ds_read_b64_tr_b16 v[124:125], v6 offset:6912
    ds_read_b64_tr_b16 v[126:127], v6 offset:7424
    ds_read_b64_tr_b16 v[128:129], v6 offset:11520
    ds_read_b64_tr_b16 v[130:131], v6 offset:12032
    s_waitcnt lgkmcnt(6)
    ds_read_b64_tr_b16 v[132:133], v6 offset:16128
    ds_read_b64_tr_b16 v[134:135], v6 offset:16640
    ds_read_b64_tr_b16 v[136:137], v6 offset:20736
    ds_read_b64_tr_b16 v[138:139], v6 offset:21248
    ds_read_b64_tr_b16 v[140:141], v6 offset:25344
    ds_read_b64_tr_b16 v[142:143], v6 offset:25856
    s_waitcnt lgkmcnt(6)
    ds_read_b64_tr_b16 v[144:145], v6 offset:29952
    ds_read_b64_tr_b16 v[146:147], v6 offset:30464
    ds_read_b64_tr_b16 v[148:149], v6 offset:34560
    ds_read_b64_tr_b16 v[150:151], v6 offset:35072
    ds_read_b64_tr_b16 v[152:153], v9 offset:2304
    ds_read_b64_tr_b16 v[154:155], v9 offset:11520
    s_waitcnt lgkmcnt(6)
    ds_read_b64_tr_b16 v[156:157], v6 offset:3456
    ds_read_b64_tr_b16 v[158:159], v6 offset:3968
    ds_read_b64_tr_b16 v[160:161], v6 offset:8064
    ds_read_b64_tr_b16 v[162:163], v6 offset:8576
    ds_read_b64_tr_b16 v[164:165], v6 offset:12672
    ds_read_b64_tr_b16 v[166:167], v6 offset:13184
    s_waitcnt lgkmcnt(6)
    ds_read_b64_tr_b16 v[168:169], v6 offset:17280
    ds_read_b64_tr_b16 v[170:171], v6 offset:17792
    ds_read_b64_tr_b16 v[172:173], v6 offset:21888
    ds_read_b64_tr_b16 v[174:175], v6 offset:22400
    ds_read_b64_tr_b16 v[176:177], v6 offset:26496
    ds_read_b64_tr_b16 v[178:179], v6 offset:27008
    s_waitcnt lgkmcnt(6)
    ds_read_b64_tr_b16 v[180:181], v6 offset:31104
    ds_read_b64_tr_b16 v[182:183], v6 offset:31616
    ds_read_b64_tr_b16 v[184:185], v6 offset:35712
    ds_read_b64_tr_b16 v[186:187], v6 offset:36224
    ds_read_b64_tr_b16 v[188:189], v9 offset:3456
    ds_read_b64_tr_b16 v[190:191], v9 offset:12672
    s_waitcnt lgkmcnt(6)
    s_waitcnt lgkmcnt(0)
    s_mov_b64 exec, 1
    ds_add_u32 v2, v3 offset:2088
    s_mov_b64 exec, -1
    s_waitcnt vmcnt(0)
    v_cmp_ne_u32 vcc, s71, v238
    v_cmp_ne_u32 s[74:75], s71, v239
    s_or_b64 vcc, vcc, s[74:75]
    v_cmp_ne_u32 s[74:75], s71, v240
    s_or_b64 vcc, vcc, s[74:75]
    v_cmp_ne_u32 s[74:75], s71, v241
    s_or_b64 vcc, vcc, s[74:75]
    v_cmp_ne_u32 s[74:75], s71, v242
    s_or_b64 vcc, vcc, s[74:75]
    v_cmp_ne_u32 s[74:75], s71, v243
    s_or_b64 vcc, vcc, s[74:75]
    v_cmp_ne_u32 s[74:75], s71, v244
    s_or_b64 vcc, vcc, s[74:75]
    v_cmp_ne_u32 s[74:75], s71, v245
    s_or_b64 vcc, vcc, s[74:75]
    v_cmp_ne_u32 s[74:75], s71, v246
    s_or_b64 vcc, vcc, s[74:75]
    s_cmp_eq_u64 vcc, 0
    s_cbranch_scc1 YOK_50
PL_51:
    buffer_load_dwordx4 v[238:241], v236, s[44:47], s99 offen sc1
    buffer_load_dwordx4 v[242:245], v237, s[44:47], s92 offen sc1
    buffer_load_dword v246, off, s[44:47], s88 sc1
    s_waitcnt vmcnt(0)
    v_cmp_ne_u32 vcc, s71, v238
    v_cmp_ne_u32 s[74:75], s71, v239
    s_or_b64 vcc, vcc, s[74:75]
    v_cmp_ne_u32 s[74:75], s71, v240
    s_or_b64 vcc, vcc, s[74:75]
    v_cmp_ne_u32 s[74:75], s71, v241
    s_or_b64 vcc, vcc, s[74:75]
    v_cmp_ne_u32 s[74:75], s71, v242
    s_or_b64 vcc, vcc, s[74:75]
    v_cmp_ne_u32 s[74:75], s71, v243
    s_or_b64 vcc, vcc, s[74:75]
    v_cmp_ne_u32 s[74:75], s71, v244
    s_or_b64 vcc, vcc, s[74:75]
    v_cmp_ne_u32 s[74:75], s71, v245
    s_or_b64 vcc, vcc, s[74:75]
    v_cmp_ne_u32 s[74:75], s71, v246
    s_or_b64 vcc, vcc, s[74:75]
    s_cmp_eq_u64 vcc, 0
    s_cbranch_scc1 PD_52
    s_sleep 12
    s_sub_u32 s72, s72, 1
    s_cbranch_scc0 PL_51
    s_branch L_bail
PD_52:
YOK_50:
    s_mov_b64 exec, 1
    ds_add_u32 v2, v3 offset:2080
    s_mov_b64 exec, -1
    s_cmp_lg_u32 s2, 0
    s_cbranch_scc1 NE_53
    v_mov_b32 v1, s71
    s_mov_b64 exec, 1
    buffer_store_dword v1, off, s[44:47], 0 sc1
    s_mov_b64 exec, -1
NE_53:
LW_54:
    ds_read_b32 v1, v2 offset:2088
    s_waitcnt lgkmcnt(0)
    v_readfirstlane_b32 s73, v1
    s_cmp_ge_u32 s73, 4
    s_cbranch_scc1 LWD_55
    s_sleep 1
    s_sub_u32 s72, s72, 1
    s_cbranch_scc0 LW_54
    s_branch L_bail
LWD_55:
    s_lshl_b32 s99, s69, 7
    s_add_u32 s99, s99, 5242880
    s_mov_b32 s92, 0
    s_mov_b32 s88, 5
YL_56:
    s_mov_b32 m0, s92
    s_add_u32 s92, s92, 2048
    buffer_load_dwordx4 v15, s[44:47], s99 offen sc1 lds
    s_add_u32 s99, s99, 67584
    s_mov_b32 m0, s92
    s_add_u32 s92, s92, 2048
    buffer_load_dwordx4 v15, s[44:47], s99 offen sc1 lds
    s_add_u32 s99, s99, 67584
    s_mov_b32 m0, s92
    s_add_u32 s92, s92, 2048
    buffer_load_dwordx4 v15, s[44:47], s99 offen sc1 lds
    s_add_u32 s99, s99, 67584
    s_mov_b32 m0, s92
    s_add_u32 s92, s92, 2048
    buffer_load_dwordx4 v15, s[44:47], s99 offen sc1 lds
    s_add_u32 s99, s99, 67584
    s_mov_b32 m0, s92
    s_add_u32 s92, s92, 2048
    buffer_load_dwordx4 v15, s[44:47], s99 offen sc1 lds
    s_add_u32 s99, s99, 67584
    s_mov_b32 m0, s92
    s_add_u32 s92, s92, 2048
    buffer_load_dwordx4 v15, s[44:47], s99 offen sc1 lds
    s_add_u32 s99, s99, 67584
    s_sub_u32 s88, s88, 1
    s_cbranch_scc0 YL_56
    s_waitcnt vmcnt(18)
    s_mov_b64 exec, 1
    ds_add_u32 v2, v3 offset:2084
    s_mov_b64 exec, -1
LW_57:
    ds_read_b32 v1, v2 offset:2084
    s_waitcnt lgkmcnt(0)
    v_readfirstlane_b32 s73, v1
    s_cmp_ge_u32 s73, 2
    s_cbranch_scc1 LWD_58
    s_sleep 1
    s_sub_u32 s72, s72, 1
    s_cbranch_scc0 LW_57
    s_branch L_bail
LWD_58:
    ds_read_b64_tr_b16 v[236:237], v16 offset:0
    ds_read_b64_tr_b16 v[238:239], v16 offset:512
    ds_read_b64_tr_b16 v[240:241], v16 offset:2048
    ds_read_b64_tr_b16 v[242:243], v16 offset:2560
    ds_read_b64_tr_b16 v[248:249], v17 offset:0
    ds_read_b64_tr_b16 v[250:251], v17 offset:512
    s_waitcnt lgkmcnt(4)
    v_mfma_f32_32x32x16_bf16 v[24:39], v[192:195], v[236:239], 0
    buffer_load_dwordx4 v[192:195], v5, s[44:47], s93 offen offset:0 sc1
    ds_read_b64_tr_b16 v[244:245], v16 offset:4096
    ds_read_b64_tr_b16 v[246:247], v16 offset:4608
    s_waitcnt lgkmcnt(4)
    v_mfma_f32_32x32x16_bf16 v[24:39], v[196:199], v[240:243], v[24:39]
    buffer_load_dwordx4 v[196:199], v5, s[44:47], s93 offen offset:1024 sc1
    ds_read_b64_tr_b16 v[236:237], v16 offset:6144
    ds_read_b64_tr_b16 v[238:239], v16 offset:6656
    s_waitcnt lgkmcnt(4)
    v_mfma_f32_16x16x32_bf16 v[40:43], v[224:227], v[248:251], 0
    buffer_load_dwordx4 v[224:227], v14, s[44:47], s98 offen offset:2048 sc1
    s_add_u32 s98, s98, 4096
    ds_read_b64_tr_b16 v[252:253], v17 offset:4096
    ds_read_b64_tr_b16 v[254:255], v17 offset:4608
    s_waitcnt lgkmcnt(4)
    v_mfma_f32_32x32x16_bf16 v[24:39], v[200:203], v[244:247], v[24:39]
    buffer_load_dwordx4 v[200:203], v5, s[44:47], s93 offen offset:2048 sc1
    ds_read_b64_tr_b16 v[240:241], v16 offset:8192
    ds_read_b64_tr_b16 v[242:243], v16 offset:8704
    s_waitcnt lgkmcnt(4)
    v_mfma_f32_32x32x16_bf16 v[24:39], v[204:207], v[236:239], v[24:39]
    buffer_load_dwordx4 v[204:207], v5, s[44:47], s93 offen offset:3072 sc1
    s_add_u32 s93, s93, 4096
    ds_read_b64_tr_b16 v[244:245], v16 offset:10240
    ds_read_b64_tr_b16 v[246:247], v16 offset:10752
    s_waitcnt lgkmcnt(4)
    v_mfma_f32_16x16x32_bf16 v[40:43], v[228:231], v[252:255], v[40:43]
    buffer_load_dwordx4 v[228:231], v14, s[44:47], s98 offen offset:0 sc1
    ds_read_b64_tr_b16 v[248:249], v17 offset:8192
    ds_read_b64_tr_b16 v[250:251], v17 offset:8704
    s_waitcnt lgkmcnt(4)
    v_mfma_f32_32x32x16_bf16 v[24:39], v[208:211], v[240:243], v[24:39]
    buffer_load_dwordx4 v[208:211], v5, s[44:47], s93 offen offset:0 sc1
    ds_read_b64_tr_b16 v[236:237], v16 offset:12288
    ds_read_b64_tr_b16 v[238:239], v16 offset:12800
    s_waitcnt lgkmcnt(4)
    v_mfma_f32_32x32x16_bf16 v[24:39], v[212:215], v[244:247], v[24:39]
    buffer_load_dwordx4 v[212:215], v5, s[44:47], s93 offen offset:1024 sc1
    ds_read_b64_tr_b16 v[240:241], v16 offset:14336
    ds_read_b64_tr_b16 v[242:243], v16 offset:14848
    s_waitcnt lgkmcnt(4)
    v_mfma_f32_16x16x32_bf16 v[40:43], v[232:235], v[248:251], v[40:43]
    buffer_load_dwordx4 v[232:235], v14, s[44:47], s98 offen offset:2048 sc1
    s_add_u32 s98, s98, 4096
    ds_read_b64_tr_b16 v[252:253], v17 offset:12288
    ds_read_b64_tr_b16 v[254:255], v17 offset:12800
    s_waitcnt lgkmcnt(4)
    v_mfma_f32_32x32x16_bf16 v[24:39], v[216:219], v[236:239], v[24:39]
    buffer_load_dwordx4 v[216:219], v5, s[44:47], s93 offen offset:2048 sc1
    ds_read_b64_tr_b16 v[244:245], v16 offset:16384
    ds_read_b64_tr_b16 v[246:247], v16 offset:16896
    s_waitcnt lgkmcnt(4)
    v_mfma_f32_32x32x16_bf16 v[24:39], v[220:223], v[240:243], v[24:39]
    buffer_load_dwordx4 v[220:223], v5, s[44:47], s93 offen offset:3072 sc1
    s_add_u32 s93, s93, 4096
    ds_read_b64_tr_b16 v[236:237], v16 offset:18432
    ds_read_b64_tr_b16 v[238:239], v16 offset:18944
    s_waitcnt vmcnt(8) lgkmcnt(4)
    v_mfma_f32_16x16x32_bf16 v[40:43], v[224:227], v[252:255], v[40:43]
    buffer_load_dwordx4 v[224:227], v14, s[44:47], s98 offen offset:0 sc1
    ds_read_b64_tr_b16 v[248:249], v17 offset:16384
    ds_read_b64_tr_b16 v[250:251], v17 offset:16896
    s_waitcnt lgkmcnt(4)
    v_mfma_f32_32x32x16_bf16 v[24:39], v[192:195], v[244:247], v[24:39]
    buffer_load_dwordx4 v[192:195], v5, s[44:47], s93 offen offset:0 sc1
    ds_read_b64_tr_b16 v[240:241], v16 offset:20480
    ds_read_b64_tr_b16 v[242:243], v16 offset:20992
    s_mov_b64 exec, 1
    ds_add_u32 v2, v3 offset:2116
    s_mov_b64 exec, -1
    s_waitcnt lgkmcnt(4)
    v_mfma_f32_32x32x16_bf16 v[24:39], v[196:199], v[236:239], v[24:39]
    buffer_load_dwordx4 v[196:199], v5, s[44:47], s93 offen offset:1024 sc1
    ds_read_b64_tr_b16 v[244:245], v16 offset:22528
    ds_read_b64_tr_b16 v[246:247], v16 offset:23040
    s_waitcnt vmcnt(8) lgkmcnt(4)
    v_mfma_f32_16x16x32_bf16 v[40:43], v[228:231], v[248:251], v[40:43]
    buffer_load_dwordx4 v[228:231], v14, s[44:47], s98 offen offset:2048 sc1
    s_add_u32 s98, s98, 4096
    ds_read_b64_tr_b16 v[252:253], v17 offset:20480
    ds_read_b64_tr_b16 v[254:255], v17 offset:20992
    s_waitcnt lgkmcnt(4)
    v_mfma_f32_32x32x16_bf16 v[24:39], v[200:203], v[240:243], v[24:39]
    buffer_load_dwordx4 v[200:203], v5, s[44:47], s93 offen offset:2048 sc1
    ds_read_b64_tr_b16 v[236:237], v16 offset:24576
    ds_read_b64_tr_b16 v[238:239], v16 offset:25088
    s_waitcnt lgkmcnt(4)
    v_mfma_f32_32x32x16_bf16 v[24:39], v[204:207], v[244:247], v[24:39]
    buffer_load_dwordx4 v[204:207], v5, s[44:47], s93 offen offset:3072 sc1
    s_add_u32 s93, s93, 4096
    ds_read_b64_tr_b16 v[240:241], v16 offset:26624
    ds_read_b64_tr_b16 v[242:243], v16 offset:27136
    s_waitcnt vmcnt(8) lgkmcnt(4)
    v_mfma_f32_16x16x32_bf16 v[40:43], v[232:235], v[252:255], v[40:43]
    buffer_load_dwordx4 v[232:235], v14, s[44:47], s98 offen offset:0 sc1
    ds_read_b64_tr_b16 v[248:249], v17 offset:24576
    ds_read_b64_tr_b16 v[250:251], v17 offset:25088
    s_waitcnt lgkmcnt(4)
    v_mfma_f32_32x32x16_bf16 v[24:39], v[208:211], v[236:239], v[24:39]
    buffer_load_dwordx4 v[208:211], v5, s[44:47], s93 offen offset:0 sc1
    ds_read_b64_tr_b16 v[244:245], v16 offset:28672
    ds_read_b64_tr_b16 v[246:247], v16 offset:29184
    s_waitcnt lgkmcnt(4)
    v_mfma_f32_32x32x16_bf16 v[24:39], v[212:215], v[240:243], v[24:39]
    buffer_load_dwordx4 v[212:215], v5, s[44:47], s93 offen offset:1024 sc1
    ds_read_b64_tr_b16 v[236:237], v16 offset:30720
    ds_read_b64_tr_b16 v[238:239], v16 offset:31232
    s_waitcnt vmcnt(8) lgkmcnt(4)
    v_mfma_f32_16x16x32_bf16 v[40:43], v[224:227], v[248:251], v[40:43]
    buffer_load_dwordx4 v[224:227], v14, s[44:47], s98 offen offset:2048 sc1
    s_add_u32 s98, s98, 4096
    ds_read_b64_tr_b16 v[252:253], v17 offset:28672
    ds_read_b64_tr_b16 v[254:255], v17 offset:29184
    s_waitcnt lgkmcnt(4)
    v_mfma_f32_32x32x16_bf16 v[24:39], v[216:219], v[244:247], v[24:39]
    buffer_load_dwordx4 v[216:219], v5, s[44:47], s93 offen offset:2048 sc1
    ds_read_b64_tr_b16 v[240:241], v16 offset:32768
    ds_read_b64_tr_b16 v[242:243], v16 offset:33280
    s_waitcnt lgkmcnt(4)
    v_mfma_f32_32x32x16_bf16 v[24:39], v[220:223], v[236:239], v[24:39]
    buffer_load_dwordx4 v[220:223], v5, s[44:47], s93 offen offset:3072 sc1
    s_add_u32 s93, s93, 4096
    ds_read_b64_tr_b16 v[244:245], v16 offset:34816
    ds_read_b64_tr_b16 v[246:247], v16 offset:35328
    s_waitcnt vmcnt(8) lgkmcnt(4)
    v_mfma_f32_16x16x32_bf16 v[40:43], v[228:231], v[252:255], v[40:43]
    buffer_load_dwordx4 v[228:231], v14, s[44:47], s98 offen offset:0 sc1
    ds_read_b64_tr_b16 v[248:249], v17 offset:32768
    ds_read_b64_tr_b16 v[250:251], v17 offset:33280
    s_waitcnt lgkmcnt(4)
    v_mfma_f32_32x32x16_bf16 v[24:39], v[192:195], v[240:243], v[24:39]
    buffer_load_dwordx4 v[192:195], v5, s[44:47], s93 offen offset:0 sc1
    s_waitcnt lgkmcnt(2)
    v_mfma_f32_32x32x16_bf16 v[24:39], v[196:199], v[244:247], v[24:39]
    buffer_load_dwordx4 v[196:199], v5, s[44:47], s93 offen offset:1024 sc1
    s_waitcnt vmcnt(8) lgkmcnt(0)
    v_mfma_f32_16x16x32_bf16 v[40:43], v[232:235], v[248:251], v[40:43]
    buffer_load_dwordx4 v[232:235], v14, s[44:47], s98 offen offset:2048 sc1
    s_add_u32 s98, s98, 4096
LW_59:
    ds_read_b32 v1, v2 offset:2116
    s_waitcnt lgkmcnt(0)
    v_readfirstlane_b32 s73, v1
    s_cmp_ge_u32 s73, 2
    s_cbranch_scc1 LWD_60
    s_sleep 1
    s_sub_u32 s72, s72, 1
    s_cbranch_scc0 LW_59
    s_branch L_bail
LWD_60:
    ds_read_b64_tr_b16 v[236:237], v7 offset:0
    ds_read_b64_tr_b16 v[238:239], v7 offset:512
    ds_read_b64_tr_b16 v[240:241], v7 offset:2048
    ds_read_b64_tr_b16 v[242:243], v7 offset:2560
    ds_read_b64_tr_b16 v[252:253], v8 offset:0
    ds_read_b64_tr_b16 v[254:255], v8 offset:512
    s_waitcnt lgkmcnt(4)
    v_mfma_f32_32x32x16_bf16 v[24:39], v[200:203], v[236:239], v[24:39]
    buffer_load_dwordx4 v[200:203], v5, s[44:47], s93 offen offset:2048 sc1
    ds_read_b64_tr_b16 v[244:245], v7 offset:4096
    ds_read_b64_tr_b16 v[246:247], v7 offset:4608
    s_waitcnt lgkmcnt(4)
    v_mfma_f32_32x32x16_bf16 v[24:39], v[204:207], v[240:243], v[24:39]
    buffer_load_dwordx4 v[204:207], v5, s[44:47], s93 offen offset:3072 sc1
    s_add_u32 s93, s93, 4096
    ds_read_b64_tr_b16 v[236:237], v7 offset:6144
    ds_read_b64_tr_b16 v[238:239], v7 offset:6656
    s_waitcnt vmcnt(8) lgkmcnt(4)
    v_mfma_f32_16x16x32_bf16 v[40:43], v[224:227], v[252:255], v[40:43]
    buffer_load_dwordx4 v[224:227], v14, s[44:47], s98 offen offset:0 sc1
    ds_read_b64_tr_b16 v[248:249], v8 offset:4096
    ds_read_b64_tr_b16 v[250:251], v8 offset:4608
    s_waitcnt lgkmcnt(4)
    v_mfma_f32_32x32x16_bf16 v[24:39], v[208:211], v[244:247], v[24:39]
    buffer_load_dwordx4 v[208:211], v5, s[44:47], s93 offen offset:0 sc1
    ds_read_b64_tr_b16 v[240:241], v7 offset:8192
    ds_read_b64_tr_b16 v[242:243], v7 offset:8704
    s_waitcnt lgkmcnt(4)
    v_mfma_f32_32x32x16_bf16 v[24:39], v[212:215], v[236:239], v[24:39]
    buffer_load_dwordx4 v[212:215], v5, s[44:47], s93 offen offset:1024 sc1
    ds_read_b64_tr_b16 v[244:245], v7 offset:10240
    ds_read_b64_tr_b16 v[246:247], v7 offset:10752
    s_waitcnt vmcnt(8) lgkmcnt(4)
    v_mfma_f32_16x16x32_bf16 v[40:43], v[228:231], v[248:251], v[40:43]
    buffer_load_dwordx4 v[228:231], v14, s[44:47], s98 offen offset:2048 sc1
    s_add_u32 s98, s98, 4096
    ds_read_b64_tr_b16 v[252:253], v8 offset:8192
    ds_read_b64_tr_b16 v[254:255], v8 offset:8704
    s_waitcnt lgkmcnt(4)
    v_mfma_f32_32x32x16_bf16 v[24:39], v[216:219], v[240:243], v[24:39]
    buffer_load_dwordx4 v[216:219], v5, s[44:47], s93 offen offset:2048 sc1
    ds_read_b64_tr_b16 v[236:237], v7 offset:12288
    ds_read_b64_tr_b16 v[238:239], v7 offset:12800
    s_waitcnt lgkmcnt(4)
    v_mfma_f32_32x32x16_bf16 v[24:39], v[220:223], v[244:247], v[24:39]
    buffer_load_dwordx4 v[220:223], v5, s[44:47], s93 offen offset:3072 sc1
    s_add_u32 s93, s93, 4096
    ds_read_b64_tr_b16 v[240:241], v7 offset:14336
    ds_read_b64_tr_b16 v[242:243], v7 offset:14848
    s_waitcnt vmcnt(8) lgkmcnt(4)
    v_mfma_f32_16x16x32_bf16 v[40:43], v[232:235], v[252:255], v[40:43]
    buffer_load_dwordx4 v[232:235], v14, s[44:47], s98 offen offset:0 sc1
    ds_read_b64_tr_b16 v[248:249], v8 offset:12288
    ds_read_b64_tr_b16 v[250:251], v8 offset:12800
    s_waitcnt lgkmcnt(4)
    v_mfma_f32_32x32x16_bf16 v[24:39], v[192:195], v[236:239], v[24:39]
    buffer_load_dwordx4 v[192:195], v5, s[44:47], s93 offen offset:0 sc1
    ds_read_b64_tr_b16 v[244:245], v7 offset:16384
    ds_read_b64_tr_b16 v[246:247], v7 offset:16896
    s_waitcnt lgkmcnt(4)
    v_mfma_f32_32x32x16_bf16 v[24:39], v[196:199], v[240:243], v[24:39]
    buffer_load_dwordx4 v[196:199], v5, s[44:47], s93 offen offset:1024 sc1
    ds_read_b64_tr_b16 v[236:237], v7 offset:18432
    ds_read_b64_tr_b16 v[238:239], v7 offset:18944
    s_waitcnt vmcnt(8) lgkmcnt(4)
    v_mfma_f32_16x16x32_bf16 v[40:43], v[224:227], v[248:251], v[40:43]
    buffer_load_dwordx4 v[224:227], v14, s[44:47], s98 offen offset:2048 sc1
    s_add_u32 s98, s98, 4096
    ds_read_b64_tr_b16 v[252:253], v8 offset:16384
    ds_read_b64_tr_b16 v[254:255], v8 offset:16896
    s_waitcnt lgkmcnt(4)
    v_mfma_f32_32x32x16_bf16 v[24:39], v[200:203], v[244:247], v[24:39]
    buffer_load_dwordx4 v[200:203], v5, s[44:47], s93 offen offset:2048 sc1
    ds_read_b64_tr_b16 v[240:241], v7 offset:20480
    ds_read_b64_tr_b16 v[242:243], v7 offset:20992
    s_waitcnt lgkmcnt(4)
    v_mfma_f32_32x32x16_bf16 v[24:39], v[204:207], v[236:239], v[24:39]
    buffer_load_dwordx4 v[204:207], v5, s[44:47], s93 offen offset:3072 sc1
    s_add_u32 s93, s93, 4096
    ds_read_b64_tr_b16 v[244:245], v7 offset:22528
    ds_read_b64_tr_b16 v[246:247], v7 offset:23040
    s_waitcnt vmcnt(8) lgkmcnt(4)
    v_mfma_f32_16x16x32_bf16 v[40:43], v[228:231], v[252:255], v[40:43]
    buffer_load_dwordx4 v[228:231], v14, s[44:47], s98 offen offset:0 sc1
    ds_read_b64_tr_b16 v[248:249], v8 offset:20480
    ds_read_b64_tr_b16 v[250:251], v8 offset:20992
    s_waitcnt lgkmcnt(4)
    v_mfma_f32_32x32x16_bf16 v[24:39], v[208:211], v[240:243], v[24:39]
    ds_read_b64_tr_b16 v[236:237], v7 offset:24576
    ds_read_b64_tr_b16 v[238:239], v7 offset:25088
    s_waitcnt lgkmcnt(4)
    v_mfma_f32_32x32x16_bf16 v[24:39], v[212:215], v[244:247], v[24:39]
    ds_read_b64_tr_b16 v[240:241], v7 offset:26624
    ds_read_b64_tr_b16 v[242:243], v7 offset:27136
    s_waitcnt vmcnt(6) lgkmcnt(4)
    v_mfma_f32_16x16x32_bf16 v[40:43], v[232:235], v[248:251], v[40:43]
    buffer_load_dwordx4 v[232:235], v14, s[44:47], s98 offen offset:2048 sc1
    s_add_u32 s98, s98, 4096
    ds_read_b64_tr_b16 v[252:253], v8 offset:24576
    ds_read_b64_tr_b16 v[254:255], v8 offset:25088
    s_waitcnt lgkmcnt(4)
    v_mfma_f32_32x32x16_bf16 v[24:39], v[216:219], v[236:239], v[24:39]
    ds_read_b64_tr_b16 v[244:245], v7 offset:28672
    ds_read_b64_tr_b16 v[246:247], v7 offset:29184
    s_waitcnt lgkmcnt(4)
    v_mfma_f32_32x32x16_bf16 v[24:39], v[220:223], v[240:243], v[24:39]
    ds_read_b64_tr_b16 v[236:237], v7 offset:30720
    ds_read_b64_tr_b16 v[238:239], v7 offset:31232
    s_waitcnt vmcnt(4) lgkmcnt(4)
    v_mfma_f32_16x16x32_bf16 v[40:43], v[224:227], v[252:255], v[40:43]
    ds_read_b64_tr_b16 v[248:249], v8 offset:28672
    ds_read_b64_tr_b16 v[250:251], v8 offset:29184
    s_waitcnt lgkmcnt(4)
    v_mfma_f32_32x32x16_bf16 v[24:39], v[192:195], v[244:247], v[24:39]
    ds_read_b64_tr_b16 v[240:241], v7 offset:32768
    ds_read_b64_tr_b16 v[242:243], v7 offset:33280
    s_waitcnt lgkmcnt(4)
    v_mfma_f32_32x32x16_bf16 v[24:39], v[196:199], v[236:239], v[24:39]
    ds_read_b64_tr_b16 v[244:245], v7 offset:34816
    ds_read_b64_tr_b16 v[246:247], v7 offset:35328
    s_waitcnt vmcnt(1) lgkmcnt(4)
    v_mfma_f32_16x16x32_bf16 v[40:43], v[228:231], v[248:251], v[40:43]
    ds_read_b64_tr_b16 v[252:253], v8 offset:32768
    ds_read_b64_tr_b16 v[254:255], v8 offset:33280
    s_waitcnt lgkmcnt(4)
    v_mfma_f32_32x32x16_bf16 v[24:39], v[200:203], v[240:243], v[24:39]
    s_waitcnt lgkmcnt(2)
    v_mfma_f32_32x32x16_bf16 v[24:39], v[204:207], v[244:247], v[24:39]
    s_waitcnt vmcnt(0) lgkmcnt(0)
    v_mfma_f32_16x16x32_bf16 v[40:43], v[232:235], v[252:255], v[40:43]
    s_mov_b32 s52, s22
    s_mov_b32 s53, s23
    s_mov_b32 s54, 2359296
    s_mov_b32 s55, 0x20000
    s_mul_i32 s93, s69, 2304
    s_add_u32 s93, s93, s95
    s_add_u32 s93, s93, 0
    s_add_u32 s92, s93, 0
    s_nop 1
    v_pk_mul_f32 v[24:25], v[24:25], v[44:45] op_sel:[0,1] op_sel_hi:[1,1]
    v_pk_mul_f32 v[26:27], v[26:27], v[44:45] op_sel:[0,1] op_sel_hi:[1,1]
    v_pk_mul_f32 v[28:29], v[28:29], v[44:45] op_sel:[0,1] op_sel_hi:[1,1]
    v_pk_mul_f32 v[30:31], v[30:31], v[44:45] op_sel:[0,1] op_sel_hi:[1,1]
    v_pk_mul_f32 v[32:33], v[32:33], v[44:45] op_sel:[0,1] op_sel_hi:[1,1]
    v_pk_mul_f32 v[34:35], v[34:35], v[44:45] op_sel:[0,1] op_sel_hi:[1,1]
    v_pk_mul_f32 v[36:37], v[36:37], v[44:45] op_sel:[0,1] op_sel_hi:[1,1]
    v_pk_mul_f32 v[38:39], v[38:39], v[44:45] op_sel:[0,1] op_sel_hi:[1,1]
    v_pk_mul_f32 v[40:41], v[40:41], v[46:47] op_sel_hi:[1,0]
    v_pk_mul_f32 v[42:43], v[42:43], v[46:47] op_sel_hi:[1,0]
LW_61:
    ds_read_b32 v1, v2 offset:1280
    s_waitcnt lgkmcnt(0)
    v_readfirstlane_b32 s73, v1
    s_cmp_ge_u32 s73, 4
    s_cbranch_scc1 LWD_62
    s_sleep 4
    s_sub_u32 s72, s72, 1
    s_cbranch_scc0 LW_61
    s_branch L_bail
LWD_62:
    ds_read_b128 v[192:195], v20 offset:10240
    ds_read_b128 v[196:199], v20 offset:11264
    ds_read_b64 v[200:201], v21 offset:10240
    ds_read_b32 v202, v22 offset:10240
    ds_read_b128 v[204:207], v20 offset:12800
    ds_read_b128 v[208:211], v20 offset:13824
    ds_read_b64 v[212:213], v21 offset:12800
    ds_read_b32 v214, v22 offset:12800
    s_add_u32 s90, s96, 46080
    s_add_u32 s91, s97, 46080
    s_movk_i32 s89, 5
    ds_read_b128 v[216:219], v20 offset:15360
    ds_read_b128 v[220:223], v20 offset:16384
    ds_read_b64 v[224:225], v21 offset:15360
    ds_read_b32 v226, v22 offset:15360
    s_waitcnt lgkmcnt(4)
    ds_read_b128 v[228:231], v20 offset:17920
    ds_read_b128 v[232:235], v20 offset:18944
    ds_read_b64 v[236:237], v21 offset:17920
    ds_read_b32 v238, v22 offset:17920
    v_pk_add_f32 v[192:193], v[192:193], v[204:205]
    v_pk_add_f32 v[194:195], v[194:195], v[206:207]
    v_pk_add_f32 v[196:197], v[196:197], v[208:209]
    v_pk_add_f32 v[198:199], v[198:199], v[210:211]
    v_pk_add_f32 v[200:201], v[200:201], v[212:213]
    v_add_f32 v202, v202, v214
    s_waitcnt lgkmcnt(4)
    v_pk_add_f32 v[192:193], v[192:193], v[216:217]
    v_pk_add_f32 v[194:195], v[194:195], v[218:219]
    v_pk_add_f32 v[196:197], v[196:197], v[220:221]
    v_pk_add_f32 v[198:199], v[198:199], v[222:223]
    v_pk_add_f32 v[200:201], v[200:201], v[224:225]
    v_add_f32 v202, v202, v226
    s_waitcnt lgkmcnt(0)
    v_pk_add_f32 v[192:193], v[192:193], v[228:229]
    v_pk_add_f32 v[194:195], v[194:195], v[230:231]
    v_pk_add_f32 v[196:197], v[196:197], v[232:233]
    v_pk_add_f32 v[198:199], v[198:199], v[234:235]
    v_pk_add_f32 v[200:201], v[200:201], v[236:237]
    v_add_f32 v202, v202, v238
    v_pk_mul_f32 v[204:205], v[192:193], 0 op_sel_hi:[1,0]
    v_pk_fma_f32 v[204:205], v[194:195], 0, v[204:205] op_sel_hi:[1,0,1]
    v_pk_fma_f32 v[204:205], v[196:197], 0, v[204:205] op_sel_hi:[1,0,1]
    v_pk_fma_f32 v[204:205], v[198:199], 0, v[204:205] op_sel_hi:[1,0,1]
    v_pk_fma_f32 v[204:205], v[200:201], 0, v[204:205] op_sel_hi:[1,0,1]
    v_add_f32 v204, v204, v205
    v_subrev_u32 v205, 0x21800000, v202
    v_cmp_u_f32 vcc, v204, v204
    s_mov_b32 s73, 0x3e000000
    v_cmp_lt_u32 s[74:75], s73, v205
    s_or_b64 vcc, vcc, s[74:75]
    s_cmp_eq_u64 vcc, 0
    s_cbranch_scc1 SOK_63
    s_call_b64 s[86:87], L_fallback
SOK_63:
    v_rcp_f32 v202, v202
    s_nop 0
    v_mul_f32 v202, v4, v202
    v_pk_mul_f32 v[192:193], v[192:193], v[202:203] op_sel_hi:[1,0]
    v_pk_mul_f32 v[194:195], v[194:195], v[202:203] op_sel_hi:[1,0]
    v_pk_mul_f32 v[196:197], v[196:197], v[202:203] op_sel_hi:[1,0]
    v_pk_mul_f32 v[198:199], v[198:199], v[202:203] op_sel_hi:[1,0]
    v_pk_mul_f32 v[200:201], v[200:201], v[202:203] op_sel_hi:[1,0]
    v_cvt_pk_bf16_f32 v204, v192, v193
    v_cvt_pk_bf16_f32 v205, v194, v195
    v_cvt_pk_bf16_f32 v206, v196, v197
    v_cvt_pk_bf16_f32 v207, v198, v199
    v_cvt_pk_bf16_f32 v208, v200, v201
    v_min_u32 v204, -2, v204
    v_min_u32 v208, -2, v208
    buffer_store_dwordx4 v[204:207], v5, s[44:47], s90 offen sc1
    s_mov_b32 exec_hi, 0
    buffer_store_dword v208, v5, s[44:47], s91 offen sc1
    s_mov_b64 exec, -1
    ds_read_b64_tr_b16 v[248:249], v10 offset:0
    ds_read_b64_tr_b16 v[250:251], v10 offset:128
    ds_read_b64_tr_b16 v[252:253], v10 offset:2304
    ds_read_b64_tr_b16 v[254:255], v10 offset:2432
CL_64:
    s_add_u32 s90, s94, 0
    buffer_load_dwordx4 v[192:195], v5, s[44:47], s90 offen offset:0 sc1
    buffer_load_dwordx4 v[196:199], v5, s[44:47], s90 offen offset:1024 sc1
    buffer_load_dwordx4 v[228:231], v12, s[44:47], s90 offen offset:0 sc1
    buffer_load_dwordx4 v[200:203], v5, s[44:47], s90 offen offset:2048 sc1
    buffer_load_dwordx4 v[204:207], v5, s[44:47], s90 offen offset:3072 sc1
    buffer_load_dwordx4 v[232:235], v12, s[44:47], s90 offen offset:2048 sc1
    s_add_u32 s90, s94, 4096
    buffer_load_dwordx4 v[208:211], v5, s[44:47], s90 offen offset:0 sc1
    buffer_load_dwordx4 v[212:215], v5, s[44:47], s90 offen offset:1024 sc1
    buffer_load_dwordx4 v[236:239], v12, s[44:47], s90 offen offset:0 sc1
    buffer_load_dwordx4 v[216:219], v5, s[44:47], s90 offen offset:2048 sc1
    buffer_load_dwordx4 v[220:223], v5, s[44:47], s90 offen offset:3072 sc1
    buffer_load_dwordx4 v[240:243], v12, s[44:47], s90 offen offset:2048 sc1
    s_add_u32 s90, s94, 8192
    buffer_load_dwordx4 v[224:227], v5, s[44:47], s90 offen offset:0 sc1
    buffer_load_dwordx4 v[244:247], v13, s[44:47], s90 offen offset:0 sc1
    s_waitcnt vmcnt(12)
    v_max_u32 v1, v192, v196
    s_waitcnt vmcnt(10)
    v_max3_u32 v1, v1, v228, v200
    s_waitcnt vmcnt(8)
    v_max3_u32 v1, v1, v204, v232
    s_waitcnt vmcnt(6)
    v_max3_u32 v1, v1, v208, v212
    s_waitcnt vmcnt(4)
    v_max3_u32 v1, v1, v236, v216
    s_waitcnt vmcnt(2)
    v_max3_u32 v1, v1, v220, v240
    s_waitcnt vmcnt(1)
    v_max3_u32 v1, v1, v224, v225
    s_waitcnt vmcnt(1)
    v_max3_u32 v1, v1, v226, v227
    s_waitcnt vmcnt(0)
    v_max3_u32 v1, v1, v244, v245
    s_waitcnt vmcnt(0)
    v_max3_u32 v1, v1, v246, v247
    v_cmp_eq_u32 vcc, -1, v1
    s_cmp_eq_u64 vcc, 0
    s_cbranch_scc1 CD_65
    s_sleep 8
    s_sub_u32 s72, s72, 1
    s_cbranch_scc0 CL_64
    s_branch L_bail
CD_65:
    v_mfma_f32_32x32x16_bf16 v[24:39], v[48:51], v[192:195], v[24:39]
    v_mfma_f32_32x32x16_bf16 v[24:39], v[52:55], v[196:199], v[24:39]
    s_waitcnt lgkmcnt(2)
    v_mfma_f32_16x16x32_bf16 v[40:43], v[248:251], v[228:231], v[40:43]
    ds_read_b64_tr_b16 v[248:249], v10 offset:4608
    ds_read_b64_tr_b16 v[250:251], v10 offset:4736
    v_mfma_f32_32x32x16_bf16 v[24:39], v[56:59], v[200:203], v[24:39]
    v_mfma_f32_32x32x16_bf16 v[24:39], v[60:63], v[204:207], v[24:39]
    s_waitcnt lgkmcnt(2)
    v_mfma_f32_16x16x32_bf16 v[40:43], v[252:255], v[232:235], v[40:43]
    ds_read_b64_tr_b16 v[252:253], v10 offset:6912
    ds_read_b64_tr_b16 v[254:255], v10 offset:7040
    v_mfma_f32_32x32x16_bf16 v[24:39], v[64:67], v[208:211], v[24:39]
    v_mfma_f32_32x32x16_bf16 v[24:39], v[68:71], v[212:215], v[24:39]
    s_waitcnt lgkmcnt(2)
    v_mfma_f32_16x16x32_bf16 v[40:43], v[248:251], v[236:239], v[40:43]
    ds_read_b64_tr_b16 v[248:249], v11 offset:0
    ds_read_b64_tr_b16 v[250:251], v11 offset:2304
    v_mfma_f32_32x32x16_bf16 v[24:39], v[72:75], v[216:219], v[24:39]
    v_mfma_f32_32x32x16_bf16 v[24:39], v[76:79], v[220:223], v[24:39]
    s_waitcnt lgkmcnt(2)
    v_mfma_f32_16x16x32_bf16 v[40:43], v[252:255], v[240:243], v[40:43]
    v_mfma_f32_32x32x16_bf16 v[24:39], v[80:83], v[224:227], v[24:39]
    s_waitcnt lgkmcnt(0)
    v_mfma_f32_16x16x32_bf16 v[40:43], v[248:251], v[244:247], v[40:43]
    ds_read_b64_tr_b16 v[248:249], v10 offset:288
    ds_read_b64_tr_b16 v[250:251], v10 offset:416
    ds_read_b64_tr_b16 v[252:253], v10 offset:2592
    ds_read_b64_tr_b16 v[254:255], v10 offset:2720
CL_66:
    s_add_u32 s90, s94, 18432
    buffer_load_dwordx4 v[192:195], v5, s[44:47], s90 offen offset:0 sc1
    buffer_load_dwordx4 v[196:199], v5, s[44:47], s90 offen offset:1024 sc1
    buffer_load_dwordx4 v[228:231], v12, s[44:47], s90 offen offset:0 sc1
    buffer_load_dwordx4 v[200:203], v5, s[44:47], s90 offen offset:2048 sc1
    buffer_load_dwordx4 v[204:207], v5, s[44:47], s90 offen offset:3072 sc1
    buffer_load_dwordx4 v[232:235], v12, s[44:47], s90 offen offset:2048 sc1
    s_add_u32 s90, s94, 22528
    buffer_load_dwordx4 v[208:211], v5, s[44:47], s90 offen offset:0 sc1
    buffer_load_dwordx4 v[212:215], v5, s[44:47], s90 offen offset:1024 sc1
    buffer_load_dwordx4 v[236:239], v12, s[44:47], s90 offen offset:0 sc1
    buffer_load_dwordx4 v[216:219], v5, s[44:47], s90 offen offset:2048 sc1
    buffer_load_dwordx4 v[220:223], v5, s[44:47], s90 offen offset:3072 sc1
    buffer_load_dwordx4 v[240:243], v12, s[44:47], s90 offen offset:2048 sc1
    s_add_u32 s90, s94, 26624
    buffer_load_dwordx4 v[224:227], v5, s[44:47], s90 offen offset:0 sc1
    buffer_load_dwordx4 v[244:247], v13, s[44:47], s90 offen offset:0 sc1
    s_waitcnt vmcnt(12)
    v_max_u32 v1, v192, v196
    s_waitcnt vmcnt(10)
    v_max3_u32 v1, v1, v228, v200
    s_waitcnt vmcnt(8)
    v_max3_u32 v1, v1, v204, v232
    s_waitcnt vmcnt(6)
    v_max3_u32 v1, v1, v208, v212
    s_waitcnt vmcnt(4)
    v_max3_u32 v1, v1, v236, v216
    s_waitcnt vmcnt(2)
    v_max3_u32 v1, v1, v220, v240
    s_waitcnt vmcnt(1)
    v_max3_u32 v1, v1, v224, v225
    s_waitcnt vmcnt(1)
    v_max3_u32 v1, v1, v226, v227
    s_waitcnt vmcnt(0)
    v_max3_u32 v1, v1, v244, v245
    s_waitcnt vmcnt(0)
    v_max3_u32 v1, v1, v246, v247
    v_cmp_eq_u32 vcc, -1, v1
    s_cmp_eq_u64 vcc, 0
    s_cbranch_scc1 CD_67
    s_sleep 8
    s_sub_u32 s72, s72, 1
    s_cbranch_scc0 CL_66
    s_branch L_bail
CD_67:
    v_mfma_f32_32x32x16_bf16 v[24:39], v[84:87], v[192:195], v[24:39]
    v_mfma_f32_32x32x16_bf16 v[24:39], v[88:91], v[196:199], v[24:39]
    s_waitcnt lgkmcnt(2)
    v_mfma_f32_16x16x32_bf16 v[40:43], v[248:251], v[228:231], v[40:43]
    ds_read_b64_tr_b16 v[248:249], v10 offset:4896
    ds_read_b64_tr_b16 v[250:251], v10 offset:5024
    v_mfma_f32_32x32x16_bf16 v[24:39], v[92:95], v[200:203], v[24:39]
    v_mfma_f32_32x32x16_bf16 v[24:39], v[96:99], v[204:207], v[24:39]
    s_waitcnt lgkmcnt(2)
    v_mfma_f32_16x16x32_bf16 v[40:43], v[252:255], v[232:235], v[40:43]
    ds_read_b64_tr_b16 v[252:253], v10 offset:7200
    ds_read_b64_tr_b16 v[254:255], v10 offset:7328
    v_mfma_f32_32x32x16_bf16 v[24:39], v[100:103], v[208:211], v[24:39]
    v_mfma_f32_32x32x16_bf16 v[24:39], v[104:107], v[212:215], v[24:39]
    s_waitcnt lgkmcnt(2)
    v_mfma_f32_16x16x32_bf16 v[40:43], v[248:251], v[236:239], v[40:43]
    ds_read_b64_tr_b16 v[248:249], v11 offset:288
    ds_read_b64_tr_b16 v[250:251], v11 offset:2592
    v_mfma_f32_32x32x16_bf16 v[24:39], v[108:111], v[216:219], v[24:39]
    v_mfma_f32_32x32x16_bf16 v[24:39], v[112:115], v[220:223], v[24:39]
    s_waitcnt lgkmcnt(2)
    v_mfma_f32_16x16x32_bf16 v[40:43], v[252:255], v[240:243], v[40:43]
    v_mfma_f32_32x32x16_bf16 v[24:39], v[116:119], v[224:227], v[24:39]
    s_waitcnt lgkmcnt(0)
    v_mfma_f32_16x16x32_bf16 v[40:43], v[248:251], v[244:247], v[40:43]
LW_68:
    ds_read_b32 v1, v2 offset:1280
    s_waitcnt lgkmcnt(0)
    v_readfirstlane_b32 s73, v1
    s_cmp_ge_u32 s73, 4
    s_cbranch_scc1 LWD_69
    s_sleep 4
    s_sub_u32 s72, s72, 1
    s_cbranch_scc0 LW_68
    s_branch L_bail
LWD_69:
    ds_read_b64_tr_b16 v[248:249], v10 offset:576
    ds_read_b64_tr_b16 v[250:251], v10 offset:704
    ds_read_b64_tr_b16 v[252:253], v10 offset:2880
    ds_read_b64_tr_b16 v[254:255], v10 offset:3008
CP_70:
    s_add_u32 s90, s94, 45056
    buffer_load_dwordx4 v[192:195], v5, s[44:47], s90 offen sc1
    s_waitcnt vmcnt(0)
    v_max_u32 v1, v192, v193
    v_max3_u32 v1, v1, v194, v195
    v_cmp_eq_u32 vcc, -1, v1
    s_cmp_eq_u64 vcc, 0
    s_cbranch_scc1 CQ_71
    s_sleep 8
    s_sub_u32 s72, s72, 1
    s_cbranch_scc0 CP_70
    s_branch L_bail
CQ_71:
CL_72:
    s_add_u32 s90, s94, 36864
    buffer_load_dwordx4 v[192:195], v5, s[44:47], s90 offen offset:0 sc1
    buffer_load_dwordx4 v[196:199], v5, s[44:47], s90 offen offset:1024 sc1
    buffer_load_dwordx4 v[228:231], v12, s[44:47], s90 offen offset:0 sc1
    buffer_load_dwordx4 v[200:203], v5, s[44:47], s90 offen offset:2048 sc1
    buffer_load_dwordx4 v[204:207], v5, s[44:47], s90 offen offset:3072 sc1
    buffer_load_dwordx4 v[232:235], v12, s[44:47], s90 offen offset:2048 sc1
    s_add_u32 s90, s94, 40960
    buffer_load_dwordx4 v[208:211], v5, s[44:47], s90 offen offset:0 sc1
    buffer_load_dwordx4 v[212:215], v5, s[44:47], s90 offen offset:1024 sc1
    buffer_load_dwordx4 v[236:239], v12, s[44:47], s90 offen offset:0 sc1
    buffer_load_dwordx4 v[216:219], v5, s[44:47], s90 offen offset:2048 sc1
    buffer_load_dwordx4 v[220:223], v5, s[44:47], s90 offen offset:3072 sc1
    buffer_load_dwordx4 v[240:243], v12, s[44:47], s90 offen offset:2048 sc1
    s_add_u32 s90, s94, 45056
    buffer_load_dwordx4 v[224:227], v5, s[44:47], s90 offen offset:0 sc1
    buffer_load_dwordx4 v[244:247], v13, s[44:47], s90 offen offset:0 sc1
    s_waitcnt vmcnt(12)
    v_max_u32 v1, v192, v196
    s_waitcnt vmcnt(10)
    v_max3_u32 v1, v1, v228, v200
    s_waitcnt vmcnt(8)
    v_max3_u32 v1, v1, v204, v232
    s_waitcnt vmcnt(6)
    v_max3_u32 v1, v1, v208, v212
    s_waitcnt vmcnt(4)
    v_max3_u32 v1, v1, v236, v216
    s_waitcnt vmcnt(2)
    v_max3_u32 v1, v1, v220, v240
    s_waitcnt vmcnt(1)
    v_max3_u32 v1, v1, v224, v225
    s_waitcnt vmcnt(1)
    v_max3_u32 v1, v1, v226, v227
    s_waitcnt vmcnt(0)
    v_max3_u32 v1, v1, v244, v245
    s_waitcnt vmcnt(0)
    v_max3_u32 v1, v1, v246, v247
    v_cmp_eq_u32 vcc, -1, v1
    s_cmp_eq_u64 vcc, 0
    s_cbranch_scc1 CD_73
    s_sleep 8
    s_sub_u32 s72, s72, 1
    s_cbranch_scc0 CL_72
    s_branch L_bail
CD_73:
    v_mfma_f32_32x32x16_bf16 v[24:39], v[120:123], v[192:195], v[24:39]
    v_mfma_f32_32x32x16_bf16 v[24:39], v[124:127], v[196:199], v[24:39]
    s_waitcnt lgkmcnt(2)
    v_mfma_f32_16x16x32_bf16 v[40:43], v[248:251], v[228:231], v[40:43]
    ds_read_b64_tr_b16 v[248:249], v10 offset:5184
    ds_read_b64_tr_b16 v[250:251], v10 offset:5312
    v_mfma_f32_32x32x16_bf16 v[24:39], v[128:131], v[200:203], v[24:39]
    v_mfma_f32_32x32x16_bf16 v[24:39], v[132:135], v[204:207], v[24:39]
    s_waitcnt lgkmcnt(2)
    v_mfma_f32_16x16x32_bf16 v[40:43], v[252:255], v[232:235], v[40:43]
    ds_read_b64_tr_b16 v[252:253], v10 offset:7488
    ds_read_b64_tr_b16 v[254:255], v10 offset:7616
    v_mfma_f32_32x32x16_bf16 v[24:39], v[136:139], v[208:211], v[24:39]
    v_mfma_f32_32x32x16_bf16 v[24:39], v[140:143], v[212:215], v[24:39]
    s_waitcnt lgkmcnt(2)
    v_mfma_f32_16x16x32_bf16 v[40:43], v[248:251], v[236:239], v[40:43]
    ds_read_b64_tr_b16 v[248:249], v11 offset:576
    ds_read_b64_tr_b16 v[250:251], v11 offset:2880
    v_mfma_f32_32x32x16_bf16 v[24:39], v[144:147], v[216:219], v[24:39]
    v_mfma_f32_32x32x16_bf16 v[24:39], v[148:151], v[220:223], v[24:39]
    s_waitcnt lgkmcnt(2)
    v_mfma_f32_16x16x32_bf16 v[40:43], v[252:255], v[240:243], v[40:43]
    v_mfma_f32_32x32x16_bf16 v[24:39], v[152:155], v[224:227], v[24:39]
    s_waitcnt lgkmcnt(0)
    v_mfma_f32_16x16x32_bf16 v[40:43], v[248:251], v[244:247], v[40:43]
LW_74:
    ds_read_b32 v1, v2 offset:1792
    s_waitcnt lgkmcnt(0)
    v_readfirstlane_b32 s73, v1
    s_cmp_ge_u32 s73, 4
    s_cbranch_scc1 LWD_75
    s_sleep 2
    s_sub_u32 s72, s72, 1
    s_cbranch_scc0 LW_74
    s_branch L_bail
LWD_75:
    ds_read_b64_tr_b16 v[248:249], v10 offset:864
    ds_read_b64_tr_b16 v[250:251], v10 offset:992
    ds_read_b64_tr_b16 v[252:253], v10 offset:3168
    ds_read_b64_tr_b16 v[254:255], v10 offset:3296
CL_76:
    s_add_u32 s90, s94, 55296
    buffer_load_dwordx4 v[192:195], v5, s[44:47], s90 offen offset:0 sc1
    buffer_load_dwordx4 v[196:199], v5, s[44:47], s90 offen offset:1024 sc1
    buffer_load_dwordx4 v[228:231], v12, s[44:47], s90 offen offset:0 sc1
    buffer_load_dwordx4 v[200:203], v5, s[44:47], s90 offen offset:2048 sc1
    buffer_load_dwordx4 v[204:207], v5, s[44:47], s90 offen offset:3072 sc1
    buffer_load_dwordx4 v[232:235], v12, s[44:47], s90 offen offset:2048 sc1
    s_add_u32 s90, s94, 59392
    buffer_load_dwordx4 v[208:211], v5, s[44:47], s90 offen offset:0 sc1
    buffer_load_dwordx4 v[212:215], v5, s[44:47], s90 offen offset:1024 sc1
    buffer_load_dwordx4 v[236:239], v12, s[44:47], s90 offen offset:0 sc1
    buffer_load_dwordx4 v[216:219], v5, s[44:47], s90 offen offset:2048 sc1
    buffer_load_dwordx4 v[220:223], v5, s[44:47], s90 offen offset:3072 sc1
    buffer_load_dwordx4 v[240:243], v12, s[44:47], s90 offen offset:2048 sc1
    s_add_u32 s90, s94, 63488
    buffer_load_dwordx4 v[224:227], v5, s[44:47], s90 offen offset:0 sc1
    buffer_load_dwordx4 v[244:247], v13, s[44:47], s90 offen offset:0 sc1
    s_waitcnt vmcnt(12)
    v_max_u32 v1, v192, v196
    s_waitcnt vmcnt(10)
    v_max3_u32 v1, v1, v228, v200
    s_waitcnt vmcnt(8)
    v_max3_u32 v1, v1, v204, v232
    s_waitcnt vmcnt(6)
    v_max3_u32 v1, v1, v208, v212
    s_waitcnt vmcnt(4)
    v_max3_u32 v1, v1, v236, v216
    s_waitcnt vmcnt(2)
    v_max3_u32 v1, v1, v220, v240
    s_waitcnt vmcnt(1)
    v_max3_u32 v1, v1, v224, v225
    s_waitcnt vmcnt(1)
    v_max3_u32 v1, v1, v226, v227
    s_waitcnt vmcnt(0)
    v_max3_u32 v1, v1, v244, v245
    s_waitcnt vmcnt(0)
    v_max3_u32 v1, v1, v246, v247
    v_cmp_eq_u32 vcc, -1, v1
    s_cmp_eq_u64 vcc, 0
    s_cbranch_scc1 CD_77
    s_sleep 2
    s_sub_u32 s72, s72, 1
    s_cbranch_scc0 CL_76
    s_branch L_bail
CD_77:
    v_mfma_f32_32x32x16_bf16 v[24:39], v[156:159], v[192:195], v[24:39]
    v_mfma_f32_32x32x16_bf16 v[24:39], v[160:163], v[196:199], v[24:39]
    s_waitcnt lgkmcnt(2)
    v_mfma_f32_16x16x32_bf16 v[40:43], v[248:251], v[228:231], v[40:43]
    ds_read_b64_tr_b16 v[248:249], v10 offset:5472
    ds_read_b64_tr_b16 v[250:251], v10 offset:5600
    v_mfma_f32_32x32x16_bf16 v[24:39], v[164:167], v[200:203], v[24:39]
    v_mfma_f32_32x32x16_bf16 v[24:39], v[168:171], v[204:207], v[24:39]
    s_waitcnt lgkmcnt(2)
    v_mfma_f32_16x16x32_bf16 v[40:43], v[252:255], v[232:235], v[40:43]
    ds_read_b64_tr_b16 v[252:253], v10 offset:7776
    ds_read_b64_tr_b16 v[254:255], v10 offset:7904
    v_mfma_f32_32x32x16_bf16 v[24:39], v[172:175], v[208:211], v[24:39]
    v_mfma_f32_32x32x16_bf16 v[24:39], v[176:179], v[212:215], v[24:39]
    s_waitcnt lgkmcnt(2)
    v_mfma_f32_16x16x32_bf16 v[40:43], v[248:251], v[236:239], v[40:43]
    ds_read_b64_tr_b16 v[248:249], v11 offset:864
    ds_read_b64_tr_b16 v[250:251], v11 offset:3168
    v_mfma_f32_32x32x16_bf16 v[24:39], v[180:183], v[216:219], v[24:39]
    v_mfma_f32_32x32x16_bf16 v[24:39], v[184:187], v[220:223], v[24:39]
    s_waitcnt lgkmcnt(2)
    v_mfma_f32_16x16x32_bf16 v[40:43], v[252:255], v[240:243], v[40:43]
    v_mfma_f32_32x32x16_bf16 v[24:39], v[188:191], v[224:227], v[24:39]
    s_waitcnt lgkmcnt(0)
    v_mfma_f32_16x16x32_bf16 v[40:43], v[248:251], v[244:247], v[40:43]
    s_nop 4
    s_nop 2
    v_cvt_pk_bf16_f32 v40, v40, v41
    v_cvt_pk_bf16_f32 v41, v42, v43
    s_nop 3
    s_nop 0
    v_cvt_pk_bf16_f32 v24, v24, v25
    v_cvt_pk_bf16_f32 v25, v26, v27
    v_cvt_pk_bf16_f32 v26, v28, v29
    v_cvt_pk_bf16_f32 v27, v30, v31
    v_cvt_pk_bf16_f32 v28, v32, v33
    v_cvt_pk_bf16_f32 v29, v34, v35
    v_cvt_pk_bf16_f32 v30, v36, v37
    v_cvt_pk_bf16_f32 v31, v38, v39
    buffer_store_dwordx4 v[24:27], v18, s[52:55], s93 offen offset:0
    buffer_store_dwordx4 v[28:31], v18, s[52:55], s93 offen offset:16
    s_mov_b32 exec_hi, 0
    buffer_store_dwordx2 v[40:41], v19, s[52:55], s92 offen offset:128
    s_mov_b64 exec, -1
    s_branch L_fin
TL_37:
    s_setprio 2
    ds_read_b32 v4, v23 offset:2304
    ds_read_b32 v45, v23 offset:2432
    v_and_b32 v7, 15, v0
    v_lshl_add_u32 v7, v7, 2, v2
    ds_read_b32 v46, v7 offset:2432
    v_add_u32 v7, 36864, v16
    v_add_u32 v8, 36864, v17
    s_waitcnt lgkmcnt(0)
    v_sub_f32 v4, 1.0, v4
LW_78:
    ds_read_b32 v1, v2 offset:0
    s_waitcnt lgkmcnt(0)
    v_readfirstlane_b32 s73, v1
    s_cmp_ge_u32 s73, 4
    s_cbranch_scc1 LWD_79
    s_sleep 4
    s_sub_u32 s72, s72, 1
    s_cbranch_scc0 LW_78
    s_branch L_bail
LWD_79:
    ds_read_b128 v[192:195], v20 offset:0
    ds_read_b128 v[196:199], v20 offset:1024
    ds_read_b64 v[200:201], v21 offset:0
    ds_read_b32 v202, v22 offset:0
    ds_read_b128 v[204:207], v20 offset:2560
    ds_read_b128 v[208:211], v20 offset:3584
    ds_read_b64 v[212:213], v21 offset:2560
    ds_read_b32 v214, v22 offset:2560
    s_add_u32 s90, s96, 0
    s_add_u32 s91, s97, 0
    s_movk_i32 s89, 0
    ds_read_b128 v[216:219], v20 offset:5120
    ds_read_b128 v[220:223], v20 offset:6144
    ds_read_b64 v[224:225], v21 offset:5120
    ds_read_b32 v226, v22 offset:5120
    s_waitcnt lgkmcnt(4)
    ds_read_b128 v[228:231], v20 offset:7680
    ds_read_b128 v[232:235], v20 offset:8704
    ds_read_b64 v[236:237], v21 offset:7680
    ds_read_b32 v238, v22 offset:7680
    v_pk_add_f32 v[192:193], v[192:193], v[204:205]
    v_pk_add_f32 v[194:195], v[194:195], v[206:207]
    v_pk_add_f32 v[196:197], v[196:197], v[208:209]
    v_pk_add_f32 v[198:199], v[198:199], v[210:211]
    v_pk_add_f32 v[200:201], v[200:201], v[212:213]
    v_add_f32 v202, v202, v214
    s_waitcnt lgkmcnt(4)
    v_pk_add_f32 v[192:193], v[192:193], v[216:217]
    v_pk_add_f32 v[194:195], v[194:195], v[218:219]
    v_pk_add_f32 v[196:197], v[196:197], v[220:221]
    v_pk_add_f32 v[198:199], v[198:199], v[222:223]
    v_pk_add_f32 v[200:201], v[200:201], v[224:225]
    v_add_f32 v202, v202, v226
    s_waitcnt lgkmcnt(0)
    v_pk_add_f32 v[192:193], v[192:193], v[228:229]
    v_pk_add_f32 v[194:195], v[194:195], v[230:231]
    v_pk_add_f32 v[196:197], v[196:197], v[232:233]
    v_pk_add_f32 v[198:199], v[198:199], v[234:235]
    v_pk_add_f32 v[200:201], v[200:201], v[236:237]
    v_add_f32 v202, v202, v238
LW_80:
    ds_read_b32 v1, v2 offset:2112
    s_waitcnt lgkmcnt(0)
    v_readfirstlane_b32 s73, v1
    s_cmp_ge_u32 s73, 1
    s_cbranch_scc1 LWD_81
    s_sleep 2
    s_sub_u32 s72, s72, 1
    s_cbranch_scc0 LW_80
    s_branch L_bail
LWD_81:
    s_mov_b64 exec, 1
    ds_add_u32 v2, v3 offset:2096
    s_mov_b64 exec, -1
    v_pk_mul_f32 v[204:205], v[192:193], 0 op_sel_hi:[1,0]
    v_pk_fma_f32 v[204:205], v[194:195], 0, v[204:205] op_sel_hi:[1,0,1]
    v_pk_fma_f32 v[204:205], v[196:197], 0, v[204:205] op_sel_hi:[1,0,1]
    v_pk_fma_f32 v[204:205], v[198:199], 0, v[204:205] op_sel_hi:[1,0,1]
    v_pk_fma_f32 v[204:205], v[200:201], 0, v[204:205] op_sel_hi:[1,0,1]
    v_add_f32 v204, v204, v205
    v_subrev_u32 v205, 0x21800000, v202
    v_cmp_u_f32 vcc, v204, v204
    s_mov_b32 s73, 0x3e000000
    v_cmp_lt_u32 s[74:75], s73, v205
    s_or_b64 vcc, vcc, s[74:75]
    s_cmp_eq_u64 vcc, 0
    s_cbranch_scc1 SOK_82
    s_call_b64 s[86:87], L_fallback
SOK_82:
    v_rcp_f32 v202, v202
    s_nop 0
    v_mul_f32 v202, v4, v202
    v_pk_mul_f32 v[192:193], v[192:193], v[202:203] op_sel_hi:[1,0]
    v_pk_mul_f32 v[194:195], v[194:195], v[202:203] op_sel_hi:[1,0]
    v_pk_mul_f32 v[196:197], v[196:197], v[202:203] op_sel_hi:[1,0]
    v_pk_mul_f32 v[198:199], v[198:199], v[202:203] op_sel_hi:[1,0]
    v_pk_mul_f32 v[200:201], v[200:201], v[202:203] op_sel_hi:[1,0]
    v_cvt_pk_bf16_f32 v204, v192, v193
    v_cvt_pk_bf16_f32 v205, v194, v195
    v_cvt_pk_bf16_f32 v206, v196, v197
    v_cvt_pk_bf16_f32 v207, v198, v199
    v_cvt_pk_bf16_f32 v208, v200, v201
    v_min_u32 v204, -2, v204
    v_min_u32 v208, -2, v208
    buffer_store_dwordx4 v[204:207], v5, s[44:47], s90 offen sc1
    s_mov_b32 exec_hi, 0
    buffer_store_dword v208, v5, s[44:47], s91 offen sc1
    s_mov_b64 exec, -1
    s_mov_b32 s48, s18
    s_mov_b32 s49, s19
    s_mov_b32 s50, 663552
    s_mov_b32 s51, 0x20000
    v_lshrrev_b32 v48, 2, v0
    v_mul_u32_u24 v48, 1152, v48
    v_and_b32 v49, 3, v0
    v_lshl_add_u32 v48, v49, 4, v48
    v_mul_u32_u24 v49, 1152, v0
    s_and_b32 s73, s68, 1
    s_mul_i32 s84, s73, 18432
    s_add_u32 s84, s84, s95
    s_lshl_b32 s85, s73, 10
    s_mul_i32 s93, s70, 110592
    s_add_u32 s98, s93, 1122304
    s_add_u32 s93, s93, 1048576
LW_83:
    ds_read_b32 v1, v2 offset:2076
    s_waitcnt lgkmcnt(0)
    v_readfirstlane_b32 s73, v1
    s_cmp_ge_u32 s73, 8
    s_cbranch_scc1 LWD_84
    s_sleep 3
    s_sub_u32 s72, s72, 1
    s_cbranch_scc0 LW_83
    s_branch L_bail
LWD_84:
    s_lshr_b32 s73, s69, 3
    s_mul_i32 s82, s73, 8192
    s_add_u32 s85, s85, s82
    s_mul_i32 s82, s73, 147456
    s_add_u32 s84, s84, s82
    s_mov_b32 s88, 17
PNL_85:
    s_add_u32 m0, s85, 0
    s_add_u32 s83, s84, 128
    buffer_load_dwordx4 v48, s[48:51], s84 offen lds
    s_add_u32 m0, s85, 36800
    s_lshr_b32 s82, s85, 2
    buffer_load_dwordx4 v48, s[48:51], s84 offen offset:64 lds
    s_add_u32 m0, s82, 128000
    s_mov_b64 exec, 0xffff
    buffer_load_dwordx4 v49, s[48:51], s83 offen lds
    s_mov_b64 exec, -1
    s_add_u32 s85, s85, 2048
    s_add_u32 s84, s84, 36864
    s_cmp_lt_u32 s85, 36864
    s_cselect_b32 s82, 0, 36864
    s_cselect_b32 s83, 0, 663552
    s_sub_u32 s85, s85, s82
    s_sub_u32 s84, s84, s83
    s_sub_u32 s88, s88, 1
    s_cbranch_scc0 PNL_85
    buffer_load_dwordx4 v[192:195], v5, s[44:47], s93 offen offset:0 sc1
    buffer_load_dwordx4 v[196:199], v5, s[44:47], s93 offen offset:1024 sc1
    buffer_load_dwordx4 v[224:227], v14, s[44:47], s98 offen offset:0 sc1
    buffer_load_dwordx4 v[200:203], v5, s[44:47], s93 offen offset:2048 sc1
    buffer_load_dwordx4 v[204:207], v5, s[44:47], s93 offen offset:3072 sc1
    s_add_u32 s93, s93, 4096
    buffer_load_dwordx4 v[228:231], v14, s[44:47], s98 offen offset:2048 sc1
    s_add_u32 s98, s98, 4096
    buffer_load_dwordx4 v[208:211], v5, s[44:47], s93 offen offset:0 sc1
    buffer_load_dwordx4 v[212:215], v5, s[44:47], s93 offen offset:1024 sc1
    buffer_load_dwordx4 v[232:235], v14, s[44:47], s98 offen offset:0 sc1
    buffer_load_dwordx4 v[216:219], v5, s[44:47], s93 offen offset:2048 sc1
    buffer_load_dwordx4 v[220:223], v5, s[44:47], s93 offen offset:3072 sc1
    s_add_u32 s93, s93, 4096
    s_waitcnt vmcnt(11)
    s_mov_b64 exec, 1
    ds_add_u32 v2, v3 offset:2092
    s_mov_b64 exec, -1
LW_86:
    ds_read_b32 v1, v2 offset:2092
    s_waitcnt lgkmcnt(0)
    v_readfirstlane_b32 s73, v1
    s_cmp_ge_u32 s73, 2
    s_cbranch_scc1 LWD_87
    s_sleep 1
    s_sub_u32 s72, s72, 1
    s_cbranch_scc0 LW_86
    s_branch L_bail
LWD_87:
    ds_read_b64_tr_b16 v[48:49], v6 offset:0
    ds_read_b64_tr_b16 v[50:51], v6 offset:512
    ds_read_b64_tr_b16 v[52:53], v6 offset:4608
    ds_read_b64_tr_b16 v[54:55], v6 offset:5120
    ds_read_b64_tr_b16 v[56:57], v6 offset:9216
    ds_read_b64_tr_b16 v[58:59], v6 offset:9728
    s_waitcnt lgkmcnt(6)
    ds_read_b64_tr_b16 v[60:61], v6 offset:13824
    ds_read_b64_tr_b16 v[62:63], v6 offset:14336
    ds_read_b64_tr_b16 v[64:65], v6 offset:18432
    ds_read_b64_tr_b16 v[66:67], v6 offset:18944
    ds_read_b64_tr_b16 v[68:69], v6 offset:23040
    ds_read_b64_tr_b16 v[70:71], v6 offset:23552
    s_waitcnt lgkmcnt(6)
    ds_read_b64_tr_b16 v[72:73], v6 offset:27648
    ds_read_b64_tr_b16 v[74:75], v6 offset:28160
    ds_read_b64_tr_b16 v[76:77], v6 offset:32256
    ds_read_b64_tr_b16 v[78:79], v6 offset:32768
    ds_read_b64_tr_b16 v[80:81], v9 offset:0
    ds_read_b64_tr_b16 v[82:83], v9 offset:9216
    s_waitcnt lgkmcnt(6)
    ds_read_b64_tr_b16 v[84:85], v6 offset:1152
    ds_read_b64_tr_b16 v[86:87], v6 offset:1664
    ds_read_b64_tr_b16 v[88:89], v6 offset:5760
    ds_read_b64_tr_b16 v[90:91], v6 offset:6272
    ds_read_b64_tr_b16 v[92:93], v6 offset:10368
    ds_read_b64_tr_b16 v[94:95], v6 offset:10880
    s_waitcnt lgkmcnt(6)
    ds_read_b64_tr_b16 v[96:97], v6 offset:14976
    ds_read_b64_tr_b16 v[98:99], v6 offset:15488
    ds_read_b64_tr_b16 v[100:101], v6 offset:19584
    ds_read_b64_tr_b16 v[102:103], v6 offset:20096
    ds_read_b64_tr_b16 v[104:105], v6 offset:24192
    ds_read_b64_tr_b16 v[106:107], v6 offset:24704
    s_waitcnt lgkmcnt(6)
    ds_read_b64_tr_b16 v[108:109], v6 offset:28800
    ds_read_b64_tr_b16 v[110:111], v6 offset:29312
    ds_read_b64_tr_b16 v[112:113], v6 offset:33408
    ds_read_b64_tr_b16 v[114:115], v6 offset:33920
    ds_read_b64_tr_b16 v[116:117], v9 offset:1152
    ds_read_b64_tr_b16 v[118:119], v9 offset:10368
    s_waitcnt lgkmcnt(6)
    ds_read_b64_tr_b16 v[120:121], v6 offset:2304
    ds_read_b64_tr_b16 v[122:123], v6 offset:2816
    ds_read_b64_tr_b16 v[124:125], v6 offset:6912
    ds_read_b64_tr_b16 v[126:127], v6 offset:7424
    ds_read_b64_tr_b16 v[128:129], v6 offset:11520
    ds_read_b64_tr_b16 v[130:131], v6 offset:12032
    s_waitcnt lgkmcnt(6)
    ds_read_b64_tr_b16 v[132:133], v6 offset:16128
    ds_read_b64_tr_b16 v[134:135], v6 offset:16640
    ds_read_b64_tr_b16 v[136:137], v6 offset:20736
    ds_read_b64_tr_b16 v[138:139], v6 offset:21248
    ds_read_b64_tr_b16 v[140:141], v6 offset:25344
    ds_read_b64_tr_b16 v[142:143], v6 offset:25856
    s_waitcnt lgkmcnt(6)
    ds_read_b64_tr_b16 v[144:145], v6 offset:29952
    ds_read_b64_tr_b16 v[146:147], v6 offset:30464
    ds_read_b64_tr_b16 v[148:149], v6 offset:34560
    ds_read_b64_tr_b16 v[150:151], v6 offset:35072
    ds_read_b64_tr_b16 v[152:153], v9 offset:2304
    ds_read_b64_tr_b16 v[154:155], v9 offset:11520
    s_waitcnt lgkmcnt(6)
    ds_read_b64_tr_b16 v[156:157], v6 offset:3456
    ds_read_b64_tr_b16 v[158:159], v6 offset:3968
    ds_read_b64_tr_b16 v[160:161], v6 offset:8064
    ds_read_b64_tr_b16 v[162:163], v6 offset:8576
    ds_read_b64_tr_b16 v[164:165], v6 offset:12672
    ds_read_b64_tr_b16 v[166:167], v6 offset:13184
    s_waitcnt lgkmcnt(6)
    ds_read_b64_tr_b16 v[168:169], v6 offset:17280
    ds_read_b64_tr_b16 v[170:171], v6 offset:17792
    ds_read_b64_tr_b16 v[172:173], v6 offset:21888
    ds_read_b64_tr_b16 v[174:175], v6 offset:22400
    ds_read_b64_tr_b16 v[176:177], v6 offset:26496
    ds_read_b64_tr_b16 v[178:179], v6 offset:27008
    s_waitcnt lgkmcnt(6)
    ds_read_b64_tr_b16 v[180:181], v6 offset:31104
    ds_read_b64_tr_b16 v[182:183], v6 offset:31616
    ds_read_b64_tr_b16 v[184:185], v6 offset:35712
    ds_read_b64_tr_b16 v[186:187], v6 offset:36224
    ds_read_b64_tr_b16 v[188:189], v9 offset:3456
    ds_read_b64_tr_b16 v[190:191], v9 offset:12672
    s_waitcnt lgkmcnt(6)
    s_waitcnt lgkmcnt(0)
    s_mov_b64 exec, 1
    ds_add_u32 v2, v3 offset:2088
    s_mov_b64 exec, -1
LW_88:
    ds_read_b32 v1, v2 offset:2080
    s_waitcnt lgkmcnt(0)
    v_readfirstlane_b32 s73, v1
    s_cmp_ge_u32 s73, 1
    s_cbranch_scc1 LWD_89
    s_sleep 2
    s_sub_u32 s72, s72, 1
    s_cbranch_scc0 LW_88
    s_branch L_bail
LWD_89:
LW_90:
    ds_read_b32 v1, v2 offset:2088
    s_waitcnt lgkmcnt(0)
    v_readfirstlane_b32 s73, v1
    s_cmp_ge_u32 s73, 4
    s_cbranch_scc1 LWD_91
    s_sleep 1
    s_sub_u32 s72, s72, 1
    s_cbranch_scc0 LW_90
    s_branch L_bail
LWD_91:
    s_lshl_b32 s99, s69, 7
    s_add_u32 s99, s99, 5276672
    s_mov_b32 s92, 1024
    s_mov_b32 s88, 5
YL_92:
    s_mov_b32 m0, s92
    s_add_u32 s92, s92, 2048
    buffer_load_dwordx4 v15, s[44:47], s99 offen sc1 lds
    s_add_u32 s99, s99, 67584
    s_mov_b32 m0, s92
    s_add_u32 s92, s92, 2048
    buffer_load_dwordx4 v15, s[44:47], s99 offen sc1 lds
    s_add_u32 s99, s99, 67584
    s_mov_b32 m0, s92
    s_add_u32 s92, s92, 2048
    buffer_load_dwordx4 v15, s[44:47], s99 offen sc1 lds
    s_add_u32 s99, s99, 67584
    s_mov_b32 m0, s92
    s_add_u32 s92, s92, 2048
    buffer_load_dwordx4 v15, s[44:47], s99 offen sc1 lds
    s_add_u32 s99, s99, 67584
    s_mov_b32 m0, s92
    s_add_u32 s92, s92, 2048
    buffer_load_dwordx4 v15, s[44:47], s99 offen sc1 lds
    s_add_u32 s99, s99, 67584
    s_mov_b32 m0, s92
    s_add_u32 s92, s92, 2048
    buffer_load_dwordx4 v15, s[44:47], s99 offen sc1 lds
    s_add_u32 s99, s99, 67584
    s_sub_u32 s88, s88, 1
    s_cbranch_scc0 YL_92
    s_waitcnt vmcnt(18)
    s_mov_b64 exec, 1
    ds_add_u32 v2, v3 offset:2084
    s_mov_b64 exec, -1
LW_93:
    ds_read_b32 v1, v2 offset:2084
    s_waitcnt lgkmcnt(0)
    v_readfirstlane_b32 s73, v1
    s_cmp_ge_u32 s73, 2
    s_cbranch_scc1 LWD_94
    s_sleep 1
    s_sub_u32 s72, s72, 1
    s_cbranch_scc0 LW_93
    s_branch L_bail
LWD_94:
    ds_read_b64_tr_b16 v[236:237], v16 offset:0
    ds_read_b64_tr_b16 v[238:239], v16 offset:512
    ds_read_b64_tr_b16 v[240:241], v16 offset:2048
    ds_read_b64_tr_b16 v[242:243], v16 offset:2560
    ds_read_b64_tr_b16 v[248:249], v17 offset:0
    ds_read_b64_tr_b16 v[250:251], v17 offset:512
    s_waitcnt lgkmcnt(4)
    v_mfma_f32_32x32x16_bf16 v[24:39], v[192:195], v[236:239], 0
    buffer_load_dwordx4 v[192:195], v5, s[44:47], s93 offen offset:0 sc1
    ds_read_b64_tr_b16 v[244:245], v16 offset:4096
    ds_read_b64_tr_b16 v[246:247], v16 offset:4608
    s_waitcnt lgkmcnt(4)
    v_mfma_f32_32x32x16_bf16 v[24:39], v[196:199], v[240:243], v[24:39]
    buffer_load_dwordx4 v[196:199], v5, s[44:47], s93 offen offset:1024 sc1
    ds_read_b64_tr_b16 v[236:237], v16 offset:6144
    ds_read_b64_tr_b16 v[238:239], v16 offset:6656
    s_waitcnt lgkmcnt(4)
    v_mfma_f32_16x16x32_bf16 v[40:43], v[224:227], v[248:251], 0
    buffer_load_dwordx4 v[224:227], v14, s[44:47], s98 offen offset:2048 sc1
    s_add_u32 s98, s98, 4096
    ds_read_b64_tr_b16 v[252:253], v17 offset:4096
    ds_read_b64_tr_b16 v[254:255], v17 offset:4608
    s_waitcnt lgkmcnt(4)
    v_mfma_f32_32x32x16_bf16 v[24:39], v[200:203], v[244:247], v[24:39]
    buffer_load_dwordx4 v[200:203], v5, s[44:47], s93 offen offset:2048 sc1
    ds_read_b64_tr_b16 v[240:241], v16 offset:8192
    ds_read_b64_tr_b16 v[242:243], v16 offset:8704
    s_waitcnt lgkmcnt(4)
    v_mfma_f32_32x32x16_bf16 v[24:39], v[204:207], v[236:239], v[24:39]
    buffer_load_dwordx4 v[204:207], v5, s[44:47], s93 offen offset:3072 sc1
    s_add_u32 s93, s93, 4096
    ds_read_b64_tr_b16 v[244:245], v16 offset:10240
    ds_read_b64_tr_b16 v[246:247], v16 offset:10752
    s_waitcnt lgkmcnt(4)
    v_mfma_f32_16x16x32_bf16 v[40:43], v[228:231], v[252:255], v[40:43]
    buffer_load_dwordx4 v[228:231], v14, s[44:47], s98 offen offset:0 sc1
    ds_read_b64_tr_b16 v[248:249], v17 offset:8192
    ds_read_b64_tr_b16 v[250:251], v17 offset:8704
    s_waitcnt lgkmcnt(4)
    v_mfma_f32_32x32x16_bf16 v[24:39], v[208:211], v[240:243], v[24:39]
    buffer_load_dwordx4 v[208:211], v5, s[44:47], s93 offen offset:0 sc1
    ds_read_b64_tr_b16 v[236:237], v16 offset:12288
    ds_read_b64_tr_b16 v[238:239], v16 offset:12800
    s_waitcnt lgkmcnt(4)
    v_mfma_f32_32x32x16_bf16 v[24:39], v[212:215], v[244:247], v[24:39]
    buffer_load_dwordx4 v[212:215], v5, s[44:47], s93 offen offset:1024 sc1
    ds_read_b64_tr_b16 v[240:241], v16 offset:14336
    ds_read_b64_tr_b16 v[242:243], v16 offset:14848
    s_waitcnt lgkmcnt(4)
    v_mfma_f32_16x16x32_bf16 v[40:43], v[232:235], v[248:251], v[40:43]
    buffer_load_dwordx4 v[232:235], v14, s[44:47], s98 offen offset:2048 sc1
    s_add_u32 s98, s98, 4096
    ds_read_b64_tr_b16 v[252:253], v17 offset:12288
    ds_read_b64_tr_b16 v[254:255], v17 offset:12800
    s_waitcnt lgkmcnt(4)
    v_mfma_f32_32x32x16_bf16 v[24:39], v[216:219], v[236:239], v[24:39]
    buffer_load_dwordx4 v[216:219], v5, s[44:47], s93 offen offset:2048 sc1
    ds_read_b64_tr_b16 v[244:245], v16 offset:16384
    ds_read_b64_tr_b16 v[246:247], v16 offset:16896
    s_waitcnt lgkmcnt(4)
    v_mfma_f32_32x32x16_bf16 v[24:39], v[220:223], v[240:243], v[24:39]
    buffer_load_dwordx4 v[220:223], v5, s[44:47], s93 offen offset:3072 sc1
    s_add_u32 s93, s93, 4096
    ds_read_b64_tr_b16 v[236:237], v16 offset:18432
    ds_read_b64_tr_b16 v[238:239], v16 offset:18944
    s_waitcnt vmcnt(8) lgkmcnt(4)
    v_mfma_f32_16x16x32_bf16 v[40:43], v[224:227], v[252:255], v[40:43]
    buffer_load_dwordx4 v[224:227], v14, s[44:47], s98 offen offset:0 sc1
    ds_read_b64_tr_b16 v[248:249], v17 offset:16384
    ds_read_b64_tr_b16 v[250:251], v17 offset:16896
    s_waitcnt lgkmcnt(4)
    v_mfma_f32_32x32x16_bf16 v[24:39], v[192:195], v[244:247], v[24:39]
    buffer_load_dwordx4 v[192:195], v5, s[44:47], s93 offen offset:0 sc1
    ds_read_b64_tr_b16 v[240:241], v16 offset:20480
    ds_read_b64_tr_b16 v[242:243], v16 offset:20992
    s_mov_b64 exec, 1
    ds_add_u32 v2, v3 offset:2116
    s_mov_b64 exec, -1
    s_waitcnt lgkmcnt(4)
    v_mfma_f32_32x32x16_bf16 v[24:39], v[196:199], v[236:239], v[24:39]
    buffer_load_dwordx4 v[196:199], v5, s[44:47], s93 offen offset:1024 sc1
    ds_read_b64_tr_b16 v[244:245], v16 offset:22528
    ds_read_b64_tr_b16 v[246:247], v16 offset:23040
    s_waitcnt vmcnt(8) lgkmcnt(4)
    v_mfma_f32_16x16x32_bf16 v[40:43], v[228:231], v[248:251], v[40:43]
    buffer_load_dwordx4 v[228:231], v14, s[44:47], s98 offen offset:2048 sc1
    s_add_u32 s98, s98, 4096
    ds_read_b64_tr_b16 v[252:253], v17 offset:20480
    ds_read_b64_tr_b16 v[254:255], v17 offset:20992
    s_waitcnt lgkmcnt(4)
    v_mfma_f32_32x32x16_bf16 v[24:39], v[200:203], v[240:243], v[24:39]
    buffer_load_dwordx4 v[200:203], v5, s[44:47], s93 offen offset:2048 sc1
    ds_read_b64_tr_b16 v[236:237], v16 offset:24576
    ds_read_b64_tr_b16 v[238:239], v16 offset:25088
    s_waitcnt lgkmcnt(4)
    v_mfma_f32_32x32x16_bf16 v[24:39], v[204:207], v[244:247], v[24:39]
    buffer_load_dwordx4 v[204:207], v5, s[44:47], s93 offen offset:3072 sc1
    s_add_u32 s93, s93, 4096
    ds_read_b64_tr_b16 v[240:241], v16 offset:26624
    ds_read_b64_tr_b16 v[242:243], v16 offset:27136
    s_waitcnt vmcnt(8) lgkmcnt(4)
    v_mfma_f32_16x16x32_bf16 v[40:43], v[232:235], v[252:255], v[40:43]
    buffer_load_dwordx4 v[232:235], v14, s[44:47], s98 offen offset:0 sc1
    ds_read_b64_tr_b16 v[248:249], v17 offset:24576
    ds_read_b64_tr_b16 v[250:251], v17 offset:25088
    s_waitcnt lgkmcnt(4)
    v_mfma_f32_32x32x16_bf16 v[24:39], v[208:211], v[236:239], v[24:39]
    buffer_load_dwordx4 v[208:211], v5, s[44:47], s93 offen offset:0 sc1
    ds_read_b64_tr_b16 v[244:245], v16 offset:28672
    ds_read_b64_tr_b16 v[246:247], v16 offset:29184
    s_waitcnt lgkmcnt(4)
    v_mfma_f32_32x32x16_bf16 v[24:39], v[212:215], v[240:243], v[24:39]
    buffer_load_dwordx4 v[212:215], v5, s[44:47], s93 offen offset:1024 sc1
    ds_read_b64_tr_b16 v[236:237], v16 offset:30720
    ds_read_b64_tr_b16 v[238:239], v16 offset:31232
    s_waitcnt vmcnt(8) lgkmcnt(4)
    v_mfma_f32_16x16x32_bf16 v[40:43], v[224:227], v[248:251], v[40:43]
    buffer_load_dwordx4 v[224:227], v14, s[44:47], s98 offen offset:2048 sc1
    s_add_u32 s98, s98, 4096
    ds_read_b64_tr_b16 v[252:253], v17 offset:28672
    ds_read_b64_tr_b16 v[254:255], v17 offset:29184
    s_waitcnt lgkmcnt(4)
    v_mfma_f32_32x32x16_bf16 v[24:39], v[216:219], v[244:247], v[24:39]
    buffer_load_dwordx4 v[216:219], v5, s[44:47], s93 offen offset:2048 sc1
    ds_read_b64_tr_b16 v[240:241], v16 offset:32768
    ds_read_b64_tr_b16 v[242:243], v16 offset:33280
    s_waitcnt lgkmcnt(4)
    v_mfma_f32_32x32x16_bf16 v[24:39], v[220:223], v[236:239], v[24:39]
    buffer_load_dwordx4 v[220:223], v5, s[44:47], s93 offen offset:3072 sc1
    s_add_u32 s93, s93, 4096
    ds_read_b64_tr_b16 v[244:245], v16 offset:34816
    ds_read_b64_tr_b16 v[246:247], v16 offset:35328
    s_waitcnt vmcnt(8) lgkmcnt(4)
    v_mfma_f32_16x16x32_bf16 v[40:43], v[228:231], v[252:255], v[40:43]
    buffer_load_dwordx4 v[228:231], v14, s[44:47], s98 offen offset:0 sc1
    ds_read_b64_tr_b16 v[248:249], v17 offset:32768
    ds_read_b64_tr_b16 v[250:251], v17 offset:33280
    s_waitcnt lgkmcnt(4)
    v_mfma_f32_32x32x16_bf16 v[24:39], v[192:195], v[240:243], v[24:39]
    buffer_load_dwordx4 v[192:195], v5, s[44:47], s93 offen offset:0 sc1
    s_waitcnt lgkmcnt(2)
    v_mfma_f32_32x32x16_bf16 v[24:39], v[196:199], v[244:247], v[24:39]
    buffer_load_dwordx4 v[196:199], v5, s[44:47], s93 offen offset:1024 sc1
    s_waitcnt vmcnt(8) lgkmcnt(0)
    v_mfma_f32_16x16x32_bf16 v[40:43], v[232:235], v[248:251], v[40:43]
    buffer_load_dwordx4 v[232:235], v14, s[44:47], s98 offen offset:2048 sc1
    s_add_u32 s98, s98, 4096
LW_95:
    ds_read_b32 v1, v2 offset:2116
    s_waitcnt lgkmcnt(0)
    v_readfirstlane_b32 s73, v1
    s_cmp_ge_u32 s73, 2
    s_cbranch_scc1 LWD_96
    s_sleep 1
    s_sub_u32 s72, s72, 1
    s_cbranch_scc0 LW_95
    s_branch L_bail
LWD_96:
    ds_read_b64_tr_b16 v[236:237], v7 offset:0
    ds_read_b64_tr_b16 v[238:239], v7 offset:512
    ds_read_b64_tr_b16 v[240:241], v7 offset:2048
    ds_read_b64_tr_b16 v[242:243], v7 offset:2560
    ds_read_b64_tr_b16 v[252:253], v8 offset:0
    ds_read_b64_tr_b16 v[254:255], v8 offset:512
    s_waitcnt lgkmcnt(4)
    v_mfma_f32_32x32x16_bf16 v[24:39], v[200:203], v[236:239], v[24:39]
    buffer_load_dwordx4 v[200:203], v5, s[44:47], s93 offen offset:2048 sc1
    ds_read_b64_tr_b16 v[244:245], v7 offset:4096
    ds_read_b64_tr_b16 v[246:247], v7 offset:4608
    s_waitcnt lgkmcnt(4)
    v_mfma_f32_32x32x16_bf16 v[24:39], v[204:207], v[240:243], v[24:39]
    buffer_load_dwordx4 v[204:207], v5, s[44:47], s93 offen offset:3072 sc1
    s_add_u32 s93, s93, 4096
    ds_read_b64_tr_b16 v[236:237], v7 offset:6144
    ds_read_b64_tr_b16 v[238:239], v7 offset:6656
    s_waitcnt vmcnt(8) lgkmcnt(4)
    v_mfma_f32_16x16x32_bf16 v[40:43], v[224:227], v[252:255], v[40:43]
    buffer_load_dwordx4 v[224:227], v14, s[44:47], s98 offen offset:0 sc1
    ds_read_b64_tr_b16 v[248:249], v8 offset:4096
    ds_read_b64_tr_b16 v[250:251], v8 offset:4608
    s_waitcnt lgkmcnt(4)
    v_mfma_f32_32x32x16_bf16 v[24:39], v[208:211], v[244:247], v[24:39]
    buffer_load_dwordx4 v[208:211], v5, s[44:47], s93 offen offset:0 sc1
    ds_read_b64_tr_b16 v[240:241], v7 offset:8192
    ds_read_b64_tr_b16 v[242:243], v7 offset:8704
    s_waitcnt lgkmcnt(4)
    v_mfma_f32_32x32x16_bf16 v[24:39], v[212:215], v[236:239], v[24:39]
    buffer_load_dwordx4 v[212:215], v5, s[44:47], s93 offen offset:1024 sc1
    ds_read_b64_tr_b16 v[244:245], v7 offset:10240
    ds_read_b64_tr_b16 v[246:247], v7 offset:10752
    s_waitcnt vmcnt(8) lgkmcnt(4)
    v_mfma_f32_16x16x32_bf16 v[40:43], v[228:231], v[248:251], v[40:43]
    buffer_load_dwordx4 v[228:231], v14, s[44:47], s98 offen offset:2048 sc1
    s_add_u32 s98, s98, 4096
    ds_read_b64_tr_b16 v[252:253], v8 offset:8192
    ds_read_b64_tr_b16 v[254:255], v8 offset:8704
    s_waitcnt lgkmcnt(4)
    v_mfma_f32_32x32x16_bf16 v[24:39], v[216:219], v[240:243], v[24:39]
    buffer_load_dwordx4 v[216:219], v5, s[44:47], s93 offen offset:2048 sc1
    ds_read_b64_tr_b16 v[236:237], v7 offset:12288
    ds_read_b64_tr_b16 v[238:239], v7 offset:12800
    s_waitcnt lgkmcnt(4)
    v_mfma_f32_32x32x16_bf16 v[24:39], v[220:223], v[244:247], v[24:39]
    buffer_load_dwordx4 v[220:223], v5, s[44:47], s93 offen offset:3072 sc1
    s_add_u32 s93, s93, 4096
    ds_read_b64_tr_b16 v[240:241], v7 offset:14336
    ds_read_b64_tr_b16 v[242:243], v7 offset:14848
    s_waitcnt vmcnt(8) lgkmcnt(4)
    v_mfma_f32_16x16x32_bf16 v[40:43], v[232:235], v[252:255], v[40:43]
    buffer_load_dwordx4 v[232:235], v14, s[44:47], s98 offen offset:0 sc1
    ds_read_b64_tr_b16 v[248:249], v8 offset:12288
    ds_read_b64_tr_b16 v[250:251], v8 offset:12800
    s_waitcnt lgkmcnt(4)
    v_mfma_f32_32x32x16_bf16 v[24:39], v[192:195], v[236:239], v[24:39]
    buffer_load_dwordx4 v[192:195], v5, s[44:47], s93 offen offset:0 sc1
    ds_read_b64_tr_b16 v[244:245], v7 offset:16384
    ds_read_b64_tr_b16 v[246:247], v7 offset:16896
    s_waitcnt lgkmcnt(4)
    v_mfma_f32_32x32x16_bf16 v[24:39], v[196:199], v[240:243], v[24:39]
    buffer_load_dwordx4 v[196:199], v5, s[44:47], s93 offen offset:1024 sc1
    ds_read_b64_tr_b16 v[236:237], v7 offset:18432
    ds_read_b64_tr_b16 v[238:239], v7 offset:18944
    s_waitcnt vmcnt(8) lgkmcnt(4)
    v_mfma_f32_16x16x32_bf16 v[40:43], v[224:227], v[248:251], v[40:43]
    buffer_load_dwordx4 v[224:227], v14, s[44:47], s98 offen offset:2048 sc1
    s_add_u32 s98, s98, 4096
    ds_read_b64_tr_b16 v[252:253], v8 offset:16384
    ds_read_b64_tr_b16 v[254:255], v8 offset:16896
    s_waitcnt lgkmcnt(4)
    v_mfma_f32_32x32x16_bf16 v[24:39], v[200:203], v[244:247], v[24:39]
    buffer_load_dwordx4 v[200:203], v5, s[44:47], s93 offen offset:2048 sc1
    ds_read_b64_tr_b16 v[240:241], v7 offset:20480
    ds_read_b64_tr_b16 v[242:243], v7 offset:20992
    s_waitcnt lgkmcnt(4)
    v_mfma_f32_32x32x16_bf16 v[24:39], v[204:207], v[236:239], v[24:39]
    buffer_load_dwordx4 v[204:207], v5, s[44:47], s93 offen offset:3072 sc1
    s_add_u32 s93, s93, 4096
    ds_read_b64_tr_b16 v[244:245], v7 offset:22528
    ds_read_b64_tr_b16 v[246:247], v7 offset:23040
    s_waitcnt vmcnt(8) lgkmcnt(4)
    v_mfma_f32_16x16x32_bf16 v[40:43], v[228:231], v[252:255], v[40:43]
    buffer_load_dwordx4 v[228:231], v14, s[44:47], s98 offen offset:0 sc1
    ds_read_b64_tr_b16 v[248:249], v8 offset:20480
    ds_read_b64_tr_b16 v[250:251], v8 offset:20992
    s_waitcnt lgkmcnt(4)
    v_mfma_f32_32x32x16_bf16 v[24:39], v[208:211], v[240:243], v[24:39]
    ds_read_b64_tr_b16 v[236:237], v7 offset:24576
    ds_read_b64_tr_b16 v[238:239], v7 offset:25088
    s_waitcnt lgkmcnt(4)
    v_mfma_f32_32x32x16_bf16 v[24:39], v[212:215], v[244:247], v[24:39]
    ds_read_b64_tr_b16 v[240:241], v7 offset:26624
    ds_read_b64_tr_b16 v[242:243], v7 offset:27136
    s_waitcnt vmcnt(6) lgkmcnt(4)
    v_mfma_f32_16x16x32_bf16 v[40:43], v[232:235], v[248:251], v[40:43]
    buffer_load_dwordx4 v[232:235], v14, s[44:47], s98 offen offset:2048 sc1
    s_add_u32 s98, s98, 4096
    ds_read_b64_tr_b16 v[252:253], v8 offset:24576
    ds_read_b64_tr_b16 v[254:255], v8 offset:25088
    s_waitcnt lgkmcnt(4)
    v_mfma_f32_32x32x16_bf16 v[24:39], v[216:219], v[236:239], v[24:39]
    ds_read_b64_tr_b16 v[244:245], v7 offset:28672
    ds_read_b64_tr_b16 v[246:247], v7 offset:29184
    s_waitcnt lgkmcnt(4)
    v_mfma_f32_32x32x16_bf16 v[24:39], v[220:223], v[240:243], v[24:39]
    ds_read_b64_tr_b16 v[236:237], v7 offset:30720
    ds_read_b64_tr_b16 v[238:239], v7 offset:31232
    s_waitcnt vmcnt(4) lgkmcnt(4)
    v_mfma_f32_16x16x32_bf16 v[40:43], v[224:227], v[252:255], v[40:43]
    ds_read_b64_tr_b16 v[248:249], v8 offset:28672
    ds_read_b64_tr_b16 v[250:251], v8 offset:29184
    s_waitcnt lgkmcnt(4)
    v_mfma_f32_32x32x16_bf16 v[24:39], v[192:195], v[244:247], v[24:39]
    ds_read_b64_tr_b16 v[240:241], v7 offset:32768
    ds_read_b64_tr_b16 v[242:243], v7 offset:33280
    s_waitcnt lgkmcnt(4)
    v_mfma_f32_32x32x16_bf16 v[24:39], v[196:199], v[236:239], v[24:39]
    ds_read_b64_tr_b16 v[244:245], v7 offset:34816
    ds_read_b64_tr_b16 v[246:247], v7 offset:35328
    s_waitcnt vmcnt(1) lgkmcnt(4)
    v_mfma_f32_16x16x32_bf16 v[40:43], v[228:231], v[248:251], v[40:43]
    ds_read_b64_tr_b16 v[252:253], v8 offset:32768
    ds_read_b64_tr_b16 v[254:255], v8 offset:33280
    s_waitcnt lgkmcnt(4)
    v_mfma_f32_32x32x16_bf16 v[24:39], v[200:203], v[240:243], v[24:39]
    s_waitcnt lgkmcnt(2)
    v_mfma_f32_32x32x16_bf16 v[24:39], v[204:207], v[244:247], v[24:39]
    s_waitcnt vmcnt(0) lgkmcnt(0)
    v_mfma_f32_16x16x32_bf16 v[40:43], v[232:235], v[252:255], v[40:43]
    s_mov_b32 s52, s22
    s_mov_b32 s53, s23
    s_mov_b32 s54, 2359296
    s_mov_b32 s55, 0x20000
    s_mul_i32 s93, s69, 2304
    s_add_u32 s93, s93, s95
    s_add_u32 s93, s93, 1152
    s_add_u32 s92, s93, 0
    s_nop 1
    v_pk_mul_f32 v[24:25], v[24:25], v[44:45] op_sel:[0,1] op_sel_hi:[1,1]
    v_pk_mul_f32 v[26:27], v[26:27], v[44:45] op_sel:[0,1] op_sel_hi:[1,1]
    v_pk_mul_f32 v[28:29], v[28:29], v[44:45] op_sel:[0,1] op_sel_hi:[1,1]
    v_pk_mul_f32 v[30:31], v[30:31], v[44:45] op_sel:[0,1] op_sel_hi:[1,1]
    v_pk_mul_f32 v[32:33], v[32:33], v[44:45] op_sel:[0,1] op_sel_hi:[1,1]
    v_pk_mul_f32 v[34:35], v[34:35], v[44:45] op_sel:[0,1] op_sel_hi:[1,1]
    v_pk_mul_f32 v[36:37], v[36:37], v[44:45] op_sel:[0,1] op_sel_hi:[1,1]
    v_pk_mul_f32 v[38:39], v[38:39], v[44:45] op_sel:[0,1] op_sel_hi:[1,1]
    v_pk_mul_f32 v[40:41], v[40:41], v[46:47] op_sel_hi:[1,0]
    v_pk_mul_f32 v[42:43], v[42:43], v[46:47] op_sel_hi:[1,0]
LW_97:
    ds_read_b32 v1, v2 offset:1024
    s_waitcnt lgkmcnt(0)
    v_readfirstlane_b32 s73, v1
    s_cmp_ge_u32 s73, 4
    s_cbranch_scc1 LWD_98
    s_sleep 4
    s_sub_u32 s72, s72, 1
    s_cbranch_scc0 LW_97
    s_branch L_bail
LWD_98:
    ds_read_b128 v[192:195], v20 offset:0
    ds_read_b128 v[196:199], v20 offset:1024
    ds_read_b64 v[200:201], v21 offset:0
    ds_read_b32 v202, v22 offset:0
    ds_read_b128 v[204:207], v20 offset:2560
    ds_read_b128 v[208:211], v20 offset:3584
    ds_read_b64 v[212:213], v21 offset:2560
    ds_read_b32 v214, v22 offset:2560
    s_add_u32 s90, s96, 36864
    s_add_u32 s91, s97, 36864
    s_movk_i32 s89, 4
    ds_read_b128 v[216:219], v20 offset:5120
    ds_read_b128 v[220:223], v20 offset:6144
    ds_read_b64 v[224:225], v21 offset:5120
    ds_read_b32 v226, v22 offset:5120
    s_waitcnt lgkmcnt(4)
    ds_read_b128 v[228:231], v20 offset:7680
    ds_read_b128 v[232:235], v20 offset:8704
    ds_read_b64 v[236:237], v21 offset:7680
    ds_read_b32 v238, v22 offset:7680
    v_pk_add_f32 v[192:193], v[192:193], v[204:205]
    v_pk_add_f32 v[194:195], v[194:195], v[206:207]
    v_pk_add_f32 v[196:197], v[196:197], v[208:209]
    v_pk_add_f32 v[198:199], v[198:199], v[210:211]
    v_pk_add_f32 v[200:201], v[200:201], v[212:213]
    v_add_f32 v202, v202, v214
    s_waitcnt lgkmcnt(4)
    v_pk_add_f32 v[192:193], v[192:193], v[216:217]
    v_pk_add_f32 v[194:195], v[194:195], v[218:219]
    v_pk_add_f32 v[196:197], v[196:197], v[220:221]
    v_pk_add_f32 v[198:199], v[198:199], v[222:223]
    v_pk_add_f32 v[200:201], v[200:201], v[224:225]
    v_add_f32 v202, v202, v226
    s_waitcnt lgkmcnt(0)
    v_pk_add_f32 v[192:193], v[192:193], v[228:229]
    v_pk_add_f32 v[194:195], v[194:195], v[230:231]
    v_pk_add_f32 v[196:197], v[196:197], v[232:233]
    v_pk_add_f32 v[198:199], v[198:199], v[234:235]
    v_pk_add_f32 v[200:201], v[200:201], v[236:237]
    v_add_f32 v202, v202, v238
    v_pk_mul_f32 v[204:205], v[192:193], 0 op_sel_hi:[1,0]
    v_pk_fma_f32 v[204:205], v[194:195], 0, v[204:205] op_sel_hi:[1,0,1]
    v_pk_fma_f32 v[204:205], v[196:197], 0, v[204:205] op_sel_hi:[1,0,1]
    v_pk_fma_f32 v[204:205], v[198:199], 0, v[204:205] op_sel_hi:[1,0,1]
    v_pk_fma_f32 v[204:205], v[200:201], 0, v[204:205] op_sel_hi:[1,0,1]
    v_add_f32 v204, v204, v205
    v_subrev_u32 v205, 0x21800000, v202
    v_cmp_u_f32 vcc, v204, v204
    s_mov_b32 s73, 0x3e000000
    v_cmp_lt_u32 s[74:75], s73, v205
    s_or_b64 vcc, vcc, s[74:75]
    s_cmp_eq_u64 vcc, 0
    s_cbranch_scc1 SOK_99
    s_call_b64 s[86:87], L_fallback
SOK_99:
    v_rcp_f32 v202, v202
    s_nop 0
    v_mul_f32 v202, v4, v202
    v_pk_mul_f32 v[192:193], v[192:193], v[202:203] op_sel_hi:[1,0]
    v_pk_mul_f32 v[194:195], v[194:195], v[202:203] op_sel_hi:[1,0]
    v_pk_mul_f32 v[196:197], v[196:197], v[202:203] op_sel_hi:[1,0]
    v_pk_mul_f32 v[198:199], v[198:199], v[202:203] op_sel_hi:[1,0]
    v_pk_mul_f32 v[200:201], v[200:201], v[202:203] op_sel_hi:[1,0]
    v_cvt_pk_bf16_f32 v204, v192, v193
    v_cvt_pk_bf16_f32 v205, v194, v195
    v_cvt_pk_bf16_f32 v206, v196, v197
    v_cvt_pk_bf16_f32 v207, v198, v199
    v_cvt_pk_bf16_f32 v208, v200, v201
    v_min_u32 v204, -2, v204
    v_min_u32 v208, -2, v208
    buffer_store_dwordx4 v[204:207], v5, s[44:47], s90 offen sc1
    s_mov_b32 exec_hi, 0
    buffer_store_dword v208, v5, s[44:47], s91 offen sc1
    s_mov_b64 exec, -1
    ds_read_b64_tr_b16 v[248:249], v10 offset:0
    ds_read_b64_tr_b16 v[250:251], v10 offset:128
    ds_read_b64_tr_b16 v[252:253], v10 offset:2304
    ds_read_b64_tr_b16 v[254:255], v10 offset:2432
CL_100:
    s_add_u32 s90, s94, 9216
    buffer_load_dwordx4 v[192:195], v5, s[44:47], s90 offen offset:0 sc1
    buffer_load_dwordx4 v[196:199], v5, s[44:47], s90 offen offset:1024 sc1
    buffer_load_dwordx4 v[228:231], v12, s[44:47], s90 offen offset:0 sc1
    buffer_load_dwordx4 v[200:203], v5, s[44:47], s90 offen offset:2048 sc1
    buffer_load_dwordx4 v[204:207], v5, s[44:47], s90 offen offset:3072 sc1
    buffer_load_dwordx4 v[232:235], v12, s[44:47], s90 offen offset:2048 sc1
    s_add_u32 s90, s94, 13312
    buffer_load_dwordx4 v[208:211], v5, s[44:47], s90 offen offset:0 sc1
    buffer_load_dwordx4 v[212:215], v5, s[44:47], s90 offen offset:1024 sc1
    buffer_load_dwordx4 v[236:239], v12, s[44:47], s90 offen offset:0 sc1
    buffer_load_dwordx4 v[216:219], v5, s[44:47], s90 offen offset:2048 sc1
    buffer_load_dwordx4 v[220:223], v5, s[44:47], s90 offen offset:3072 sc1
    buffer_load_dwordx4 v[240:243], v12, s[44:47], s90 offen offset:2048 sc1
    s_add_u32 s90, s94, 17408
    buffer_load_dwordx4 v[224:227], v5, s[44:47], s90 offen offset:0 sc1
    buffer_load_dwordx4 v[244:247], v13, s[44:47], s90 offen offset:0 sc1
    s_waitcnt vmcnt(12)
    v_max_u32 v1, v192, v196
    s_waitcnt vmcnt(10)
    v_max3_u32 v1, v1, v228, v200
    s_waitcnt vmcnt(8)
    v_max3_u32 v1, v1, v204, v232
    s_waitcnt vmcnt(6)
    v_max3_u32 v1, v1, v208, v212
    s_waitcnt vmcnt(4)
    v_max3_u32 v1, v1, v236, v216
    s_waitcnt vmcnt(2)
    v_max3_u32 v1, v1, v220, v240
    s_waitcnt vmcnt(1)
    v_max3_u32 v1, v1, v224, v225
    s_waitcnt vmcnt(1)
    v_max3_u32 v1, v1, v226, v227
    s_waitcnt vmcnt(0)
    v_max3_u32 v1, v1, v244, v245
    s_waitcnt vmcnt(0)
    v_max3_u32 v1, v1, v246, v247
    v_cmp_eq_u32 vcc, -1, v1
    s_cmp_eq_u64 vcc, 0
    s_cbranch_scc1 CD_101
    s_sleep 8
    s_sub_u32 s72, s72, 1
    s_cbranch_scc0 CL_100
    s_branch L_bail
CD_101:
    v_mfma_f32_32x32x16_bf16 v[24:39], v[48:51], v[192:195], v[24:39]
    v_mfma_f32_32x32x16_bf16 v[24:39], v[52:55], v[196:199], v[24:39]
    s_waitcnt lgkmcnt(2)
    v_mfma_f32_16x16x32_bf16 v[40:43], v[248:251], v[228:231], v[40:43]
    ds_read_b64_tr_b16 v[248:249], v10 offset:4608
    ds_read_b64_tr_b16 v[250:251], v10 offset:4736
    v_mfma_f32_32x32x16_bf16 v[24:39], v[56:59], v[200:203], v[24:39]
    v_mfma_f32_32x32x16_bf16 v[24:39], v[60:63], v[204:207], v[24:39]
    s_waitcnt lgkmcnt(2)
    v_mfma_f32_16x16x32_bf16 v[40:43], v[252:255], v[232:235], v[40:43]
    ds_read_b64_tr_b16 v[252:253], v10 offset:6912
    ds_read_b64_tr_b16 v[254:255], v10 offset:7040
    v_mfma_f32_32x32x16_bf16 v[24:39], v[64:67], v[208:211], v[24:39]
    v_mfma_f32_32x32x16_bf16 v[24:39], v[68:71], v[212:215], v[24:39]
    s_waitcnt lgkmcnt(2)
    v_mfma_f32_16x16x32_bf16 v[40:43], v[248:251], v[236:239], v[40:43]
    ds_read_b64_tr_b16 v[248:249], v11 offset:0
    ds_read_b64_tr_b16 v[250:251], v11 offset:2304
    v_mfma_f32_32x32x16_bf16 v[24:39], v[72:75], v[216:219], v[24:39]
    v_mfma_f32_32x32x16_bf16 v[24:39], v[76:79], v[220:223], v[24:39]
    s_waitcnt lgkmcnt(2)
    v_mfma_f32_16x16x32_bf16 v[40:43], v[252:255], v[240:243], v[40:43]
    v_mfma_f32_32x32x16_bf16 v[24:39], v[80:83], v[224:227], v[24:39]
    s_waitcnt lgkmcnt(0)
    v_mfma_f32_16x16x32_bf16 v[40:43], v[248:251], v[244:247], v[40:43]
    ds_read_b64_tr_b16 v[248:249], v10 offset:288
    ds_read_b64_tr_b16 v[250:251], v10 offset:416
    ds_read_b64_tr_b16 v[252:253], v10 offset:2592
    ds_read_b64_tr_b16 v[254:255], v10 offset:2720
CL_102:
    s_add_u32 s90, s94, 27648
    buffer_load_dwordx4 v[192:195], v5, s[44:47], s90 offen offset:0 sc1
    buffer_load_dwordx4 v[196:199], v5, s[44:47], s90 offen offset:1024 sc1
    buffer_load_dwordx4 v[228:231], v12, s[44:47], s90 offen offset:0 sc1
    buffer_load_dwordx4 v[200:203], v5, s[44:47], s90 offen offset:2048 sc1
    buffer_load_dwordx4 v[204:207], v5, s[44:47], s90 offen offset:3072 sc1
    buffer_load_dwordx4 v[232:235], v12, s[44:47], s90 offen offset:2048 sc1
    s_add_u32 s90, s94, 31744
    buffer_load_dwordx4 v[208:211], v5, s[44:47], s90 offen offset:0 sc1
    buffer_load_dwordx4 v[212:215], v5, s[44:47], s90 offen offset:1024 sc1
    buffer_load_dwordx4 v[236:239], v12, s[44:47], s90 offen offset:0 sc1
    buffer_load_dwordx4 v[216:219], v5, s[44:47], s90 offen offset:2048 sc1
    buffer_load_dwordx4 v[220:223], v5, s[44:47], s90 offen offset:3072 sc1
    buffer_load_dwordx4 v[240:243], v12, s[44:47], s90 offen offset:2048 sc1
    s_add_u32 s90, s94, 35840
    buffer_load_dwordx4 v[224:227], v5, s[44:47], s90 offen offset:0 sc1
    buffer_load_dwordx4 v[244:247], v13, s[44:47], s90 offen offset:0 sc1
    s_waitcnt vmcnt(12)
    v_max_u32 v1, v192, v196
    s_waitcnt vmcnt(10)
    v_max3_u32 v1, v1, v228, v200
    s_waitcnt vmcnt(8)
    v_max3_u32 v1, v1, v204, v232
    s_waitcnt vmcnt(6)
    v_max3_u32 v1, v1, v208, v212
    s_waitcnt vmcnt(4)
    v_max3_u32 v1, v1, v236, v216
    s_waitcnt vmcnt(2)
    v_max3_u32 v1, v1, v220, v240
    s_waitcnt vmcnt(1)
    v_max3_u32 v1, v1, v224, v225
    s_waitcnt vmcnt(1)
    v_max3_u32 v1, v1, v226, v227
    s_waitcnt vmcnt(0)
    v_max3_u32 v1, v1, v244, v245
    s_waitcnt vmcnt(0)
    v_max3_u32 v1, v1, v246, v247
    v_cmp_eq_u32 vcc, -1, v1
    s_cmp_eq_u64 vcc, 0
    s_cbranch_scc1 CD_103
    s_sleep 8
    s_sub_u32 s72, s72, 1
    s_cbranch_scc0 CL_102
    s_branch L_bail
CD_103:
    v_mfma_f32_32x32x16_bf16 v[24:39], v[84:87], v[192:195], v[24:39]
    v_mfma_f32_32x32x16_bf16 v[24:39], v[88:91], v[196:199], v[24:39]
    s_waitcnt lgkmcnt(2)
    v_mfma_f32_16x16x32_bf16 v[40:43], v[248:251], v[228:231], v[40:43]
    ds_read_b64_tr_b16 v[248:249], v10 offset:4896
    ds_read_b64_tr_b16 v[250:251], v10 offset:5024
    v_mfma_f32_32x32x16_bf16 v[24:39], v[92:95], v[200:203], v[24:39]
    v_mfma_f32_32x32x16_bf16 v[24:39], v[96:99], v[204:207], v[24:39]
    s_waitcnt lgkmcnt(2)
    v_mfma_f32_16x16x32_bf16 v[40:43], v[252:255], v[232:235], v[40:43]
    ds_read_b64_tr_b16 v[252:253], v10 offset:7200
    ds_read_b64_tr_b16 v[254:255], v10 offset:7328
    v_mfma_f32_32x32x16_bf16 v[24:39], v[100:103], v[208:211], v[24:39]
    v_mfma_f32_32x32x16_bf16 v[24:39], v[104:107], v[212:215], v[24:39]
    s_waitcnt lgkmcnt(2)
    v_mfma_f32_16x16x32_bf16 v[40:43], v[248:251], v[236:239], v[40:43]
    ds_read_b64_tr_b16 v[248:249], v11 offset:288
    ds_read_b64_tr_b16 v[250:251], v11 offset:2592
    v_mfma_f32_32x32x16_bf16 v[24:39], v[108:111], v[216:219], v[24:39]
    v_mfma_f32_32x32x16_bf16 v[24:39], v[112:115], v[220:223], v[24:39]
    s_waitcnt lgkmcnt(2)
    v_mfma_f32_16x16x32_bf16 v[40:43], v[252:255], v[240:243], v[40:43]
    v_mfma_f32_32x32x16_bf16 v[24:39], v[116:119], v[224:227], v[24:39]
    s_waitcnt lgkmcnt(0)
    v_mfma_f32_16x16x32_bf16 v[40:43], v[248:251], v[244:247], v[40:43]
LW_104:
    ds_read_b32 v1, v2 offset:1536
    s_waitcnt lgkmcnt(0)
    v_readfirstlane_b32 s73, v1
    s_cmp_ge_u32 s73, 4
    s_cbranch_scc1 LWD_105
    s_sleep 4
    s_sub_u32 s72, s72, 1
    s_cbranch_scc0 LW_104
    s_branch L_bail
LWD_105:
    ds_read_b64_tr_b16 v[248:249], v10 offset:576
    ds_read_b64_tr_b16 v[250:251], v10 offset:704
    ds_read_b64_tr_b16 v[252:253], v10 offset:2880
    ds_read_b64_tr_b16 v[254:255], v10 offset:3008
CP_106:
    s_add_u32 s90, s94, 54272
    buffer_load_dwordx4 v[192:195], v5, s[44:47], s90 offen sc1
    s_waitcnt vmcnt(0)
    v_max_u32 v1, v192, v193
    v_max3_u32 v1, v1, v194, v195
    v_cmp_eq_u32 vcc, -1, v1
    s_cmp_eq_u64 vcc, 0
    s_cbranch_scc1 CQ_107
    s_sleep 8
    s_sub_u32 s72, s72, 1
    s_cbranch_scc0 CP_106
    s_branch L_bail
CQ_107:
CL_108:
    s_add_u32 s90, s94, 46080
    buffer_load_dwordx4 v[192:195], v5, s[44:47], s90 offen offset:0 sc1
    buffer_load_dwordx4 v[196:199], v5, s[44:47], s90 offen offset:1024 sc1
    buffer_load_dwordx4 v[228:231], v12, s[44:47], s90 offen offset:0 sc1
    buffer_load_dwordx4 v[200:203], v5, s[44:47], s90 offen offset:2048 sc1
    buffer_load_dwordx4 v[204:207], v5, s[44:47], s90 offen offset:3072 sc1
    buffer_load_dwordx4 v[232:235], v12, s[44:47], s90 offen offset:2048 sc1
    s_add_u32 s90, s94, 50176
    buffer_load_dwordx4 v[208:211], v5, s[44:47], s90 offen offset:0 sc1
    buffer_load_dwordx4 v[212:215], v5, s[44:47], s90 offen offset:1024 sc1
    buffer_load_dwordx4 v[236:239], v12, s[44:47], s90 offen offset:0 sc1
    buffer_load_dwordx4 v[216:219], v5, s[44:47], s90 offen offset:2048 sc1
    buffer_load_dwordx4 v[220:223], v5, s[44:47], s90 offen offset:3072 sc1
    buffer_load_dwordx4 v[240:243], v12, s[44:47], s90 offen offset:2048 sc1
    s_add_u32 s90, s94, 54272
    buffer_load_dwordx4 v[224:227], v5, s[44:47], s90 offen offset:0 sc1
    buffer_load_dwordx4 v[244:247], v13, s[44:47], s90 offen offset:0 sc1
    s_waitcnt vmcnt(12)
    v_max_u32 v1, v192, v196
    s_waitcnt vmcnt(10)
    v_max3_u32 v1, v1, v228, v200
    s_waitcnt vmcnt(8)
    v_max3_u32 v1, v1, v204, v232
    s_waitcnt vmcnt(6)
    v_max3_u32 v1, v1, v208, v212
    s_waitcnt vmcnt(4)
    v_max3_u32 v1, v1, v236, v216
    s_waitcnt vmcnt(2)
    v_max3_u32 v1, v1, v220, v240
    s_waitcnt vmcnt(1)
    v_max3_u32 v1, v1, v224, v225
    s_waitcnt vmcnt(1)
    v_max3_u32 v1, v1, v226, v227
    s_waitcnt vmcnt(0)
    v_max3_u32 v1, v1, v244, v245
    s_waitcnt vmcnt(0)
    v_max3_u32 v1, v1, v246, v247
    v_cmp_eq_u32 vcc, -1, v1
    s_cmp_eq_u64 vcc, 0
    s_cbranch_scc1 CD_109
    s_sleep 8
    s_sub_u32 s72, s72, 1
    s_cbranch_scc0 CL_108
    s_branch L_bail
CD_109:
    v_mfma_f32_32x32x16_bf16 v[24:39], v[120:123], v[192:195], v[24:39]
    v_mfma_f32_32x32x16_bf16 v[24:39], v[124:127], v[196:199], v[24:39]
    s_waitcnt lgkmcnt(2)
    v_mfma_f32_16x16x32_bf16 v[40:43], v[248:251], v[228:231], v[40:43]
    ds_read_b64_tr_b16 v[248:249], v10 offset:5184
    ds_read_b64_tr_b16 v[250:251], v10 offset:5312
    v_mfma_f32_32x32x16_bf16 v[24:39], v[128:131], v[200:203], v[24:39]
    v_mfma_f32_32x32x16_bf16 v[24:39], v[132:135], v[204:207], v[24:39]
    s_waitcnt lgkmcnt(2)
    v_mfma_f32_16x16x32_bf16 v[40:43], v[252:255], v[232:235], v[40:43]
    ds_read_b64_tr_b16 v[252:253], v10 offset:7488
    ds_read_b64_tr_b16 v[254:255], v10 offset:7616
    v_mfma_f32_32x32x16_bf16 v[24:39], v[136:139], v[208:211], v[24:39]
    v_mfma_f32_32x32x16_bf16 v[24:39], v[140:143], v[212:215], v[24:39]
    s_waitcnt lgkmcnt(2)
    v_mfma_f32_16x16x32_bf16 v[40:43], v[248:251], v[236:239], v[40:43]
    ds_read_b64_tr_b16 v[248:249], v11 offset:576
    ds_read_b64_tr_b16 v[250:251], v11 offset:2880
    v_mfma_f32_32x32x16_bf16 v[24:39], v[144:147], v[216:219], v[24:39]
    v_mfma_f32_32x32x16_bf16 v[24:39], v[148:151], v[220:223], v[24:39]
    s_waitcnt lgkmcnt(2)
    v_mfma_f32_16x16x32_bf16 v[40:43], v[252:255], v[240:243], v[40:43]
    v_mfma_f32_32x32x16_bf16 v[24:39], v[152:155], v[224:227], v[24:39]
    s_waitcnt lgkmcnt(0)
    v_mfma_f32_16x16x32_bf16 v[40:43], v[248:251], v[244:247], v[40:43]
LW_110:
    ds_read_b32 v1, v2 offset:1792
    s_waitcnt lgkmcnt(0)
    v_readfirstlane_b32 s73, v1
    s_cmp_ge_u32 s73, 4
    s_cbranch_scc1 LWD_111
    s_sleep 2
    s_sub_u32 s72, s72, 1
    s_cbranch_scc0 LW_110
    s_branch L_bail
LWD_111:
    s_sleep 4
    ds_read_b64_tr_b16 v[248:249], v10 offset:864
    ds_read_b64_tr_b16 v[250:251], v10 offset:992
    ds_read_b64_tr_b16 v[252:253], v10 offset:3168
    ds_read_b64_tr_b16 v[254:255], v10 offset:3296
CL_112:
    s_add_u32 s90, s94, 64512
    buffer_load_dwordx4 v[192:195], v5, s[44:47], s90 offen offset:0 sc1
    buffer_load_dwordx4 v[196:199], v5, s[44:47], s90 offen offset:1024 sc1
    buffer_load_dwordx4 v[228:231], v12, s[44:47], s90 offen offset:0 sc1
    buffer_load_dwordx4 v[200:203], v5, s[44:47], s90 offen offset:2048 sc1
    buffer_load_dwordx4 v[204:207], v5, s[44:47], s90 offen offset:3072 sc1
    buffer_load_dwordx4 v[232:235], v12, s[44:47], s90 offen offset:2048 sc1
    s_add_u32 s90, s94, 68608
    buffer_load_dwordx4 v[208:211], v5, s[44:47], s90 offen offset:0 sc1
    buffer_load_dwordx4 v[212:215], v5, s[44:47], s90 offen offset:1024 sc1
    buffer_load_dwordx4 v[236:239], v12, s[44:47], s90 offen offset:0 sc1
    buffer_load_dwordx4 v[216:219], v5, s[44:47], s90 offen offset:2048 sc1
    buffer_load_dwordx4 v[220:223], v5, s[44:47], s90 offen offset:3072 sc1
    buffer_load_dwordx4 v[240:243], v12, s[44:47], s90 offen offset:2048 sc1
    s_add_u32 s90, s94, 72704
    buffer_load_dwordx4 v[224:227], v5, s[44:47], s90 offen offset:0 sc1
    buffer_load_dwordx4 v[244:247], v13, s[44:47], s90 offen offset:0 sc1
    s_waitcnt vmcnt(12)
    v_max_u32 v1, v192, v196
    s_waitcnt vmcnt(10)
    v_max3_u32 v1, v1, v228, v200
    s_waitcnt vmcnt(8)
    v_max3_u32 v1, v1, v204, v232
    s_waitcnt vmcnt(6)
    v_max3_u32 v1, v1, v208, v212
    s_waitcnt vmcnt(4)
    v_max3_u32 v1, v1, v236, v216
    s_waitcnt vmcnt(2)
    v_max3_u32 v1, v1, v220, v240
    s_waitcnt vmcnt(1)
    v_max3_u32 v1, v1, v224, v225
    s_waitcnt vmcnt(1)
    v_max3_u32 v1, v1, v226, v227
    s_waitcnt vmcnt(0)
    v_max3_u32 v1, v1, v244, v245
    s_waitcnt vmcnt(0)
    v_max3_u32 v1, v1, v246, v247
    v_cmp_eq_u32 vcc, -1, v1
    s_cmp_eq_u64 vcc, 0
    s_cbranch_scc1 CD_113
    s_sleep 2
    s_sub_u32 s72, s72, 1
    s_cbranch_scc0 CL_112
    s_branch L_bail
CD_113:
    v_mfma_f32_32x32x16_bf16 v[24:39], v[156:159], v[192:195], v[24:39]
    v_mfma_f32_32x32x16_bf16 v[24:39], v[160:163], v[196:199], v[24:39]
    s_waitcnt lgkmcnt(2)
    v_mfma_f32_16x16x32_bf16 v[40:43], v[248:251], v[228:231], v[40:43]
    ds_read_b64_tr_b16 v[248:249], v10 offset:5472
    ds_read_b64_tr_b16 v[250:251], v10 offset:5600
    v_mfma_f32_32x32x16_bf16 v[24:39], v[164:167], v[200:203], v[24:39]
    v_mfma_f32_32x32x16_bf16 v[24:39], v[168:171], v[204:207], v[24:39]
    s_waitcnt lgkmcnt(2)
    v_mfma_f32_16x16x32_bf16 v[40:43], v[252:255], v[232:235], v[40:43]
    ds_read_b64_tr_b16 v[252:253], v10 offset:7776
    ds_read_b64_tr_b16 v[254:255], v10 offset:7904
    v_mfma_f32_32x32x16_bf16 v[24:39], v[172:175], v[208:211], v[24:39]
    v_mfma_f32_32x32x16_bf16 v[24:39], v[176:179], v[212:215], v[24:39]
    s_waitcnt lgkmcnt(2)
    v_mfma_f32_16x16x32_bf16 v[40:43], v[248:251], v[236:239], v[40:43]
    ds_read_b64_tr_b16 v[248:249], v11 offset:864
    ds_read_b64_tr_b16 v[250:251], v11 offset:3168
    v_mfma_f32_32x32x16_bf16 v[24:39], v[180:183], v[216:219], v[24:39]
    v_mfma_f32_32x32x16_bf16 v[24:39], v[184:187], v[220:223], v[24:39]
    s_waitcnt lgkmcnt(2)
    v_mfma_f32_16x16x32_bf16 v[40:43], v[252:255], v[240:243], v[40:43]
    v_mfma_f32_32x32x16_bf16 v[24:39], v[188:191], v[224:227], v[24:39]
    s_waitcnt lgkmcnt(0)
    v_mfma_f32_16x16x32_bf16 v[40:43], v[248:251], v[244:247], v[40:43]
    s_nop 4
    s_nop 2
    v_cvt_pk_bf16_f32 v40, v40, v41
    v_cvt_pk_bf16_f32 v41, v42, v43
    s_nop 3
    s_nop 0
    v_cvt_pk_bf16_f32 v24, v24, v25
    v_cvt_pk_bf16_f32 v25, v26, v27
    v_cvt_pk_bf16_f32 v26, v28, v29
    v_cvt_pk_bf16_f32 v27, v30, v31
    v_cvt_pk_bf16_f32 v28, v32, v33
    v_cvt_pk_bf16_f32 v29, v34, v35
    v_cvt_pk_bf16_f32 v30, v36, v37
    v_cvt_pk_bf16_f32 v31, v38, v39
    buffer_store_dwordx4 v[24:27], v18, s[52:55], s93 offen offset:0
    buffer_store_dwordx4 v[28:31], v18, s[52:55], s93 offen offset:16
    s_mov_b32 exec_hi, 0
    buffer_store_dwordx2 v[40:41], v19, s[52:55], s92 offen offset:128
    s_mov_b64 exec, -1
    s_branch L_fin
TL_38:
    s_setprio 2
    ds_read_b32 v4, v23 offset:2432
    ds_read_b32 v45, v23 offset:2304
    v_and_b32 v7, 15, v0
    v_lshl_add_u32 v7, v7, 2, v2
    ds_read_b32 v46, v7 offset:2368
    v_add_u32 v7, 36864, v16
    v_add_u32 v8, 36864, v17
    s_waitcnt lgkmcnt(0)
    v_sub_f32 v4, 1.0, v4
LW_114:
    ds_read_b32 v1, v2 offset:768
    s_waitcnt lgkmcnt(0)
    v_readfirstlane_b32 s73, v1
    s_cmp_ge_u32 s73, 4
    s_cbranch_scc1 LWD_115
    s_sleep 4
    s_sub_u32 s72, s72, 1
    s_cbranch_scc0 LW_114
    s_branch L_bail
LWD_115:
    ds_read_b128 v[192:195], v20 offset:30720
    ds_read_b128 v[196:199], v20 offset:31744
    ds_read_b64 v[200:201], v21 offset:30720
    ds_read_b32 v202, v22 offset:30720
    ds_read_b128 v[204:207], v20 offset:33280
    ds_read_b128 v[208:211], v20 offset:34304
    ds_read_b64 v[212:213], v21 offset:33280
    ds_read_b32 v214, v22 offset:33280
    s_add_u32 s90, s96, 27648
    s_add_u32 s91, s97, 27648
    s_movk_i32 s89, 3
    ds_read_b128 v[216:219], v20 offset:35840
    ds_read_b128 v[220:223], v20 offset:36864
    ds_read_b64 v[224:225], v21 offset:35840
    ds_read_b32 v226, v22 offset:35840
    s_waitcnt lgkmcnt(4)
    ds_read_b128 v[228:231], v20 offset:38400
    ds_read_b128 v[232:235], v20 offset:39424
    ds_read_b64 v[236:237], v21 offset:38400
    ds_read_b32 v238, v22 offset:38400
    v_pk_add_f32 v[192:193], v[192:193], v[204:205]
    v_pk_add_f32 v[194:195], v[194:195], v[206:207]
    v_pk_add_f32 v[196:197], v[196:197], v[208:209]
    v_pk_add_f32 v[198:199], v[198:199], v[210:211]
    v_pk_add_f32 v[200:201], v[200:201], v[212:213]
    v_add_f32 v202, v202, v214
    s_waitcnt lgkmcnt(4)
    v_pk_add_f32 v[192:193], v[192:193], v[216:217]
    v_pk_add_f32 v[194:195], v[194:195], v[218:219]
    v_pk_add_f32 v[196:197], v[196:197], v[220:221]
    v_pk_add_f32 v[198:199], v[198:199], v[222:223]
    v_pk_add_f32 v[200:201], v[200:201], v[224:225]
    v_add_f32 v202, v202, v226
    s_waitcnt lgkmcnt(0)
    v_pk_add_f32 v[192:193], v[192:193], v[228:229]
    v_pk_add_f32 v[194:195], v[194:195], v[230:231]
    v_pk_add_f32 v[196:197], v[196:197], v[232:233]
    v_pk_add_f32 v[198:199], v[198:199], v[234:235]
    v_pk_add_f32 v[200:201], v[200:201], v[236:237]
    v_add_f32 v202, v202, v238
LW_116:
    ds_read_b32 v1, v2 offset:2112
    s_waitcnt lgkmcnt(0)
    v_readfirstlane_b32 s73, v1
    s_cmp_ge_u32 s73, 1
    s_cbranch_scc1 LWD_117
    s_sleep 2
    s_sub_u32 s72, s72, 1
    s_cbranch_scc0 LW_116
    s_branch L_bail
LWD_117:
    s_mov_b64 exec, 1
    ds_add_u32 v2, v3 offset:2096
    s_mov_b64 exec, -1
    v_pk_mul_f32 v[204:205], v[192:193], 0 op_sel_hi:[1,0]
    v_pk_fma_f32 v[204:205], v[194:195], 0, v[204:205] op_sel_hi:[1,0,1]
    v_pk_fma_f32 v[204:205], v[196:197], 0, v[204:205] op_sel_hi:[1,0,1]
    v_pk_fma_f32 v[204:205], v[198:199], 0, v[204:205] op_sel_hi:[1,0,1]
    v_pk_fma_f32 v[204:205], v[200:201], 0, v[204:205] op_sel_hi:[1,0,1]
    v_add_f32 v204, v204, v205
    v_subrev_u32 v205, 0x21800000, v202
    v_cmp_u_f32 vcc, v204, v204
    s_mov_b32 s73, 0x3e000000
    v_cmp_lt_u32 s[74:75], s73, v205
    s_or_b64 vcc, vcc, s[74:75]
    s_cmp_eq_u64 vcc, 0
    s_cbranch_scc1 SOK_118
    s_call_b64 s[86:87], L_fallback
SOK_118:
    v_rcp_f32 v202, v202
    s_nop 0
    v_mul_f32 v202, v4, v202
    v_pk_mul_f32 v[192:193], v[192:193], v[202:203] op_sel_hi:[1,0]
    v_pk_mul_f32 v[194:195], v[194:195], v[202:203] op_sel_hi:[1,0]
    v_pk_mul_f32 v[196:197], v[196:197], v[202:203] op_sel_hi:[1,0]
    v_pk_mul_f32 v[198:199], v[198:199], v[202:203] op_sel_hi:[1,0]
    v_pk_mul_f32 v[200:201], v[200:201], v[202:203] op_sel_hi:[1,0]
    v_cvt_pk_bf16_f32 v204, v192, v193
    v_cvt_pk_bf16_f32 v205, v194, v195
    v_cvt_pk_bf16_f32 v206, v196, v197
    v_cvt_pk_bf16_f32 v207, v198, v199
    v_cvt_pk_bf16_f32 v208, v200, v201
    v_min_u32 v204, -2, v204
    v_min_u32 v208, -2, v208
    buffer_store_dwordx4 v[204:207], v5, s[44:47], s90 offen sc1
    s_mov_b32 exec_hi, 0
    buffer_store_dword v208, v5, s[44:47], s91 offen sc1
    s_mov_b64 exec, -1
    s_mul_i32 s93, s70, 110592
    s_add_u32 s98, s93, 1122304
    s_add_u32 s93, s93, 1085440
LW_119:
    ds_read_b32 v1, v2 offset:2076
    s_waitcnt lgkmcnt(0)
    v_readfirstlane_b32 s73, v1
    s_cmp_ge_u32 s73, 8
    s_cbranch_scc1 LWD_120
    s_sleep 3
    s_sub_u32 s72, s72, 1
    s_cbranch_scc0 LW_119
    s_branch L_bail
LWD_120:
    buffer_load_dwordx4 v[192:195], v5, s[44:47], s93 offen offset:0 sc1
    buffer_load_dwordx4 v[196:199], v5, s[44:47], s93 offen offset:1024 sc1
    buffer_load_dwordx4 v[224:227], v14, s[44:47], s98 offen offset:0 sc1
    buffer_load_dwordx4 v[200:203], v5, s[44:47], s93 offen offset:2048 sc1
    buffer_load_dwordx4 v[204:207], v5, s[44:47], s93 offen offset:3072 sc1
    s_add_u32 s93, s93, 4096
    buffer_load_dwordx4 v[228:231], v14, s[44:47], s98 offen offset:2048 sc1
    s_add_u32 s98, s98, 4096
    buffer_load_dwordx4 v[208:211], v5, s[44:47], s93 offen offset:0 sc1
    buffer_load_dwordx4 v[212:215], v5, s[44:47], s93 offen offset:1024 sc1
    buffer_load_dwordx4 v[232:235], v14, s[44:47], s98 offen offset:0 sc1
    buffer_load_dwordx4 v[216:219], v5, s[44:47], s93 offen offset:2048 sc1
    buffer_load_dwordx4 v[220:223], v5, s[44:47], s93 offen offset:3072 sc1
    s_add_u32 s93, s93, 4096
LW_121:
    ds_read_b32 v1, v2 offset:2092
    s_waitcnt lgkmcnt(0)
    v_readfirstlane_b32 s73, v1
    s_cmp_ge_u32 s73, 2
    s_cbranch_scc1 LWD_122
    s_sleep 3
    s_sub_u32 s72, s72, 1
    s_cbranch_scc0 LW_121
    s_branch L_bail
LWD_122:
    ds_read_b64_tr_b16 v[48:49], v6 offset:0
    ds_read_b64_tr_b16 v[50:51], v6 offset:512
    ds_read_b64_tr_b16 v[52:53], v6 offset:4608
    ds_read_b64_tr_b16 v[54:55], v6 offset:5120
    ds_read_b64_tr_b16 v[56:57], v6 offset:9216
    ds_read_b64_tr_b16 v[58:59], v6 offset:9728
    s_waitcnt lgkmcnt(6)
    ds_read_b64_tr_b16 v[60:61], v6 offset:13824
    ds_read_b64_tr_b16 v[62:63], v6 offset:14336
    ds_read_b64_tr_b16 v[64:65], v6 offset:18432
    ds_read_b64_tr_b16 v[66:67], v6 offset:18944
    ds_read_b64_tr_b16 v[68:69], v6 offset:23040
    ds_read_b64_tr_b16 v[70:71], v6 offset:23552
    s_waitcnt lgkmcnt(6)
    ds_read_b64_tr_b16 v[72:73], v6 offset:27648
    ds_read_b64_tr_b16 v[74:75], v6 offset:28160
    ds_read_b64_tr_b16 v[76:77], v6 offset:32256
    ds_read_b64_tr_b16 v[78:79], v6 offset:32768
    ds_read_b64_tr_b16 v[80:81], v9 offset:0
    ds_read_b64_tr_b16 v[82:83], v9 offset:9216
    s_waitcnt lgkmcnt(6)
    ds_read_b64_tr_b16 v[84:85], v6 offset:1152
    ds_read_b64_tr_b16 v[86:87], v6 offset:1664
    ds_read_b64_tr_b16 v[88:89], v6 offset:5760
    ds_read_b64_tr_b16 v[90:91], v6 offset:6272
    ds_read_b64_tr_b16 v[92:93], v6 offset:10368
    ds_read_b64_tr_b16 v[94:95], v6 offset:10880
    s_waitcnt lgkmcnt(6)
    ds_read_b64_tr_b16 v[96:97], v6 offset:14976
    ds_read_b64_tr_b16 v[98:99], v6 offset:15488
    ds_read_b64_tr_b16 v[100:101], v6 offset:19584
    ds_read_b64_tr_b16 v[102:103], v6 offset:20096
    ds_read_b64_tr_b16 v[104:105], v6 offset:24192
    ds_read_b64_tr_b16 v[106:107], v6 offset:24704
    s_waitcnt lgkmcnt(6)
    ds_read_b64_tr_b16 v[108:109], v6 offset:28800
    ds_read_b64_tr_b16 v[110:111], v6 offset:29312
    ds_read_b64_tr_b16 v[112:113], v6 offset:33408
    ds_read_b64_tr_b16 v[114:115], v6 offset:33920
    ds_read_b64_tr_b16 v[116:117], v9 offset:1152
    ds_read_b64_tr_b16 v[118:119], v9 offset:10368
    s_waitcnt lgkmcnt(6)
    ds_read_b64_tr_b16 v[120:121], v6 offset:2304
    ds_read_b64_tr_b16 v[122:123], v6 offset:2816
    ds_read_b64_tr_b16 v[124:125], v6 offset:6912
    ds_read_b64_tr_b16 v[126:127], v6 offset:7424
    ds_read_b64_tr_b16 v[128:129], v6 offset:11520
    ds_read_b64_tr_b16 v[130:131], v6 offset:12032
    s_waitcnt lgkmcnt(6)
    ds_read_b64_tr_b16 v[132:133], v6 offset:16128
    ds_read_b64_tr_b16 v[134:135], v6 offset:16640
    ds_read_b64_tr_b16 v[136:137], v6 offset:20736
    ds_read_b64_tr_b16 v[138:139], v6 offset:21248
    ds_read_b64_tr_b16 v[140:141], v6 offset:25344
    ds_read_b64_tr_b16 v[142:143], v6 offset:25856
    s_waitcnt lgkmcnt(6)
    ds_read_b64_tr_b16 v[144:145], v6 offset:29952
    ds_read_b64_tr_b16 v[146:147], v6 offset:30464
    ds_read_b64_tr_b16 v[148:149], v6 offset:34560
    ds_read_b64_tr_b16 v[150:151], v6 offset:35072
    ds_read_b64_tr_b16 v[152:153], v9 offset:2304
    ds_read_b64_tr_b16 v[154:155], v9 offset:11520
    s_waitcnt lgkmcnt(6)
    ds_read_b64_tr_b16 v[156:157], v6 offset:3456
    ds_read_b64_tr_b16 v[158:159], v6 offset:3968
    ds_read_b64_tr_b16 v[160:161], v6 offset:8064
    ds_read_b64_tr_b16 v[162:163], v6 offset:8576
    ds_read_b64_tr_b16 v[164:165], v6 offset:12672
    ds_read_b64_tr_b16 v[166:167], v6 offset:13184
    s_waitcnt lgkmcnt(6)
    ds_read_b64_tr_b16 v[168:169], v6 offset:17280
    ds_read_b64_tr_b16 v[170:171], v6 offset:17792
    ds_read_b64_tr_b16 v[172:173], v6 offset:21888
    ds_read_b64_tr_b16 v[174:175], v6 offset:22400
    ds_read_b64_tr_b16 v[176:177], v6 offset:26496
    ds_read_b64_tr_b16 v[178:179], v6 offset:27008
    s_waitcnt lgkmcnt(6)
    ds_read_b64_tr_b16 v[180:181], v6 offset:31104
    ds_read_b64_tr_b16 v[182:183], v6 offset:31616
    ds_read_b64_tr_b16 v[184:185], v6 offset:35712
    ds_read_b64_tr_b16 v[186:187], v6 offset:36224
    ds_read_b64_tr_b16 v[188:189], v9 offset:3456
    ds_read_b64_tr_b16 v[190:191], v9 offset:12672
    s_waitcnt lgkmcnt(6)
    s_waitcnt lgkmcnt(0)
    s_mov_b64 exec, 1
    ds_add_u32 v2, v3 offset:2088
    s_mov_b64 exec, -1
LW_123:
    ds_read_b32 v1, v2 offset:2084
    s_waitcnt lgkmcnt(0)
    v_readfirstlane_b32 s73, v1
    s_cmp_ge_u32 s73, 2
    s_cbranch_scc1 LWD_124
    s_sleep 2
    s_sub_u32 s72, s72, 1
    s_cbranch_scc0 LW_123
    s_branch L_bail
LWD_124:
    ds_read_b64_tr_b16 v[236:237], v16 offset:0
    ds_read_b64_tr_b16 v[238:239], v16 offset:512
    ds_read_b64_tr_b16 v[240:241], v16 offset:2048
    ds_read_b64_tr_b16 v[242:243], v16 offset:2560
    ds_read_b64_tr_b16 v[248:249], v17 offset:0
    ds_read_b64_tr_b16 v[250:251], v17 offset:512
    s_waitcnt vmcnt(10) lgkmcnt(4)
    v_mfma_f32_32x32x16_bf16 v[24:39], v[192:195], v[236:239], 0
    buffer_load_dwordx4 v[192:195], v5, s[44:47], s93 offen offset:0 sc1
    ds_read_b64_tr_b16 v[244:245], v16 offset:4096
    ds_read_b64_tr_b16 v[246:247], v16 offset:4608
    s_waitcnt vmcnt(10) lgkmcnt(4)
    v_mfma_f32_32x32x16_bf16 v[24:39], v[196:199], v[240:243], v[24:39]
    buffer_load_dwordx4 v[196:199], v5, s[44:47], s93 offen offset:1024 sc1
    ds_read_b64_tr_b16 v[236:237], v16 offset:6144
    ds_read_b64_tr_b16 v[238:239], v16 offset:6656
    s_waitcnt vmcnt(10) lgkmcnt(4)
    v_mfma_f32_16x16x32_bf16 v[40:43], v[224:227], v[248:251], 0
    buffer_load_dwordx4 v[224:227], v14, s[44:47], s98 offen offset:2048 sc1
    s_add_u32 s98, s98, 4096
    ds_read_b64_tr_b16 v[252:253], v17 offset:4096
    ds_read_b64_tr_b16 v[254:255], v17 offset:4608
    s_waitcnt vmcnt(10) lgkmcnt(4)
    v_mfma_f32_32x32x16_bf16 v[24:39], v[200:203], v[244:247], v[24:39]
    buffer_load_dwordx4 v[200:203], v5, s[44:47], s93 offen offset:2048 sc1
    ds_read_b64_tr_b16 v[240:241], v16 offset:8192
    ds_read_b64_tr_b16 v[242:243], v16 offset:8704
    s_waitcnt vmcnt(10) lgkmcnt(4)
    v_mfma_f32_32x32x16_bf16 v[24:39], v[204:207], v[236:239], v[24:39]
    buffer_load_dwordx4 v[204:207], v5, s[44:47], s93 offen offset:3072 sc1
    s_add_u32 s93, s93, 4096
    ds_read_b64_tr_b16 v[244:245], v16 offset:10240
    ds_read_b64_tr_b16 v[246:247], v16 offset:10752
    s_waitcnt vmcnt(10) lgkmcnt(4)
    v_mfma_f32_16x16x32_bf16 v[40:43], v[228:231], v[252:255], v[40:43]
    buffer_load_dwordx4 v[228:231], v14, s[44:47], s98 offen offset:0 sc1
    ds_read_b64_tr_b16 v[248:249], v17 offset:8192
    ds_read_b64_tr_b16 v[250:251], v17 offset:8704
    s_waitcnt vmcnt(10) lgkmcnt(4)
    v_mfma_f32_32x32x16_bf16 v[24:39], v[208:211], v[240:243], v[24:39]
    buffer_load_dwordx4 v[208:211], v5, s[44:47], s93 offen offset:0 sc1
    ds_read_b64_tr_b16 v[236:237], v16 offset:12288
    ds_read_b64_tr_b16 v[238:239], v16 offset:12800
    s_waitcnt vmcnt(10) lgkmcnt(4)
    v_mfma_f32_32x32x16_bf16 v[24:39], v[212:215], v[244:247], v[24:39]
    buffer_load_dwordx4 v[212:215], v5, s[44:47], s93 offen offset:1024 sc1
    ds_read_b64_tr_b16 v[240:241], v16 offset:14336
    ds_read_b64_tr_b16 v[242:243], v16 offset:14848
    s_waitcnt vmcnt(10) lgkmcnt(4)
    v_mfma_f32_16x16x32_bf16 v[40:43], v[232:235], v[248:251], v[40:43]
    buffer_load_dwordx4 v[232:235], v14, s[44:47], s98 offen offset:2048 sc1
    s_add_u32 s98, s98, 4096
    ds_read_b64_tr_b16 v[252:253], v17 offset:12288
    ds_read_b64_tr_b16 v[254:255], v17 offset:12800
    s_waitcnt vmcnt(10) lgkmcnt(4)
    v_mfma_f32_32x32x16_bf16 v[24:39], v[216:219], v[236:239], v[24:39]
    buffer_load_dwordx4 v[216:219], v5, s[44:47], s93 offen offset:2048 sc1
    ds_read_b64_tr_b16 v[244:245], v16 offset:16384
    ds_read_b64_tr_b16 v[246:247], v16 offset:16896
    s_waitcnt vmcnt(10) lgkmcnt(4)
    v_mfma_f32_32x32x16_bf16 v[24:39], v[220:223], v[240:243], v[24:39]
    buffer_load_dwordx4 v[220:223], v5, s[44:47], s93 offen offset:3072 sc1
    s_add_u32 s93, s93, 4096
    ds_read_b64_tr_b16 v[236:237], v16 offset:18432
    ds_read_b64_tr_b16 v[238:239], v16 offset:18944
    s_waitcnt vmcnt(8) lgkmcnt(4)
    v_mfma_f32_16x16x32_bf16 v[40:43], v[224:227], v[252:255], v[40:43]
    buffer_load_dwordx4 v[224:227], v14, s[44:47], s98 offen offset:0 sc1
    ds_read_b64_tr_b16 v[248:249], v17 offset:16384
    ds_read_b64_tr_b16 v[250:251], v17 offset:16896
    s_waitcnt lgkmcnt(4)
    v_mfma_f32_32x32x16_bf16 v[24:39], v[192:195], v[244:247], v[24:39]
    buffer_load_dwordx4 v[192:195], v5, s[44:47], s93 offen offset:0 sc1
    ds_read_b64_tr_b16 v[240:241], v16 offset:20480
    ds_read_b64_tr_b16 v[242:243], v16 offset:20992
    s_waitcnt lgkmcnt(4)
    v_mfma_f32_32x32x16_bf16 v[24:39], v[196:199], v[236:239], v[24:39]
    buffer_load_dwordx4 v[196:199], v5, s[44:47], s93 offen offset:1024 sc1
    ds_read_b64_tr_b16 v[244:245], v16 offset:22528
    ds_read_b64_tr_b16 v[246:247], v16 offset:23040
    s_waitcnt vmcnt(8) lgkmcnt(4)
    v_mfma_f32_16x16x32_bf16 v[40:43], v[228:231], v[248:251], v[40:43]
    buffer_load_dwordx4 v[228:231], v14, s[44:47], s98 offen offset:2048 sc1
    s_add_u32 s98, s98, 4096
    ds_read_b64_tr_b16 v[252:253], v17 offset:20480
    ds_read_b64_tr_b16 v[254:255], v17 offset:20992
    s_waitcnt lgkmcnt(4)
    v_mfma_f32_32x32x16_bf16 v[24:39], v[200:203], v[240:243], v[24:39]
    buffer_load_dwordx4 v[200:203], v5, s[44:47], s93 offen offset:2048 sc1
    ds_read_b64_tr_b16 v[236:237], v16 offset:24576
    ds_read_b64_tr_b16 v[238:239], v16 offset:25088
    s_waitcnt lgkmcnt(4)
    v_mfma_f32_32x32x16_bf16 v[24:39], v[204:207], v[244:247], v[24:39]
    buffer_load_dwordx4 v[204:207], v5, s[44:47], s93 offen offset:3072 sc1
    s_add_u32 s93, s93, 4096
    ds_read_b64_tr_b16 v[240:241], v16 offset:26624
    ds_read_b64_tr_b16 v[242:243], v16 offset:27136
    s_waitcnt vmcnt(8) lgkmcnt(4)
    v_mfma_f32_16x16x32_bf16 v[40:43], v[232:235], v[252:255], v[40:43]
    buffer_load_dwordx4 v[232:235], v14, s[44:47], s98 offen offset:0 sc1
    ds_read_b64_tr_b16 v[248:249], v17 offset:24576
    ds_read_b64_tr_b16 v[250:251], v17 offset:25088
    s_waitcnt lgkmcnt(4)
    v_mfma_f32_32x32x16_bf16 v[24:39], v[208:211], v[236:239], v[24:39]
    buffer_load_dwordx4 v[208:211], v5, s[44:47], s93 offen offset:0 sc1
    ds_read_b64_tr_b16 v[244:245], v16 offset:28672
    ds_read_b64_tr_b16 v[246:247], v16 offset:29184
    s_waitcnt lgkmcnt(4)
    v_mfma_f32_32x32x16_bf16 v[24:39], v[212:215], v[240:243], v[24:39]
    buffer_load_dwordx4 v[212:215], v5, s[44:47], s93 offen offset:1024 sc1
    ds_read_b64_tr_b16 v[236:237], v16 offset:30720
    ds_read_b64_tr_b16 v[238:239], v16 offset:31232
    s_waitcnt vmcnt(8) lgkmcnt(4)
    v_mfma_f32_16x16x32_bf16 v[40:43], v[224:227], v[248:251], v[40:43]
    buffer_load_dwordx4 v[224:227], v14, s[44:47], s98 offen offset:2048 sc1
    s_add_u32 s98, s98, 4096
    ds_read_b64_tr_b16 v[252:253], v17 offset:28672
    ds_read_b64_tr_b16 v[254:255], v17 offset:29184
    s_waitcnt lgkmcnt(4)
    v_mfma_f32_32x32x16_bf16 v[24:39], v[216:219], v[244:247], v[24:39]
    buffer_load_dwordx4 v[216:219], v5, s[44:47], s93 offen offset:2048 sc1
    ds_read_b64_tr_b16 v[240:241], v16 offset:32768
    ds_read_b64_tr_b16 v[242:243], v16 offset:33280
    s_waitcnt lgkmcnt(4)
    v_mfma_f32_32x32x16_bf16 v[24:39], v[220:223], v[236:239], v[24:39]
    buffer_load_dwordx4 v[220:223], v5, s[44:47], s93 offen offset:3072 sc1
    s_add_u32 s93, s93, 4096
    ds_read_b64_tr_b16 v[244:245], v16 offset:34816
    ds_read_b64_tr_b16 v[246:247], v16 offset:35328
    s_waitcnt vmcnt(8) lgkmcnt(4)
    v_mfma_f32_16x16x32_bf16 v[40:43], v[228:231], v[252:255], v[40:43]
    buffer_load_dwordx4 v[228:231], v14, s[44:47], s98 offen offset:0 sc1
    ds_read_b64_tr_b16 v[248:249], v17 offset:32768
    ds_read_b64_tr_b16 v[250:251], v17 offset:33280
    s_waitcnt lgkmcnt(4)
    v_mfma_f32_32x32x16_bf16 v[24:39], v[192:195], v[240:243], v[24:39]
    buffer_load_dwordx4 v[192:195], v5, s[44:47], s93 offen offset:0 sc1
    s_waitcnt lgkmcnt(2)
    v_mfma_f32_32x32x16_bf16 v[24:39], v[196:199], v[244:247], v[24:39]
    buffer_load_dwordx4 v[196:199], v5, s[44:47], s93 offen offset:1024 sc1
    s_waitcnt vmcnt(8) lgkmcnt(0)
    v_mfma_f32_16x16x32_bf16 v[40:43], v[232:235], v[248:251], v[40:43]
    buffer_load_dwordx4 v[232:235], v14, s[44:47], s98 offen offset:2048 sc1
    s_add_u32 s98, s98, 4096
LW_125:
    ds_read_b32 v1, v2 offset:2116
    s_waitcnt lgkmcnt(0)
    v_readfirstlane_b32 s73, v1
    s_cmp_ge_u32 s73, 2
    s_cbranch_scc1 LWD_126
    s_sleep 1
    s_sub_u32 s72, s72, 1
    s_cbranch_scc0 LW_125
    s_branch L_bail
LWD_126:
    ds_read_b64_tr_b16 v[236:237], v7 offset:0
    ds_read_b64_tr_b16 v[238:239], v7 offset:512
    ds_read_b64_tr_b16 v[240:241], v7 offset:2048
    ds_read_b64_tr_b16 v[242:243], v7 offset:2560
    ds_read_b64_tr_b16 v[252:253], v8 offset:0
    ds_read_b64_tr_b16 v[254:255], v8 offset:512
    s_waitcnt lgkmcnt(4)
    v_mfma_f32_32x32x16_bf16 v[24:39], v[200:203], v[236:239], v[24:39]
    buffer_load_dwordx4 v[200:203], v5, s[44:47], s93 offen offset:2048 sc1
    ds_read_b64_tr_b16 v[244:245], v7 offset:4096
    ds_read_b64_tr_b16 v[246:247], v7 offset:4608
    s_waitcnt lgkmcnt(4)
    v_mfma_f32_32x32x16_bf16 v[24:39], v[204:207], v[240:243], v[24:39]
    buffer_load_dwordx4 v[204:207], v5, s[44:47], s93 offen offset:3072 sc1
    s_add_u32 s93, s93, 4096
    ds_read_b64_tr_b16 v[236:237], v7 offset:6144
    ds_read_b64_tr_b16 v[238:239], v7 offset:6656
    s_waitcnt vmcnt(8) lgkmcnt(4)
    v_mfma_f32_16x16x32_bf16 v[40:43], v[224:227], v[252:255], v[40:43]
    buffer_load_dwordx4 v[224:227], v14, s[44:47], s98 offen offset:0 sc1
    ds_read_b64_tr_b16 v[248:249], v8 offset:4096
    ds_read_b64_tr_b16 v[250:251], v8 offset:4608
    s_waitcnt lgkmcnt(4)
    v_mfma_f32_32x32x16_bf16 v[24:39], v[208:211], v[244:247], v[24:39]
    buffer_load_dwordx4 v[208:211], v5, s[44:47], s93 offen offset:0 sc1
    ds_read_b64_tr_b16 v[240:241], v7 offset:8192
    ds_read_b64_tr_b16 v[242:243], v7 offset:8704
    s_waitcnt lgkmcnt(4)
    v_mfma_f32_32x32x16_bf16 v[24:39], v[212:215], v[236:239], v[24:39]
    buffer_load_dwordx4 v[212:215], v5, s[44:47], s93 offen offset:1024 sc1
    ds_read_b64_tr_b16 v[244:245], v7 offset:10240
    ds_read_b64_tr_b16 v[246:247], v7 offset:10752
    s_waitcnt vmcnt(8) lgkmcnt(4)
    v_mfma_f32_16x16x32_bf16 v[40:43], v[228:231], v[248:251], v[40:43]
    buffer_load_dwordx4 v[228:231], v14, s[44:47], s98 offen offset:2048 sc1
    s_add_u32 s98, s98, 4096
    ds_read_b64_tr_b16 v[252:253], v8 offset:8192
    ds_read_b64_tr_b16 v[254:255], v8 offset:8704
    s_waitcnt lgkmcnt(4)
    v_mfma_f32_32x32x16_bf16 v[24:39], v[216:219], v[240:243], v[24:39]
    buffer_load_dwordx4 v[216:219], v5, s[44:47], s93 offen offset:2048 sc1
    ds_read_b64_tr_b16 v[236:237], v7 offset:12288
    ds_read_b64_tr_b16 v[238:239], v7 offset:12800
    s_waitcnt lgkmcnt(4)
    v_mfma_f32_32x32x16_bf16 v[24:39], v[220:223], v[244:247], v[24:39]
    buffer_load_dwordx4 v[220:223], v5, s[44:47], s93 offen offset:3072 sc1
    s_add_u32 s93, s93, 4096
    ds_read_b64_tr_b16 v[240:241], v7 offset:14336
    ds_read_b64_tr_b16 v[242:243], v7 offset:14848
    s_waitcnt vmcnt(8) lgkmcnt(4)
    v_mfma_f32_16x16x32_bf16 v[40:43], v[232:235], v[252:255], v[40:43]
    buffer_load_dwordx4 v[232:235], v14, s[44:47], s98 offen offset:0 sc1
    ds_read_b64_tr_b16 v[248:249], v8 offset:12288
    ds_read_b64_tr_b16 v[250:251], v8 offset:12800
    s_waitcnt lgkmcnt(4)
    v_mfma_f32_32x32x16_bf16 v[24:39], v[192:195], v[236:239], v[24:39]
    buffer_load_dwordx4 v[192:195], v5, s[44:47], s93 offen offset:0 sc1
    ds_read_b64_tr_b16 v[244:245], v7 offset:16384
    ds_read_b64_tr_b16 v[246:247], v7 offset:16896
    s_waitcnt lgkmcnt(4)
    v_mfma_f32_32x32x16_bf16 v[24:39], v[196:199], v[240:243], v[24:39]
    buffer_load_dwordx4 v[196:199], v5, s[44:47], s93 offen offset:1024 sc1
    ds_read_b64_tr_b16 v[236:237], v7 offset:18432
    ds_read_b64_tr_b16 v[238:239], v7 offset:18944
    s_waitcnt vmcnt(8) lgkmcnt(4)
    v_mfma_f32_16x16x32_bf16 v[40:43], v[224:227], v[248:251], v[40:43]
    buffer_load_dwordx4 v[224:227], v14, s[44:47], s98 offen offset:2048 sc1
    s_add_u32 s98, s98, 4096
    ds_read_b64_tr_b16 v[252:253], v8 offset:16384
    ds_read_b64_tr_b16 v[254:255], v8 offset:16896
    s_waitcnt lgkmcnt(4)
    v_mfma_f32_32x32x16_bf16 v[24:39], v[200:203], v[244:247], v[24:39]
    buffer_load_dwordx4 v[200:203], v5, s[44:47], s93 offen offset:2048 sc1
    ds_read_b64_tr_b16 v[240:241], v7 offset:20480
    ds_read_b64_tr_b16 v[242:243], v7 offset:20992
    s_waitcnt lgkmcnt(4)
    v_mfma_f32_32x32x16_bf16 v[24:39], v[204:207], v[236:239], v[24:39]
    buffer_load_dwordx4 v[204:207], v5, s[44:47], s93 offen offset:3072 sc1
    s_add_u32 s93, s93, 4096
    ds_read_b64_tr_b16 v[244:245], v7 offset:22528
    ds_read_b64_tr_b16 v[246:247], v7 offset:23040
    s_waitcnt vmcnt(8) lgkmcnt(4)
    v_mfma_f32_16x16x32_bf16 v[40:43], v[228:231], v[252:255], v[40:43]
    buffer_load_dwordx4 v[228:231], v14, s[44:47], s98 offen offset:0 sc1
    ds_read_b64_tr_b16 v[248:249], v8 offset:20480
    ds_read_b64_tr_b16 v[250:251], v8 offset:20992
    s_waitcnt lgkmcnt(4)
    v_mfma_f32_32x32x16_bf16 v[24:39], v[208:211], v[240:243], v[24:39]
    ds_read_b64_tr_b16 v[236:237], v7 offset:24576
    ds_read_b64_tr_b16 v[238:239], v7 offset:25088
    s_waitcnt lgkmcnt(4)
    v_mfma_f32_32x32x16_bf16 v[24:39], v[212:215], v[244:247], v[24:39]
    ds_read_b64_tr_b16 v[240:241], v7 offset:26624
    ds_read_b64_tr_b16 v[242:243], v7 offset:27136
    s_waitcnt vmcnt(6) lgkmcnt(4)
    v_mfma_f32_16x16x32_bf16 v[40:43], v[232:235], v[248:251], v[40:43]
    buffer_load_dwordx4 v[232:235], v14, s[44:47], s98 offen offset:2048 sc1
    s_add_u32 s98, s98, 4096
    ds_read_b64_tr_b16 v[252:253], v8 offset:24576
    ds_read_b64_tr_b16 v[254:255], v8 offset:25088
    s_waitcnt lgkmcnt(4)
    v_mfma_f32_32x32x16_bf16 v[24:39], v[216:219], v[236:239], v[24:39]
    ds_read_b64_tr_b16 v[244:245], v7 offset:28672
    ds_read_b64_tr_b16 v[246:247], v7 offset:29184
    s_waitcnt lgkmcnt(4)
    v_mfma_f32_32x32x16_bf16 v[24:39], v[220:223], v[240:243], v[24:39]
    ds_read_b64_tr_b16 v[236:237], v7 offset:30720
    ds_read_b64_tr_b16 v[238:239], v7 offset:31232
    s_waitcnt vmcnt(4) lgkmcnt(4)
    v_mfma_f32_16x16x32_bf16 v[40:43], v[224:227], v[252:255], v[40:43]
    ds_read_b64_tr_b16 v[248:249], v8 offset:28672
    ds_read_b64_tr_b16 v[250:251], v8 offset:29184
    s_waitcnt lgkmcnt(4)
    v_mfma_f32_32x32x16_bf16 v[24:39], v[192:195], v[244:247], v[24:39]
    ds_read_b64_tr_b16 v[240:241], v7 offset:32768
    ds_read_b64_tr_b16 v[242:243], v7 offset:33280
    s_waitcnt lgkmcnt(4)
    v_mfma_f32_32x32x16_bf16 v[24:39], v[196:199], v[236:239], v[24:39]
    ds_read_b64_tr_b16 v[244:245], v7 offset:34816
    ds_read_b64_tr_b16 v[246:247], v7 offset:35328
    s_waitcnt vmcnt(1) lgkmcnt(4)
    v_mfma_f32_16x16x32_bf16 v[40:43], v[228:231], v[248:251], v[40:43]
    ds_read_b64_tr_b16 v[252:253], v8 offset:32768
    ds_read_b64_tr_b16 v[254:255], v8 offset:33280
    s_waitcnt lgkmcnt(4)
    v_mfma_f32_32x32x16_bf16 v[24:39], v[200:203], v[240:243], v[24:39]
    s_waitcnt lgkmcnt(2)
    v_mfma_f32_32x32x16_bf16 v[24:39], v[204:207], v[244:247], v[24:39]
    s_waitcnt vmcnt(0) lgkmcnt(0)
    v_mfma_f32_16x16x32_bf16 v[40:43], v[232:235], v[252:255], v[40:43]
    s_mov_b32 s52, s22
    s_mov_b32 s53, s23
    s_mov_b32 s54, 2359296
    s_mov_b32 s55, 0x20000
    s_mul_i32 s93, s69, 2304
    s_add_u32 s93, s93, s95
    s_add_u32 s93, s93, 0
    s_add_u32 s92, s93, 1179648
    s_nop 1
    v_pk_mul_f32 v[24:25], v[24:25], v[44:45] op_sel:[0,1] op_sel_hi:[1,1]
    v_pk_mul_f32 v[26:27], v[26:27], v[44:45] op_sel:[0,1] op_sel_hi:[1,1]
    v_pk_mul_f32 v[28:29], v[28:29], v[44:45] op_sel:[0,1] op_sel_hi:[1,1]
    v_pk_mul_f32 v[30:31], v[30:31], v[44:45] op_sel:[0,1] op_sel_hi:[1,1]
    v_pk_mul_f32 v[32:33], v[32:33], v[44:45] op_sel:[0,1] op_sel_hi:[1,1]
    v_pk_mul_f32 v[34:35], v[34:35], v[44:45] op_sel:[0,1] op_sel_hi:[1,1]
    v_pk_mul_f32 v[36:37], v[36:37], v[44:45] op_sel:[0,1] op_sel_hi:[1,1]
    v_pk_mul_f32 v[38:39], v[38:39], v[44:45] op_sel:[0,1] op_sel_hi:[1,1]
    v_pk_mul_f32 v[40:41], v[40:41], v[46:47] op_sel_hi:[1,0]
    v_pk_mul_f32 v[42:43], v[42:43], v[46:47] op_sel_hi:[1,0]
    ds_read_b64_tr_b16 v[248:249], v10 offset:0
    ds_read_b64_tr_b16 v[250:251], v10 offset:128
    ds_read_b64_tr_b16 v[252:253], v10 offset:2304
    ds_read_b64_tr_b16 v[254:255], v10 offset:2432
CL_127:
    s_add_u32 s90, s94, 0
    buffer_load_dwordx4 v[192:195], v5, s[44:47], s90 offen offset:0 sc1
    buffer_load_dwordx4 v[196:199], v5, s[44:47], s90 offen offset:1024 sc1
    buffer_load_dwordx4 v[228:231], v12, s[44:47], s90 offen offset:0 sc1
    buffer_load_dwordx4 v[200:203], v5, s[44:47], s90 offen offset:2048 sc1
    buffer_load_dwordx4 v[204:207], v5, s[44:47], s90 offen offset:3072 sc1
    buffer_load_dwordx4 v[232:235], v12, s[44:47], s90 offen offset:2048 sc1
    s_add_u32 s90, s94, 4096
    buffer_load_dwordx4 v[208:211], v5, s[44:47], s90 offen offset:0 sc1
    buffer_load_dwordx4 v[212:215], v5, s[44:47], s90 offen offset:1024 sc1
    buffer_load_dwordx4 v[236:239], v12, s[44:47], s90 offen offset:0 sc1
    buffer_load_dwordx4 v[216:219], v5, s[44:47], s90 offen offset:2048 sc1
    buffer_load_dwordx4 v[220:223], v5, s[44:47], s90 offen offset:3072 sc1
    buffer_load_dwordx4 v[240:243], v12, s[44:47], s90 offen offset:2048 sc1
    s_add_u32 s90, s94, 8192
    buffer_load_dwordx4 v[224:227], v5, s[44:47], s90 offen offset:0 sc1
    buffer_load_dwordx4 v[244:247], v13, s[44:47], s90 offen offset:0 sc1
    s_waitcnt vmcnt(12)
    v_max_u32 v1, v192, v196
    s_waitcnt vmcnt(10)
    v_max3_u32 v1, v1, v228, v200
    s_waitcnt vmcnt(8)
    v_max3_u32 v1, v1, v204, v232
    s_waitcnt vmcnt(6)
    v_max3_u32 v1, v1, v208, v212
    s_waitcnt vmcnt(4)
    v_max3_u32 v1, v1, v236, v216
    s_waitcnt vmcnt(2)
    v_max3_u32 v1, v1, v220, v240
    s_waitcnt vmcnt(1)
    v_max3_u32 v1, v1, v224, v225
    s_waitcnt vmcnt(1)
    v_max3_u32 v1, v1, v226, v227
    s_waitcnt vmcnt(0)
    v_max3_u32 v1, v1, v244, v245
    s_waitcnt vmcnt(0)
    v_max3_u32 v1, v1, v246, v247
    v_cmp_eq_u32 vcc, -1, v1
    s_cmp_eq_u64 vcc, 0
    s_cbranch_scc1 CD_128
    s_sleep 8
    s_sub_u32 s72, s72, 1
    s_cbranch_scc0 CL_127
    s_branch L_bail
CD_128:
    v_mfma_f32_32x32x16_bf16 v[24:39], v[48:51], v[192:195], v[24:39]
    v_mfma_f32_32x32x16_bf16 v[24:39], v[52:55], v[196:199], v[24:39]
    s_waitcnt lgkmcnt(2)
    v_mfma_f32_16x16x32_bf16 v[40:43], v[248:251], v[228:231], v[40:43]
    ds_read_b64_tr_b16 v[248:249], v10 offset:4608
    ds_read_b64_tr_b16 v[250:251], v10 offset:4736
    v_mfma_f32_32x32x16_bf16 v[24:39], v[56:59], v[200:203], v[24:39]
    v_mfma_f32_32x32x16_bf16 v[24:39], v[60:63], v[204:207], v[24:39]
    s_waitcnt lgkmcnt(2)
    v_mfma_f32_16x16x32_bf16 v[40:43], v[252:255], v[232:235], v[40:43]
    ds_read_b64_tr_b16 v[252:253], v10 offset:6912
    ds_read_b64_tr_b16 v[254:255], v10 offset:7040
    v_mfma_f32_32x32x16_bf16 v[24:39], v[64:67], v[208:211], v[24:39]
    v_mfma_f32_32x32x16_bf16 v[24:39], v[68:71], v[212:215], v[24:39]
    s_waitcnt lgkmcnt(2)
    v_mfma_f32_16x16x32_bf16 v[40:43], v[248:251], v[236:239], v[40:43]
    ds_read_b64_tr_b16 v[248:249], v11 offset:0
    ds_read_b64_tr_b16 v[250:251], v11 offset:2304
    v_mfma_f32_32x32x16_bf16 v[24:39], v[72:75], v[216:219], v[24:39]
    v_mfma_f32_32x32x16_bf16 v[24:39], v[76:79], v[220:223], v[24:39]
    s_waitcnt lgkmcnt(2)
    v_mfma_f32_16x16x32_bf16 v[40:43], v[252:255], v[240:243], v[40:43]
    v_mfma_f32_32x32x16_bf16 v[24:39], v[80:83], v[224:227], v[24:39]
    s_waitcnt lgkmcnt(0)
    v_mfma_f32_16x16x32_bf16 v[40:43], v[248:251], v[244:247], v[40:43]
    ds_read_b64_tr_b16 v[248:249], v10 offset:288
    ds_read_b64_tr_b16 v[250:251], v10 offset:416
    ds_read_b64_tr_b16 v[252:253], v10 offset:2592
    ds_read_b64_tr_b16 v[254:255], v10 offset:2720
CL_129:
    s_add_u32 s90, s94, 18432
    buffer_load_dwordx4 v[192:195], v5, s[44:47], s90 offen offset:0 sc1
    buffer_load_dwordx4 v[196:199], v5, s[44:47], s90 offen offset:1024 sc1
    buffer_load_dwordx4 v[228:231], v12, s[44:47], s90 offen offset:0 sc1
    buffer_load_dwordx4 v[200:203], v5, s[44:47], s90 offen offset:2048 sc1
    buffer_load_dwordx4 v[204:207], v5, s[44:47], s90 offen offset:3072 sc1
    buffer_load_dwordx4 v[232:235], v12, s[44:47], s90 offen offset:2048 sc1
    s_add_u32 s90, s94, 22528
    buffer_load_dwordx4 v[208:211], v5, s[44:47], s90 offen offset:0 sc1
    buffer_load_dwordx4 v[212:215], v5, s[44:47], s90 offen offset:1024 sc1
    buffer_load_dwordx4 v[236:239], v12, s[44:47], s90 offen offset:0 sc1
    buffer_load_dwordx4 v[216:219], v5, s[44:47], s90 offen offset:2048 sc1
    buffer_load_dwordx4 v[220:223], v5, s[44:47], s90 offen offset:3072 sc1
    buffer_load_dwordx4 v[240:243], v12, s[44:47], s90 offen offset:2048 sc1
    s_add_u32 s90, s94, 26624
    buffer_load_dwordx4 v[224:227], v5, s[44:47], s90 offen offset:0 sc1
    buffer_load_dwordx4 v[244:247], v13, s[44:47], s90 offen offset:0 sc1
    s_waitcnt vmcnt(12)
    v_max_u32 v1, v192, v196
    s_waitcnt vmcnt(10)
    v_max3_u32 v1, v1, v228, v200
    s_waitcnt vmcnt(8)
    v_max3_u32 v1, v1, v204, v232
    s_waitcnt vmcnt(6)
    v_max3_u32 v1, v1, v208, v212
    s_waitcnt vmcnt(4)
    v_max3_u32 v1, v1, v236, v216
    s_waitcnt vmcnt(2)
    v_max3_u32 v1, v1, v220, v240
    s_waitcnt vmcnt(1)
    v_max3_u32 v1, v1, v224, v225
    s_waitcnt vmcnt(1)
    v_max3_u32 v1, v1, v226, v227
    s_waitcnt vmcnt(0)
    v_max3_u32 v1, v1, v244, v245
    s_waitcnt vmcnt(0)
    v_max3_u32 v1, v1, v246, v247
    v_cmp_eq_u32 vcc, -1, v1
    s_cmp_eq_u64 vcc, 0
    s_cbranch_scc1 CD_130
    s_sleep 8
    s_sub_u32 s72, s72, 1
    s_cbranch_scc0 CL_129
    s_branch L_bail
CD_130:
    v_mfma_f32_32x32x16_bf16 v[24:39], v[84:87], v[192:195], v[24:39]
    v_mfma_f32_32x32x16_bf16 v[24:39], v[88:91], v[196:199], v[24:39]
    s_waitcnt lgkmcnt(2)
    v_mfma_f32_16x16x32_bf16 v[40:43], v[248:251], v[228:231], v[40:43]
    ds_read_b64_tr_b16 v[248:249], v10 offset:4896
    ds_read_b64_tr_b16 v[250:251], v10 offset:5024
    v_mfma_f32_32x32x16_bf16 v[24:39], v[92:95], v[200:203], v[24:39]
    v_mfma_f32_32x32x16_bf16 v[24:39], v[96:99], v[204:207], v[24:39]
    s_waitcnt lgkmcnt(2)
    v_mfma_f32_16x16x32_bf16 v[40:43], v[252:255], v[232:235], v[40:43]
    ds_read_b64_tr_b16 v[252:253], v10 offset:7200
    ds_read_b64_tr_b16 v[254:255], v10 offset:7328
    v_mfma_f32_32x32x16_bf16 v[24:39], v[100:103], v[208:211], v[24:39]
    v_mfma_f32_32x32x16_bf16 v[24:39], v[104:107], v[212:215], v[24:39]
    s_waitcnt lgkmcnt(2)
    v_mfma_f32_16x16x32_bf16 v[40:43], v[248:251], v[236:239], v[40:43]
    ds_read_b64_tr_b16 v[248:249], v11 offset:288
    ds_read_b64_tr_b16 v[250:251], v11 offset:2592
    v_mfma_f32_32x32x16_bf16 v[24:39], v[108:111], v[216:219], v[24:39]
    v_mfma_f32_32x32x16_bf16 v[24:39], v[112:115], v[220:223], v[24:39]
    s_waitcnt lgkmcnt(2)
    v_mfma_f32_16x16x32_bf16 v[40:43], v[252:255], v[240:243], v[40:43]
    v_mfma_f32_32x32x16_bf16 v[24:39], v[116:119], v[224:227], v[24:39]
    s_waitcnt lgkmcnt(0)
    v_mfma_f32_16x16x32_bf16 v[40:43], v[248:251], v[244:247], v[40:43]
LW_131:
    ds_read_b32 v1, v2 offset:1280
    s_waitcnt lgkmcnt(0)
    v_readfirstlane_b32 s73, v1
    s_cmp_ge_u32 s73, 4
    s_cbranch_scc1 LWD_132
    s_sleep 4
    s_sub_u32 s72, s72, 1
    s_cbranch_scc0 LW_131
    s_branch L_bail
LWD_132:
    ds_read_b64_tr_b16 v[248:249], v10 offset:576
    ds_read_b64_tr_b16 v[250:251], v10 offset:704
    ds_read_b64_tr_b16 v[252:253], v10 offset:2880
    ds_read_b64_tr_b16 v[254:255], v10 offset:3008
CP_133:
    s_add_u32 s90, s94, 45056
    buffer_load_dwordx4 v[192:195], v5, s[44:47], s90 offen sc1
    s_waitcnt vmcnt(0)
    v_max_u32 v1, v192, v193
    v_max3_u32 v1, v1, v194, v195
    v_cmp_eq_u32 vcc, -1, v1
    s_cmp_eq_u64 vcc, 0
    s_cbranch_scc1 CQ_134
    s_sleep 8
    s_sub_u32 s72, s72, 1
    s_cbranch_scc0 CP_133
    s_branch L_bail
CQ_134:
CL_135:
    s_add_u32 s90, s94, 36864
    buffer_load_dwordx4 v[192:195], v5, s[44:47], s90 offen offset:0 sc1
    buffer_load_dwordx4 v[196:199], v5, s[44:47], s90 offen offset:1024 sc1
    buffer_load_dwordx4 v[228:231], v12, s[44:47], s90 offen offset:0 sc1
    buffer_load_dwordx4 v[200:203], v5, s[44:47], s90 offen offset:2048 sc1
    buffer_load_dwordx4 v[204:207], v5, s[44:47], s90 offen offset:3072 sc1
    buffer_load_dwordx4 v[232:235], v12, s[44:47], s90 offen offset:2048 sc1
    s_add_u32 s90, s94, 40960
    buffer_load_dwordx4 v[208:211], v5, s[44:47], s90 offen offset:0 sc1
    buffer_load_dwordx4 v[212:215], v5, s[44:47], s90 offen offset:1024 sc1
    buffer_load_dwordx4 v[236:239], v12, s[44:47], s90 offen offset:0 sc1
    buffer_load_dwordx4 v[216:219], v5, s[44:47], s90 offen offset:2048 sc1
    buffer_load_dwordx4 v[220:223], v5, s[44:47], s90 offen offset:3072 sc1
    buffer_load_dwordx4 v[240:243], v12, s[44:47], s90 offen offset:2048 sc1
    s_add_u32 s90, s94, 45056
    buffer_load_dwordx4 v[224:227], v5, s[44:47], s90 offen offset:0 sc1
    buffer_load_dwordx4 v[244:247], v13, s[44:47], s90 offen offset:0 sc1
    s_waitcnt vmcnt(12)
    v_max_u32 v1, v192, v196
    s_waitcnt vmcnt(10)
    v_max3_u32 v1, v1, v228, v200
    s_waitcnt vmcnt(8)
    v_max3_u32 v1, v1, v204, v232
    s_waitcnt vmcnt(6)
    v_max3_u32 v1, v1, v208, v212
    s_waitcnt vmcnt(4)
    v_max3_u32 v1, v1, v236, v216
    s_waitcnt vmcnt(2)
    v_max3_u32 v1, v1, v220, v240
    s_waitcnt vmcnt(1)
    v_max3_u32 v1, v1, v224, v225
    s_waitcnt vmcnt(1)
    v_max3_u32 v1, v1, v226, v227
    s_waitcnt vmcnt(0)
    v_max3_u32 v1, v1, v244, v245
    s_waitcnt vmcnt(0)
    v_max3_u32 v1, v1, v246, v247
    v_cmp_eq_u32 vcc, -1, v1
    s_cmp_eq_u64 vcc, 0
    s_cbranch_scc1 CD_136
    s_sleep 8
    s_sub_u32 s72, s72, 1
    s_cbranch_scc0 CL_135
    s_branch L_bail
CD_136:
    v_mfma_f32_32x32x16_bf16 v[24:39], v[120:123], v[192:195], v[24:39]
    v_mfma_f32_32x32x16_bf16 v[24:39], v[124:127], v[196:199], v[24:39]
    s_waitcnt lgkmcnt(2)
    v_mfma_f32_16x16x32_bf16 v[40:43], v[248:251], v[228:231], v[40:43]
    ds_read_b64_tr_b16 v[248:249], v10 offset:5184
    ds_read_b64_tr_b16 v[250:251], v10 offset:5312
    v_mfma_f32_32x32x16_bf16 v[24:39], v[128:131], v[200:203], v[24:39]
    v_mfma_f32_32x32x16_bf16 v[24:39], v[132:135], v[204:207], v[24:39]
    s_waitcnt lgkmcnt(2)
    v_mfma_f32_16x16x32_bf16 v[40:43], v[252:255], v[232:235], v[40:43]
    ds_read_b64_tr_b16 v[252:253], v10 offset:7488
    ds_read_b64_tr_b16 v[254:255], v10 offset:7616
    v_mfma_f32_32x32x16_bf16 v[24:39], v[136:139], v[208:211], v[24:39]
    v_mfma_f32_32x32x16_bf16 v[24:39], v[140:143], v[212:215], v[24:39]
    s_waitcnt lgkmcnt(2)
    v_mfma_f32_16x16x32_bf16 v[40:43], v[248:251], v[236:239], v[40:43]
    ds_read_b64_tr_b16 v[248:249], v11 offset:576
    ds_read_b64_tr_b16 v[250:251], v11 offset:2880
    v_mfma_f32_32x32x16_bf16 v[24:39], v[144:147], v[216:219], v[24:39]
    v_mfma_f32_32x32x16_bf16 v[24:39], v[148:151], v[220:223], v[24:39]
    s_waitcnt lgkmcnt(2)
    v_mfma_f32_16x16x32_bf16 v[40:43], v[252:255], v[240:243], v[40:43]
    v_mfma_f32_32x32x16_bf16 v[24:39], v[152:155], v[224:227], v[24:39]
    s_waitcnt lgkmcnt(0)
    v_mfma_f32_16x16x32_bf16 v[40:43], v[248:251], v[244:247], v[40:43]
LW_137:
    ds_read_b32 v1, v2 offset:1792
    s_waitcnt lgkmcnt(0)
    v_readfirstlane_b32 s73, v1
    s_cmp_ge_u32 s73, 4
    s_cbranch_scc1 LWD_138
    s_sleep 2
    s_sub_u32 s72, s72, 1
    s_cbranch_scc0 LW_137
    s_branch L_bail
LWD_138:
    ds_read_b64_tr_b16 v[248:249], v10 offset:864
    ds_read_b64_tr_b16 v[250:251], v10 offset:992
    ds_read_b64_tr_b16 v[252:253], v10 offset:3168
    ds_read_b64_tr_b16 v[254:255], v10 offset:3296
CL_139:
    s_add_u32 s90, s94, 55296
    buffer_load_dwordx4 v[192:195], v5, s[44:47], s90 offen offset:0 sc1
    buffer_load_dwordx4 v[196:199], v5, s[44:47], s90 offen offset:1024 sc1
    buffer_load_dwordx4 v[228:231], v12, s[44:47], s90 offen offset:0 sc1
    buffer_load_dwordx4 v[200:203], v5, s[44:47], s90 offen offset:2048 sc1
    buffer_load_dwordx4 v[204:207], v5, s[44:47], s90 offen offset:3072 sc1
    buffer_load_dwordx4 v[232:235], v12, s[44:47], s90 offen offset:2048 sc1
    s_add_u32 s90, s94, 59392
    buffer_load_dwordx4 v[208:211], v5, s[44:47], s90 offen offset:0 sc1
    buffer_load_dwordx4 v[212:215], v5, s[44:47], s90 offen offset:1024 sc1
    buffer_load_dwordx4 v[236:239], v12, s[44:47], s90 offen offset:0 sc1
    buffer_load_dwordx4 v[216:219], v5, s[44:47], s90 offen offset:2048 sc1
    buffer_load_dwordx4 v[220:223], v5, s[44:47], s90 offen offset:3072 sc1
    buffer_load_dwordx4 v[240:243], v12, s[44:47], s90 offen offset:2048 sc1
    s_add_u32 s90, s94, 63488
    buffer_load_dwordx4 v[224:227], v5, s[44:47], s90 offen offset:0 sc1
    buffer_load_dwordx4 v[244:247], v13, s[44:47], s90 offen offset:0 sc1
    s_waitcnt vmcnt(12)
    v_max_u32 v1, v192, v196
    s_waitcnt vmcnt(10)
    v_max3_u32 v1, v1, v228, v200
    s_waitcnt vmcnt(8)
    v_max3_u32 v1, v1, v204, v232
    s_waitcnt vmcnt(6)
    v_max3_u32 v1, v1, v208, v212
    s_waitcnt vmcnt(4)
    v_max3_u32 v1, v1, v236, v216
    s_waitcnt vmcnt(2)
    v_max3_u32 v1, v1, v220, v240
    s_waitcnt vmcnt(1)
    v_max3_u32 v1, v1, v224, v225
    s_waitcnt vmcnt(1)
    v_max3_u32 v1, v1, v226, v227
    s_waitcnt vmcnt(0)
    v_max3_u32 v1, v1, v244, v245
    s_waitcnt vmcnt(0)
    v_max3_u32 v1, v1, v246, v247
    v_cmp_eq_u32 vcc, -1, v1
    s_cmp_eq_u64 vcc, 0
    s_cbranch_scc1 CD_140
    s_sleep 2
    s_sub_u32 s72, s72, 1
    s_cbranch_scc0 CL_139
    s_branch L_bail
CD_140:
    v_mfma_f32_32x32x16_bf16 v[24:39], v[156:159], v[192:195], v[24:39]
    v_mfma_f32_32x32x16_bf16 v[24:39], v[160:163], v[196:199], v[24:39]
    s_waitcnt lgkmcnt(2)
    v_mfma_f32_16x16x32_bf16 v[40:43], v[248:251], v[228:231], v[40:43]
    ds_read_b64_tr_b16 v[248:249], v10 offset:5472
    ds_read_b64_tr_b16 v[250:251], v10 offset:5600
    v_mfma_f32_32x32x16_bf16 v[24:39], v[164:167], v[200:203], v[24:39]
    v_mfma_f32_32x32x16_bf16 v[24:39], v[168:171], v[204:207], v[24:39]
    s_waitcnt lgkmcnt(2)
    v_mfma_f32_16x16x32_bf16 v[40:43], v[252:255], v[232:235], v[40:43]
    ds_read_b64_tr_b16 v[252:253], v10 offset:7776
    ds_read_b64_tr_b16 v[254:255], v10 offset:7904
    v_mfma_f32_32x32x16_bf16 v[24:39], v[172:175], v[208:211], v[24:39]
    v_mfma_f32_32x32x16_bf16 v[24:39], v[176:179], v[212:215], v[24:39]
    s_waitcnt lgkmcnt(2)
    v_mfma_f32_16x16x32_bf16 v[40:43], v[248:251], v[236:239], v[40:43]
    ds_read_b64_tr_b16 v[248:249], v11 offset:864
    ds_read_b64_tr_b16 v[250:251], v11 offset:3168
    v_mfma_f32_32x32x16_bf16 v[24:39], v[180:183], v[216:219], v[24:39]
    v_mfma_f32_32x32x16_bf16 v[24:39], v[184:187], v[220:223], v[24:39]
    s_waitcnt lgkmcnt(2)
    v_mfma_f32_16x16x32_bf16 v[40:43], v[252:255], v[240:243], v[40:43]
    v_mfma_f32_32x32x16_bf16 v[24:39], v[188:191], v[224:227], v[24:39]
    s_waitcnt lgkmcnt(0)
    v_mfma_f32_16x16x32_bf16 v[40:43], v[248:251], v[244:247], v[40:43]
    s_nop 4
    s_nop 2
    v_cvt_pk_bf16_f32 v40, v40, v41
    v_cvt_pk_bf16_f32 v41, v42, v43
    s_nop 3
    s_nop 0
    v_cvt_pk_bf16_f32 v24, v24, v25
    v_cvt_pk_bf16_f32 v25, v26, v27
    v_cvt_pk_bf16_f32 v26, v28, v29
    v_cvt_pk_bf16_f32 v27, v30, v31
    v_cvt_pk_bf16_f32 v28, v32, v33
    v_cvt_pk_bf16_f32 v29, v34, v35
    v_cvt_pk_bf16_f32 v30, v36, v37
    v_cvt_pk_bf16_f32 v31, v38, v39
    buffer_store_dwordx4 v[24:27], v18, s[52:55], s93 offen offset:64
    buffer_store_dwordx4 v[28:31], v18, s[52:55], s93 offen offset:80
    s_mov_b32 exec_hi, 0
    buffer_store_dwordx2 v[40:41], v19, s[52:55], s92 offen offset:128
    s_mov_b64 exec, -1
    s_branch L_fin
TL_39:
    s_setprio 2
    ds_read_b32 v4, v23 offset:2304
    ds_read_b32 v45, v23 offset:2432
    v_and_b32 v7, 15, v0
    v_lshl_add_u32 v7, v7, 2, v2
    ds_read_b32 v46, v7 offset:2496
    v_add_u32 v7, 36864, v16
    v_add_u32 v8, 36864, v17
    s_waitcnt lgkmcnt(0)
    v_sub_f32 v4, 1.0, v4
LW_141:
    ds_read_b32 v1, v2 offset:512
    s_waitcnt lgkmcnt(0)
    v_readfirstlane_b32 s73, v1
    s_cmp_ge_u32 s73, 4
    s_cbranch_scc1 LWD_142
    s_sleep 4
    s_sub_u32 s72, s72, 1
    s_cbranch_scc0 LW_141
    s_branch L_bail
LWD_142:
    ds_read_b128 v[192:195], v20 offset:20480
    ds_read_b128 v[196:199], v20 offset:21504
    ds_read_b64 v[200:201], v21 offset:20480
    ds_read_b32 v202, v22 offset:20480
    ds_read_b128 v[204:207], v20 offset:23040
    ds_read_b128 v[208:211], v20 offset:24064
    ds_read_b64 v[212:213], v21 offset:23040
    ds_read_b32 v214, v22 offset:23040
    s_add_u32 s90, s96, 18432
    s_add_u32 s91, s97, 18432
    s_movk_i32 s89, 2
    ds_read_b128 v[216:219], v20 offset:25600
    ds_read_b128 v[220:223], v20 offset:26624
    ds_read_b64 v[224:225], v21 offset:25600
    ds_read_b32 v226, v22 offset:25600
    s_waitcnt lgkmcnt(4)
    ds_read_b128 v[228:231], v20 offset:28160
    ds_read_b128 v[232:235], v20 offset:29184
    ds_read_b64 v[236:237], v21 offset:28160
    ds_read_b32 v238, v22 offset:28160
    v_pk_add_f32 v[192:193], v[192:193], v[204:205]
    v_pk_add_f32 v[194:195], v[194:195], v[206:207]
    v_pk_add_f32 v[196:197], v[196:197], v[208:209]
    v_pk_add_f32 v[198:199], v[198:199], v[210:211]
    v_pk_add_f32 v[200:201], v[200:201], v[212:213]
    v_add_f32 v202, v202, v214
    s_waitcnt lgkmcnt(4)
    v_pk_add_f32 v[192:193], v[192:193], v[216:217]
    v_pk_add_f32 v[194:195], v[194:195], v[218:219]
    v_pk_add_f32 v[196:197], v[196:197], v[220:221]
    v_pk_add_f32 v[198:199], v[198:199], v[222:223]
    v_pk_add_f32 v[200:201], v[200:201], v[224:225]
    v_add_f32 v202, v202, v226
    s_waitcnt lgkmcnt(0)
    v_pk_add_f32 v[192:193], v[192:193], v[228:229]
    v_pk_add_f32 v[194:195], v[194:195], v[230:231]
    v_pk_add_f32 v[196:197], v[196:197], v[232:233]
    v_pk_add_f32 v[198:199], v[198:199], v[234:235]
    v_pk_add_f32 v[200:201], v[200:201], v[236:237]
    v_add_f32 v202, v202, v238
LW_143:
    ds_read_b32 v1, v2 offset:2112
    s_waitcnt lgkmcnt(0)
    v_readfirstlane_b32 s73, v1
    s_cmp_ge_u32 s73, 1
    s_cbranch_scc1 LWD_144
    s_sleep 2
    s_sub_u32 s72, s72, 1
    s_cbranch_scc0 LW_143
    s_branch L_bail
LWD_144:
    s_mov_b64 exec, 1
    ds_add_u32 v2, v3 offset:2096
    s_mov_b64 exec, -1
    v_pk_mul_f32 v[204:205], v[192:193], 0 op_sel_hi:[1,0]
    v_pk_fma_f32 v[204:205], v[194:195], 0, v[204:205] op_sel_hi:[1,0,1]
    v_pk_fma_f32 v[204:205], v[196:197], 0, v[204:205] op_sel_hi:[1,0,1]
    v_pk_fma_f32 v[204:205], v[198:199], 0, v[204:205] op_sel_hi:[1,0,1]
    v_pk_fma_f32 v[204:205], v[200:201], 0, v[204:205] op_sel_hi:[1,0,1]
    v_add_f32 v204, v204, v205
    v_subrev_u32 v205, 0x21800000, v202
    v_cmp_u_f32 vcc, v204, v204
    s_mov_b32 s73, 0x3e000000
    v_cmp_lt_u32 s[74:75], s73, v205
    s_or_b64 vcc, vcc, s[74:75]
    s_cmp_eq_u64 vcc, 0
    s_cbranch_scc1 SOK_145
    s_call_b64 s[86:87], L_fallback
SOK_145:
    v_rcp_f32 v202, v202
    s_nop 0
    v_mul_f32 v202, v4, v202
    v_pk_mul_f32 v[192:193], v[192:193], v[202:203] op_sel_hi:[1,0]
    v_pk_mul_f32 v[194:195], v[194:195], v[202:203] op_sel_hi:[1,0]
    v_pk_mul_f32 v[196:197], v[196:197], v[202:203] op_sel_hi:[1,0]
    v_pk_mul_f32 v[198:199], v[198:199], v[202:203] op_sel_hi:[1,0]
    v_pk_mul_f32 v[200:201], v[200:201], v[202:203] op_sel_hi:[1,0]
    v_cvt_pk_bf16_f32 v204, v192, v193
    v_cvt_pk_bf16_f32 v205, v194, v195
    v_cvt_pk_bf16_f32 v206, v196, v197
    v_cvt_pk_bf16_f32 v207, v198, v199
    v_cvt_pk_bf16_f32 v208, v200, v201
    v_min_u32 v204, -2, v204
    v_min_u32 v208, -2, v208
    buffer_store_dwordx4 v[204:207], v5, s[44:47], s90 offen sc1
    s_mov_b32 exec_hi, 0
    buffer_store_dword v208, v5, s[44:47], s91 offen sc1
    s_mov_b64 exec, -1
    s_mul_i32 s93, s70, 110592
    s_add_u32 s98, s93, 1122304
    s_add_u32 s93, s93, 1085440
LW_146:
    ds_read_b32 v1, v2 offset:2076
    s_waitcnt lgkmcnt(0)
    v_readfirstlane_b32 s73, v1
    s_cmp_ge_u32 s73, 8
    s_cbranch_scc1 LWD_147
    s_sleep 3
    s_sub_u32 s72, s72, 1
    s_cbranch_scc0 LW_146
    s_branch L_bail
LWD_147:
    buffer_load_dwordx4 v[192:195], v5, s[44:47], s93 offen offset:0 sc1
    buffer_load_dwordx4 v[196:199], v5, s[44:47], s93 offen offset:1024 sc1
    buffer_load_dwordx4 v[224:227], v14, s[44:47], s98 offen offset:0 sc1
    buffer_load_dwordx4 v[200:203], v5, s[44:47], s93 offen offset:2048 sc1
    buffer_load_dwordx4 v[204:207], v5, s[44:47], s93 offen offset:3072 sc1
    s_add_u32 s93, s93, 4096
    buffer_load_dwordx4 v[228:231], v14, s[44:47], s98 offen offset:2048 sc1
    s_add_u32 s98, s98, 4096
    buffer_load_dwordx4 v[208:211], v5, s[44:47], s93 offen offset:0 sc1
    buffer_load_dwordx4 v[212:215], v5, s[44:47], s93 offen offset:1024 sc1
    buffer_load_dwordx4 v[232:235], v14, s[44:47], s98 offen offset:0 sc1
    buffer_load_dwordx4 v[216:219], v5, s[44:47], s93 offen offset:2048 sc1
    buffer_load_dwordx4 v[220:223], v5, s[44:47], s93 offen offset:3072 sc1
    s_add_u32 s93, s93, 4096
LW_148:
    ds_read_b32 v1, v2 offset:2092
    s_waitcnt lgkmcnt(0)
    v_readfirstlane_b32 s73, v1
    s_cmp_ge_u32 s73, 2
    s_cbranch_scc1 LWD_149
    s_sleep 3
    s_sub_u32 s72, s72, 1
    s_cbranch_scc0 LW_148
    s_branch L_bail
LWD_149:
    ds_read_b64_tr_b16 v[48:49], v6 offset:0
    ds_read_b64_tr_b16 v[50:51], v6 offset:512
    ds_read_b64_tr_b16 v[52:53], v6 offset:4608
    ds_read_b64_tr_b16 v[54:55], v6 offset:5120
    ds_read_b64_tr_b16 v[56:57], v6 offset:9216
    ds_read_b64_tr_b16 v[58:59], v6 offset:9728
    s_waitcnt lgkmcnt(6)
    ds_read_b64_tr_b16 v[60:61], v6 offset:13824
    ds_read_b64_tr_b16 v[62:63], v6 offset:14336
    ds_read_b64_tr_b16 v[64:65], v6 offset:18432
    ds_read_b64_tr_b16 v[66:67], v6 offset:18944
    ds_read_b64_tr_b16 v[68:69], v6 offset:23040
    ds_read_b64_tr_b16 v[70:71], v6 offset:23552
    s_waitcnt lgkmcnt(6)
    ds_read_b64_tr_b16 v[72:73], v6 offset:27648
    ds_read_b64_tr_b16 v[74:75], v6 offset:28160
    ds_read_b64_tr_b16 v[76:77], v6 offset:32256
    ds_read_b64_tr_b16 v[78:79], v6 offset:32768
    ds_read_b64_tr_b16 v[80:81], v9 offset:0
    ds_read_b64_tr_b16 v[82:83], v9 offset:9216
    s_waitcnt lgkmcnt(6)
    ds_read_b64_tr_b16 v[84:85], v6 offset:1152
    ds_read_b64_tr_b16 v[86:87], v6 offset:1664
    ds_read_b64_tr_b16 v[88:89], v6 offset:5760
    ds_read_b64_tr_b16 v[90:91], v6 offset:6272
    ds_read_b64_tr_b16 v[92:93], v6 offset:10368
    ds_read_b64_tr_b16 v[94:95], v6 offset:10880
    s_waitcnt lgkmcnt(6)
    ds_read_b64_tr_b16 v[96:97], v6 offset:14976
    ds_read_b64_tr_b16 v[98:99], v6 offset:15488
    ds_read_b64_tr_b16 v[100:101], v6 offset:19584
    ds_read_b64_tr_b16 v[102:103], v6 offset:20096
    ds_read_b64_tr_b16 v[104:105], v6 offset:24192
    ds_read_b64_tr_b16 v[106:107], v6 offset:24704
    s_waitcnt lgkmcnt(6)
    ds_read_b64_tr_b16 v[108:109], v6 offset:28800
    ds_read_b64_tr_b16 v[110:111], v6 offset:29312
    ds_read_b64_tr_b16 v[112:113], v6 offset:33408
    ds_read_b64_tr_b16 v[114:115], v6 offset:33920
    ds_read_b64_tr_b16 v[116:117], v9 offset:1152
    ds_read_b64_tr_b16 v[118:119], v9 offset:10368
    s_waitcnt lgkmcnt(6)
    ds_read_b64_tr_b16 v[120:121], v6 offset:2304
    ds_read_b64_tr_b16 v[122:123], v6 offset:2816
    ds_read_b64_tr_b16 v[124:125], v6 offset:6912
    ds_read_b64_tr_b16 v[126:127], v6 offset:7424
    ds_read_b64_tr_b16 v[128:129], v6 offset:11520
    ds_read_b64_tr_b16 v[130:131], v6 offset:12032
    s_waitcnt lgkmcnt(6)
    ds_read_b64_tr_b16 v[132:133], v6 offset:16128
    ds_read_b64_tr_b16 v[134:135], v6 offset:16640
    ds_read_b64_tr_b16 v[136:137], v6 offset:20736
    ds_read_b64_tr_b16 v[138:139], v6 offset:21248
    ds_read_b64_tr_b16 v[140:141], v6 offset:25344
    ds_read_b64_tr_b16 v[142:143], v6 offset:25856
    s_waitcnt lgkmcnt(6)
    ds_read_b64_tr_b16 v[144:145], v6 offset:29952
    ds_read_b64_tr_b16 v[146:147], v6 offset:30464
    ds_read_b64_tr_b16 v[148:149], v6 offset:34560
    ds_read_b64_tr_b16 v[150:151], v6 offset:35072
    ds_read_b64_tr_b16 v[152:153], v9 offset:2304
    ds_read_b64_tr_b16 v[154:155], v9 offset:11520
    s_waitcnt lgkmcnt(6)
    ds_read_b64_tr_b16 v[156:157], v6 offset:3456
    ds_read_b64_tr_b16 v[158:159], v6 offset:3968
    ds_read_b64_tr_b16 v[160:161], v6 offset:8064
    ds_read_b64_tr_b16 v[162:163], v6 offset:8576
    ds_read_b64_tr_b16 v[164:165], v6 offset:12672
    ds_read_b64_tr_b16 v[166:167], v6 offset:13184
    s_waitcnt lgkmcnt(6)
    ds_read_b64_tr_b16 v[168:169], v6 offset:17280
    ds_read_b64_tr_b16 v[170:171], v6 offset:17792
    ds_read_b64_tr_b16 v[172:173], v6 offset:21888
    ds_read_b64_tr_b16 v[174:175], v6 offset:22400
    ds_read_b64_tr_b16 v[176:177], v6 offset:26496
    ds_read_b64_tr_b16 v[178:179], v6 offset:27008
    s_waitcnt lgkmcnt(6)
    ds_read_b64_tr_b16 v[180:181], v6 offset:31104
    ds_read_b64_tr_b16 v[182:183], v6 offset:31616
    ds_read_b64_tr_b16 v[184:185], v6 offset:35712
    ds_read_b64_tr_b16 v[186:187], v6 offset:36224
    ds_read_b64_tr_b16 v[188:189], v9 offset:3456
    ds_read_b64_tr_b16 v[190:191], v9 offset:12672
    s_waitcnt lgkmcnt(6)
    s_waitcnt lgkmcnt(0)
    s_mov_b64 exec, 1
    ds_add_u32 v2, v3 offset:2088
    s_mov_b64 exec, -1
LW_150:
    ds_read_b32 v1, v2 offset:2084
    s_waitcnt lgkmcnt(0)
    v_readfirstlane_b32 s73, v1
    s_cmp_ge_u32 s73, 2
    s_cbranch_scc1 LWD_151
    s_sleep 2
    s_sub_u32 s72, s72, 1
    s_cbranch_scc0 LW_150
    s_branch L_bail
LWD_151:
    ds_read_b64_tr_b16 v[236:237], v16 offset:0
    ds_read_b64_tr_b16 v[238:239], v16 offset:512
    ds_read_b64_tr_b16 v[240:241], v16 offset:2048
    ds_read_b64_tr_b16 v[242:243], v16 offset:2560
    ds_read_b64_tr_b16 v[248:249], v17 offset:0
    ds_read_b64_tr_b16 v[250:251], v17 offset:512
    s_waitcnt vmcnt(10) lgkmcnt(4)
    v_mfma_f32_32x32x16_bf16 v[24:39], v[192:195], v[236:239], 0
    buffer_load_dwordx4 v[192:195], v5, s[44:47], s93 offen offset:0 sc1
    ds_read_b64_tr_b16 v[244:245], v16 offset:4096
    ds_read_b64_tr_b16 v[246:247], v16 offset:4608
    s_waitcnt vmcnt(10) lgkmcnt(4)
    v_mfma_f32_32x32x16_bf16 v[24:39], v[196:199], v[240:243], v[24:39]
    buffer_load_dwordx4 v[196:199], v5, s[44:47], s93 offen offset:1024 sc1
    ds_read_b64_tr_b16 v[236:237], v16 offset:6144
    ds_read_b64_tr_b16 v[238:239], v16 offset:6656
    s_waitcnt vmcnt(10) lgkmcnt(4)
    v_mfma_f32_16x16x32_bf16 v[40:43], v[224:227], v[248:251], 0
    buffer_load_dwordx4 v[224:227], v14, s[44:47], s98 offen offset:2048 sc1
    s_add_u32 s98, s98, 4096
    ds_read_b64_tr_b16 v[252:253], v17 offset:4096
    ds_read_b64_tr_b16 v[254:255], v17 offset:4608
    s_waitcnt vmcnt(10) lgkmcnt(4)
    v_mfma_f32_32x32x16_bf16 v[24:39], v[200:203], v[244:247], v[24:39]
    buffer_load_dwordx4 v[200:203], v5, s[44:47], s93 offen offset:2048 sc1
    ds_read_b64_tr_b16 v[240:241], v16 offset:8192
    ds_read_b64_tr_b16 v[242:243], v16 offset:8704
    s_waitcnt vmcnt(10) lgkmcnt(4)
    v_mfma_f32_32x32x16_bf16 v[24:39], v[204:207], v[236:239], v[24:39]
    buffer_load_dwordx4 v[204:207], v5, s[44:47], s93 offen offset:3072 sc1
    s_add_u32 s93, s93, 4096
    ds_read_b64_tr_b16 v[244:245], v16 offset:10240
    ds_read_b64_tr_b16 v[246:247], v16 offset:10752
    s_waitcnt vmcnt(10) lgkmcnt(4)
    v_mfma_f32_16x16x32_bf16 v[40:43], v[228:231], v[252:255], v[40:43]
    buffer_load_dwordx4 v[228:231], v14, s[44:47], s98 offen offset:0 sc1
    ds_read_b64_tr_b16 v[248:249], v17 offset:8192
    ds_read_b64_tr_b16 v[250:251], v17 offset:8704
    s_waitcnt vmcnt(10) lgkmcnt(4)
    v_mfma_f32_32x32x16_bf16 v[24:39], v[208:211], v[240:243], v[24:39]
    buffer_load_dwordx4 v[208:211], v5, s[44:47], s93 offen offset:0 sc1
    ds_read_b64_tr_b16 v[236:237], v16 offset:12288
    ds_read_b64_tr_b16 v[238:239], v16 offset:12800
    s_waitcnt vmcnt(10) lgkmcnt(4)
    v_mfma_f32_32x32x16_bf16 v[24:39], v[212:215], v[244:247], v[24:39]
    buffer_load_dwordx4 v[212:215], v5, s[44:47], s93 offen offset:1024 sc1
    ds_read_b64_tr_b16 v[240:241], v16 offset:14336
    ds_read_b64_tr_b16 v[242:243], v16 offset:14848
    s_waitcnt vmcnt(10) lgkmcnt(4)
    v_mfma_f32_16x16x32_bf16 v[40:43], v[232:235], v[248:251], v[40:43]
    buffer_load_dwordx4 v[232:235], v14, s[44:47], s98 offen offset:2048 sc1
    s_add_u32 s98, s98, 4096
    ds_read_b64_tr_b16 v[252:253], v17 offset:12288
    ds_read_b64_tr_b16 v[254:255], v17 offset:12800
    s_waitcnt vmcnt(10) lgkmcnt(4)
    v_mfma_f32_32x32x16_bf16 v[24:39], v[216:219], v[236:239], v[24:39]
    buffer_load_dwordx4 v[216:219], v5, s[44:47], s93 offen offset:2048 sc1
    ds_read_b64_tr_b16 v[244:245], v16 offset:16384
    ds_read_b64_tr_b16 v[246:247], v16 offset:16896
    s_waitcnt vmcnt(10) lgkmcnt(4)
    v_mfma_f32_32x32x16_bf16 v[24:39], v[220:223], v[240:243], v[24:39]
    buffer_load_dwordx4 v[220:223], v5, s[44:47], s93 offen offset:3072 sc1
    s_add_u32 s93, s93, 4096
    ds_read_b64_tr_b16 v[236:237], v16 offset:18432
    ds_read_b64_tr_b16 v[238:239], v16 offset:18944
    s_waitcnt vmcnt(8) lgkmcnt(4)
    v_mfma_f32_16x16x32_bf16 v[40:43], v[224:227], v[252:255], v[40:43]
    buffer_load_dwordx4 v[224:227], v14, s[44:47], s98 offen offset:0 sc1
    ds_read_b64_tr_b16 v[248:249], v17 offset:16384
    ds_read_b64_tr_b16 v[250:251], v17 offset:16896
    s_waitcnt lgkmcnt(4)
    v_mfma_f32_32x32x16_bf16 v[24:39], v[192:195], v[244:247], v[24:39]
    buffer_load_dwordx4 v[192:195], v5, s[44:47], s93 offen offset:0 sc1
    ds_read_b64_tr_b16 v[240:241], v16 offset:20480
    ds_read_b64_tr_b16 v[242:243], v16 offset:20992
    s_waitcnt lgkmcnt(4)
    v_mfma_f32_32x32x16_bf16 v[24:39], v[196:199], v[236:239], v[24:39]
    buffer_load_dwordx4 v[196:199], v5, s[44:47], s93 offen offset:1024 sc1
    ds_read_b64_tr_b16 v[244:245], v16 offset:22528
    ds_read_b64_tr_b16 v[246:247], v16 offset:23040
    s_waitcnt vmcnt(8) lgkmcnt(4)
    v_mfma_f32_16x16x32_bf16 v[40:43], v[228:231], v[248:251], v[40:43]
    buffer_load_dwordx4 v[228:231], v14, s[44:47], s98 offen offset:2048 sc1
    s_add_u32 s98, s98, 4096
    ds_read_b64_tr_b16 v[252:253], v17 offset:20480
    ds_read_b64_tr_b16 v[254:255], v17 offset:20992
    s_waitcnt lgkmcnt(4)
    v_mfma_f32_32x32x16_bf16 v[24:39], v[200:203], v[240:243], v[24:39]
    buffer_load_dwordx4 v[200:203], v5, s[44:47], s93 offen offset:2048 sc1
    ds_read_b64_tr_b16 v[236:237], v16 offset:24576
    ds_read_b64_tr_b16 v[238:239], v16 offset:25088
    s_waitcnt lgkmcnt(4)
    v_mfma_f32_32x32x16_bf16 v[24:39], v[204:207], v[244:247], v[24:39]
    buffer_load_dwordx4 v[204:207], v5, s[44:47], s93 offen offset:3072 sc1
    s_add_u32 s93, s93, 4096
    ds_read_b64_tr_b16 v[240:241], v16 offset:26624
    ds_read_b64_tr_b16 v[242:243], v16 offset:27136
    s_waitcnt vmcnt(8) lgkmcnt(4)
    v_mfma_f32_16x16x32_bf16 v[40:43], v[232:235], v[252:255], v[40:43]
    buffer_load_dwordx4 v[232:235], v14, s[44:47], s98 offen offset:0 sc1
    ds_read_b64_tr_b16 v[248:249], v17 offset:24576
    ds_read_b64_tr_b16 v[250:251], v17 offset:25088
    s_waitcnt lgkmcnt(4)
    v_mfma_f32_32x32x16_bf16 v[24:39], v[208:211], v[236:239], v[24:39]
    buffer_load_dwordx4 v[208:211], v5, s[44:47], s93 offen offset:0 sc1
    ds_read_b64_tr_b16 v[244:245], v16 offset:28672
    ds_read_b64_tr_b16 v[246:247], v16 offset:29184
    s_waitcnt lgkmcnt(4)
    v_mfma_f32_32x32x16_bf16 v[24:39], v[212:215], v[240:243], v[24:39]
    buffer_load_dwordx4 v[212:215], v5, s[44:47], s93 offen offset:1024 sc1
    ds_read_b64_tr_b16 v[236:237], v16 offset:30720
    ds_read_b64_tr_b16 v[238:239], v16 offset:31232
    s_waitcnt vmcnt(8) lgkmcnt(4)
    v_mfma_f32_16x16x32_bf16 v[40:43], v[224:227], v[248:251], v[40:43]
    buffer_load_dwordx4 v[224:227], v14, s[44:47], s98 offen offset:2048 sc1
    s_add_u32 s98, s98, 4096
    ds_read_b64_tr_b16 v[252:253], v17 offset:28672
    ds_read_b64_tr_b16 v[254:255], v17 offset:29184
    s_waitcnt lgkmcnt(4)
    v_mfma_f32_32x32x16_bf16 v[24:39], v[216:219], v[244:247], v[24:39]
    buffer_load_dwordx4 v[216:219], v5, s[44:47], s93 offen offset:2048 sc1
    ds_read_b64_tr_b16 v[240:241], v16 offset:32768
    ds_read_b64_tr_b16 v[242:243], v16 offset:33280
    s_waitcnt lgkmcnt(4)
    v_mfma_f32_32x32x16_bf16 v[24:39], v[220:223], v[236:239], v[24:39]
    buffer_load_dwordx4 v[220:223], v5, s[44:47], s93 offen offset:3072 sc1
    s_add_u32 s93, s93, 4096
    ds_read_b64_tr_b16 v[244:245], v16 offset:34816
    ds_read_b64_tr_b16 v[246:247], v16 offset:35328
    s_waitcnt vmcnt(8) lgkmcnt(4)
    v_mfma_f32_16x16x32_bf16 v[40:43], v[228:231], v[252:255], v[40:43]
    buffer_load_dwordx4 v[228:231], v14, s[44:47], s98 offen offset:0 sc1
    ds_read_b64_tr_b16 v[248:249], v17 offset:32768
    ds_read_b64_tr_b16 v[250:251], v17 offset:33280
    s_waitcnt lgkmcnt(4)
    v_mfma_f32_32x32x16_bf16 v[24:39], v[192:195], v[240:243], v[24:39]
    buffer_load_dwordx4 v[192:195], v5, s[44:47], s93 offen offset:0 sc1
    s_waitcnt lgkmcnt(2)
    v_mfma_f32_32x32x16_bf16 v[24:39], v[196:199], v[244:247], v[24:39]
    buffer_load_dwordx4 v[196:199], v5, s[44:47], s93 offen offset:1024 sc1
    s_waitcnt vmcnt(8) lgkmcnt(0)
    v_mfma_f32_16x16x32_bf16 v[40:43], v[232:235], v[248:251], v[40:43]
    buffer_load_dwordx4 v[232:235], v14, s[44:47], s98 offen offset:2048 sc1
    s_add_u32 s98, s98, 4096
LW_152:
    ds_read_b32 v1, v2 offset:2116
    s_waitcnt lgkmcnt(0)
    v_readfirstlane_b32 s73, v1
    s_cmp_ge_u32 s73, 2
    s_cbranch_scc1 LWD_153
    s_sleep 1
    s_sub_u32 s72, s72, 1
    s_cbranch_scc0 LW_152
    s_branch L_bail
LWD_153:
    ds_read_b64_tr_b16 v[236:237], v7 offset:0
    ds_read_b64_tr_b16 v[238:239], v7 offset:512
    ds_read_b64_tr_b16 v[240:241], v7 offset:2048
    ds_read_b64_tr_b16 v[242:243], v7 offset:2560
    ds_read_b64_tr_b16 v[252:253], v8 offset:0
    ds_read_b64_tr_b16 v[254:255], v8 offset:512
    s_waitcnt lgkmcnt(4)
    v_mfma_f32_32x32x16_bf16 v[24:39], v[200:203], v[236:239], v[24:39]
    buffer_load_dwordx4 v[200:203], v5, s[44:47], s93 offen offset:2048 sc1
    ds_read_b64_tr_b16 v[244:245], v7 offset:4096
    ds_read_b64_tr_b16 v[246:247], v7 offset:4608
    s_waitcnt lgkmcnt(4)
    v_mfma_f32_32x32x16_bf16 v[24:39], v[204:207], v[240:243], v[24:39]
    buffer_load_dwordx4 v[204:207], v5, s[44:47], s93 offen offset:3072 sc1
    s_add_u32 s93, s93, 4096
    ds_read_b64_tr_b16 v[236:237], v7 offset:6144
    ds_read_b64_tr_b16 v[238:239], v7 offset:6656
    s_waitcnt vmcnt(8) lgkmcnt(4)
    v_mfma_f32_16x16x32_bf16 v[40:43], v[224:227], v[252:255], v[40:43]
    buffer_load_dwordx4 v[224:227], v14, s[44:47], s98 offen offset:0 sc1
    ds_read_b64_tr_b16 v[248:249], v8 offset:4096
    ds_read_b64_tr_b16 v[250:251], v8 offset:4608
    s_waitcnt lgkmcnt(4)
    v_mfma_f32_32x32x16_bf16 v[24:39], v[208:211], v[244:247], v[24:39]
    buffer_load_dwordx4 v[208:211], v5, s[44:47], s93 offen offset:0 sc1
    ds_read_b64_tr_b16 v[240:241], v7 offset:8192
    ds_read_b64_tr_b16 v[242:243], v7 offset:8704
    s_waitcnt lgkmcnt(4)
    v_mfma_f32_32x32x16_bf16 v[24:39], v[212:215], v[236:239], v[24:39]
    buffer_load_dwordx4 v[212:215], v5, s[44:47], s93 offen offset:1024 sc1
    ds_read_b64_tr_b16 v[244:245], v7 offset:10240
    ds_read_b64_tr_b16 v[246:247], v7 offset:10752
    s_waitcnt vmcnt(8) lgkmcnt(4)
    v_mfma_f32_16x16x32_bf16 v[40:43], v[228:231], v[248:251], v[40:43]
    buffer_load_dwordx4 v[228:231], v14, s[44:47], s98 offen offset:2048 sc1
    s_add_u32 s98, s98, 4096
    ds_read_b64_tr_b16 v[252:253], v8 offset:8192
    ds_read_b64_tr_b16 v[254:255], v8 offset:8704
    s_waitcnt lgkmcnt(4)
    v_mfma_f32_32x32x16_bf16 v[24:39], v[216:219], v[240:243], v[24:39]
    buffer_load_dwordx4 v[216:219], v5, s[44:47], s93 offen offset:2048 sc1
    ds_read_b64_tr_b16 v[236:237], v7 offset:12288
    ds_read_b64_tr_b16 v[238:239], v7 offset:12800
    s_waitcnt lgkmcnt(4)
    v_mfma_f32_32x32x16_bf16 v[24:39], v[220:223], v[244:247], v[24:39]
    buffer_load_dwordx4 v[220:223], v5, s[44:47], s93 offen offset:3072 sc1
    s_add_u32 s93, s93, 4096
    ds_read_b64_tr_b16 v[240:241], v7 offset:14336
    ds_read_b64_tr_b16 v[242:243], v7 offset:14848
    s_waitcnt vmcnt(8) lgkmcnt(4)
    v_mfma_f32_16x16x32_bf16 v[40:43], v[232:235], v[252:255], v[40:43]
    buffer_load_dwordx4 v[232:235], v14, s[44:47], s98 offen offset:0 sc1
    ds_read_b64_tr_b16 v[248:249], v8 offset:12288
    ds_read_b64_tr_b16 v[250:251], v8 offset:12800
    s_waitcnt lgkmcnt(4)
    v_mfma_f32_32x32x16_bf16 v[24:39], v[192:195], v[236:239], v[24:39]
    buffer_load_dwordx4 v[192:195], v5, s[44:47], s93 offen offset:0 sc1
    ds_read_b64_tr_b16 v[244:245], v7 offset:16384
    ds_read_b64_tr_b16 v[246:247], v7 offset:16896
    s_waitcnt lgkmcnt(4)
    v_mfma_f32_32x32x16_bf16 v[24:39], v[196:199], v[240:243], v[24:39]
    buffer_load_dwordx4 v[196:199], v5, s[44:47], s93 offen offset:1024 sc1
    ds_read_b64_tr_b16 v[236:237], v7 offset:18432
    ds_read_b64_tr_b16 v[238:239], v7 offset:18944
    s_waitcnt vmcnt(8) lgkmcnt(4)
    v_mfma_f32_16x16x32_bf16 v[40:43], v[224:227], v[248:251], v[40:43]
    buffer_load_dwordx4 v[224:227], v14, s[44:47], s98 offen offset:2048 sc1
    s_add_u32 s98, s98, 4096
    ds_read_b64_tr_b16 v[252:253], v8 offset:16384
    ds_read_b64_tr_b16 v[254:255], v8 offset:16896
    s_waitcnt lgkmcnt(4)
    v_mfma_f32_32x32x16_bf16 v[24:39], v[200:203], v[244:247], v[24:39]
    buffer_load_dwordx4 v[200:203], v5, s[44:47], s93 offen offset:2048 sc1
    ds_read_b64_tr_b16 v[240:241], v7 offset:20480
    ds_read_b64_tr_b16 v[242:243], v7 offset:20992
    s_waitcnt lgkmcnt(4)
    v_mfma_f32_32x32x16_bf16 v[24:39], v[204:207], v[236:239], v[24:39]
    buffer_load_dwordx4 v[204:207], v5, s[44:47], s93 offen offset:3072 sc1
    s_add_u32 s93, s93, 4096
    ds_read_b64_tr_b16 v[244:245], v7 offset:22528
    ds_read_b64_tr_b16 v[246:247], v7 offset:23040
    s_waitcnt vmcnt(8) lgkmcnt(4)
    v_mfma_f32_16x16x32_bf16 v[40:43], v[228:231], v[252:255], v[40:43]
    buffer_load_dwordx4 v[228:231], v14, s[44:47], s98 offen offset:0 sc1
    ds_read_b64_tr_b16 v[248:249], v8 offset:20480
    ds_read_b64_tr_b16 v[250:251], v8 offset:20992
    s_waitcnt lgkmcnt(4)
    v_mfma_f32_32x32x16_bf16 v[24:39], v[208:211], v[240:243], v[24:39]
    ds_read_b64_tr_b16 v[236:237], v7 offset:24576
    ds_read_b64_tr_b16 v[238:239], v7 offset:25088
    s_waitcnt lgkmcnt(4)
    v_mfma_f32_32x32x16_bf16 v[24:39], v[212:215], v[244:247], v[24:39]
    ds_read_b64_tr_b16 v[240:241], v7 offset:26624
    ds_read_b64_tr_b16 v[242:243], v7 offset:27136
    s_waitcnt vmcnt(6) lgkmcnt(4)
    v_mfma_f32_16x16x32_bf16 v[40:43], v[232:235], v[248:251], v[40:43]
    buffer_load_dwordx4 v[232:235], v14, s[44:47], s98 offen offset:2048 sc1
    s_add_u32 s98, s98, 4096
    ds_read_b64_tr_b16 v[252:253], v8 offset:24576
    ds_read_b64_tr_b16 v[254:255], v8 offset:25088
    s_waitcnt lgkmcnt(4)
    v_mfma_f32_32x32x16_bf16 v[24:39], v[216:219], v[236:239], v[24:39]
    ds_read_b64_tr_b16 v[244:245], v7 offset:28672
    ds_read_b64_tr_b16 v[246:247], v7 offset:29184
    s_waitcnt lgkmcnt(4)
    v_mfma_f32_32x32x16_bf16 v[24:39], v[220:223], v[240:243], v[24:39]
    ds_read_b64_tr_b16 v[236:237], v7 offset:30720
    ds_read_b64_tr_b16 v[238:239], v7 offset:31232
    s_waitcnt vmcnt(4) lgkmcnt(4)
    v_mfma_f32_16x16x32_bf16 v[40:43], v[224:227], v[252:255], v[40:43]
    ds_read_b64_tr_b16 v[248:249], v8 offset:28672
    ds_read_b64_tr_b16 v[250:251], v8 offset:29184
    s_waitcnt lgkmcnt(4)
    v_mfma_f32_32x32x16_bf16 v[24:39], v[192:195], v[244:247], v[24:39]
    ds_read_b64_tr_b16 v[240:241], v7 offset:32768
    ds_read_b64_tr_b16 v[242:243], v7 offset:33280
    s_waitcnt lgkmcnt(4)
    v_mfma_f32_32x32x16_bf16 v[24:39], v[196:199], v[236:239], v[24:39]
    ds_read_b64_tr_b16 v[244:245], v7 offset:34816
    ds_read_b64_tr_b16 v[246:247], v7 offset:35328
    s_waitcnt vmcnt(1) lgkmcnt(4)
    v_mfma_f32_16x16x32_bf16 v[40:43], v[228:231], v[248:251], v[40:43]
    ds_read_b64_tr_b16 v[252:253], v8 offset:32768
    ds_read_b64_tr_b16 v[254:255], v8 offset:33280
    s_waitcnt lgkmcnt(4)
    v_mfma_f32_32x32x16_bf16 v[24:39], v[200:203], v[240:243], v[24:39]
    s_waitcnt lgkmcnt(2)
    v_mfma_f32_32x32x16_bf16 v[24:39], v[204:207], v[244:247], v[24:39]
    s_waitcnt vmcnt(0) lgkmcnt(0)
    v_mfma_f32_16x16x32_bf16 v[40:43], v[232:235], v[252:255], v[40:43]
    s_mov_b32 s52, s22
    s_mov_b32 s53, s23
    s_mov_b32 s54, 2359296
    s_mov_b32 s55, 0x20000
    s_mul_i32 s93, s69, 2304
    s_add_u32 s93, s93, s95
    s_add_u32 s93, s93, 1152
    s_add_u32 s92, s93, 1179648
    s_nop 1
    v_pk_mul_f32 v[24:25], v[24:25], v[44:45] op_sel:[0,1] op_sel_hi:[1,1]
    v_pk_mul_f32 v[26:27], v[26:27], v[44:45] op_sel:[0,1] op_sel_hi:[1,1]
    v_pk_mul_f32 v[28:29], v[28:29], v[44:45] op_sel:[0,1] op_sel_hi:[1,1]
    v_pk_mul_f32 v[30:31], v[30:31], v[44:45] op_sel:[0,1] op_sel_hi:[1,1]
    v_pk_mul_f32 v[32:33], v[32:33], v[44:45] op_sel:[0,1] op_sel_hi:[1,1]
    v_pk_mul_f32 v[34:35], v[34:35], v[44:45] op_sel:[0,1] op_sel_hi:[1,1]
    v_pk_mul_f32 v[36:37], v[36:37], v[44:45] op_sel:[0,1] op_sel_hi:[1,1]
    v_pk_mul_f32 v[38:39], v[38:39], v[44:45] op_sel:[0,1] op_sel_hi:[1,1]
    v_pk_mul_f32 v[40:41], v[40:41], v[46:47] op_sel_hi:[1,0]
    v_pk_mul_f32 v[42:43], v[42:43], v[46:47] op_sel_hi:[1,0]
    ds_read_b64_tr_b16 v[248:249], v10 offset:0
    ds_read_b64_tr_b16 v[250:251], v10 offset:128
    ds_read_b64_tr_b16 v[252:253], v10 offset:2304
    ds_read_b64_tr_b16 v[254:255], v10 offset:2432
CL_154:
    s_add_u32 s90, s94, 9216
    buffer_load_dwordx4 v[192:195], v5, s[44:47], s90 offen offset:0 sc1
    buffer_load_dwordx4 v[196:199], v5, s[44:47], s90 offen offset:1024 sc1
    buffer_load_dwordx4 v[228:231], v12, s[44:47], s90 offen offset:0 sc1
    buffer_load_dwordx4 v[200:203], v5, s[44:47], s90 offen offset:2048 sc1
    buffer_load_dwordx4 v[204:207], v5, s[44:47], s90 offen offset:3072 sc1
    buffer_load_dwordx4 v[232:235], v12, s[44:47], s90 offen offset:2048 sc1
    s_add_u32 s90, s94, 13312
    buffer_load_dwordx4 v[208:211], v5, s[44:47], s90 offen offset:0 sc1
    buffer_load_dwordx4 v[212:215], v5, s[44:47], s90 offen offset:1024 sc1
    buffer_load_dwordx4 v[236:239], v12, s[44:47], s90 offen offset:0 sc1
    buffer_load_dwordx4 v[216:219], v5, s[44:47], s90 offen offset:2048 sc1
    buffer_load_dwordx4 v[220:223], v5, s[44:47], s90 offen offset:3072 sc1
    buffer_load_dwordx4 v[240:243], v12, s[44:47], s90 offen offset:2048 sc1
    s_add_u32 s90, s94, 17408
    buffer_load_dwordx4 v[224:227], v5, s[44:47], s90 offen offset:0 sc1
    buffer_load_dwordx4 v[244:247], v13, s[44:47], s90 offen offset:0 sc1
    s_waitcnt vmcnt(12)
    v_max_u32 v1, v192, v196
    s_waitcnt vmcnt(10)
    v_max3_u32 v1, v1, v228, v200
    s_waitcnt vmcnt(8)
    v_max3_u32 v1, v1, v204, v232
    s_waitcnt vmcnt(6)
    v_max3_u32 v1, v1, v208, v212
    s_waitcnt vmcnt(4)
    v_max3_u32 v1, v1, v236, v216
    s_waitcnt vmcnt(2)
    v_max3_u32 v1, v1, v220, v240
    s_waitcnt vmcnt(1)
    v_max3_u32 v1, v1, v224, v225
    s_waitcnt vmcnt(1)
    v_max3_u32 v1, v1, v226, v227
    s_waitcnt vmcnt(0)
    v_max3_u32 v1, v1, v244, v245
    s_waitcnt vmcnt(0)
    v_max3_u32 v1, v1, v246, v247
    v_cmp_eq_u32 vcc, -1, v1
    s_cmp_eq_u64 vcc, 0
    s_cbranch_scc1 CD_155
    s_sleep 8
    s_sub_u32 s72, s72, 1
    s_cbranch_scc0 CL_154
    s_branch L_bail
CD_155:
    v_mfma_f32_32x32x16_bf16 v[24:39], v[48:51], v[192:195], v[24:39]
    v_mfma_f32_32x32x16_bf16 v[24:39], v[52:55], v[196:199], v[24:39]
    s_waitcnt lgkmcnt(2)
    v_mfma_f32_16x16x32_bf16 v[40:43], v[248:251], v[228:231], v[40:43]
    ds_read_b64_tr_b16 v[248:249], v10 offset:4608
    ds_read_b64_tr_b16 v[250:251], v10 offset:4736
    v_mfma_f32_32x32x16_bf16 v[24:39], v[56:59], v[200:203], v[24:39]
    v_mfma_f32_32x32x16_bf16 v[24:39], v[60:63], v[204:207], v[24:39]
    s_waitcnt lgkmcnt(2)
    v_mfma_f32_16x16x32_bf16 v[40:43], v[252:255], v[232:235], v[40:43]
    ds_read_b64_tr_b16 v[252:253], v10 offset:6912
    ds_read_b64_tr_b16 v[254:255], v10 offset:7040
    v_mfma_f32_32x32x16_bf16 v[24:39], v[64:67], v[208:211], v[24:39]
    v_mfma_f32_32x32x16_bf16 v[24:39], v[68:71], v[212:215], v[24:39]
    s_waitcnt lgkmcnt(2)
    v_mfma_f32_16x16x32_bf16 v[40:43], v[248:251], v[236:239], v[40:43]
    ds_read_b64_tr_b16 v[248:249], v11 offset:0
    ds_read_b64_tr_b16 v[250:251], v11 offset:2304
    v_mfma_f32_32x32x16_bf16 v[24:39], v[72:75], v[216:219], v[24:39]
    v_mfma_f32_32x32x16_bf16 v[24:39], v[76:79], v[220:223], v[24:39]
    s_waitcnt lgkmcnt(2)
    v_mfma_f32_16x16x32_bf16 v[40:43], v[252:255], v[240:243], v[40:43]
    v_mfma_f32_32x32x16_bf16 v[24:39], v[80:83], v[224:227], v[24:39]
    s_waitcnt lgkmcnt(0)
    v_mfma_f32_16x16x32_bf16 v[40:43], v[248:251], v[244:247], v[40:43]
    ds_read_b64_tr_b16 v[248:249], v10 offset:288
    ds_read_b64_tr_b16 v[250:251], v10 offset:416
    ds_read_b64_tr_b16 v[252:253], v10 offset:2592
    ds_read_b64_tr_b16 v[254:255], v10 offset:2720
CL_156:
    s_add_u32 s90, s94, 27648
    buffer_load_dwordx4 v[192:195], v5, s[44:47], s90 offen offset:0 sc1
    buffer_load_dwordx4 v[196:199], v5, s[44:47], s90 offen offset:1024 sc1
    buffer_load_dwordx4 v[228:231], v12, s[44:47], s90 offen offset:0 sc1
    buffer_load_dwordx4 v[200:203], v5, s[44:47], s90 offen offset:2048 sc1
    buffer_load_dwordx4 v[204:207], v5, s[44:47], s90 offen offset:3072 sc1
    buffer_load_dwordx4 v[232:235], v12, s[44:47], s90 offen offset:2048 sc1
    s_add_u32 s90, s94, 31744
    buffer_load_dwordx4 v[208:211], v5, s[44:47], s90 offen offset:0 sc1
    buffer_load_dwordx4 v[212:215], v5, s[44:47], s90 offen offset:1024 sc1
    buffer_load_dwordx4 v[236:239], v12, s[44:47], s90 offen offset:0 sc1
    buffer_load_dwordx4 v[216:219], v5, s[44:47], s90 offen offset:2048 sc1
    buffer_load_dwordx4 v[220:223], v5, s[44:47], s90 offen offset:3072 sc1
    buffer_load_dwordx4 v[240:243], v12, s[44:47], s90 offen offset:2048 sc1
    s_add_u32 s90, s94, 35840
    buffer_load_dwordx4 v[224:227], v5, s[44:47], s90 offen offset:0 sc1
    buffer_load_dwordx4 v[244:247], v13, s[44:47], s90 offen offset:0 sc1
    s_waitcnt vmcnt(12)
    v_max_u32 v1, v192, v196
    s_waitcnt vmcnt(10)
    v_max3_u32 v1, v1, v228, v200
    s_waitcnt vmcnt(8)
    v_max3_u32 v1, v1, v204, v232
    s_waitcnt vmcnt(6)
    v_max3_u32 v1, v1, v208, v212
    s_waitcnt vmcnt(4)
    v_max3_u32 v1, v1, v236, v216
    s_waitcnt vmcnt(2)
    v_max3_u32 v1, v1, v220, v240
    s_waitcnt vmcnt(1)
    v_max3_u32 v1, v1, v224, v225
    s_waitcnt vmcnt(1)
    v_max3_u32 v1, v1, v226, v227
    s_waitcnt vmcnt(0)
    v_max3_u32 v1, v1, v244, v245
    s_waitcnt vmcnt(0)
    v_max3_u32 v1, v1, v246, v247
    v_cmp_eq_u32 vcc, -1, v1
    s_cmp_eq_u64 vcc, 0
    s_cbranch_scc1 CD_157
    s_sleep 8
    s_sub_u32 s72, s72, 1
    s_cbranch_scc0 CL_156
    s_branch L_bail
CD_157:
    v_mfma_f32_32x32x16_bf16 v[24:39], v[84:87], v[192:195], v[24:39]
    v_mfma_f32_32x32x16_bf16 v[24:39], v[88:91], v[196:199], v[24:39]
    s_waitcnt lgkmcnt(2)
    v_mfma_f32_16x16x32_bf16 v[40:43], v[248:251], v[228:231], v[40:43]
    ds_read_b64_tr_b16 v[248:249], v10 offset:4896
    ds_read_b64_tr_b16 v[250:251], v10 offset:5024
    v_mfma_f32_32x32x16_bf16 v[24:39], v[92:95], v[200:203], v[24:39]
    v_mfma_f32_32x32x16_bf16 v[24:39], v[96:99], v[204:207], v[24:39]
    s_waitcnt lgkmcnt(2)
    v_mfma_f32_16x16x32_bf16 v[40:43], v[252:255], v[232:235], v[40:43]
    ds_read_b64_tr_b16 v[252:253], v10 offset:7200
    ds_read_b64_tr_b16 v[254:255], v10 offset:7328
    v_mfma_f32_32x32x16_bf16 v[24:39], v[100:103], v[208:211], v[24:39]
    v_mfma_f32_32x32x16_bf16 v[24:39], v[104:107], v[212:215], v[24:39]
    s_waitcnt lgkmcnt(2)
    v_mfma_f32_16x16x32_bf16 v[40:43], v[248:251], v[236:239], v[40:43]
    ds_read_b64_tr_b16 v[248:249], v11 offset:288
    ds_read_b64_tr_b16 v[250:251], v11 offset:2592
    v_mfma_f32_32x32x16_bf16 v[24:39], v[108:111], v[216:219], v[24:39]
    v_mfma_f32_32x32x16_bf16 v[24:39], v[112:115], v[220:223], v[24:39]
    s_waitcnt lgkmcnt(2)
    v_mfma_f32_16x16x32_bf16 v[40:43], v[252:255], v[240:243], v[40:43]
    v_mfma_f32_32x32x16_bf16 v[24:39], v[116:119], v[224:227], v[24:39]
    s_waitcnt lgkmcnt(0)
    v_mfma_f32_16x16x32_bf16 v[40:43], v[248:251], v[244:247], v[40:43]
LW_158:
    ds_read_b32 v1, v2 offset:1536
    s_waitcnt lgkmcnt(0)
    v_readfirstlane_b32 s73, v1
    s_cmp_ge_u32 s73, 4
    s_cbranch_scc1 LWD_159
    s_sleep 2
    s_sub_u32 s72, s72, 1
    s_cbranch_scc0 LW_158
    s_branch L_bail
LWD_159:
    ds_read_b128 v[192:195], v20 offset:20480
    ds_read_b128 v[196:199], v20 offset:21504
    ds_read_b64 v[200:201], v21 offset:20480
    ds_read_b32 v202, v22 offset:20480
    ds_read_b128 v[204:207], v20 offset:23040
    ds_read_b128 v[208:211], v20 offset:24064
    ds_read_b64 v[212:213], v21 offset:23040
    ds_read_b32 v214, v22 offset:23040
    s_add_u32 s90, s96, 55296
    s_add_u32 s91, s97, 55296
    s_movk_i32 s89, 6
    ds_read_b128 v[216:219], v20 offset:25600
    ds_read_b128 v[220:223], v20 offset:26624
    ds_read_b64 v[224:225], v21 offset:25600
    ds_read_b32 v226, v22 offset:25600
    s_waitcnt lgkmcnt(4)
    ds_read_b128 v[228:231], v20 offset:28160
    ds_read_b128 v[232:235], v20 offset:29184
    ds_read_b64 v[236:237], v21 offset:28160
    ds_read_b32 v238, v22 offset:28160
    v_pk_add_f32 v[192:193], v[192:193], v[204:205]
    v_pk_add_f32 v[194:195], v[194:195], v[206:207]
    v_pk_add_f32 v[196:197], v[196:197], v[208:209]
    v_pk_add_f32 v[198:199], v[198:199], v[210:211]
    v_pk_add_f32 v[200:201], v[200:201], v[212:213]
    v_add_f32 v202, v202, v214
    s_waitcnt lgkmcnt(4)
    v_pk_add_f32 v[192:193], v[192:193], v[216:217]
    v_pk_add_f32 v[194:195], v[194:195], v[218:219]
    v_pk_add_f32 v[196:197], v[196:197], v[220:221]
    v_pk_add_f32 v[198:199], v[198:199], v[222:223]
    v_pk_add_f32 v[200:201], v[200:201], v[224:225]
    v_add_f32 v202, v202, v226
    s_waitcnt lgkmcnt(0)
    v_pk_add_f32 v[192:193], v[192:193], v[228:229]
    v_pk_add_f32 v[194:195], v[194:195], v[230:231]
    v_pk_add_f32 v[196:197], v[196:197], v[232:233]
    v_pk_add_f32 v[198:199], v[198:199], v[234:235]
    v_pk_add_f32 v[200:201], v[200:201], v[236:237]
    v_add_f32 v202, v202, v238
    v_pk_mul_f32 v[204:205], v[192:193], 0 op_sel_hi:[1,0]
    v_pk_fma_f32 v[204:205], v[194:195], 0, v[204:205] op_sel_hi:[1,0,1]
    v_pk_fma_f32 v[204:205], v[196:197], 0, v[204:205] op_sel_hi:[1,0,1]
    v_pk_fma_f32 v[204:205], v[198:199], 0, v[204:205] op_sel_hi:[1,0,1]
    v_pk_fma_f32 v[204:205], v[200:201], 0, v[204:205] op_sel_hi:[1,0,1]
    v_add_f32 v204, v204, v205
    v_subrev_u32 v205, 0x21800000, v202
    v_cmp_u_f32 vcc, v204, v204
    s_mov_b32 s73, 0x3e000000
    v_cmp_lt_u32 s[74:75], s73, v205
    s_or_b64 vcc, vcc, s[74:75]
    s_cmp_eq_u64 vcc, 0
    s_cbranch_scc1 SOK_160
    s_call_b64 s[86:87], L_fallback
SOK_160:
    v_rcp_f32 v202, v202
    s_nop 0
    v_mul_f32 v202, v4, v202
    v_pk_mul_f32 v[192:193], v[192:193], v[202:203] op_sel_hi:[1,0]
    v_pk_mul_f32 v[194:195], v[194:195], v[202:203] op_sel_hi:[1,0]
    v_pk_mul_f32 v[196:197], v[196:197], v[202:203] op_sel_hi:[1,0]
    v_pk_mul_f32 v[198:199], v[198:199], v[202:203] op_sel_hi:[1,0]
    v_pk_mul_f32 v[200:201], v[200:201], v[202:203] op_sel_hi:[1,0]
    v_cvt_pk_bf16_f32 v204, v192, v193
    v_cvt_pk_bf16_f32 v205, v194, v195
    v_cvt_pk_bf16_f32 v206, v196, v197
    v_cvt_pk_bf16_f32 v207, v198, v199
    v_cvt_pk_bf16_f32 v208, v200, v201
    v_min_u32 v204, -2, v204
    v_min_u32 v208, -2, v208
    buffer_store_dwordx4 v[204:207], v5, s[44:47], s90 offen sc1
    s_mov_b32 exec_hi, 0
    buffer_store_dword v208, v5, s[44:47], s91 offen sc1
    s_mov_b64 exec, -1
LW_161:
    ds_read_b32 v1, v2 offset:1536
    s_waitcnt lgkmcnt(0)
    v_readfirstlane_b32 s73, v1
    s_cmp_ge_u32 s73, 4
    s_cbranch_scc1 LWD_162
    s_sleep 4
    s_sub_u32 s72, s72, 1
    s_cbranch_scc0 LW_161
    s_branch L_bail
LWD_162:
    ds_read_b64_tr_b16 v[248:249], v10 offset:576
    ds_read_b64_tr_b16 v[250:251], v10 offset:704
    ds_read_b64_tr_b16 v[252:253], v10 offset:2880
    ds_read_b64_tr_b16 v[254:255], v10 offset:3008
CP_163:
    s_add_u32 s90, s94, 54272
    buffer_load_dwordx4 v[192:195], v5, s[44:47], s90 offen sc1
    s_waitcnt vmcnt(0)
    v_max_u32 v1, v192, v193
    v_max3_u32 v1, v1, v194, v195
    v_cmp_eq_u32 vcc, -1, v1
    s_cmp_eq_u64 vcc, 0
    s_cbranch_scc1 CQ_164
    s_sleep 8
    s_sub_u32 s72, s72, 1
    s_cbranch_scc0 CP_163
    s_branch L_bail
CQ_164:
CL_165:
    s_add_u32 s90, s94, 46080
    buffer_load_dwordx4 v[192:195], v5, s[44:47], s90 offen offset:0 sc1
    buffer_load_dwordx4 v[196:199], v5, s[44:47], s90 offen offset:1024 sc1
    buffer_load_dwordx4 v[228:231], v12, s[44:47], s90 offen offset:0 sc1
    buffer_load_dwordx4 v[200:203], v5, s[44:47], s90 offen offset:2048 sc1
    buffer_load_dwordx4 v[204:207], v5, s[44:47], s90 offen offset:3072 sc1
    buffer_load_dwordx4 v[232:235], v12, s[44:47], s90 offen offset:2048 sc1
    s_add_u32 s90, s94, 50176
    buffer_load_dwordx4 v[208:211], v5, s[44:47], s90 offen offset:0 sc1
    buffer_load_dwordx4 v[212:215], v5, s[44:47], s90 offen offset:1024 sc1
    buffer_load_dwordx4 v[236:239], v12, s[44:47], s90 offen offset:0 sc1
    buffer_load_dwordx4 v[216:219], v5, s[44:47], s90 offen offset:2048 sc1
    buffer_load_dwordx4 v[220:223], v5, s[44:47], s90 offen offset:3072 sc1
    buffer_load_dwordx4 v[240:243], v12, s[44:47], s90 offen offset:2048 sc1
    s_add_u32 s90, s94, 54272
    buffer_load_dwordx4 v[224:227], v5, s[44:47], s90 offen offset:0 sc1
    buffer_load_dwordx4 v[244:247], v13, s[44:47], s90 offen offset:0 sc1
    s_waitcnt vmcnt(12)
    v_max_u32 v1, v192, v196
    s_waitcnt vmcnt(10)
    v_max3_u32 v1, v1, v228, v200
    s_waitcnt vmcnt(8)
    v_max3_u32 v1, v1, v204, v232
    s_waitcnt vmcnt(6)
    v_max3_u32 v1, v1, v208, v212
    s_waitcnt vmcnt(4)
    v_max3_u32 v1, v1, v236, v216
    s_waitcnt vmcnt(2)
    v_max3_u32 v1, v1, v220, v240
    s_waitcnt vmcnt(1)
    v_max3_u32 v1, v1, v224, v225
    s_waitcnt vmcnt(1)
    v_max3_u32 v1, v1, v226, v227
    s_waitcnt vmcnt(0)
    v_max3_u32 v1, v1, v244, v245
    s_waitcnt vmcnt(0)
    v_max3_u32 v1, v1, v246, v247
    v_cmp_eq_u32 vcc, -1, v1
    s_cmp_eq_u64 vcc, 0
    s_cbranch_scc1 CD_166
    s_sleep 8
    s_sub_u32 s72, s72, 1
    s_cbranch_scc0 CL_165
    s_branch L_bail
CD_166:
    v_mfma_f32_32x32x16_bf16 v[24:39], v[120:123], v[192:195], v[24:39]
    v_mfma_f32_32x32x16_bf16 v[24:39], v[124:127], v[196:199], v[24:39]
    s_waitcnt lgkmcnt(2)
    v_mfma_f32_16x16x32_bf16 v[40:43], v[248:251], v[228:231], v[40:43]
    ds_read_b64_tr_b16 v[248:249], v10 offset:5184
    ds_read_b64_tr_b16 v[250:251], v10 offset:5312
    v_mfma_f32_32x32x16_bf16 v[24:39], v[128:131], v[200:203], v[24:39]
    v_mfma_f32_32x32x16_bf16 v[24:39], v[132:135], v[204:207], v[24:39]
    s_waitcnt lgkmcnt(2)
    v_mfma_f32_16x16x32_bf16 v[40:43], v[252:255], v[232:235], v[40:43]
    ds_read_b64_tr_b16 v[252:253], v10 offset:7488
    ds_read_b64_tr_b16 v[254:255], v10 offset:7616
    v_mfma_f32_32x32x16_bf16 v[24:39], v[136:139], v[208:211], v[24:39]
    v_mfma_f32_32x32x16_bf16 v[24:39], v[140:143], v[212:215], v[24:39]
    s_waitcnt lgkmcnt(2)
    v_mfma_f32_16x16x32_bf16 v[40:43], v[248:251], v[236:239], v[40:43]
    ds_read_b64_tr_b16 v[248:249], v11 offset:576
    ds_read_b64_tr_b16 v[250:251], v11 offset:2880
    v_mfma_f32_32x32x16_bf16 v[24:39], v[144:147], v[216:219], v[24:39]
    v_mfma_f32_32x32x16_bf16 v[24:39], v[148:151], v[220:223], v[24:39]
    s_waitcnt lgkmcnt(2)
    v_mfma_f32_16x16x32_bf16 v[40:43], v[252:255], v[240:243], v[40:43]
    v_mfma_f32_32x32x16_bf16 v[24:39], v[152:155], v[224:227], v[24:39]
    s_waitcnt lgkmcnt(0)
    v_mfma_f32_16x16x32_bf16 v[40:43], v[248:251], v[244:247], v[40:43]
LW_167:
    ds_read_b32 v1, v2 offset:1792
    s_waitcnt lgkmcnt(0)
    v_readfirstlane_b32 s73, v1
    s_cmp_ge_u32 s73, 4
    s_cbranch_scc1 LWD_168
    s_sleep 2
    s_sub_u32 s72, s72, 1
    s_cbranch_scc0 LW_167
    s_branch L_bail
LWD_168:
    s_sleep 4
    ds_read_b64_tr_b16 v[248:249], v10 offset:864
    ds_read_b64_tr_b16 v[250:251], v10 offset:992
    ds_read_b64_tr_b16 v[252:253], v10 offset:3168
    ds_read_b64_tr_b16 v[254:255], v10 offset:3296
CL_169:
    s_add_u32 s90, s94, 64512
    buffer_load_dwordx4 v[192:195], v5, s[44:47], s90 offen offset:0 sc1
    buffer_load_dwordx4 v[196:199], v5, s[44:47], s90 offen offset:1024 sc1
    buffer_load_dwordx4 v[228:231], v12, s[44:47], s90 offen offset:0 sc1
    buffer_load_dwordx4 v[200:203], v5, s[44:47], s90 offen offset:2048 sc1
    buffer_load_dwordx4 v[204:207], v5, s[44:47], s90 offen offset:3072 sc1
    buffer_load_dwordx4 v[232:235], v12, s[44:47], s90 offen offset:2048 sc1
    s_add_u32 s90, s94, 68608
    buffer_load_dwordx4 v[208:211], v5, s[44:47], s90 offen offset:0 sc1
    buffer_load_dwordx4 v[212:215], v5, s[44:47], s90 offen offset:1024 sc1
    buffer_load_dwordx4 v[236:239], v12, s[44:47], s90 offen offset:0 sc1
    buffer_load_dwordx4 v[216:219], v5, s[44:47], s90 offen offset:2048 sc1
    buffer_load_dwordx4 v[220:223], v5, s[44:47], s90 offen offset:3072 sc1
    buffer_load_dwordx4 v[240:243], v12, s[44:47], s90 offen offset:2048 sc1
    s_add_u32 s90, s94, 72704
    buffer_load_dwordx4 v[224:227], v5, s[44:47], s90 offen offset:0 sc1
    buffer_load_dwordx4 v[244:247], v13, s[44:47], s90 offen offset:0 sc1
    s_waitcnt vmcnt(12)
    v_max_u32 v1, v192, v196
    s_waitcnt vmcnt(10)
    v_max3_u32 v1, v1, v228, v200
    s_waitcnt vmcnt(8)
    v_max3_u32 v1, v1, v204, v232
    s_waitcnt vmcnt(6)
    v_max3_u32 v1, v1, v208, v212
    s_waitcnt vmcnt(4)
    v_max3_u32 v1, v1, v236, v216
    s_waitcnt vmcnt(2)
    v_max3_u32 v1, v1, v220, v240
    s_waitcnt vmcnt(1)
    v_max3_u32 v1, v1, v224, v225
    s_waitcnt vmcnt(1)
    v_max3_u32 v1, v1, v226, v227
    s_waitcnt vmcnt(0)
    v_max3_u32 v1, v1, v244, v245
    s_waitcnt vmcnt(0)
    v_max3_u32 v1, v1, v246, v247
    v_cmp_eq_u32 vcc, -1, v1
    s_cmp_eq_u64 vcc, 0
    s_cbranch_scc1 CD_170
    s_sleep 2
    s_sub_u32 s72, s72, 1
    s_cbranch_scc0 CL_169
    s_branch L_bail
CD_170:
    v_mfma_f32_32x32x16_bf16 v[24:39], v[156:159], v[192:195], v[24:39]
    v_mfma_f32_32x32x16_bf16 v[24:39], v[160:163], v[196:199], v[24:39]
    s_waitcnt lgkmcnt(2)
    v_mfma_f32_16x16x32_bf16 v[40:43], v[248:251], v[228:231], v[40:43]
    ds_read_b64_tr_b16 v[248:249], v10 offset:5472
    ds_read_b64_tr_b16 v[250:251], v10 offset:5600
    v_mfma_f32_32x32x16_bf16 v[24:39], v[164:167], v[200:203], v[24:39]
    v_mfma_f32_32x32x16_bf16 v[24:39], v[168:171], v[204:207], v[24:39]
    s_waitcnt lgkmcnt(2)
    v_mfma_f32_16x16x32_bf16 v[40:43], v[252:255], v[232:235], v[40:43]
    ds_read_b64_tr_b16 v[252:253], v10 offset:7776
    ds_read_b64_tr_b16 v[254:255], v10 offset:7904
    v_mfma_f32_32x32x16_bf16 v[24:39], v[172:175], v[208:211], v[24:39]
    v_mfma_f32_32x32x16_bf16 v[24:39], v[176:179], v[212:215], v[24:39]
    s_waitcnt lgkmcnt(2)
    v_mfma_f32_16x16x32_bf16 v[40:43], v[248:251], v[236:239], v[40:43]
    ds_read_b64_tr_b16 v[248:249], v11 offset:864
    ds_read_b64_tr_b16 v[250:251], v11 offset:3168
    v_mfma_f32_32x32x16_bf16 v[24:39], v[180:183], v[216:219], v[24:39]
    v_mfma_f32_32x32x16_bf16 v[24:39], v[184:187], v[220:223], v[24:39]
    s_waitcnt lgkmcnt(2)
    v_mfma_f32_16x16x32_bf16 v[40:43], v[252:255], v[240:243], v[40:43]
    v_mfma_f32_32x32x16_bf16 v[24:39], v[188:191], v[224:227], v[24:39]
    s_waitcnt lgkmcnt(0)
    v_mfma_f32_16x16x32_bf16 v[40:43], v[248:251], v[244:247], v[40:43]
    s_nop 4
    s_nop 2
    v_cvt_pk_bf16_f32 v40, v40, v41
    v_cvt_pk_bf16_f32 v41, v42, v43
    s_nop 3
    s_nop 0
    v_cvt_pk_bf16_f32 v24, v24, v25
    v_cvt_pk_bf16_f32 v25, v26, v27
    v_cvt_pk_bf16_f32 v26, v28, v29
    v_cvt_pk_bf16_f32 v27, v30, v31
    v_cvt_pk_bf16_f32 v28, v32, v33
    v_cvt_pk_bf16_f32 v29, v34, v35
    v_cvt_pk_bf16_f32 v30, v36, v37
    v_cvt_pk_bf16_f32 v31, v38, v39
    buffer_store_dwordx4 v[24:27], v18, s[52:55], s93 offen offset:64
    buffer_store_dwordx4 v[28:31], v18, s[52:55], s93 offen offset:80
    s_mov_b32 exec_hi, 0
    buffer_store_dwordx2 v[40:41], v19, s[52:55], s92 offen offset:128
    s_mov_b64 exec, -1
    s_branch L_fin
L_last:
    s_setprio 3
    ds_read_b128 v[192:195], v20 offset:30720
    ds_read_b128 v[196:199], v20 offset:31744
    ds_read_b64 v[200:201], v21 offset:30720
    ds_read_b32 v202, v22 offset:30720
    ds_read_b128 v[204:207], v20 offset:33280
    ds_read_b128 v[208:211], v20 offset:34304
    ds_read_b64 v[212:213], v21 offset:33280
    ds_read_b32 v214, v22 offset:33280
    s_add_u32 s90, s96, 64512
    s_add_u32 s91, s97, 64512
    s_movk_i32 s89, 7
    s_waitcnt lgkmcnt(8)
    v_readfirstlane_b32 s73, v1
    v_sub_f32 v4, 1.0, v4
    s_cmp_lg_u32 s73, 3
    s_cbranch_scc1 L_fin
    ds_read_b128 v[216:219], v20 offset:35840
    ds_read_b128 v[220:223], v20 offset:36864
    ds_read_b64 v[224:225], v21 offset:35840
    ds_read_b32 v226, v22 offset:35840
    s_waitcnt lgkmcnt(4)
    ds_read_b128 v[228:231], v20 offset:38400
    ds_read_b128 v[232:235], v20 offset:39424
    ds_read_b64 v[236:237], v21 offset:38400
    ds_read_b32 v238, v22 offset:38400
    v_pk_add_f32 v[192:193], v[192:193], v[204:205]
    v_pk_add_f32 v[194:195], v[194:195], v[206:207]
    v_pk_add_f32 v[196:197], v[196:197], v[208:209]
    v_pk_add_f32 v[198:199], v[198:199], v[210:211]
    v_pk_add_f32 v[200:201], v[200:201], v[212:213]
    v_add_f32 v202, v202, v214
    s_waitcnt lgkmcnt(4)
    v_pk_add_f32 v[192:193], v[192:193], v[216:217]
    v_pk_add_f32 v[194:195], v[194:195], v[218:219]
    v_pk_add_f32 v[196:197], v[196:197], v[220:221]
    v_pk_add_f32 v[198:199], v[198:199], v[222:223]
    v_pk_add_f32 v[200:201], v[200:201], v[224:225]
    v_add_f32 v202, v202, v226
    s_waitcnt lgkmcnt(0)
    v_pk_add_f32 v[192:193], v[192:193], v[228:229]
    v_pk_add_f32 v[194:195], v[194:195], v[230:231]
    v_pk_add_f32 v[196:197], v[196:197], v[232:233]
    v_pk_add_f32 v[198:199], v[198:199], v[234:235]
    v_pk_add_f32 v[200:201], v[200:201], v[236:237]
    v_add_f32 v202, v202, v238
    v_pk_mul_f32 v[204:205], v[192:193], 0 op_sel_hi:[1,0]
    v_pk_fma_f32 v[204:205], v[194:195], 0, v[204:205] op_sel_hi:[1,0,1]
    v_pk_fma_f32 v[204:205], v[196:197], 0, v[204:205] op_sel_hi:[1,0,1]
    v_pk_fma_f32 v[204:205], v[198:199], 0, v[204:205] op_sel_hi:[1,0,1]
    v_pk_fma_f32 v[204:205], v[200:201], 0, v[204:205] op_sel_hi:[1,0,1]
    v_add_f32 v204, v204, v205
    v_subrev_u32 v205, 0x21800000, v202
    v_cmp_u_f32 vcc, v204, v204
    s_mov_b32 s73, 0x3e000000
    v_cmp_lt_u32 s[74:75], s73, v205
    s_or_b64 vcc, vcc, s[74:75]
    s_cmp_eq_u64 vcc, 0
    s_cbranch_scc1 SOK_171
    s_call_b64 s[86:87], L_fallback
SOK_171:
    v_rcp_f32 v202, v202
    s_nop 0
    v_mul_f32 v202, v4, v202
    v_pk_mul_f32 v[192:193], v[192:193], v[202:203] op_sel_hi:[1,0]
    v_pk_mul_f32 v[194:195], v[194:195], v[202:203] op_sel_hi:[1,0]
    v_pk_mul_f32 v[196:197], v[196:197], v[202:203] op_sel_hi:[1,0]
    v_pk_mul_f32 v[198:199], v[198:199], v[202:203] op_sel_hi:[1,0]
    v_pk_mul_f32 v[200:201], v[200:201], v[202:203] op_sel_hi:[1,0]
    v_cvt_pk_bf16_f32 v204, v192, v193
    v_cvt_pk_bf16_f32 v205, v194, v195
    v_cvt_pk_bf16_f32 v206, v196, v197
    v_cvt_pk_bf16_f32 v207, v198, v199
    v_cvt_pk_bf16_f32 v208, v200, v201
    v_min_u32 v204, -2, v204
    v_min_u32 v208, -2, v208
    buffer_store_dwordx4 v[204:207], v5, s[44:47], s90 offen sc1
    s_mov_b32 exec_hi, 0
    buffer_store_dword v208, v5, s[44:47], s91 offen sc1
    s_mov_b64 exec, -1
    s_branch L_fin
L_lwave:
    s_load_dword s71, s[26:27], 0
    v_lshl_add_u32 v5, v0, 2, v2
    v_mov_b32 v6, 0
    ds_write_b32 v5, v6 offset:2048
    v_lshlrev_b32 v5, 3, v4
    v_add_u32 v5, 158720, v5
    v_mov_b32 v7, 0
    ds_write_b64 v5, v[6:7]
    s_sub_u32 s99, s68, 4
    v_and_b32 v18, 31, v0
    v_lshrrev_b32 v19, 5, v0
    s_lshl_b32 s89, s99, 3
    s_add_u32 s89, s89, s70
    s_cmp_ge_u32 s89, 18
    s_cselect_b32 s89, 99, s89
    v_bfe_u32 v20, v0, 2, 1
    v_lshlrev_b32 v20, 4, v20
    v_bfe_u32 v21, v0, 3, 2
    v_lshl_add_u32 v20, v21, 2, v20
    v_and_b32 v21, 3, v0
    v_add_u32 v20, v20, v21
    s_cmp_lg_u32 s68, 6
    s_cbranch_scc1 NPF_172
    s_getpc_b64 s[64:65]
L_pc0:
    s_sub_u32 s64, s64, L_pc0-gated_mix__spectral_gfnet__grouped_kv_mqa__prompt_kernel
    s_subb_u32 s65, s65, 0
    s_mov_b32 s66, L_end-gated_mix__spectral_gfnet__grouped_kv_mqa__prompt_kernel
    s_mov_b32 s67, 0x20000
    s_lshr_b32 s73, s2, 3
    v_lshlrev_b32 v8, 12, v0
    s_lshl_b32 s73, s73, 7
    buffer_load_dword v9, v8, s[64:67], s73 offen
    s_getpc_b64 s[64:65]
    s_add_u32 s64, s64, spectral_tables@rel32@lo+4
    s_addc_u32 s65, s65, spectral_tables@rel32@hi+12
    s_mov_b32 s66, 100352
    s_nop 1
    buffer_load_dword v10, v8, s[64:67], s73 offen
NPF_172:
    s_mov_b32 s44, s26
    s_mov_b32 s45, s27
    s_mov_b32 s46, 16777216
    s_mov_b32 s47, 0x20000
    s_mov_b32 s32, s12
    s_mov_b32 s33, s13
    s_mov_b32 s34, 663552
    s_mov_b32 s35, 0x20000
    s_waitcnt lgkmcnt(0)
    s_barrier
    s_mul_i32 s71, s71, 0x9E3779B1
    s_add_u32 s71, s71, 0x7F4A7C15
NW7_174:
    s_cmp_eq_u32 s89, 99
    s_cbranch_scc1 NPRE_173
    s_lshl_b32 s73, s89, 5
    v_add_u32 v44, s73, v18
    v_lshrrev_b32 v45, 1, v44
    v_and_b32 v46, 1, v44
    v_cmp_eq_u32 vcc, 1, v44
    v_mov_b32 v47, 288
    s_nop 0
    v_cndmask_b32 v45, v45, v47, vcc
    v_cndmask_b32 v46, v46, 0, vcc
    v_and_b32 v47, 1, v45
    v_lshlrev_b32 v47, 31, v47
    v_or_b32 v17, 1.0, v47
    v_cvt_f32_u32 v45, v45
    v_cvt_f32_u32 v46, v46
    v_mul_f32 v45, 0x3ae38e39, v45
    v_mul_f32 v46, 0x3e800000, v46
    v_lshlrev_b32 v47, 3, v19
    v_cvt_f32_u32 v47, v47
    v_fma_f32 v46, v47, v45, v46
    v_mul_f32 v55, 0x41800000, v45
    s_mov_b32 s73, 0x0
    v_fma_f32 v56, s73, v45, v46
    s_mov_b32 s73, 0x3f800000
    v_fma_f32 v57, s73, v45, v46
    s_mov_b32 s73, 0x40000000
    v_fma_f32 v58, s73, v45, v46
    s_mov_b32 s73, 0x40400000
    v_fma_f32 v59, s73, v45, v46
    s_mov_b32 s73, 0x40800000
    v_fma_f32 v60, s73, v45, v46
    s_mov_b32 s73, 0x40a00000
    v_fma_f32 v61, s73, v45, v46
    s_mov_b32 s73, 0x40c00000
    v_fma_f32 v62, s73, v45, v46
    s_mov_b32 s73, 0x40e00000
    v_fma_f32 v63, s73, v45, v46
    v_cos_f32 v64, v56
    v_cos_f32 v65, v57
    v_cos_f32 v66, v58
    v_cos_f32 v67, v59
    v_cos_f32 v68, v60
    v_cos_f32 v69, v61
    v_cos_f32 v70, v62
    v_cos_f32 v71, v63
    v_cvt_pk_bf16_f32 v104, v64, v65
    v_cvt_pk_bf16_f32 v105, v66, v67
    v_cvt_pk_bf16_f32 v106, v68, v69
    v_cvt_pk_bf16_f32 v107, v70, v71
    s_mov_b32 s73, 0x3f800000
    v_fma_f32 v64, s73, v55, v56
    v_cos_f32 v64, v64
    v_fma_f32 v65, s73, v55, v57
    v_cos_f32 v65, v65
    v_fma_f32 v66, s73, v55, v58
    v_cos_f32 v66, v66
    v_fma_f32 v67, s73, v55, v59
    v_cos_f32 v67, v67
    v_fma_f32 v68, s73, v55, v60
    v_cos_f32 v68, v68
    v_fma_f32 v69, s73, v55, v61
    v_cos_f32 v69, v69
    v_fma_f32 v70, s73, v55, v62
    v_cos_f32 v70, v70
    v_fma_f32 v71, s73, v55, v63
    v_cos_f32 v71, v71
    v_cvt_pk_bf16_f32 v108, v64, v65
    v_cvt_pk_bf16_f32 v109, v66, v67
    v_cvt_pk_bf16_f32 v110, v68, v69
    v_cvt_pk_bf16_f32 v111, v70, v71
    s_mov_b32 s73, 0x40000000
    v_fma_f32 v64, s73, v55, v56
    v_cos_f32 v64, v64
    v_fma_f32 v65, s73, v55, v57
    v_cos_f32 v65, v65
    v_fma_f32 v66, s73, v55, v58
    v_cos_f32 v66, v66
    v_fma_f32 v67, s73, v55, v59
    v_cos_f32 v67, v67
    v_fma_f32 v68, s73, v55, v60
    v_cos_f32 v68, v68
    v_fma_f32 v69, s73, v55, v61
    v_cos_f32 v69, v69
    v_fma_f32 v70, s73, v55, v62
    v_cos_f32 v70, v70
    v_fma_f32 v71, s73, v55, v63
    v_cos_f32 v71, v71
    v_cvt_pk_bf16_f32 v112, v64, v65
    v_cvt_pk_bf16_f32 v113, v66, v67
    v_cvt_pk_bf16_f32 v114, v68, v69
    v_cvt_pk_bf16_f32 v115, v70, v71
    s_mov_b32 s73, 0x40400000
    v_fma_f32 v64, s73, v55, v56
    v_cos_f32 v64, v64
    v_fma_f32 v65, s73, v55, v57
    v_cos_f32 v65, v65
    v_fma_f32 v66, s73, v55, v58
    v_cos_f32 v66, v66
    v_fma_f32 v67, s73, v55, v59
    v_cos_f32 v67, v67
    v_fma_f32 v68, s73, v55, v60
    v_cos_f32 v68, v68
    v_fma_f32 v69, s73, v55, v61
    v_cos_f32 v69, v69
    v_fma_f32 v70, s73, v55, v62
    v_cos_f32 v70, v70
    v_fma_f32 v71, s73, v55, v63
    v_cos_f32 v71, v71
    v_cvt_pk_bf16_f32 v116, v64, v65
    v_cvt_pk_bf16_f32 v117, v66, v67
    v_cvt_pk_bf16_f32 v118, v68, v69
    v_cvt_pk_bf16_f32 v119, v70, v71
    s_mov_b32 s73, 0x40800000
    v_fma_f32 v64, s73, v55, v56
    v_cos_f32 v64, v64
    v_fma_f32 v65, s73, v55, v57
    v_cos_f32 v65, v65
    v_fma_f32 v66, s73, v55, v58
    v_cos_f32 v66, v66
    v_fma_f32 v67, s73, v55, v59
    v_cos_f32 v67, v67
    v_fma_f32 v68, s73, v55, v60
    v_cos_f32 v68, v68
    v_fma_f32 v69, s73, v55, v61
    v_cos_f32 v69, v69
    v_fma_f32 v70, s73, v55, v62
    v_cos_f32 v70, v70
    v_fma_f32 v71, s73, v55, v63
    v_cos_f32 v71, v71
    v_cvt_pk_bf16_f32 v120, v64, v65
    v_cvt_pk_bf16_f32 v121, v66, v67
    v_cvt_pk_bf16_f32 v122, v68, v69
    v_cvt_pk_bf16_f32 v123, v70, v71
    s_mov_b32 s73, 0x40a00000
    v_fma_f32 v64, s73, v55, v56
    v_cos_f32 v64, v64
    v_fma_f32 v65, s73, v55, v57
    v_cos_f32 v65, v65
    v_fma_f32 v66, s73, v55, v58
    v_cos_f32 v66, v66
    v_fma_f32 v67, s73, v55, v59
    v_cos_f32 v67, v67
    v_fma_f32 v68, s73, v55, v60
    v_cos_f32 v68, v68
    v_fma_f32 v69, s73, v55, v61
    v_cos_f32 v69, v69
    v_fma_f32 v70, s73, v55, v62
    v_cos_f32 v70, v70
    v_fma_f32 v71, s73, v55, v63
    v_cos_f32 v71, v71
    v_cvt_pk_bf16_f32 v124, v64, v65
    v_cvt_pk_bf16_f32 v125, v66, v67
    v_cvt_pk_bf16_f32 v126, v68, v69
    v_cvt_pk_bf16_f32 v127, v70, v71
    s_mov_b32 s73, 0x40c00000
    v_fma_f32 v64, s73, v55, v56
    v_cos_f32 v64, v64
    v_fma_f32 v65, s73, v55, v57
    v_cos_f32 v65, v65
    v_fma_f32 v66, s73, v55, v58
    v_cos_f32 v66, v66
    v_fma_f32 v67, s73, v55, v59
    v_cos_f32 v67, v67
    v_fma_f32 v68, s73, v55, v60
    v_cos_f32 v68, v68
    v_fma_f32 v69, s73, v55, v61
    v_cos_f32 v69, v69
    v_fma_f32 v70, s73, v55, v62
    v_cos_f32 v70, v70
    v_fma_f32 v71, s73, v55, v63
    v_cos_f32 v71, v71
    v_cvt_pk_bf16_f32 v128, v64, v65
    v_cvt_pk_bf16_f32 v129, v66, v67
    v_cvt_pk_bf16_f32 v130, v68, v69
    v_cvt_pk_bf16_f32 v131, v70, v71
    s_mov_b32 s73, 0x40e00000
    v_fma_f32 v64, s73, v55, v56
    v_cos_f32 v64, v64
    v_fma_f32 v65, s73, v55, v57
    v_cos_f32 v65, v65
    v_fma_f32 v66, s73, v55, v58
    v_cos_f32 v66, v66
    v_fma_f32 v67, s73, v55, v59
    v_cos_f32 v67, v67
    v_fma_f32 v68, s73, v55, v60
    v_cos_f32 v68, v68
    v_fma_f32 v69, s73, v55, v61
    v_cos_f32 v69, v69
    v_fma_f32 v70, s73, v55, v62
    v_cos_f32 v70, v70
    v_fma_f32 v71, s73, v55, v63
    v_cos_f32 v71, v71
    v_cvt_pk_bf16_f32 v132, v64, v65
    v_cvt_pk_bf16_f32 v133, v66, v67
    v_cvt_pk_bf16_f32 v134, v68, v69
    v_cvt_pk_bf16_f32 v135, v70, v71
NPRE_173:
    s_cmp_lt_u32 s68, 6
    s_cbranch_scc1 WQD_175
    v_lshrrev_b32 v14, 2, v0
    v_mul_u32_u24 v14, 1152, v14
    v_and_b32 v15, 3, v0
    v_lshl_add_u32 v14, v15, 4, v14
    v_mul_u32_u24 v15, 1152, v0
    s_and_b32 s73, s68, 1
    s_mul_i32 s84, s73, 18432
    s_add_u32 s84, s84, s95
    s_lshl_b32 s85, s73, 10
LW_176:
    ds_read_b32 v1, v2 offset:2152
    s_waitcnt lgkmcnt(0)
    v_readfirstlane_b32 s73, v1
    s_cmp_ge_u32 s73, 4
    s_cbranch_scc1 LWD_177
    s_sub_u32 s72, s72, 1
    s_cbranch_scc0 LW_176
    s_branch L_bail
LWD_177:
PNL_178:
    s_add_u32 m0, s85, 74752
    s_add_u32 s83, s84, 128
    buffer_load_dwordx4 v14, s[32:35], s84 offen lds
    s_add_u32 m0, s85, 111552
    s_lshr_b32 s82, s85, 2
    buffer_load_dwordx4 v14, s[32:35], s84 offen offset:64 lds
    s_lshr_b32 s73, s85, 13
    s_lshl_b32 s73, s73, 7
    s_add_u32 s82, s82, s73
    s_add_u32 m0, s82, 148480
    s_mov_b64 exec, 0xffff
    buffer_load_dwordx4 v15, s[32:35], s83 offen lds
    s_mov_b64 exec, -1
    s_add_u32 s85, s85, 2048
    s_add_u32 s84, s84, 36864
    s_cmp_lt_u32 s85, 20480
    s_cbranch_scc1 PNL_178
    s_waitcnt vmcnt(12)
    s_mov_b64 exec, 1
    ds_add_u32 v2, v3 offset:2048
    s_mov_b64 exec, -1
PNL_179:
    s_add_u32 m0, s85, 74752
    s_add_u32 s83, s84, 128
    buffer_load_dwordx4 v14, s[32:35], s84 offen lds
    s_add_u32 m0, s85, 111552
    s_lshr_b32 s82, s85, 2
    buffer_load_dwordx4 v14, s[32:35], s84 offen offset:64 lds
    s_lshr_b32 s73, s85, 13
    s_lshl_b32 s73, s73, 7
    s_add_u32 s82, s82, s73
    s_add_u32 m0, s82, 148480
    s_mov_b64 exec, 0xffff
    buffer_load_dwordx4 v15, s[32:35], s83 offen lds
    s_mov_b64 exec, -1
    s_add_u32 s85, s85, 2048
    s_add_u32 s84, s84, 36864
    s_cmp_lt_u32 s85, 26624
    s_cbranch_scc1 PNL_179
LW_180:
    ds_read_b32 v1, v2 offset:2068
    s_waitcnt lgkmcnt(0)
    v_readfirstlane_b32 s73, v1
    s_cmp_ge_u32 s73, 4
    s_cbranch_scc1 LWD_181
    s_sub_u32 s72, s72, 1
    s_cbranch_scc0 LW_180
    s_branch L_bail
LWD_181:
PNL_182:
    s_add_u32 m0, s85, 74752
    s_add_u32 s83, s84, 128
    buffer_load_dwordx4 v14, s[32:35], s84 offen lds
    s_add_u32 m0, s85, 111552
    s_lshr_b32 s82, s85, 2
    buffer_load_dwordx4 v14, s[32:35], s84 offen offset:64 lds
    s_lshr_b32 s73, s85, 13
    s_lshl_b32 s73, s73, 7
    s_add_u32 s82, s82, s73
    s_add_u32 m0, s82, 148480
    s_mov_b64 exec, 0xffff
    buffer_load_dwordx4 v15, s[32:35], s83 offen lds
    s_mov_b64 exec, -1
    s_add_u32 s85, s85, 2048
    s_add_u32 s84, s84, 36864
    s_cmp_lt_u32 s85, 36864
    s_cbranch_scc1 PNL_182
    s_waitcnt vmcnt(24)
    s_mov_b64 exec, 1
    ds_add_u32 v2, v3 offset:2052
    s_mov_b64 exec, -1
    s_waitcnt vmcnt(6)
    s_mov_b64 exec, 1
    ds_add_u32 v2, v3 offset:2120
    s_mov_b64 exec, -1
    s_waitcnt vmcnt(0)
    s_mov_b64 exec, 1
    ds_add_u32 v2, v3 offset:2056
    s_mov_b64 exec, -1
WQD_175:
    s_cmp_eq_u32 s89, 99
    s_cbranch_scc1 NOD_183
    s_mov_b32 s73, 0x41000000
    v_fma_f32 v64, s73, v55, v56
    v_cos_f32 v64, v64
    v_fma_f32 v65, s73, v55, v57
    v_cos_f32 v65, v65
    v_fma_f32 v66, s73, v55, v58
    v_cos_f32 v66, v66
    v_fma_f32 v67, s73, v55, v59
    v_cos_f32 v67, v67
    v_fma_f32 v68, s73, v55, v60
    v_cos_f32 v68, v68
    v_fma_f32 v69, s73, v55, v61
    v_cos_f32 v69, v69
    v_fma_f32 v70, s73, v55, v62
    v_cos_f32 v70, v70
    v_fma_f32 v71, s73, v55, v63
    v_cos_f32 v71, v71
    v_cvt_pk_bf16_f32 v136, v64, v65
    v_cvt_pk_bf16_f32 v137, v66, v67
    v_cvt_pk_bf16_f32 v138, v68, v69
    v_cvt_pk_bf16_f32 v139, v70, v71
    s_mov_b32 s73, 0x41100000
    v_fma_f32 v64, s73, v55, v56
    v_cos_f32 v64, v64
    v_fma_f32 v65, s73, v55, v57
    v_cos_f32 v65, v65
    v_fma_f32 v66, s73, v55, v58
    v_cos_f32 v66, v66
    v_fma_f32 v67, s73, v55, v59
    v_cos_f32 v67, v67
    v_fma_f32 v68, s73, v55, v60
    v_cos_f32 v68, v68
    v_fma_f32 v69, s73, v55, v61
    v_cos_f32 v69, v69
    v_fma_f32 v70, s73, v55, v62
    v_cos_f32 v70, v70
    v_fma_f32 v71, s73, v55, v63
    v_cos_f32 v71, v71
    v_cvt_pk_bf16_f32 v140, v64, v65
    v_cvt_pk_bf16_f32 v141, v66, v67
    v_cvt_pk_bf16_f32 v142, v68, v69
    v_cvt_pk_bf16_f32 v143, v70, v71
    s_mov_b32 s73, 0x41200000
    v_fma_f32 v64, s73, v55, v56
    v_cos_f32 v64, v64
    v_fma_f32 v65, s73, v55, v57
    v_cos_f32 v65, v65
    v_fma_f32 v66, s73, v55, v58
    v_cos_f32 v66, v66
    v_fma_f32 v67, s73, v55, v59
    v_cos_f32 v67, v67
    v_fma_f32 v68, s73, v55, v60
    v_cos_f32 v68, v68
    v_fma_f32 v69, s73, v55, v61
    v_cos_f32 v69, v69
    v_fma_f32 v70, s73, v55, v62
    v_cos_f32 v70, v70
    v_fma_f32 v71, s73, v55, v63
    v_cos_f32 v71, v71
    v_cvt_pk_bf16_f32 v144, v64, v65
    v_cvt_pk_bf16_f32 v145, v66, v67
    v_cvt_pk_bf16_f32 v146, v68, v69
    v_cvt_pk_bf16_f32 v147, v70, v71
    s_mov_b32 s73, 0x41300000
    v_fma_f32 v64, s73, v55, v56
    v_cos_f32 v64, v64
    v_fma_f32 v65, s73, v55, v57
    v_cos_f32 v65, v65
    v_fma_f32 v66, s73, v55, v58
    v_cos_f32 v66, v66
    v_fma_f32 v67, s73, v55, v59
    v_cos_f32 v67, v67
    v_fma_f32 v68, s73, v55, v60
    v_cos_f32 v68, v68
    v_fma_f32 v69, s73, v55, v61
    v_cos_f32 v69, v69
    v_fma_f32 v70, s73, v55, v62
    v_cos_f32 v70, v70
    v_fma_f32 v71, s73, v55, v63
    v_cos_f32 v71, v71
    v_cvt_pk_bf16_f32 v148, v64, v65
    v_cvt_pk_bf16_f32 v149, v66, v67
    v_cvt_pk_bf16_f32 v150, v68, v69
    v_cvt_pk_bf16_f32 v151, v70, v71
    s_mov_b32 s73, 0x41400000
    v_fma_f32 v64, s73, v55, v56
    v_cos_f32 v64, v64
    v_fma_f32 v65, s73, v55, v57
    v_cos_f32 v65, v65
    v_fma_f32 v66, s73, v55, v58
    v_cos_f32 v66, v66
    v_fma_f32 v67, s73, v55, v59
    v_cos_f32 v67, v67
    v_fma_f32 v68, s73, v55, v60
    v_cos_f32 v68, v68
    v_fma_f32 v69, s73, v55, v61
    v_cos_f32 v69, v69
    v_fma_f32 v70, s73, v55, v62
    v_cos_f32 v70, v70
    v_fma_f32 v71, s73, v55, v63
    v_cos_f32 v71, v71
    v_cvt_pk_bf16_f32 v152, v64, v65
    v_cvt_pk_bf16_f32 v153, v66, v67
    v_cvt_pk_bf16_f32 v154, v68, v69
    v_cvt_pk_bf16_f32 v155, v70, v71
    s_mov_b32 s73, 0x41500000
    v_fma_f32 v64, s73, v55, v56
    v_cos_f32 v64, v64
    v_fma_f32 v65, s73, v55, v57
    v_cos_f32 v65, v65
    v_fma_f32 v66, s73, v55, v58
    v_cos_f32 v66, v66
    v_fma_f32 v67, s73, v55, v59
    v_cos_f32 v67, v67
    v_fma_f32 v68, s73, v55, v60
    v_cos_f32 v68, v68
    v_fma_f32 v69, s73, v55, v61
    v_cos_f32 v69, v69
    v_fma_f32 v70, s73, v55, v62
    v_cos_f32 v70, v70
    v_fma_f32 v71, s73, v55, v63
    v_cos_f32 v71, v71
    v_cvt_pk_bf16_f32 v156, v64, v65
    v_cvt_pk_bf16_f32 v157, v66, v67
    v_cvt_pk_bf16_f32 v158, v68, v69
    v_cvt_pk_bf16_f32 v159, v70, v71
    s_mov_b32 s73, 0x41600000
    v_fma_f32 v64, s73, v55, v56
    v_cos_f32 v64, v64
    v_fma_f32 v65, s73, v55, v57
    v_cos_f32 v65, v65
    v_fma_f32 v66, s73, v55, v58
    v_cos_f32 v66, v66
    v_fma_f32 v67, s73, v55, v59
    v_cos_f32 v67, v67
    v_fma_f32 v68, s73, v55, v60
    v_cos_f32 v68, v68
    v_fma_f32 v69, s73, v55, v61
    v_cos_f32 v69, v69
    v_fma_f32 v70, s73, v55, v62
    v_cos_f32 v70, v70
    v_fma_f32 v71, s73, v55, v63
    v_cos_f32 v71, v71
    v_cvt_pk_bf16_f32 v160, v64, v65
    v_cvt_pk_bf16_f32 v161, v66, v67
    v_cvt_pk_bf16_f32 v162, v68, v69
    v_cvt_pk_bf16_f32 v163, v70, v71
    s_mov_b32 s73, 0x41700000
    v_fma_f32 v64, s73, v55, v56
    v_cos_f32 v64, v64
    v_fma_f32 v65, s73, v55, v57
    v_cos_f32 v65, v65
    v_fma_f32 v66, s73, v55, v58
    v_cos_f32 v66, v66
    v_fma_f32 v67, s73, v55, v59
    v_cos_f32 v67, v67
    v_fma_f32 v68, s73, v55, v60
    v_cos_f32 v68, v68
    v_fma_f32 v69, s73, v55, v61
    v_cos_f32 v69, v69
    v_fma_f32 v70, s73, v55, v62
    v_cos_f32 v70, v70
    v_fma_f32 v71, s73, v55, v63
    v_cos_f32 v71, v71
    v_cvt_pk_bf16_f32 v164, v64, v65
    v_cvt_pk_bf16_f32 v165, v66, v67
    v_cvt_pk_bf16_f32 v166, v68, v69
    v_cvt_pk_bf16_f32 v167, v70, v71
    s_mov_b32 s73, 0x41800000
    v_fma_f32 v64, s73, v55, v56
    v_cos_f32 v64, v64
    v_fma_f32 v65, s73, v55, v57
    v_cos_f32 v65, v65
    v_fma_f32 v66, s73, v55, v58
    v_cos_f32 v66, v66
    v_fma_f32 v67, s73, v55, v59
    v_cos_f32 v67, v67
    v_fma_f32 v68, s73, v55, v60
    v_cos_f32 v68, v68
    v_fma_f32 v69, s73, v55, v61
    v_cos_f32 v69, v69
    v_fma_f32 v70, s73, v55, v62
    v_cos_f32 v70, v70
    v_fma_f32 v71, s73, v55, v63
    v_cos_f32 v71, v71
    v_cvt_pk_bf16_f32 v168, v64, v65
    v_cvt_pk_bf16_f32 v169, v66, v67
    v_cvt_pk_bf16_f32 v170, v68, v69
    v_cvt_pk_bf16_f32 v171, v70, v71
    s_mov_b32 s73, 0x41880000
    v_fma_f32 v64, s73, v55, v56
    v_cos_f32 v64, v64
    v_fma_f32 v65, s73, v55, v57
    v_cos_f32 v65, v65
    v_fma_f32 v66, s73, v55, v58
    v_cos_f32 v66, v66
    v_fma_f32 v67, s73, v55, v59
    v_cos_f32 v67, v67
    v_fma_f32 v68, s73, v55, v60
    v_cos_f32 v68, v68
    v_fma_f32 v69, s73, v55, v61
    v_cos_f32 v69, v69
    v_fma_f32 v70, s73, v55, v62
    v_cos_f32 v70, v70
    v_fma_f32 v71, s73, v55, v63
    v_cos_f32 v71, v71
    v_cvt_pk_bf16_f32 v172, v64, v65
    v_cvt_pk_bf16_f32 v173, v66, v67
    v_cvt_pk_bf16_f32 v174, v68, v69
    v_cvt_pk_bf16_f32 v175, v70, v71
    v_mul_u32_u24 v25, 1040, v20
    v_lshl_add_u32 v25, v19, 4, v25
    v_lshrrev_b32 v22, 1, v20
    v_xor_b32 v22, v22, v19
    v_and_b32 v22, 7, v22
    v_lshlrev_b32 v22, 4, v22
    v_lshl_add_u32 v6, v20, 7, v22
    v_add_u32 v6, 66560, v6
    v_xor_b32 v7, 32, v6
    v_xor_b32 v8, 64, v6
    v_xor_b32 v9, 0x60, v6
    s_mul_i32 s73, s99, 4608
    s_add_u32 s73, s73, 87040
    v_mul_u32_u24 v10, 144, v18
    v_lshl_add_u32 v10, v19, 5, v10
    v_add_u32 v10, s73, v10
    v_lshrrev_b32 v12, 3, v0
    v_and_b32 v13, 7, v0
    v_lshlrev_b32 v13, 4, v13
    v_mul_u32_u24 v11, 144, v12
    v_add3_u32 v11, v11, v13, s73
    v_mul_u32_u24 v22, 4224, v12
    v_add_u32 v22, v22, v13
    s_mul_i32 s90, s89, 135168
    s_lshl_b32 s73, s69, 7
    s_add_u32 s90, s90, s73
    s_add_u32 s90, s90, 2097152
LW_184:
    ds_read_b32 v1, v2 offset:2068
    s_waitcnt lgkmcnt(0)
    v_readfirstlane_b32 s73, v1
    s_cmp_ge_u32 s73, 4
    s_cbranch_scc1 LWD_185
    s_sleep 1
    s_sub_u32 s72, s72, 1
    s_cbranch_scc0 LW_184
    s_branch L_bail
LWD_185:
    ds_read_b128 v[44:47], v25 offset:0
    ds_read_b128 v[48:51], v25 offset:576
    ds_read_b128 v[52:55], v25 offset:33280
    ds_read_b128 v[56:59], v25 offset:33856
    ds_read_b128 v[60:63], v25 offset:32
    ds_read_b128 v[64:67], v25 offset:608
    ds_read_b128 v[68:71], v25 offset:33312
    ds_read_b128 v[72:75], v25 offset:33888
    ds_read_b128 v[76:79], v25 offset:64
    ds_read_b128 v[80:83], v25 offset:640
    ds_read_b128 v[84:87], v25 offset:33344
    ds_read_b128 v[88:91], v25 offset:33920
    s_waitcnt lgkmcnt(8)
    v_mfma_f32_32x32x16_bf16 v[176:191], v[44:47], v[104:107], 0
    v_mfma_f32_32x32x16_bf16 v[192:207], v[48:51], v[104:107], 0
    v_mfma_f32_32x32x16_bf16 v[208:223], v[52:55], v[104:107], 0
    v_mfma_f32_32x32x16_bf16 v[224:239], v[56:59], v[104:107], 0
    ds_read_b128 v[44:47], v25 offset:96
    ds_read_b128 v[48:51], v25 offset:672
    ds_read_b128 v[52:55], v25 offset:33376
    ds_read_b128 v[56:59], v25 offset:33952
    s_waitcnt lgkmcnt(8)
    v_mfma_f32_32x32x16_bf16 v[176:191], v[60:63], v[108:111], v[176:191]
    v_mfma_f32_32x32x16_bf16 v[192:207], v[64:67], v[108:111], v[192:207]
    v_mfma_f32_32x32x16_bf16 v[208:223], v[68:71], v[108:111], v[208:223]
    v_mfma_f32_32x32x16_bf16 v[224:239], v[72:75], v[108:111], v[224:239]
    ds_read_b128 v[60:63], v25 offset:128
    ds_read_b128 v[64:67], v25 offset:704
    ds_read_b128 v[68:71], v25 offset:33408
    ds_read_b128 v[72:75], v25 offset:33984
    s_waitcnt lgkmcnt(8)
    v_mfma_f32_32x32x16_bf16 v[176:191], v[76:79], v[112:115], v[176:191]
    v_mfma_f32_32x32x16_bf16 v[192:207], v[80:83], v[112:115], v[192:207]
    v_mfma_f32_32x32x16_bf16 v[208:223], v[84:87], v[112:115], v[208:223]
    v_mfma_f32_32x32x16_bf16 v[224:239], v[88:91], v[112:115], v[224:239]
    ds_read_b128 v[76:79], v25 offset:160
    ds_read_b128 v[80:83], v25 offset:736
    ds_read_b128 v[84:87], v25 offset:33440
    ds_read_b128 v[88:91], v25 offset:34016
    s_waitcnt lgkmcnt(8)
    v_mfma_f32_32x32x16_bf16 v[176:191], v[44:47], v[116:119], v[176:191]
    v_mfma_f32_32x32x16_bf16 v[192:207], v[48:51], v[116:119], v[192:207]
    v_mfma_f32_32x32x16_bf16 v[208:223], v[52:55], v[116:119], v[208:223]
    v_mfma_f32_32x32x16_bf16 v[224:239], v[56:59], v[116:119], v[224:239]
    ds_read_b128 v[44:47], v25 offset:192
    ds_read_b128 v[48:51], v25 offset:768
    ds_read_b128 v[52:55], v25 offset:33472
    ds_read_b128 v[56:59], v25 offset:34048
    s_waitcnt lgkmcnt(8)
    v_mfma_f32_32x32x16_bf16 v[176:191], v[60:63], v[120:123], v[176:191]
    v_mfma_f32_32x32x16_bf16 v[192:207], v[64:67], v[120:123], v[192:207]
    v_mfma_f32_32x32x16_bf16 v[208:223], v[68:71], v[120:123], v[208:223]
    v_mfma_f32_32x32x16_bf16 v[224:239], v[72:75], v[120:123], v[224:239]
    ds_read_b128 v[60:63], v25 offset:224
    ds_read_b128 v[64:67], v25 offset:800
    ds_read_b128 v[68:71], v25 offset:33504
    ds_read_b128 v[72:75], v25 offset:34080
    s_waitcnt lgkmcnt(8)
    v_mfma_f32_32x32x16_bf16 v[176:191], v[76:79], v[124:127], v[176:191]
    v_mfma_f32_32x32x16_bf16 v[192:207], v[80:83], v[124:127], v[192:207]
    v_mfma_f32_32x32x16_bf16 v[208:223], v[84:87], v[124:127], v[208:223]
    v_mfma_f32_32x32x16_bf16 v[224:239], v[88:91], v[124:127], v[224:239]
    ds_read_b128 v[76:79], v25 offset:256
    ds_read_b128 v[80:83], v25 offset:832
    ds_read_b128 v[84:87], v25 offset:33536
    ds_read_b128 v[88:91], v25 offset:34112
    s_waitcnt lgkmcnt(8)
    v_mfma_f32_32x32x16_bf16 v[176:191], v[44:47], v[128:131], v[176:191]
    v_mfma_f32_32x32x16_bf16 v[192:207], v[48:51], v[128:131], v[192:207]
    v_mfma_f32_32x32x16_bf16 v[208:223], v[52:55], v[128:131], v[208:223]
    v_mfma_f32_32x32x16_bf16 v[224:239], v[56:59], v[128:131], v[224:239]
    ds_read_b128 v[44:47], v25 offset:288
    ds_read_b128 v[48:51], v25 offset:864
    ds_read_b128 v[52:55], v25 offset:33568
    ds_read_b128 v[56:59], v25 offset:34144
    s_waitcnt lgkmcnt(8)
    v_mfma_f32_32x32x16_bf16 v[176:191], v[60:63], v[132:135], v[176:191]
    v_mfma_f32_32x32x16_bf16 v[192:207], v[64:67], v[132:135], v[192:207]
    v_mfma_f32_32x32x16_bf16 v[208:223], v[68:71], v[132:135], v[208:223]
    v_mfma_f32_32x32x16_bf16 v[224:239], v[72:75], v[132:135], v[224:239]
    ds_read_b128 v[60:63], v25 offset:320
    ds_read_b128 v[64:67], v25 offset:896
    ds_read_b128 v[68:71], v25 offset:33600
    ds_read_b128 v[72:75], v25 offset:34176
    s_waitcnt lgkmcnt(8)
    v_mfma_f32_32x32x16_bf16 v[176:191], v[76:79], v[136:139], v[176:191]
    v_mfma_f32_32x32x16_bf16 v[192:207], v[80:83], v[136:139], v[192:207]
    v_mfma_f32_32x32x16_bf16 v[208:223], v[84:87], v[136:139], v[208:223]
    v_mfma_f32_32x32x16_bf16 v[224:239], v[88:91], v[136:139], v[224:239]
    ds_read_b128 v[76:79], v25 offset:352
    ds_read_b128 v[80:83], v25 offset:928
    ds_read_b128 v[84:87], v25 offset:33632
    ds_read_b128 v[88:91], v25 offset:34208
    s_waitcnt lgkmcnt(8)
    v_mfma_f32_32x32x16_bf16 v[176:191], v[44:47], v[140:143], v[176:191]
    v_mfma_f32_32x32x16_bf16 v[192:207], v[48:51], v[140:143], v[192:207]
    v_mfma_f32_32x32x16_bf16 v[208:223], v[52:55], v[140:143], v[208:223]
    v_mfma_f32_32x32x16_bf16 v[224:239], v[56:59], v[140:143], v[224:239]
    ds_read_b128 v[44:47], v25 offset:384
    ds_read_b128 v[48:51], v25 offset:960
    ds_read_b128 v[52:55], v25 offset:33664
    ds_read_b128 v[56:59], v25 offset:34240
    s_waitcnt lgkmcnt(8)
    v_mfma_f32_32x32x16_bf16 v[176:191], v[60:63], v[144:147], v[176:191]
    v_mfma_f32_32x32x16_bf16 v[192:207], v[64:67], v[144:147], v[192:207]
    v_mfma_f32_32x32x16_bf16 v[208:223], v[68:71], v[144:147], v[208:223]
    v_mfma_f32_32x32x16_bf16 v[224:239], v[72:75], v[144:147], v[224:239]
    ds_read_b128 v[60:63], v25 offset:416
    ds_read_b128 v[64:67], v25 offset:992
    ds_read_b128 v[68:71], v25 offset:33696
    ds_read_b128 v[72:75], v25 offset:34272
    s_waitcnt lgkmcnt(8)
    v_mfma_f32_32x32x16_bf16 v[176:191], v[76:79], v[148:151], v[176:191]
    v_mfma_f32_32x32x16_bf16 v[192:207], v[80:83], v[148:151], v[192:207]
    v_mfma_f32_32x32x16_bf16 v[208:223], v[84:87], v[148:151], v[208:223]
    v_mfma_f32_32x32x16_bf16 v[224:239], v[88:91], v[148:151], v[224:239]
    s_waitcnt lgkmcnt(4)
    v_mfma_f32_32x32x16_bf16 v[176:191], v[44:47], v[152:155], v[176:191]
    v_mfma_f32_32x32x16_bf16 v[192:207], v[48:51], v[152:155], v[192:207]
    v_mfma_f32_32x32x16_bf16 v[208:223], v[52:55], v[152:155], v[208:223]
    v_mfma_f32_32x32x16_bf16 v[224:239], v[56:59], v[152:155], v[224:239]
    s_waitcnt lgkmcnt(0)
    v_mfma_f32_32x32x16_bf16 v[176:191], v[60:63], v[156:159], v[176:191]
    v_mfma_f32_32x32x16_bf16 v[192:207], v[64:67], v[156:159], v[192:207]
    v_mfma_f32_32x32x16_bf16 v[208:223], v[68:71], v[156:159], v[208:223]
    v_mfma_f32_32x32x16_bf16 v[224:239], v[72:75], v[156:159], v[224:239]
    s_setprio 3
LW_186:
    ds_read_b32 v1, v2 offset:2060
    s_waitcnt lgkmcnt(0)
    v_readfirstlane_b32 s73, v1
    s_cmp_ge_u32 s73, 4
    s_cbranch_scc1 LWD_187
    s_sleep 1
    s_sub_u32 s72, s72, 1
    s_cbranch_scc0 LW_186
    s_branch L_bail
LWD_187:
    ds_read_b128 v[76:79], v25 offset:448
    ds_read_b128 v[80:83], v6 offset:0
    ds_read_b128 v[84:87], v25 offset:33728
    ds_read_b128 v[88:91], v6 offset:4096
    ds_read_b128 v[44:47], v25 offset:480
    ds_read_b128 v[48:51], v7 offset:0
    ds_read_b128 v[52:55], v25 offset:33760
    ds_read_b128 v[56:59], v7 offset:4096
    ds_read_b128 v[60:63], v25 offset:512
    ds_read_b128 v[64:67], v8 offset:0
    ds_read_b128 v[68:71], v25 offset:33792
    ds_read_b128 v[72:75], v8 offset:4096
    s_waitcnt lgkmcnt(8)
    v_mfma_f32_32x32x16_bf16 v[176:191], v[76:79], v[160:163], v[176:191]
    v_mfma_f32_32x32x16_bf16 v[192:207], v[80:83], v[160:163], v[192:207]
    v_mfma_f32_32x32x16_bf16 v[208:223], v[84:87], v[160:163], v[208:223]
    v_mfma_f32_32x32x16_bf16 v[224:239], v[88:91], v[160:163], v[224:239]
    ds_read_b128 v[76:79], v25 offset:544
    ds_read_b128 v[80:83], v9 offset:0
    ds_read_b128 v[84:87], v25 offset:33824
    ds_read_b128 v[88:91], v9 offset:4096
    s_waitcnt lgkmcnt(8)
    v_mfma_f32_32x32x16_bf16 v[176:191], v[44:47], v[164:167], v[176:191]
    v_mfma_f32_32x32x16_bf16 v[192:207], v[48:51], v[164:167], v[192:207]
    v_mfma_f32_32x32x16_bf16 v[208:223], v[52:55], v[164:167], v[208:223]
    v_mfma_f32_32x32x16_bf16 v[224:239], v[56:59], v[164:167], v[224:239]
    s_waitcnt lgkmcnt(4)
    v_mfma_f32_32x32x16_bf16 v[176:191], v[60:63], v[168:171], v[176:191]
    v_mfma_f32_32x32x16_bf16 v[192:207], v[64:67], v[168:171], v[192:207]
    v_mfma_f32_32x32x16_bf16 v[208:223], v[68:71], v[168:171], v[208:223]
    v_mfma_f32_32x32x16_bf16 v[224:239], v[72:75], v[168:171], v[224:239]
    s_waitcnt lgkmcnt(0)
    v_mfma_f32_32x32x16_bf16 v[176:191], v[76:79], v[172:175], v[176:191]
    v_mfma_f32_32x32x16_bf16 v[192:207], v[80:83], v[172:175], v[192:207]
    v_mfma_f32_32x32x16_bf16 v[208:223], v[84:87], v[172:175], v[208:223]
    v_mfma_f32_32x32x16_bf16 v[224:239], v[88:91], v[172:175], v[224:239]
    s_nop 3
    s_nop 0
    s_nop 3
    s_nop 0
    v_fma_f32 v176, v17, v192, v176
    v_fma_f32 v177, v17, v193, v177
    v_fma_f32 v178, v17, v194, v178
    v_fma_f32 v179, v17, v195, v179
    v_fma_f32 v180, v17, v196, v180
    v_fma_f32 v181, v17, v197, v181
    v_fma_f32 v182, v17, v198, v182
    v_fma_f32 v183, v17, v199, v183
    v_fma_f32 v184, v17, v200, v184
    v_fma_f32 v185, v17, v201, v185
    v_fma_f32 v186, v17, v202, v186
    v_fma_f32 v187, v17, v203, v187
    v_fma_f32 v188, v17, v204, v188
    v_fma_f32 v189, v17, v205, v189
    v_fma_f32 v190, v17, v206, v190
    v_fma_f32 v191, v17, v207, v191
    v_cvt_pk_bf16_f32 v176, v176, v177
    v_cvt_pk_bf16_f32 v177, v178, v179
    v_cvt_pk_bf16_f32 v178, v180, v181
    v_cvt_pk_bf16_f32 v179, v182, v183
    v_cvt_pk_bf16_f32 v180, v184, v185
    v_cvt_pk_bf16_f32 v181, v186, v187
    v_cvt_pk_bf16_f32 v182, v188, v189
    v_cvt_pk_bf16_f32 v183, v190, v191
    ds_write_b128 v10, v[176:179] offset:0
    ds_write_b128 v10, v[180:183] offset:16
    v_fma_f32 v208, v17, v224, v208
    v_fma_f32 v209, v17, v225, v209
    v_fma_f32 v210, v17, v226, v210
    v_fma_f32 v211, v17, v227, v211
    v_fma_f32 v212, v17, v228, v212
    v_fma_f32 v213, v17, v229, v213
    v_fma_f32 v214, v17, v230, v214
    v_fma_f32 v215, v17, v231, v215
    v_fma_f32 v216, v17, v232, v216
    v_fma_f32 v217, v17, v233, v217
    v_fma_f32 v218, v17, v234, v218
    v_fma_f32 v219, v17, v235, v219
    v_fma_f32 v220, v17, v236, v220
    v_fma_f32 v221, v17, v237, v221
    v_fma_f32 v222, v17, v238, v222
    v_fma_f32 v223, v17, v239, v223
    v_cvt_pk_bf16_f32 v208, v208, v209
    v_cvt_pk_bf16_f32 v209, v210, v211
    v_cvt_pk_bf16_f32 v210, v212, v213
    v_cvt_pk_bf16_f32 v211, v214, v215
    v_cvt_pk_bf16_f32 v212, v216, v217
    v_cvt_pk_bf16_f32 v213, v218, v219
    v_cvt_pk_bf16_f32 v214, v220, v221
    v_cvt_pk_bf16_f32 v215, v222, v223
    ds_write_b128 v10, v[208:211] offset:64
    ds_write_b128 v10, v[212:215] offset:80
    ds_read_b128 v[56:59], v11 offset:0
    ds_read_b128 v[60:63], v11 offset:1152
    ds_read_b128 v[64:67], v11 offset:2304
    ds_read_b128 v[68:71], v11 offset:3456
LW_188:
    ds_read_b32 v1, v2 offset:2076
    s_waitcnt lgkmcnt(0)
    v_readfirstlane_b32 s73, v1
    s_cmp_ge_u32 s73, 4
    s_cbranch_scc1 LWD_189
    s_sleep 2
    s_sub_u32 s72, s72, 1
    s_cbranch_scc0 LW_188
    s_branch L_bail
LWD_189:
    buffer_store_dwordx4 v[56:59], v22, s[44:47], s90 offen sc1
    s_add_u32 s90, s90, 33792
    buffer_store_dwordx4 v[60:63], v22, s[44:47], s90 offen sc1
    s_add_u32 s90, s90, 33792
    buffer_store_dwordx4 v[64:67], v22, s[44:47], s90 offen sc1
    s_add_u32 s90, s90, 33792
    buffer_store_dwordx4 v[68:71], v22, s[44:47], s90 offen sc1
    s_add_u32 s90, s90, 33792
NOD_183:
    s_cmp_eq_u32 s68, 7
    s_cbranch_scc1 N7_191
    s_cmp_lg_u32 s68, 6
    s_cbranch_scc1 N6_190
    s_setprio 3
LW_192:
    ds_read_b32 v1, v2 offset:2076
    s_waitcnt lgkmcnt(0)
    v_readfirstlane_b32 s73, v1
    s_cmp_ge_u32 s73, 4
    s_cbranch_scc1 LWD_193
    s_sleep 2
    s_sub_u32 s72, s72, 1
    s_cbranch_scc0 LW_192
    s_branch L_bail
LWD_193:
    v_lshlrev_b32 v24, 4, v0
    v_mov_b32 v28, -1
    v_mov_b32 v29, -1
    v_mov_b32 v30, -1
    v_mov_b32 v31, -1
    s_mul_i32 s90, s69, 73728
    s_add_u32 s90, s90, 8388608
    s_mul_i32 s91, s70, 9216
    s_add_u32 s91, s91, s90
    s_add_u32 s91, s91, 8192
    buffer_store_dwordx4 v[28:31], v24, s[44:47], s91 offen sc1
    s_lshl_b32 s73, s70, 10
    s_add_u32 s90, s90, s73
    buffer_store_dwordx4 v[28:31], v24, s[44:47], s90 offen sc1
    s_add_u32 s90, s90, 9216
    buffer_store_dwordx4 v[28:31], v24, s[44:47], s90 offen sc1
    s_add_u32 s90, s90, 9216
    buffer_store_dwordx4 v[28:31], v24, s[44:47], s90 offen sc1
    s_add_u32 s90, s90, 9216
    buffer_store_dwordx4 v[28:31], v24, s[44:47], s90 offen sc1
    s_add_u32 s90, s90, 9216
    buffer_store_dwordx4 v[28:31], v24, s[44:47], s90 offen sc1
    s_add_u32 s90, s90, 9216
    buffer_store_dwordx4 v[28:31], v24, s[44:47], s90 offen sc1
    s_add_u32 s90, s90, 9216
    buffer_store_dwordx4 v[28:31], v24, s[44:47], s90 offen sc1
    s_add_u32 s90, s90, 9216
    buffer_store_dwordx4 v[28:31], v24, s[44:47], s90 offen sc1
    s_add_u32 s90, s90, 9216
N6_190:
    s_waitcnt vmcnt(0)
    s_mov_b64 exec, 1
    ds_add_u32 v2, v3 offset:2108
    s_mov_b64 exec, -1
N7_191:
    s_mov_b32 s89, s2
    s_cmp_lg_u32 s68, 7
    s_cbranch_scc1 N7_196
    s_mov_b32 s99, 1073741824
    s_cmp_ge_u32 s2, 216
    s_cbranch_scc1 GS_200
    s_lshl_b32 s90, s2, 2
    s_lshl_b32 s99, s2, 12
    s_add_u32 s99, s99, 1048576
    s_mul_i32 s91, s90, 1821
    s_lshr_b32 s91, s91, 16
    s_mul_i32 s73, s91, 36
    s_sub_u32 s92, s90, s73
    s_mul_i32 s93, s91, 21846
    s_lshr_b32 s93, s93, 16
    s_mul_i32 s73, s93, 3
    s_sub_u32 s91, s91, s73
    s_mul_i32 s93, s93, 72
    s_lshl_b32 s73, s91, 5
    s_add_u32 s93, s93, s73
    v_mov_b32 v64, v20
    s_cmp_lg_u32 s91, 2
    s_cbranch_scc1 GNX_201
    v_mov_b32 v64, v18
GNX_201:
    v_add_u32 v64, s93, v64
    s_lshl_b32 s73, s92, 3
    v_lshl_add_u32 v65, v19, 2, s73
    v_mul_u32_u24 v65, v65, v64
    v_mul_u32_u24 v67, 5, v64
    s_mov_b32 s73, 0x3ae38e39
    s_mov_b32 s93, 0x35e38e39
    v_cvt_f32_u32 v66, v65
    v_mul_f32 v66, s73, v66
    v_fract_f32 v66, v66
    v_cos_f32 v68, v66
    v_sin_f32 v69, v66
    v_add_u32 v65, v65, v64
    v_cvt_f32_u32 v66, v65
    v_mul_f32 v66, s73, v66
    v_fract_f32 v66, v66
    v_cos_f32 v70, v66
    v_sin_f32 v71, v66
    v_add_u32 v65, v65, v64
    v_cvt_f32_u32 v66, v65
    v_mul_f32 v66, s73, v66
    v_fract_f32 v66, v66
    v_cos_f32 v72, v66
    v_sin_f32 v73, v66
    v_add_u32 v65, v65, v64
    v_cvt_f32_u32 v66, v65
    v_mul_f32 v66, s73, v66
    v_fract_f32 v66, v66
    v_cos_f32 v74, v66
    v_sin_f32 v75, v66
    v_add_u32 v65, v65, v67
    v_mul_f32 v68, s93, v68
    v_mul_f32 v69, s93, -v69
    v_mul_f32 v70, s93, v70
    v_mul_f32 v71, s93, -v71
    v_mul_f32 v72, s93, v72
    v_mul_f32 v73, s93, -v73
    v_mul_f32 v74, s93, v74
    v_mul_f32 v75, s93, -v75
    s_cmp_lg_u32 s92, 0
    s_cbranch_scc1 GNK_202
    s_mov_b32 exec_hi, 0
    v_mov_b32 v68, 0x35638e39
    v_lshlrev_b32 v69, 31, v64
    v_or_b32 v69, v68, v69
    s_mov_b64 exec, -1
GNK_202:
    v_cvt_pk_bf16_f32 v48, v68, v69
    v_cvt_pk_bf16_f32 v49, v70, v71
    v_cvt_pk_bf16_f32 v50, v72, v73
    v_cvt_pk_bf16_f32 v51, v74, v75
    v_cvt_f32_u32 v66, v65
    v_mul_f32 v66, s73, v66
    v_fract_f32 v66, v66
    v_cos_f32 v68, v66
    v_sin_f32 v69, v66
    v_add_u32 v65, v65, v64
    v_cvt_f32_u32 v66, v65
    v_mul_f32 v66, s73, v66
    v_fract_f32 v66, v66
    v_cos_f32 v70, v66
    v_sin_f32 v71, v66
    v_add_u32 v65, v65, v64
    v_cvt_f32_u32 v66, v65
    v_mul_f32 v66, s73, v66
    v_fract_f32 v66, v66
    v_cos_f32 v72, v66
    v_sin_f32 v73, v66
    v_add_u32 v65, v65, v64
    v_cvt_f32_u32 v66, v65
    v_mul_f32 v66, s73, v66
    v_fract_f32 v66, v66
    v_cos_f32 v74, v66
    v_sin_f32 v75, v66
    v_add_u32 v65, v65, v67
    v_mul_f32 v68, s93, v68
    v_mul_f32 v69, s93, -v69
    v_mul_f32 v70, s93, v70
    v_mul_f32 v71, s93, -v71
    v_mul_f32 v72, s93, v72
    v_mul_f32 v73, s93, -v73
    v_mul_f32 v74, s93, v74
    v_mul_f32 v75, s93, -v75
    v_cvt_pk_bf16_f32 v52, v68, v69
    v_cvt_pk_bf16_f32 v53, v70, v71
    v_cvt_pk_bf16_f32 v54, v72, v73
    v_cvt_pk_bf16_f32 v55, v74, v75
    v_cvt_f32_u32 v66, v65
    v_mul_f32 v66, s73, v66
    v_fract_f32 v66, v66
    v_cos_f32 v68, v66
    v_sin_f32 v69, v66
    v_add_u32 v65, v65, v64
    v_cvt_f32_u32 v66, v65
    v_mul_f32 v66, s73, v66
    v_fract_f32 v66, v66
    v_cos_f32 v70, v66
    v_sin_f32 v71, v66
    v_add_u32 v65, v65, v64
    v_cvt_f32_u32 v66, v65
    v_mul_f32 v66, s73, v66
    v_fract_f32 v66, v66
    v_cos_f32 v72, v66
    v_sin_f32 v73, v66
    v_add_u32 v65, v65, v64
    v_cvt_f32_u32 v66, v65
    v_mul_f32 v66, s73, v66
    v_fract_f32 v66, v66
    v_cos_f32 v74, v66
    v_sin_f32 v75, v66
    v_add_u32 v65, v65, v67
    v_mul_f32 v68, s93, v68
    v_mul_f32 v69, s93, -v69
    v_mul_f32 v70, s93, v70
    v_mul_f32 v71, s93, -v71
    v_mul_f32 v72, s93, v72
    v_mul_f32 v73, s93, -v73
    v_mul_f32 v74, s93, v74
    v_mul_f32 v75, s93, -v75
    v_cvt_pk_bf16_f32 v56, v68, v69
    v_cvt_pk_bf16_f32 v57, v70, v71
    v_cvt_pk_bf16_f32 v58, v72, v73
    v_cvt_pk_bf16_f32 v59, v74, v75
    v_cvt_f32_u32 v66, v65
    v_mul_f32 v66, s73, v66
    v_fract_f32 v66, v66
    v_cos_f32 v68, v66
    v_sin_f32 v69, v66
    v_add_u32 v65, v65, v64
    v_cvt_f32_u32 v66, v65
    v_mul_f32 v66, s73, v66
    v_fract_f32 v66, v66
    v_cos_f32 v70, v66
    v_sin_f32 v71, v66
    v_add_u32 v65, v65, v64
    v_cvt_f32_u32 v66, v65
    v_mul_f32 v66, s73, v66
    v_fract_f32 v66, v66
    v_cos_f32 v72, v66
    v_sin_f32 v73, v66
    v_add_u32 v65, v65, v64
    v_cvt_f32_u32 v66, v65
    v_mul_f32 v66, s73, v66
    v_fract_f32 v66, v66
    v_cos_f32 v74, v66
    v_sin_f32 v75, v66
    v_add_u32 v65, v65, v67
    v_mul_f32 v68, s93, v68
    v_mul_f32 v69, s93, -v69
    v_mul_f32 v70, s93, v70
    v_mul_f32 v71, s93, -v71
    v_mul_f32 v72, s93, v72
    v_mul_f32 v73, s93, -v73
    v_mul_f32 v74, s93, v74
    v_mul_f32 v75, s93, -v75
    v_cvt_pk_bf16_f32 v60, v68, v69
    v_cvt_pk_bf16_f32 v61, v70, v71
    v_cvt_pk_bf16_f32 v62, v72, v73
    v_cvt_pk_bf16_f32 v63, v74, v75
GS_200:
    s_setprio 3
    v_lshlrev_b32 v24, 4, v0
LW_203:
    ds_read_b32 v1, v2 offset:2076
    s_waitcnt lgkmcnt(0)
    v_readfirstlane_b32 s73, v1
    s_cmp_ge_u32 s73, 4
    s_cbranch_scc1 LWD_204
    s_sleep 2
    s_sub_u32 s72, s72, 1
    s_cbranch_scc0 LW_203
    s_branch L_bail
LWD_204:
    s_mov_b32 s56, s6
    s_mov_b32 s57, s7
    s_mov_b32 s58, 1183744
    s_mov_b32 s59, 0x20000
    s_mov_b32 s60, s8
    s_mov_b32 s61, s9
    s_mov_b32 s62, 1183744
    s_mov_b32 s63, 0x20000
    v_and_b32 v26, 7, v0
    v_lshrrev_b32 v27, 3, v0
    v_mul_u32_u24 v22, 578, v26
    v_mad_u32_u24 v22, v27, 18, v22
    s_lshr_b32 s93, s2, 6
    s_bfe_u32 s92, s2, 0x20004
    s_and_b32 s88, s2, 15
    s_lshl_b32 s90, s88, 7
    s_lshl_b32 s73, s92, 3
    s_add_u32 s90, s90, s73
    s_mul_i32 s90, s90, 578
    s_mul_i32 s73, s93, 144
    s_add_u32 s90, s90, s73
    buffer_load_dwordx4 v[176:179], v22, s[56:59], s90 offen
    buffer_load_dword v180, v22, s[56:59], s90 offen offset:16
    buffer_load_dwordx4 v[200:203], v22, s[60:63], s90 offen
    buffer_load_dword v204, v22, s[60:63], s90 offen offset:16
    s_add_u32 s90, s90, 18496
    buffer_load_dwordx4 v[182:185], v22, s[56:59], s90 offen
    buffer_load_dword v186, v22, s[56:59], s90 offen offset:16
    buffer_load_dwordx4 v[206:209], v22, s[60:63], s90 offen
    buffer_load_dword v210, v22, s[60:63], s90 offen offset:16
    s_add_u32 s90, s90, 18496
    buffer_load_dwordx4 v[188:191], v22, s[56:59], s90 offen
    buffer_load_dword v192, v22, s[56:59], s90 offen offset:16
    buffer_load_dwordx4 v[212:215], v22, s[60:63], s90 offen
    buffer_load_dword v216, v22, s[60:63], s90 offen offset:16
    s_add_u32 s90, s90, 18496
    buffer_load_dwordx4 v[194:197], v22, s[56:59], s90 offen
    buffer_load_dword v198, v22, s[56:59], s90 offen offset:16
    buffer_load_dwordx4 v[218:221], v22, s[60:63], s90 offen
    buffer_load_dword v222, v22, s[60:63], s90 offen offset:16
    s_mov_b32 s73, 74880
    v_mul_lo_u32 v23, v27, s73
    v_lshl_add_u32 v23, v26, 4, v23
    s_mul_i32 s98, s93, 599040
    s_lshl_b32 s73, s88, 8
    s_add_u32 s98, s98, s73
    s_and_b32 s73, s92, 1
    s_lshl_b32 s73, s73, 7
    s_add_u32 s98, s98, s73
    s_lshr_b32 s73, s92, 1
    s_lshl_b32 s73, s73, 12
    s_add_u32 s98, s98, s73
    s_add_u32 s98, s98, 11534336
    s_waitcnt vmcnt(0)
    s_mov_b32 s92, 0x05040100
    s_mov_b32 s93, 0x07060302
    v_perm_b32 v224, v182, v176, s92
    v_perm_b32 v225, v194, v188, s92
    v_perm_b32 v226, v206, v200, s92
    v_perm_b32 v227, v218, v212, s92
    buffer_store_dwordx4 v[224:227], v23, s[44:47], s98 offen sc1
    s_add_u32 s98, s98, 8320
    v_perm_b32 v228, v182, v176, s93
    v_perm_b32 v229, v194, v188, s93
    v_perm_b32 v230, v206, v200, s93
    v_perm_b32 v231, v218, v212, s93
    buffer_store_dwordx4 v[228:231], v23, s[44:47], s98 offen sc1
    s_add_u32 s98, s98, 8320
    v_perm_b32 v232, v183, v177, s92
    v_perm_b32 v233, v195, v189, s92
    v_perm_b32 v234, v207, v201, s92
    v_perm_b32 v235, v219, v213, s92
    buffer_store_dwordx4 v[232:235], v23, s[44:47], s98 offen sc1
    s_add_u32 s98, s98, 8320
    v_perm_b32 v224, v183, v177, s93
    v_perm_b32 v225, v195, v189, s93
    v_perm_b32 v226, v207, v201, s93
    v_perm_b32 v227, v219, v213, s93
    buffer_store_dwordx4 v[224:227], v23, s[44:47], s98 offen sc1
    s_add_u32 s98, s98, 8320
    v_perm_b32 v228, v184, v178, s92
    v_perm_b32 v229, v196, v190, s92
    v_perm_b32 v230, v208, v202, s92
    v_perm_b32 v231, v220, v214, s92
    buffer_store_dwordx4 v[228:231], v23, s[44:47], s98 offen sc1
    s_add_u32 s98, s98, 8320
    v_perm_b32 v232, v184, v178, s93
    v_perm_b32 v233, v196, v190, s93
    v_perm_b32 v234, v208, v202, s93
    v_perm_b32 v235, v220, v214, s93
    buffer_store_dwordx4 v[232:235], v23, s[44:47], s98 offen sc1
    s_add_u32 s98, s98, 8320
    v_perm_b32 v224, v185, v179, s92
    v_perm_b32 v225, v197, v191, s92
    v_perm_b32 v226, v209, v203, s92
    v_perm_b32 v227, v221, v215, s92
    buffer_store_dwordx4 v[224:227], v23, s[44:47], s98 offen sc1
    s_add_u32 s98, s98, 8320
    v_perm_b32 v228, v185, v179, s93
    v_perm_b32 v229, v197, v191, s93
    v_perm_b32 v230, v209, v203, s93
    v_perm_b32 v231, v221, v215, s93
    buffer_store_dwordx4 v[228:231], v23, s[44:47], s98 offen sc1
    s_add_u32 s98, s98, 8320
    v_perm_b32 v232, v186, v180, s92
    v_perm_b32 v233, v198, v192, s92
    v_perm_b32 v234, v210, v204, s92
    v_perm_b32 v235, v222, v216, s92
    buffer_store_dwordx4 v[232:235], v23, s[44:47], s98 offen sc1
    s_add_u32 s98, s98, 8320
    s_cmp_lt_u32 s2, 192
    s_cbranch_scc1 WL_205
    s_mov_b32 exec_lo, 0
    s_mov_b32 exec_hi, 0xff000000
    v_perm_b32 v224, v186, v180, s93
    v_perm_b32 v225, v198, v192, s93
    v_perm_b32 v226, v210, v204, s93
    v_perm_b32 v227, v222, v216, s93
    buffer_store_dwordx4 v[224:227], v23, s[44:47], s98 offen sc1
    s_add_u32 s98, s98, 8320
    s_mov_b64 exec, -1
WL_205:
    buffer_store_dwordx4 v[48:51], v24, s[44:47], s99 offen offset:0 sc1
    buffer_store_dwordx4 v[52:55], v24, s[44:47], s99 offen offset:1024 sc1
    buffer_store_dwordx4 v[56:59], v24, s[44:47], s99 offen offset:2048 sc1
    buffer_store_dwordx4 v[60:63], v24, s[44:47], s99 offen offset:3072 sc1
    s_lshr_b32 s91, s2, 2
    s_lshl_b32 s91, s91, 7
    s_and_b32 s73, s2, 3
    s_lshl_b32 s73, s73, 2
    s_add_u32 s91, s91, s73
    s_add_u32 s91, s91, 360448
    s_waitcnt vmcnt(0)
LW_206:
    ds_read_b32 v1, v2 offset:2108
    s_waitcnt lgkmcnt(0)
    v_readfirstlane_b32 s73, v1
    s_cmp_ge_u32 s73, 3
    s_cbranch_scc1 LWD_207
    s_sleep 2
    s_sub_u32 s72, s72, 1
    s_cbranch_scc0 LW_206
    s_branch L_bail
LWD_207:
    v_mov_b32 v1, s71
    s_mov_b64 exec, 1
    buffer_store_dword v1, off, s[44:47], s91 sc1
    s_mov_b64 exec, -1
    s_mov_b64 exec, 1
    ds_add_u32 v2, v3 offset:2100
    s_mov_b64 exec, -1
LW_208:
    ds_read_b32 v1, v2 offset:2144
    s_waitcnt lgkmcnt(0)
    v_readfirstlane_b32 s73, v1
    s_cmp_ge_u32 s73, 4
    s_cbranch_scc1 LWD_209
    s_sleep 4
    s_sub_u32 s72, s72, 1
    s_cbranch_scc0 LW_208
    s_branch L_bail
LWD_209:
    s_getpc_b64 s[64:65]
    s_add_u32 s64, s64, spectral_tables@rel32@lo+4
    s_addc_u32 s65, s65, spectral_tables@rel32@hi+12
    s_mov_b32 s66, 100352
    s_mov_b32 s67, 0x20000
    v_lshlrev_b32 v5, 4, v0
    s_and_b32 s86, s68, 1
    s_mul_i32 s87, s86, 50176
    s_add_u32 s88, s87, 0
    buffer_load_dwordx4 v[80:83], v5, s[64:67], s88 offen offset:0
    buffer_load_dwordx4 v[84:87], v5, s[64:67], s88 offen offset:1024
    buffer_load_dwordx4 v[88:91], v5, s[64:67], s88 offen offset:2048
    buffer_load_dwordx4 v[92:95], v5, s[64:67], s88 offen offset:3072
    s_add_u32 s88, s87, 4096
    buffer_load_dwordx4 v[96:99], v5, s[64:67], s88 offen offset:0
    buffer_load_dwordx4 v[100:103], v5, s[64:67], s88 offen offset:1024
    buffer_load_dwordx4 v[104:107], v5, s[64:67], s88 offen offset:2048
    buffer_load_dwordx4 v[108:111], v5, s[64:67], s88 offen offset:3072
    s_add_u32 s88, s87, 8192
    buffer_load_dwordx4 v[112:115], v5, s[64:67], s88 offen offset:0
    buffer_load_dwordx4 v[116:119], v5, s[64:67], s88 offen offset:1024
    buffer_load_dwordx4 v[120:123], v5, s[64:67], s88 offen offset:2048
    buffer_load_dwordx4 v[124:127], v5, s[64:67], s88 offen offset:3072
    s_add_u32 s88, s87, 12288
    buffer_load_dwordx4 v[128:131], v5, s[64:67], s88 offen offset:0
    buffer_load_dwordx4 v[132:135], v5, s[64:67], s88 offen offset:1024
    buffer_load_dwordx4 v[136:139], v5, s[64:67], s88 offen offset:2048
    buffer_load_dwordx4 v[140:143], v5, s[64:67], s88 offen offset:3072
    s_add_u32 s88, s87, 16384
    buffer_load_dwordx4 v[144:147], v5, s[64:67], s88 offen offset:0
    buffer_load_dwordx4 v[148:151], v5, s[64:67], s88 offen offset:1024
    buffer_load_dwordx4 v[152:155], v5, s[64:67], s88 offen offset:2048
    buffer_load_dwordx4 v[156:159], v5, s[64:67], s88 offen offset:3072
    s_add_u32 s88, s87, 20480
    buffer_load_dwordx4 v[160:163], v5, s[64:67], s88 offen offset:0
    buffer_load_dwordx4 v[164:167], v5, s[64:67], s88 offen offset:1024
    buffer_load_dwordx4 v[168:171], v5, s[64:67], s88 offen offset:2048
    buffer_load_dwordx4 v[172:175], v5, s[64:67], s88 offen offset:3072
    s_add_u32 s88, s87, 24576
    buffer_load_dwordx4 v[240:243], v5, s[64:67], s88 offen offset:0
    buffer_load_dwordx4 v[244:247], v5, s[64:67], s88 offen offset:1024
    buffer_load_dwordx4 v[248:251], v5, s[64:67], s88 offen offset:2048
    s_mov_b32 s89, s2
    s_branch S2_194
N7_196:
LW_210:
    ds_read_b32 v1, v2 offset:2100
    s_waitcnt lgkmcnt(0)
    v_readfirstlane_b32 s73, v1
    s_cmp_ge_u32 s73, 1
    s_cbranch_scc1 LWD_211
    s_sleep 6
    s_sub_u32 s72, s72, 1
    s_cbranch_scc0 LW_210
    s_branch L_bail
LWD_211:
LW_212:
    ds_read_b32 v1, v2 offset:2144
    s_waitcnt lgkmcnt(0)
    v_readfirstlane_b32 s73, v1
    s_cmp_ge_u32 s73, 4
    s_cbranch_scc1 LWD_213
    s_sleep 4
    s_sub_u32 s72, s72, 1
    s_cbranch_scc0 LW_212
    s_branch L_bail
LWD_213:
    s_cmp_eq_u32 s68, 6
    s_cbranch_scc1 TB_198
    s_add_u32 s89, s2, 192
    s_sub_u32 s73, s2, 64
    s_cmp_gt_u32 s73, 32
    s_cbranch_scc1 NW_199
TB_198:
    s_getpc_b64 s[64:65]
    s_add_u32 s64, s64, spectral_tables@rel32@lo+4
    s_addc_u32 s65, s65, spectral_tables@rel32@hi+12
    s_mov_b32 s66, 100352
    s_mov_b32 s67, 0x20000
    v_lshlrev_b32 v5, 4, v0
    s_and_b32 s86, s68, 1
    s_mul_i32 s87, s86, 50176
    s_add_u32 s88, s87, 0
    buffer_load_dwordx4 v[80:83], v5, s[64:67], s88 offen offset:0
    buffer_load_dwordx4 v[84:87], v5, s[64:67], s88 offen offset:1024
    buffer_load_dwordx4 v[88:91], v5, s[64:67], s88 offen offset:2048
    buffer_load_dwordx4 v[92:95], v5, s[64:67], s88 offen offset:3072
    s_add_u32 s88, s87, 4096
    buffer_load_dwordx4 v[96:99], v5, s[64:67], s88 offen offset:0
    buffer_load_dwordx4 v[100:103], v5, s[64:67], s88 offen offset:1024
    buffer_load_dwordx4 v[104:107], v5, s[64:67], s88 offen offset:2048
    buffer_load_dwordx4 v[108:111], v5, s[64:67], s88 offen offset:3072
    s_add_u32 s88, s87, 8192
    buffer_load_dwordx4 v[112:115], v5, s[64:67], s88 offen offset:0
    buffer_load_dwordx4 v[116:119], v5, s[64:67], s88 offen offset:1024
    buffer_load_dwordx4 v[120:123], v5, s[64:67], s88 offen offset:2048
    buffer_load_dwordx4 v[124:127], v5, s[64:67], s88 offen offset:3072
    s_add_u32 s88, s87, 12288
    buffer_load_dwordx4 v[128:131], v5, s[64:67], s88 offen offset:0
    buffer_load_dwordx4 v[132:135], v5, s[64:67], s88 offen offset:1024
    buffer_load_dwordx4 v[136:139], v5, s[64:67], s88 offen offset:2048
    buffer_load_dwordx4 v[140:143], v5, s[64:67], s88 offen offset:3072
    s_add_u32 s88, s87, 16384
    buffer_load_dwordx4 v[144:147], v5, s[64:67], s88 offen offset:0
    buffer_load_dwordx4 v[148:151], v5, s[64:67], s88 offen offset:1024
    buffer_load_dwordx4 v[152:155], v5, s[64:67], s88 offen offset:2048
    buffer_load_dwordx4 v[156:159], v5, s[64:67], s88 offen offset:3072
    s_add_u32 s88, s87, 20480
    buffer_load_dwordx4 v[160:163], v5, s[64:67], s88 offen offset:0
    buffer_load_dwordx4 v[164:167], v5, s[64:67], s88 offen offset:1024
    buffer_load_dwordx4 v[168:171], v5, s[64:67], s88 offen offset:2048
    buffer_load_dwordx4 v[172:175], v5, s[64:67], s88 offen offset:3072
    s_add_u32 s88, s87, 24576
    buffer_load_dwordx4 v[240:243], v5, s[64:67], s88 offen offset:0
    buffer_load_dwordx4 v[244:247], v5, s[64:67], s88 offen offset:1024
    buffer_load_dwordx4 v[248:251], v5, s[64:67], s88 offen offset:2048
S2_194:
    s_getpc_b64 s[64:65]
    s_add_u32 s64, s64, spectral_tables@rel32@lo+4
    s_addc_u32 s65, s65, spectral_tables@rel32@hi+12
    s_mov_b32 s66, 100352
    s_mov_b32 s67, 0x20000
    v_lshlrev_b32 v5, 4, v0
    s_and_b32 s86, s68, 1
    s_mul_i32 s87, s86, 50176
    s_add_u32 s88, s87, 24576
    buffer_load_dwordx4 v[16:19], v5, s[64:67], s88 offen offset:3072
    s_add_u32 s88, s87, 28672
    buffer_load_dwordx4 v[20:23], v5, s[64:67], s88 offen offset:0
    buffer_load_dwordx4 v[24:27], v5, s[64:67], s88 offen offset:1024
    buffer_load_dwordx4 v[28:31], v5, s[64:67], s88 offen offset:2048
    buffer_load_dwordx4 v[32:35], v5, s[64:67], s88 offen offset:3072
    s_add_u32 s88, s87, 32768
    buffer_load_dwordx4 v[36:39], v5, s[64:67], s88 offen offset:0
    buffer_load_dwordx4 v[40:43], v5, s[64:67], s88 offen offset:1024
    buffer_load_dwordx4 v[44:47], v5, s[64:67], s88 offen offset:2048
    v_and_b32 v6, 15, v0
    v_lshlrev_b32 v6, 6, v6
    v_lshrrev_b32 v7, 4, v0
    v_lshl_add_u32 v6, v7, 4, v6
    s_mul_i32 s90, s89, 8448
    s_add_u32 s91, s90, 4224
    s_cmp_eq_u32 s89, 288
    s_cmov_b32 s90, 4224
    s_cmov_b32 s91, 1073741824
    s_cmp_eq_u32 s89, 0
    s_cmov_b32 s91, 1073741824
    s_lshl_b32 s73, s86, 11
    s_add_u32 s90, s90, s73
    s_add_u32 s91, s91, s73
    s_lshl_b32 s85, s86, 12
    s_sub_u32 s85, 2048, s85
    s_lshr_b32 s73, s68, 1
    s_and_b32 s73, s73, 1
    s_xor_b32 s73, s73, 1
    s_lshl_b32 s99, s73, 2
    s_lshl_b32 s73, s73, 12
    s_lshl_b32 s84, s86, 11
    s_add_u32 s73, s73, s84
    s_add_u32 s73, s73, 137216
    v_add_u32 v7, s73, v5
    s_sub_u32 s73, s73, s84
    s_xor_b32 s84, s84, 0x800
    s_add_u32 s84, s84, s73
    s_cmp_lg_u32 s68, 7
    s_cbranch_scc1 GO_216
    s_lshr_b32 s73, s2, 3
    s_cmp_lg_u32 s73, 16
    s_cbranch_scc1 GC_214
    v_lshlrev_b32 v8, 7, v0
    s_mov_b32 s92, 360448
    s_sleep 0
PL_218:
    buffer_load_dwordx4 v[12:15], v8, s[44:47], s92 offen sc1
    s_waitcnt vmcnt(0)
    v_cmp_ne_u32 vcc, s71, v12
    v_cmp_ne_u32 s[74:75], s71, v13
    s_or_b64 vcc, vcc, s[74:75]
    v_cmp_ne_u32 s[74:75], s71, v14
    s_or_b64 vcc, vcc, s[74:75]
    v_cmp_ne_u32 s[74:75], s71, v15
    s_or_b64 vcc, vcc, s[74:75]
    s_cmp_eq_u64 vcc, 0
    s_cbranch_scc1 PD_219
    s_sleep 4
    s_sub_u32 s72, s72, 1
    s_cbranch_scc0 PL_218
    s_branch L_bail
PD_219:
    s_and_b32 s92, s2, 7
    s_lshl_b32 s92, s92, 7
    s_add_u32 s92, s92, 425984
    v_mov_b32 v1, s71
    s_mov_b64 exec, 1
    buffer_store_dword v1, off, s[44:47], s92 sc1
    s_mov_b64 exec, -1
    s_branch CG_215
GC_214:
    s_sleep 16
    s_and_b32 s92, s2, 7
    s_lshl_b32 s92, s92, 7
    s_add_u32 s92, s92, 425984
PL_220:
    s_mov_b64 exec, 1
    buffer_load_dword v252, off, s[44:47], s92 sc1
    s_waitcnt vmcnt(0)
    v_readfirstlane_b32 s73, v252
    s_mov_b64 exec, -1
    s_nop 0
    v_mov_b32 v252, s73
    s_waitcnt vmcnt(0)
    v_cmp_ne_u32 vcc, s71, v252
    s_cmp_eq_u64 vcc, 0
    s_cbranch_scc1 PD_221
    s_sleep 8
    s_sub_u32 s72, s72, 1
    s_cbranch_scc0 PL_220
    s_branch L_bail
PD_221:
CG_215:
    s_mov_b64 exec, 1
    ds_add_u32 v2, v3 offset:2112
    s_mov_b64 exec, -1
    s_branch GD_217
GO_216:
LW_222:
    ds_read_b32 v1, v2 offset:2112
    s_waitcnt lgkmcnt(0)
    v_readfirstlane_b32 s73, v1
    s_cmp_ge_u32 s73, 1
    s_cbranch_scc1 LWD_223
    s_sleep 2
    s_sub_u32 s72, s72, 1
    s_cbranch_scc0 LW_222
    s_branch L_bail
LWD_223:
    s_waitcnt vmcnt(0)
GD_217:
    s_add_u32 s92, s90, 2097152
    s_add_u32 s93, s91, 2097152
    s_add_u32 s82, s92, s85
    s_add_u32 s83, s93, s85
    buffer_load_dwordx4 v[208:211], v6, s[44:47], s92 offen offset:0 sc1
    buffer_load_dwordx4 v[212:215], v6, s[44:47], s93 offen offset:0 sc1
    buffer_load_dwordx4 v[216:219], v6, s[44:47], s92 offen offset:1024 sc1
    buffer_load_dwordx4 v[220:223], v6, s[44:47], s93 offen offset:1024 sc1
    buffer_load_dwordx4 v[224:227], v6, s[44:47], s82 offen offset:0 sc1
    buffer_load_dwordx4 v[228:231], v6, s[44:47], s83 offen offset:0 sc1
    buffer_load_dwordx4 v[232:235], v6, s[44:47], s82 offen offset:1024 sc1
    buffer_load_dwordx4 v[236:239], v6, s[44:47], s83 offen offset:1024 sc1
    s_waitcnt vmcnt(6)
    v_mfma_f32_16x16x32_bf16 v[48:51], v[208:211], v[240:243], 0
    v_mfma_f32_16x16x32_bf16 v[52:55], v[208:211], v[244:247], 0
    v_mfma_f32_16x16x32_bf16 v[48:51], v[212:215], v[248:251], v[48:51]
    v_mfma_f32_16x16x32_bf16 v[52:55], v[212:215], v[240:243], v[52:55]
    s_waitcnt vmcnt(4)
    v_mfma_f32_16x16x32_bf16 v[56:59], v[216:219], v[240:243], 0
    v_mfma_f32_16x16x32_bf16 v[60:63], v[216:219], v[244:247], 0
    v_mfma_f32_16x16x32_bf16 v[56:59], v[220:223], v[248:251], v[56:59]
    v_mfma_f32_16x16x32_bf16 v[60:63], v[220:223], v[240:243], v[60:63]
    s_waitcnt vmcnt(2)
    v_mfma_f32_16x16x32_bf16 v[64:67], v[224:227], v[240:243], 0
    v_mfma_f32_16x16x32_bf16 v[68:71], v[224:227], v[244:247], 0
    v_mfma_f32_16x16x32_bf16 v[64:67], v[228:231], v[248:251], v[64:67]
    v_mfma_f32_16x16x32_bf16 v[68:71], v[228:231], v[240:243], v[68:71]
    s_waitcnt vmcnt(0)
    v_mfma_f32_16x16x32_bf16 v[72:75], v[232:235], v[240:243], 0
    v_mfma_f32_16x16x32_bf16 v[76:79], v[232:235], v[244:247], 0
    v_mfma_f32_16x16x32_bf16 v[72:75], v[236:239], v[248:251], v[72:75]
    v_mfma_f32_16x16x32_bf16 v[76:79], v[236:239], v[240:243], v[76:79]
    s_mul_i32 s92, s89, 8320
    s_lshl_b32 s73, s86, 12
    s_add_u32 s92, s92, s73
    s_lshl_b32 s73, s86, 11
    s_add_u32 s92, s92, s73
    s_add_u32 s92, s92, 11534336
    s_add_u32 s82, s92, s85
    buffer_load_dwordx4 v[212:215], v5, s[44:47], s92 offen offset:0 sc1
    buffer_load_dwordx4 v[220:223], v5, s[44:47], s92 offen offset:1024 sc1
    buffer_load_dwordx4 v[228:231], v5, s[44:47], s82 offen offset:0 sc1
    buffer_load_dwordx4 v[236:239], v5, s[44:47], s82 offen offset:1024 sc1
    v_pk_mul_f32 v[8:9], v[48:49], v[16:17]
    v_pk_mul_f32 v[10:11], v[48:49], v[20:21]
    v_pk_mul_f32 v[12:13], v[50:51], v[18:19]
    v_pk_mul_f32 v[14:15], v[50:51], v[22:23]
    v_pk_fma_f32 v[8:9], v[52:53], v[20:21], v[8:9] neg_lo:[1,0,0] neg_hi:[1,0,0]
    v_pk_fma_f32 v[10:11], v[52:53], v[16:17], v[10:11]
    v_pk_fma_f32 v[12:13], v[54:55], v[22:23], v[12:13] neg_lo:[1,0,0] neg_hi:[1,0,0]
    v_pk_fma_f32 v[14:15], v[54:55], v[18:19], v[14:15]
    v_cvt_pk_bf16_f32 v240, v8, v9
    v_cvt_pk_bf16_f32 v248, v10, v11
    v_cvt_pk_bf16_f32 v241, v12, v13
    v_cvt_pk_bf16_f32 v249, v14, v15
    v_pk_mul_f32 v[8:9], v[56:57], v[24:25]
    v_pk_mul_f32 v[10:11], v[56:57], v[28:29]
    v_pk_mul_f32 v[12:13], v[58:59], v[26:27]
    v_pk_mul_f32 v[14:15], v[58:59], v[30:31]
    v_pk_fma_f32 v[8:9], v[60:61], v[28:29], v[8:9] neg_lo:[1,0,0] neg_hi:[1,0,0]
    v_pk_fma_f32 v[10:11], v[60:61], v[24:25], v[10:11]
    v_pk_fma_f32 v[12:13], v[62:63], v[30:31], v[12:13] neg_lo:[1,0,0] neg_hi:[1,0,0]
    v_pk_fma_f32 v[14:15], v[62:63], v[26:27], v[14:15]
    v_cvt_pk_bf16_f32 v242, v8, v9
    v_cvt_pk_bf16_f32 v250, v10, v11
    v_cvt_pk_bf16_f32 v243, v12, v13
    v_cvt_pk_bf16_f32 v251, v14, v15
    v_pk_mul_f32 v[8:9], v[64:65], v[32:33]
    v_pk_mul_f32 v[10:11], v[64:65], v[36:37]
    v_pk_mul_f32 v[12:13], v[66:67], v[34:35]
    v_pk_mul_f32 v[14:15], v[66:67], v[38:39]
    v_pk_fma_f32 v[8:9], v[68:69], v[36:37], v[8:9] neg_lo:[1,0,0] neg_hi:[1,0,0]
    v_pk_fma_f32 v[10:11], v[68:69], v[32:33], v[10:11]
    v_pk_fma_f32 v[12:13], v[70:71], v[38:39], v[12:13] neg_lo:[1,0,0] neg_hi:[1,0,0]
    v_pk_fma_f32 v[14:15], v[70:71], v[34:35], v[14:15]
    v_cvt_pk_bf16_f32 v244, v8, v9
    v_cvt_pk_bf16_f32 v252, v10, v11
    v_cvt_pk_bf16_f32 v245, v12, v13
    v_cvt_pk_bf16_f32 v253, v14, v15
    v_pk_mul_f32 v[8:9], v[72:73], v[40:41]
    v_pk_mul_f32 v[10:11], v[72:73], v[44:45]
    v_pk_mul_f32 v[12:13], v[74:75], v[42:43]
    v_pk_mul_f32 v[14:15], v[74:75], v[46:47]
    v_pk_fma_f32 v[8:9], v[76:77], v[44:45], v[8:9] neg_lo:[1,0,0] neg_hi:[1,0,0]
    v_pk_fma_f32 v[10:11], v[76:77], v[40:41], v[10:11]
    v_pk_fma_f32 v[12:13], v[78:79], v[46:47], v[12:13] neg_lo:[1,0,0] neg_hi:[1,0,0]
    v_pk_fma_f32 v[14:15], v[78:79], v[42:43], v[14:15]
    v_cvt_pk_bf16_f32 v246, v8, v9
    v_cvt_pk_bf16_f32 v254, v10, v11
    v_cvt_pk_bf16_f32 v247, v12, v13
    v_cvt_pk_bf16_f32 v255, v14, v15
    s_add_u32 s88, s87, 32768
    buffer_load_dwordx4 v[16:19], v5, s[64:67], s88 offen offset:3072
    s_add_u32 s88, s87, 36864
    buffer_load_dwordx4 v[20:23], v5, s[64:67], s88 offen offset:0
    buffer_load_dwordx4 v[24:27], v5, s[64:67], s88 offen offset:1024
    buffer_load_dwordx4 v[28:31], v5, s[64:67], s88 offen offset:2048
    buffer_load_dwordx4 v[32:35], v5, s[64:67], s88 offen offset:3072
    s_add_u32 s88, s87, 40960
    buffer_load_dwordx4 v[36:39], v5, s[64:67], s88 offen offset:0
    buffer_load_dwordx4 v[40:43], v5, s[64:67], s88 offen offset:1024
    buffer_load_dwordx4 v[44:47], v5, s[64:67], s88 offen offset:2048
    v_mfma_f32_16x16x32_bf16 v[176:179], v[80:83], v[240:243], 0
    v_mfma_f32_16x16x32_bf16 v[180:183], v[112:115], v[240:243], 0
    v_mfma_f32_16x16x32_bf16 v[176:179], v[84:87], v[244:247], v[176:179]
    v_mfma_f32_16x16x32_bf16 v[180:183], v[116:119], v[244:247], v[180:183]
    v_mfma_f32_16x16x32_bf16 v[176:179], v[144:147], v[248:251], v[176:179]
    v_mfma_f32_16x16x32_bf16 v[180:183], v[80:83], v[248:251], v[180:183]
    v_mfma_f32_16x16x32_bf16 v[176:179], v[148:151], v[252:255], v[176:179]
    v_mfma_f32_16x16x32_bf16 v[180:183], v[84:87], v[252:255], v[180:183]
    v_mfma_f32_16x16x32_bf16 v[184:187], v[88:91], v[240:243], 0
    v_mfma_f32_16x16x32_bf16 v[188:191], v[120:123], v[240:243], 0
    v_mfma_f32_16x16x32_bf16 v[184:187], v[92:95], v[244:247], v[184:187]
    v_mfma_f32_16x16x32_bf16 v[188:191], v[124:127], v[244:247], v[188:191]
    v_mfma_f32_16x16x32_bf16 v[184:187], v[152:155], v[248:251], v[184:187]
    v_mfma_f32_16x16x32_bf16 v[188:191], v[88:91], v[248:251], v[188:191]
    v_mfma_f32_16x16x32_bf16 v[184:187], v[156:159], v[252:255], v[184:187]
    v_mfma_f32_16x16x32_bf16 v[188:191], v[92:95], v[252:255], v[188:191]
    v_mfma_f32_16x16x32_bf16 v[192:195], v[96:99], v[240:243], 0
    v_mfma_f32_16x16x32_bf16 v[196:199], v[128:131], v[240:243], 0
    v_mfma_f32_16x16x32_bf16 v[192:195], v[100:103], v[244:247], v[192:195]
    v_mfma_f32_16x16x32_bf16 v[196:199], v[132:135], v[244:247], v[196:199]
    v_mfma_f32_16x16x32_bf16 v[192:195], v[160:163], v[248:251], v[192:195]
    v_mfma_f32_16x16x32_bf16 v[196:199], v[96:99], v[248:251], v[196:199]
    v_mfma_f32_16x16x32_bf16 v[192:195], v[164:167], v[252:255], v[192:195]
    v_mfma_f32_16x16x32_bf16 v[196:199], v[100:103], v[252:255], v[196:199]
    v_mfma_f32_16x16x32_bf16 v[200:203], v[104:107], v[240:243], 0
    v_mfma_f32_16x16x32_bf16 v[204:207], v[136:139], v[240:243], 0
    v_mfma_f32_16x16x32_bf16 v[200:203], v[108:111], v[244:247], v[200:203]
    v_mfma_f32_16x16x32_bf16 v[204:207], v[140:143], v[244:247], v[204:207]
    v_mfma_f32_16x16x32_bf16 v[200:203], v[168:171], v[248:251], v[200:203]
    v_mfma_f32_16x16x32_bf16 v[204:207], v[104:107], v[248:251], v[204:207]
    v_mfma_f32_16x16x32_bf16 v[200:203], v[172:175], v[252:255], v[200:203]
    v_mfma_f32_16x16x32_bf16 v[204:207], v[108:111], v[252:255], v[204:207]
    s_waitcnt vmcnt(8)
    v_lshlrev_b32 v208, 16, v212
    v_and_b32 v209, 0xffff0000, v212
    v_lshlrev_b32 v210, 16, v213
    v_and_b32 v211, 0xffff0000, v213
    v_and_b32 v213, 0xffff0000, v214
    v_lshlrev_b32 v212, 16, v214
    v_lshlrev_b32 v214, 16, v215
    v_and_b32 v215, 0xffff0000, v215
    v_lshlrev_b32 v216, 16, v220
    v_and_b32 v217, 0xffff0000, v220
    v_lshlrev_b32 v218, 16, v221
    v_and_b32 v219, 0xffff0000, v221
    v_and_b32 v221, 0xffff0000, v222
    v_lshlrev_b32 v220, 16, v222
    v_lshlrev_b32 v222, 16, v223
    v_and_b32 v223, 0xffff0000, v223
    v_lshlrev_b32 v224, 16, v228
    v_and_b32 v225, 0xffff0000, v228
    v_lshlrev_b32 v226, 16, v229
    v_and_b32 v227, 0xffff0000, v229
    v_and_b32 v229, 0xffff0000, v230
    v_lshlrev_b32 v228, 16, v230
    v_lshlrev_b32 v230, 16, v231
    v_and_b32 v231, 0xffff0000, v231
    v_lshlrev_b32 v232, 16, v236
    v_and_b32 v233, 0xffff0000, v236
    v_lshlrev_b32 v234, 16, v237
    v_and_b32 v235, 0xffff0000, v237
    v_and_b32 v237, 0xffff0000, v238
    v_lshlrev_b32 v236, 16, v238
    v_lshlrev_b32 v238, 16, v239
    v_and_b32 v239, 0xffff0000, v239
    v_pk_mul_f32 v[8:9], v[176:177], v[208:209]
    v_pk_mul_f32 v[10:11], v[176:177], v[212:213]
    v_pk_mul_f32 v[12:13], v[178:179], v[210:211]
    v_pk_mul_f32 v[14:15], v[178:179], v[214:215]
    v_pk_fma_f32 v[8:9], v[180:181], v[212:213], v[8:9] neg_lo:[1,0,0] neg_hi:[1,0,0]
    v_pk_fma_f32 v[10:11], v[180:181], v[208:209], v[10:11]
    v_pk_fma_f32 v[12:13], v[182:183], v[214:215], v[12:13] neg_lo:[1,0,0] neg_hi:[1,0,0]
    v_pk_fma_f32 v[14:15], v[182:183], v[210:211], v[14:15]
    v_cvt_pk_bf16_f32 v240, v8, v9
    v_cvt_pk_bf16_f32 v248, v10, v11
    v_cvt_pk_bf16_f32 v241, v12, v13
    v_cvt_pk_bf16_f32 v249, v14, v15
    v_pk_mul_f32 v[8:9], v[184:185], v[216:217]
    v_pk_mul_f32 v[10:11], v[184:185], v[220:221]
    v_pk_mul_f32 v[12:13], v[186:187], v[218:219]
    v_pk_mul_f32 v[14:15], v[186:187], v[222:223]
    v_pk_fma_f32 v[8:9], v[188:189], v[220:221], v[8:9] neg_lo:[1,0,0] neg_hi:[1,0,0]
    v_pk_fma_f32 v[10:11], v[188:189], v[216:217], v[10:11]
    v_pk_fma_f32 v[12:13], v[190:191], v[222:223], v[12:13] neg_lo:[1,0,0] neg_hi:[1,0,0]
    v_pk_fma_f32 v[14:15], v[190:191], v[218:219], v[14:15]
    v_cvt_pk_bf16_f32 v242, v8, v9
    v_cvt_pk_bf16_f32 v250, v10, v11
    v_cvt_pk_bf16_f32 v243, v12, v13
    v_cvt_pk_bf16_f32 v251, v14, v15
    v_pk_mul_f32 v[8:9], v[192:193], v[224:225]
    v_pk_mul_f32 v[10:11], v[192:193], v[228:229]
    v_pk_mul_f32 v[12:13], v[194:195], v[226:227]
    v_pk_mul_f32 v[14:15], v[194:195], v[230:231]
    v_pk_fma_f32 v[8:9], v[196:197], v[228:229], v[8:9] neg_lo:[1,0,0] neg_hi:[1,0,0]
    v_pk_fma_f32 v[10:11], v[196:197], v[224:225], v[10:11]
    v_pk_fma_f32 v[12:13], v[198:199], v[230:231], v[12:13] neg_lo:[1,0,0] neg_hi:[1,0,0]
    v_pk_fma_f32 v[14:15], v[198:199], v[226:227], v[14:15]
    v_cvt_pk_bf16_f32 v244, v8, v9
    v_cvt_pk_bf16_f32 v252, v10, v11
    v_cvt_pk_bf16_f32 v245, v12, v13
    v_cvt_pk_bf16_f32 v253, v14, v15
    v_pk_mul_f32 v[8:9], v[200:201], v[232:233]
    v_pk_mul_f32 v[10:11], v[200:201], v[236:237]
    v_pk_mul_f32 v[12:13], v[202:203], v[234:235]
    v_pk_mul_f32 v[14:15], v[202:203], v[238:239]
    v_pk_fma_f32 v[8:9], v[204:205], v[236:237], v[8:9] neg_lo:[1,0,0] neg_hi:[1,0,0]
    v_pk_fma_f32 v[10:11], v[204:205], v[232:233], v[10:11]
    v_pk_fma_f32 v[12:13], v[206:207], v[238:239], v[12:13] neg_lo:[1,0,0] neg_hi:[1,0,0]
    v_pk_fma_f32 v[14:15], v[206:207], v[234:235], v[14:15]
    v_cvt_pk_bf16_f32 v246, v8, v9
    v_cvt_pk_bf16_f32 v254, v10, v11
    v_cvt_pk_bf16_f32 v247, v12, v13
    v_cvt_pk_bf16_f32 v255, v14, v15
    buffer_load_dwordx4 v[208:211], v5, s[64:67], s88 offen offset:3072
    s_add_u32 s88, s87, 45056
    buffer_load_dwordx4 v[212:215], v5, s[64:67], s88 offen offset:0
    buffer_load_dwordx4 v[216:219], v5, s[64:67], s88 offen offset:1024
    buffer_load_dwordx4 v[220:223], v5, s[64:67], s88 offen offset:2048
    buffer_load_dwordx4 v[224:227], v5, s[64:67], s88 offen offset:3072
    s_add_u32 s88, s87, 49152
    buffer_load_dwordx4 v[228:231], v5, s[64:67], s88 offen offset:0
    v_mfma_f32_16x16x32_bf16 v[64:67], v[240:243], v[96:99], 0
    v_mfma_f32_16x16x32_bf16 v[68:71], v[248:251], v[96:99], 0
    v_mfma_f32_16x16x32_bf16 v[64:67], v[244:247], v[100:103], v[64:67]
    v_mfma_f32_16x16x32_bf16 v[68:71], v[252:255], v[100:103], v[68:71]
    v_mfma_f32_16x16x32_bf16 v[64:67], v[248:251], v[128:131], v[64:67]
    v_mfma_f32_16x16x32_bf16 v[68:71], v[240:243], v[160:163], v[68:71]
    v_mfma_f32_16x16x32_bf16 v[64:67], v[252:255], v[132:135], v[64:67]
    v_mfma_f32_16x16x32_bf16 v[68:71], v[244:247], v[164:167], v[68:71]
    v_mfma_f32_16x16x32_bf16 v[72:75], v[240:243], v[104:107], 0
    v_mfma_f32_16x16x32_bf16 v[76:79], v[248:251], v[104:107], 0
    v_mfma_f32_16x16x32_bf16 v[72:75], v[244:247], v[108:111], v[72:75]
    v_mfma_f32_16x16x32_bf16 v[76:79], v[252:255], v[108:111], v[76:79]
    v_mfma_f32_16x16x32_bf16 v[72:75], v[248:251], v[136:139], v[72:75]
    v_mfma_f32_16x16x32_bf16 v[76:79], v[240:243], v[168:171], v[76:79]
    v_mfma_f32_16x16x32_bf16 v[72:75], v[252:255], v[140:143], v[72:75]
    v_mfma_f32_16x16x32_bf16 v[76:79], v[244:247], v[172:175], v[76:79]
    v_mfma_f32_16x16x32_bf16 v[48:51], v[240:243], v[80:83], 0
    v_mfma_f32_16x16x32_bf16 v[52:55], v[248:251], v[80:83], 0
    v_mfma_f32_16x16x32_bf16 v[48:51], v[244:247], v[84:87], v[48:51]
    v_mfma_f32_16x16x32_bf16 v[52:55], v[252:255], v[84:87], v[52:55]
    v_mfma_f32_16x16x32_bf16 v[48:51], v[248:251], v[112:115], v[48:51]
    v_mfma_f32_16x16x32_bf16 v[52:55], v[240:243], v[144:147], v[52:55]
    v_mfma_f32_16x16x32_bf16 v[48:51], v[252:255], v[116:119], v[48:51]
    v_mfma_f32_16x16x32_bf16 v[52:55], v[244:247], v[148:151], v[52:55]
    v_mfma_f32_16x16x32_bf16 v[56:59], v[240:243], v[88:91], 0
    v_mfma_f32_16x16x32_bf16 v[60:63], v[248:251], v[88:91], 0
    v_mfma_f32_16x16x32_bf16 v[56:59], v[244:247], v[92:95], v[56:59]
    v_mfma_f32_16x16x32_bf16 v[60:63], v[252:255], v[92:95], v[60:63]
    v_mfma_f32_16x16x32_bf16 v[56:59], v[248:251], v[120:123], v[56:59]
    v_mfma_f32_16x16x32_bf16 v[60:63], v[240:243], v[152:155], v[60:63]
    v_mfma_f32_16x16x32_bf16 v[56:59], v[252:255], v[124:127], v[56:59]
    v_mfma_f32_16x16x32_bf16 v[60:63], v[244:247], v[156:159], v[60:63]
    v_add_u32 v160, s99, v2
    v_and_b32 v84, 31, v0
    v_lshrrev_b32 v85, 5, v0
    v_lshlrev_b32 v82, 5, v84
    v_lshl_add_u32 v82, v85, 4, v82
    v_mov_b32 v86, 1073741824
    v_lshlrev_b32 v83, 2, v0
    v_subrev_u32 v87, 64, v82
    v_cmp_eq_u32 vcc, 20, v84
    s_and_b32 s73, s68, 3
    s_nop 0
    v_cndmask_b32 v87, v86, v87, vcc
    v_cmp_gt_u32 vcc, 18, v84
    s_lshl_b32 s96, s73, 14
    s_nop 0
    v_cndmask_b32 v4, v87, v82, vcc
    s_add_u32 s96, s96, 65536
    s_lshl_b32 s97, s73, 11
    s_add_u32 s97, s97, 131072
    s_mul_i32 s98, s73, 20480
    s_add_u32 s98, s98, 196608
    buffer_load_dword v120, v83, s[44:47], s97 offen offset:0 sc1
    buffer_load_dword v121, v83, s[44:47], s97 offen offset:256 sc1
    buffer_load_dword v122, v83, s[44:47], s97 offen offset:512 sc1
    buffer_load_dword v123, v83, s[44:47], s97 offen offset:768 sc1
    buffer_load_dwordx4 v[88:91], v82, s[44:47], s96 offen offset:0 sc1
    buffer_load_dwordx4 v[128:131], v4, s[44:47], s98 offen offset:0 sc1
    buffer_load_dwordx4 v[132:135], v4, s[44:47], s98 offen offset:640 sc1
    buffer_load_dwordx4 v[92:95], v82, s[44:47], s96 offen offset:1024 sc1
    buffer_load_dwordx4 v[136:139], v4, s[44:47], s98 offen offset:1280 sc1
    buffer_load_dwordx4 v[140:143], v4, s[44:47], s98 offen offset:1920 sc1
    s_add_u32 s98, s98, 2560
    buffer_load_dwordx4 v[96:99], v82, s[44:47], s96 offen offset:2048 sc1
    buffer_load_dwordx4 v[144:147], v4, s[44:47], s98 offen offset:0 sc1
    buffer_load_dwordx4 v[148:151], v4, s[44:47], s98 offen offset:640 sc1
    buffer_load_dwordx4 v[100:103], v82, s[44:47], s96 offen offset:3072 sc1
    s_add_u32 s96, s96, 4096
    buffer_load_dwordx4 v[152:155], v4, s[44:47], s98 offen offset:1280 sc1
    buffer_load_dwordx4 v[156:159], v4, s[44:47], s98 offen offset:1920 sc1
    s_add_u32 s98, s98, 2560
    s_waitcnt vmcnt(22)
    v_pk_mul_f32 v[8:9], v[48:49], v[16:17]
    v_pk_mul_f32 v[10:11], v[48:49], v[20:21]
    v_pk_mul_f32 v[12:13], v[50:51], v[18:19]
    v_pk_mul_f32 v[14:15], v[50:51], v[22:23]
    v_pk_fma_f32 v[8:9], v[52:53], v[20:21], v[8:9] neg_lo:[1,0,0] neg_hi:[1,0,0]
    v_pk_fma_f32 v[10:11], v[52:53], v[16:17], v[10:11]
    v_pk_fma_f32 v[12:13], v[54:55], v[22:23], v[12:13] neg_lo:[1,0,0] neg_hi:[1,0,0]
    v_pk_fma_f32 v[14:15], v[54:55], v[18:19], v[14:15]
    v_cvt_pk_bf16_f32 v240, v8, v9
    v_cvt_pk_bf16_f32 v244, v10, v11
    v_cvt_pk_bf16_f32 v241, v12, v13
    v_cvt_pk_bf16_f32 v245, v14, v15
    v_pk_mul_f32 v[8:9], v[56:57], v[24:25]
    v_pk_mul_f32 v[10:11], v[56:57], v[28:29]
    v_pk_mul_f32 v[12:13], v[58:59], v[26:27]
    v_pk_mul_f32 v[14:15], v[58:59], v[30:31]
    v_pk_fma_f32 v[8:9], v[60:61], v[28:29], v[8:9] neg_lo:[1,0,0] neg_hi:[1,0,0]
    v_pk_fma_f32 v[10:11], v[60:61], v[24:25], v[10:11]
    v_pk_fma_f32 v[12:13], v[62:63], v[30:31], v[12:13] neg_lo:[1,0,0] neg_hi:[1,0,0]
    v_pk_fma_f32 v[14:15], v[62:63], v[26:27], v[14:15]
    v_cvt_pk_bf16_f32 v248, v8, v9
    v_cvt_pk_bf16_f32 v252, v10, v11
    v_cvt_pk_bf16_f32 v249, v12, v13
    v_cvt_pk_bf16_f32 v253, v14, v15
    v_pk_mul_f32 v[8:9], v[64:65], v[32:33]
    v_pk_mul_f32 v[10:11], v[64:65], v[36:37]
    v_pk_mul_f32 v[12:13], v[66:67], v[34:35]
    v_pk_mul_f32 v[14:15], v[66:67], v[38:39]
    v_pk_fma_f32 v[8:9], v[68:69], v[36:37], v[8:9] neg_lo:[1,0,0] neg_hi:[1,0,0]
    v_pk_fma_f32 v[10:11], v[68:69], v[32:33], v[10:11]
    v_pk_fma_f32 v[12:13], v[70:71], v[38:39], v[12:13] neg_lo:[1,0,0] neg_hi:[1,0,0]
    v_pk_fma_f32 v[14:15], v[70:71], v[34:35], v[14:15]
    v_cvt_pk_bf16_f32 v176, v8, v9
    v_cvt_pk_bf16_f32 v178, v10, v11
    v_cvt_pk_bf16_f32 v177, v12, v13
    v_cvt_pk_bf16_f32 v179, v14, v15
    v_pk_mul_f32 v[8:9], v[72:73], v[40:41]
    v_pk_mul_f32 v[10:11], v[72:73], v[44:45]
    v_pk_mul_f32 v[12:13], v[74:75], v[42:43]
    v_pk_mul_f32 v[14:15], v[74:75], v[46:47]
    v_pk_fma_f32 v[8:9], v[76:77], v[44:45], v[8:9] neg_lo:[1,0,0] neg_hi:[1,0,0]
    v_pk_fma_f32 v[10:11], v[76:77], v[40:41], v[10:11]
    v_pk_fma_f32 v[12:13], v[78:79], v[46:47], v[12:13] neg_lo:[1,0,0] neg_hi:[1,0,0]
    v_pk_fma_f32 v[14:15], v[78:79], v[42:43], v[14:15]
    v_cvt_pk_bf16_f32 v180, v8, v9
    v_cvt_pk_bf16_f32 v182, v10, v11
    v_cvt_pk_bf16_f32 v181, v12, v13
    v_cvt_pk_bf16_f32 v183, v14, v15
    ds_write_b128 v7, v[176:179]
    ds_write_b128 v7, v[180:183] offset:1024
    s_mov_b64 exec, 1
    ds_add_u32 v160, v3 offset:2128
    s_mov_b64 exec, -1
    v_add_u32 v7, s84, v5
LW_224:
    ds_read_b32 v1, v160 offset:2128
    s_waitcnt lgkmcnt(0)
    v_readfirstlane_b32 s73, v1
    s_cmp_ge_u32 s73, 2
    s_cbranch_scc1 LWD_225
    s_sub_u32 s72, s72, 1
    s_cbranch_scc0 LW_224
    s_branch L_bail
LWD_225:
    ds_read_b64 v[242:243], v7 offset:0
    ds_read_b64 v[246:247], v7 offset:8
    ds_read_b64 v[250:251], v7 offset:1024
    ds_read_b64 v[254:255], v7 offset:1032
    s_waitcnt vmcnt(16) lgkmcnt(0)
    v_mfma_f32_16x16x32_bf16 v[176:179], v[208:211], v[240:243], 0
    v_mfma_f32_16x16x32_bf16 v[184:187], v[208:211], v[244:247], 0
    v_mfma_f32_16x16x32_bf16 v[180:183], v[212:215], v[240:243], 0
    v_mfma_f32_16x16x32_bf16 v[188:191], v[212:215], v[244:247], 0
    v_mfma_f32_16x16x32_bf16 v[176:179], v[216:219], v[244:247], v[176:179]
    v_mfma_f32_16x16x32_bf16 v[184:187], v[224:227], v[240:243], v[184:187]
    v_mfma_f32_16x16x32_bf16 v[180:183], v[220:223], v[244:247], v[180:183]
    v_mfma_f32_16x16x32_bf16 v[188:191], v[228:231], v[240:243], v[188:191]
    v_mfma_f32_16x16x32_bf16 v[192:195], v[208:211], v[248:251], 0
    v_mfma_f32_16x16x32_bf16 v[200:203], v[208:211], v[252:255], 0
    v_mfma_f32_16x16x32_bf16 v[196:199], v[212:215], v[248:251], 0
    v_mfma_f32_16x16x32_bf16 v[204:207], v[212:215], v[252:255], 0
    v_mfma_f32_16x16x32_bf16 v[192:195], v[216:219], v[252:255], v[192:195]
    v_mfma_f32_16x16x32_bf16 v[200:203], v[224:227], v[248:251], v[200:203]
    v_mfma_f32_16x16x32_bf16 v[196:199], v[220:223], v[252:255], v[196:199]
    v_mfma_f32_16x16x32_bf16 v[204:207], v[228:231], v[248:251], v[204:207]
    s_add_u32 s92, s90, 5242880
    s_add_u32 s93, s91, 5242880
    v_cvt_pk_bf16_f32 v48, v176, v177
    v_cvt_pk_bf16_f32 v49, v178, v179
    v_cvt_pk_bf16_f32 v50, v180, v181
    v_cvt_pk_bf16_f32 v51, v182, v183
    buffer_store_dwordx4 v[48:51], v6, s[44:47], s92 offen offset:0 sc1
    v_cvt_pk_bf16_f32 v52, v184, v185
    v_cvt_pk_bf16_f32 v53, v186, v187
    v_cvt_pk_bf16_f32 v54, v188, v189
    v_cvt_pk_bf16_f32 v55, v190, v191
    buffer_store_dwordx4 v[52:55], v6, s[44:47], s93 offen offset:0 sc1
    v_cvt_pk_bf16_f32 v56, v192, v193
    v_cvt_pk_bf16_f32 v57, v194, v195
    v_cvt_pk_bf16_f32 v58, v196, v197
    v_cvt_pk_bf16_f32 v59, v198, v199
    buffer_store_dwordx4 v[56:59], v6, s[44:47], s92 offen offset:1024 sc1
    v_cvt_pk_bf16_f32 v60, v200, v201
    v_cvt_pk_bf16_f32 v61, v202, v203
    v_cvt_pk_bf16_f32 v62, v204, v205
    v_cvt_pk_bf16_f32 v63, v206, v207
    buffer_store_dwordx4 v[60:63], v6, s[44:47], s93 offen offset:1024 sc1
    v_mov_b32 v7, v160
    s_lshr_b32 s99, s89, 2
    s_lshl_b32 s99, s99, 7
    s_and_b32 s73, s89, 3
    s_lshl_b32 s73, s73, 2
    s_add_u32 s99, s99, s73
    s_add_u32 s99, s99, 393216
    s_branch LKV_197
NW_199:
LW_226:
    ds_read_b32 v1, v2 offset:2144
    s_waitcnt lgkmcnt(0)
    v_readfirstlane_b32 s73, v1
    s_cmp_ge_u32 s73, 4
    s_cbranch_scc1 LWD_227
    s_sleep 4
    s_sub_u32 s72, s72, 1
    s_cbranch_scc0 LW_226
    s_branch L_bail
LWD_227:
NS2_195:
    s_mov_b32 s99, 1073741824
    v_and_b32 v84, 31, v0
    v_lshrrev_b32 v85, 5, v0
    v_lshlrev_b32 v82, 5, v84
    v_lshl_add_u32 v82, v85, 4, v82
    v_mov_b32 v86, 1073741824
    v_lshlrev_b32 v83, 2, v0
    v_subrev_u32 v87, 64, v82
    v_cmp_eq_u32 vcc, 20, v84
    s_and_b32 s73, s68, 3
    s_nop 0
    v_cndmask_b32 v87, v86, v87, vcc
    v_cmp_gt_u32 vcc, 18, v84
    s_lshl_b32 s96, s73, 14
    s_nop 0
    v_cndmask_b32 v4, v87, v82, vcc
    s_add_u32 s96, s96, 65536
    s_lshl_b32 s97, s73, 11
    s_add_u32 s97, s97, 131072
    s_mul_i32 s98, s73, 20480
    s_add_u32 s98, s98, 196608
    buffer_load_dword v120, v83, s[44:47], s97 offen offset:0 sc1
    buffer_load_dword v121, v83, s[44:47], s97 offen offset:256 sc1
    buffer_load_dword v122, v83, s[44:47], s97 offen offset:512 sc1
    buffer_load_dword v123, v83, s[44:47], s97 offen offset:768 sc1
    buffer_load_dwordx4 v[88:91], v82, s[44:47], s96 offen offset:0 sc1
    buffer_load_dwordx4 v[128:131], v4, s[44:47], s98 offen offset:0 sc1
    buffer_load_dwordx4 v[132:135], v4, s[44:47], s98 offen offset:640 sc1
    buffer_load_dwordx4 v[92:95], v82, s[44:47], s96 offen offset:1024 sc1
    buffer_load_dwordx4 v[136:139], v4, s[44:47], s98 offen offset:1280 sc1
    buffer_load_dwordx4 v[140:143], v4, s[44:47], s98 offen offset:1920 sc1
    s_add_u32 s98, s98, 2560
    buffer_load_dwordx4 v[96:99], v82, s[44:47], s96 offen offset:2048 sc1
    buffer_load_dwordx4 v[144:147], v4, s[44:47], s98 offen offset:0 sc1
    buffer_load_dwordx4 v[148:151], v4, s[44:47], s98 offen offset:640 sc1
    buffer_load_dwordx4 v[100:103], v82, s[44:47], s96 offen offset:3072 sc1
    s_add_u32 s96, s96, 4096
    buffer_load_dwordx4 v[152:155], v4, s[44:47], s98 offen offset:1280 sc1
    buffer_load_dwordx4 v[156:159], v4, s[44:47], s98 offen offset:1920 sc1
    s_add_u32 s98, s98, 2560
    s_setprio 1
LKV_197:
    s_branch L_attn
L_fallback:
    s_nop 4
    v_and_b32 v250, 31, v0
    v_lshrrev_b32 v251, 5, v0
    v_lshlrev_b32 v245, 5, v250
    v_lshl_add_u32 v245, v251, 4, v245
    v_mov_b32 v248, 1073741824
    v_lshlrev_b32 v246, 2, v250
    v_cmp_lt_u32 vcc, 31, v0
    v_subrev_u32 v249, 64, v245
    s_nop 0
    v_cndmask_b32 v246, v246, v248, vcc
    v_cmp_eq_u32 vcc, 20, v250
    s_mul_i32 s73, s89, 1536
    s_nop 0
    v_cndmask_b32 v249, v248, v249, vcc
    v_cmp_gt_u32 vcc, 18, v250
    s_add_u32 s73, s73, 74752
    s_nop 0
    v_cndmask_b32 v247, v249, v245, vcc
    v_mul_u32_u24 v248, 48, v250
    v_add_u32 v248, s73, v248
    v_lshl_add_u32 v249, v251, 2, v248
    v_lshl_add_u32 v248, v251, 4, v248
    ds_read_b128 v[224:227], v248
    ds_read_b32 v228, v249 offset:32
    v_mov_b32 v229, 0
    v_mov_b32 v235, 0
    v_mov_b32 v244, 0xff800000
    s_mov_b32 s84, 65536
    s_mov_b32 s85, 131072
    s_mov_b32 s88, 63
FB1_228:
    buffer_load_dwordx4 v[230:233], v245, s[44:47], s84 offen sc1
    buffer_load_dword v234, v246, s[44:47], s85 offen sc1
    s_waitcnt vmcnt(0) lgkmcnt(0)
    v_mfma_f32_32x32x16_bf16 v[208:223], v[230:233], v[224:227], 0
    v_mfma_f32_32x32x8_bf16 v[208:223], v[234:235], v[228:229], v[208:223]
    s_add_u32 s84, s84, 1024
    s_add_u32 s85, s85, 128
    s_nop 8
    s_nop 0
    v_max3_f32 v244, v244, v208, v209
    v_max3_f32 v244, v244, v210, v211
    v_max3_f32 v244, v244, v212, v213
    v_max3_f32 v244, v244, v214, v215
    v_max3_f32 v244, v244, v216, v217
    v_max3_f32 v244, v244, v218, v219
    v_max3_f32 v244, v244, v220, v221
    v_max3_f32 v244, v244, v222, v223
    s_sub_u32 s88, s88, 1
    s_cbranch_scc0 FB1_228
    v_mov_b32 v248, v244
    s_nop 1
    v_permlane32_swap_b32 v244, v248
    v_max_f32 v244, v244, v248
    s_mov_b32 s84, 65536
    s_mov_b32 s85, 131072
    s_mov_b32 s83, 196608
    s_mov_b32 s88, 63
    v_mov_b32 v192, 0
    v_mov_b32 v193, 0
    v_mov_b32 v194, 0
    v_mov_b32 v195, 0
    v_mov_b32 v196, 0
    v_mov_b32 v197, 0
    v_mov_b32 v198, 0
    v_mov_b32 v199, 0
    v_mov_b32 v200, 0
    v_mov_b32 v201, 0
    v_mov_b32 v202, 0
    v_mov_b32 v203, 0
    v_mov_b32 v204, 0
    v_mov_b32 v205, 0
    v_mov_b32 v206, 0
    v_mov_b32 v207, 0
FB2_229:
    buffer_load_dwordx4 v[230:233], v245, s[44:47], s84 offen sc1
    buffer_load_dword v234, v246, s[44:47], s85 offen sc1
    buffer_load_dwordx4 v[236:239], v247, s[44:47], s83 offen sc1
    buffer_load_dwordx4 v[240:243], v247, s[44:47], s83 offen offset:640 sc1
    s_waitcnt vmcnt(0)
    v_mfma_f32_32x32x16_bf16 v[208:223], v[230:233], v[224:227], 0
    v_mfma_f32_32x32x8_bf16 v[208:223], v[234:235], v[228:229], v[208:223]
    s_add_u32 s84, s84, 1024
    s_add_u32 s85, s85, 128
    s_add_u32 s83, s83, 1280
    s_nop 7
    s_nop 0
    v_sub_f32 v208, v208, v244
    v_sub_f32 v209, v209, v244
    v_sub_f32 v210, v210, v244
    v_sub_f32 v211, v211, v244
    v_sub_f32 v212, v212, v244
    v_sub_f32 v213, v213, v244
    v_sub_f32 v214, v214, v244
    v_sub_f32 v215, v215, v244
    v_sub_f32 v216, v216, v244
    v_sub_f32 v217, v217, v244
    v_sub_f32 v218, v218, v244
    v_sub_f32 v219, v219, v244
    v_sub_f32 v220, v220, v244
    v_sub_f32 v221, v221, v244
    v_sub_f32 v222, v222, v244
    v_sub_f32 v223, v223, v244
    v_exp_f32 v208, v208
    v_exp_f32 v209, v209
    v_exp_f32 v210, v210
    v_exp_f32 v211, v211
    v_exp_f32 v212, v212
    v_exp_f32 v213, v213
    v_exp_f32 v214, v214
    v_exp_f32 v215, v215
    v_exp_f32 v216, v216
    v_exp_f32 v217, v217
    v_exp_f32 v218, v218
    v_exp_f32 v219, v219
    v_exp_f32 v220, v220
    v_exp_f32 v221, v221
    v_exp_f32 v222, v222
    v_exp_f32 v223, v223
    v_cvt_pk_bf16_f32 v208, v208, v209
    v_cvt_pk_bf16_f32 v209, v210, v211
    v_cvt_pk_bf16_f32 v210, v212, v213
    v_cvt_pk_bf16_f32 v211, v214, v215
    v_cvt_pk_bf16_f32 v212, v216, v217
    v_cvt_pk_bf16_f32 v213, v218, v219
    v_cvt_pk_bf16_f32 v214, v220, v221
    v_cvt_pk_bf16_f32 v215, v222, v223
    v_mfma_f32_32x32x16_bf16 v[192:207], v[236:239], v[208:211], v[192:207]
    s_nop 0
    v_mfma_f32_32x32x16_bf16 v[192:207], v[240:243], v[212:215], v[192:207]
    s_nop 15
    s_sub_u32 s88, s88, 1
    s_cbranch_scc0 FB2_229
    v_mov_b32 v248, v200
    v_mov_b32 v202, v200
    s_nop 0
    s_nop 0
    v_permlane32_swap_b32 v248, v202
    s_nop 4
    s_setpc_b64 s[86:87]
L_bail:
L_fin:
L_end:
    s_endpgm
.section .rodata,"a"
.p2align 8
.type spectral_tables,@object
spectral_tables:
.long 0x3f803f80,0x3f803f80,0x3f803f80,0x3f803f80,0x3f7f3f80,0x3f753f7b,0xbdc9248d,0xbe95be48,0x3f7b3f80,0x3f553f6d,0xbf7bbf80,0xbf55bf6d,0x3f753f80,0x3f223f55,0x3e95a554,0x3f463f0e
.long 0x3f6d3f80,0x3ec43f35,0x3f6d3f80,0x3ec43f35,0x3f623f80,0x3dc93f0e,0xbef1248d,0xbf7fbf55,0x3f553f80,0xbe483ec4,0xbf55bf80,0x3e48bec4,0x3f463f80,0xbef13e48,0x3f22a554,0x3f623f7b
.long 0x3f353f80,0xbf35248d,0x3f353f80,0xbf35248d,0x3f223f80,0xbf62be48,0xbf46248d,0xbef1bf7b,0x3f0e3f80,0xbf7bbec4,0xbf0ebf80,0x3f7b3ec4,0x3ef13f80,0xbf7fbf0e,0x3f62a554,0xbdc93f55
.long 0x3ec43f80,0xbf6dbf35,0x3ec43f80,0xbf6dbf35,0x3e953f80,0xbf46bf55,0xbf75248d,0x3f22bf0e,0x3e483f80,0xbf0ebf6d,0xbe48bf80,0x3f0e3f6d,0x3dc93f80,0xbe95bf7b,0x3f7fa554,0xbf753e48
.long 0x3f803f80,0x3f803f80,0x3f803f80,0x3f803f80,0x3f623f6d,0x3f463f55,0xbef1bec4,0xbf22bf0e,0x3f0e3f35,0x3e483ec4,0xbf0ebf35,0xbe48bec4,0x3dc93ec4,0xbef1be48,0x3f7f3f6d,0x3f623f7b
.long 0xbec4248d,0xbf6dbf35,0xbec4248d,0xbf6dbf35,0xbf46bec4,0xbf75bf7b,0xbf22bf6d,0x3e95be48,0xbf7bbf35,0xbf0ebf6d,0x3f7b3f35,0x3f0e3f6d,0xbf75bf6d,0x3dc9bf0e,0xbe953ec4,0xbf7fbf55
.long 0xbf35bf80,0x3f35a554,0xbf35bf80,0x3f35a554,0xbe95bf6d,0x3f7f3f0e,0x3f753ec4,0x3dc93f55,0x3e48bf35,0x3f553f6d,0xbe483f35,0xbf55bf6d,0x3f22bec4,0x3e953f7b,0xbf46bf6d,0x3f753e48
.long 0x3f6da554,0xbec43f35,0x3f6da554,0xbec43f35,0x3f7f3ec4,0xbf623e48,0xbdc93f6d,0xbef1bf7b,0x3f553f35,0xbf7bbec4,0xbf55bf35,0x3f7b3ec4,0x3ef13f6d,0xbf22bf55,0x3f62bec4,0xbf463f0e
.long 0x3f803f80,0x3f803f80,0x3f803f80,0x3f803f80,0x3f223f35,0x3ef13f0e,0xbf46bf35,0xbf62bf55,0xbe48248d,0xbf0ebec4,0x3e48a554,0x3f0e3ec4,0xbf62bf35,0xbf7fbf7b,0x3ef13f35,0xbdc93e48
.long 0xbf6dbf80,0xbec4bf35,0xbf6dbf80,0xbec4bf35,0xbe95bf35,0x3f223e48,0x3f753f35,0x3f463f7b,0x3f0ea554,0x3f7b3f6d,0xbf0e248d,0xbf7bbf6d,0x3f7f3f35,0x3e953f55,0xbdc9bf35,0x3f753f0e
.long 0x3f353f80,0xbf35248d,0x3f353f80,0xbf35248d,0xbdc93f35,0xbf75bf55,0xbf7fbf35,0x3e95bf0e,0xbf55248d,0xbe48bf6d,0x3f55a554,0x3e483f6d,0xbf75bf35,0x3f46be48,0xbe953f35,0xbf22bf7b
.long 0xbec4bf80,0x3f6d3f35,0xbec4bf80,0x3f6d3f35,0x3ef1bf35,0x3dc93f7b,0x3f623f35,0xbf7fbe48,0x3f7ba554,0xbf553ec4,0xbf7b248d,0x3f55bec4,0x3f463f35,0xbf62bf0e,0x3f22bf35,0xbef13f55
.long 0x3f803f80,0x3f803f80,0x3f803f80,0x3f803f80,0x3e953ec4,0x3dc93e48,0xbf75bf6d,0xbf7fbf7b,0xbf55bf35,0xbf7bbf6d,0x3f553f35,0x3f7b3f6d,0xbf46bf6d,0xbe95bf0e,0xbf22bec4,0xbf75bf55
.long 0x3ec4a554,0x3f6d3f35,0x3ec4a554,0x3f6d3f35,0x3f7f3f6d,0x3ef13f55,0xbdc93ec4,0xbf62bf0e,0x3e483f35,0xbf55bec4,0xbe48bf35,0x3f553ec4,0xbf62bec4,0xbf22bf7b,0x3ef13f6d,0xbf46be48
.long 0xbf35bf80,0x3f35a554,0xbf35bf80,0x3f35a554,0x3ef1bec4,0x3f463f7b,0x3f623f6d,0xbf223e48,0x3f7b3f35,0xbf0e3ec4,0xbf7bbf35,0x3f0ebec4,0x3dc93f6d,0xbf62bf55,0x3f7f3ec4,0xbef13f0e
.long 0xbf6d248d,0x3ec4bf35,0xbf6d248d,0x3ec4bf35,0xbf22bf6d,0x3f753f0e,0x3f46bec4,0xbe953f55,0x3f0ebf35,0xbe483f6d,0xbf0e3f35,0x3e48bf6d,0x3f753ec4,0xbf7fbe48,0x3e95bf6d,0xbdc93f7b
.long 0x3f803f80,0x3f803f80,0x3f803f80,0x3f803f80,0xbf7fbf80,0xbf75bf7b,0x3dc9a554,0x3e953e48,0x3f7b3f80,0x3f553f6d,0xbf7bbf80,0xbf55bf6d,0xbf75bf80,0xbf22bf55,0xbe95248d,0xbf46bf0e
.long 0x3f6d3f80,0x3ec43f35,0x3f6d3f80,0x3ec43f35,0xbf62bf80,0xbdc9bf0e,0x3ef1a554,0x3f7f3f55,0x3f553f80,0xbe483ec4,0xbf55bf80,0x3e48bec4,0xbf46bf80,0x3ef1be48,0xbf22248d,0xbf62bf7b
.long 0x3f353f80,0xbf35248d,0x3f353f80,0xbf35248d,0xbf22bf80,0x3f623e48,0x3f46a554,0x3ef13f7b,0x3f0e3f80,0xbf7bbec4,0xbf0ebf80,0x3f7b3ec4,0xbef1bf80,0x3f7f3f0e,0xbf62248d,0x3dc9bf55
.long 0x3ec43f80,0xbf6dbf35,0x3ec43f80,0xbf6dbf35,0xbe95bf80,0x3f463f55,0x3f75a554,0xbf223f0e,0x3e483f80,0xbf0ebf6d,0xbe48bf80,0x3f0e3f6d,0xbdc9bf80,0x3e953f7b,0xbf7f248d,0x3f75be48
.long 0x3f803f80,0x3f803f80,0x3f803f80,0x3f803f80,0xbf62bf6d,0xbf46bf55,0x3ef13ec4,0x3f223f0e,0x3f0e3f35,0x3e483ec4,0xbf0ebf35,0xbe48bec4,0xbdc9bec4,0x3ef13e48,0xbf7fbf6d,0xbf62bf7b
.long 0xbec4248d,0xbf6dbf35,0xbec4248d,0xbf6dbf35,0x3f463ec4,0x3f753f7b,0x3f223f6d,0xbe953e48,0xbf7bbf35,0xbf0ebf6d,0x3f7b3f35,0x3f0e3f6d,0x3f753f6d,0xbdc93f0e,0x3e95bec4,0x3f7f3f55
.long 0xbf35bf80,0x3f35a554,0xbf35bf80,0x3f35a554,0x3e953f6d,0xbf7fbf0e,0xbf75bec4,0xbdc9bf55,0x3e48bf35,0x3f553f6d,0xbe483f35,0xbf55bf6d,0xbf223ec4,0xbe95bf7b,0x3f463f6d,0xbf75be48
.long 0x3f6da554,0xbec43f35,0x3f6da554,0xbec43f35,0xbf7fbec4,0x3f62be48,0x3dc9bf6d,0x3ef13f7b,0x3f553f35,0xbf7bbec4,0xbf55bf35,0x3f7b3ec4,0xbef1bf6d,0x3f223f55,0xbf623ec4,0x3f46bf0e
.long 0x3f803f80,0x3f803f80,0x3f803f80,0x3f803f80,0xbf22bf35,0xbef1bf0e,0x3f463f35,0x3f623f55,0xbe48248d,0xbf0ebec4,0x3e48a554,0x3f0e3ec4,0x3f623f35,0x3f7f3f7b,0xbef1bf35,0x3dc9be48
.long 0xbf6dbf80,0xbec4bf35,0xbf6dbf80,0xbec4bf35,0x3e953f35,0xbf22be48,0xbf75bf35,0xbf46bf7b,0x3f0ea554,0x3f7b3f6d,0xbf0e248d,0xbf7bbf6d,0xbf7fbf35,0xbe95bf55,0x3dc93f35,0xbf75bf0e
.long 0x3f353f80,0xbf35248d,0x3f353f80,0xbf35248d,0x3dc9bf35,0x3f753f55,0x3f7f3f35,0xbe953f0e,0xbf55248d,0xbe48bf6d,0x3f55a554,0x3e483f6d,0x3f753f35,0xbf463e48,0x3e95bf35,0x3f223f7b
.long 0xbec4bf80,0x3f6d3f35,0xbec4bf80,0x3f6d3f35,0xbef13f35,0xbdc9bf7b,0xbf62bf35,0x3f7f3e48,0x3f7ba554,0xbf553ec4,0xbf7b248d,0x3f55bec4,0xbf46bf35,0x3f623f0e,0xbf223f35,0x3ef1bf55
.long 0x3f803f80,0x3f803f80,0x3f803f80,0x3f803f80,0xbe95bec4,0xbdc9be48,0x3f753f6d,0x3f7f3f7b,0xbf55bf35,0xbf7bbf6d,0x3f553f35,0x3f7b3f6d,0x3f463f6d,0x3e953f0e,0x3f223ec4,0x3f753f55
.long 0x3ec4a554,0x3f6d3f35,0x3ec4a554,0x3f6d3f35,0xbf7fbf6d,0xbef1bf55,0x3dc9bec4,0x3f623f0e,0x3e483f35,0xbf55bec4,0xbe48bf35,0x3f553ec4,0x3f623ec4,0x3f223f7b,0xbef1bf6d,0x3f463e48
.long 0xbf35bf80,0x3f35a554,0xbf35bf80,0x3f35a554,0xbef13ec4,0xbf46bf7b,0xbf62bf6d,0x3f22be48,0x3f7b3f35,0xbf0e3ec4,0xbf7bbf35,0x3f0ebec4,0xbdc9bf6d,0x3f623f55,0xbf7fbec4,0x3ef1bf0e
.long 0xbf6d248d,0x3ec4bf35,0xbf6d248d,0x3ec4bf35,0x3f223f6d,0xbf75bf0e,0xbf463ec4,0x3e95bf55,0x3f0ebf35,0xbe483f6d,0xbf0e3f35,0x3e48bf6d,0xbf75bec4,0x3f7f3e48,0xbe953f6d,0x3dc9bf7b
.long 0x248d3f80,0xa554bf80,0x248d3f80,0xa554bf80,0xbdc93f80,0x3e95bf7b,0xbf7f248d,0x3f753e48,0xbe483f80,0x3f0ebf6d,0x3e48bf80,0xbf0e3f6d,0xbe953f80,0x3f46bf55,0x3f75a554,0xbf22bf0e
.long 0xbec43f80,0x3f6dbf35,0xbec43f80,0x3f6dbf35,0xbef13f80,0x3f7fbf0e,0xbf62248d,0x3dc93f55,0xbf0e3f80,0x3f7bbec4,0x3f0ebf80,0xbf7b3ec4,0xbf223f80,0x3f62be48,0x3f46a554,0x3ef1bf7b
.long 0xbf353f80,0x3f35a554,0xbf353f80,0x3f35a554,0xbf463f80,0x3ef13e48,0xbf22248d,0xbf623f7b,0xbf553f80,0x3e483ec4,0x3f55bf80,0xbe48bec4,0xbf623f80,0xbdc93f0e,0x3ef1a554,0x3f7fbf55
.long 0xbf6d3f80,0xbec43f35,0xbf6d3f80,0xbec43f35,0xbf753f80,0xbf223f55,0xbe95248d,0xbf463f0e,0xbf7b3f80,0xbf553f6d,0x3f7bbf80,0x3f55bf6d,0xbf7f3f80,0xbf753f7b,0x3dc9a554,0x3e95be48
.long 0x248d3f80,0xa554bf80,0x248d3f80,0xa554bf80,0xbef13f6d,0x3f22bf55,0xbf62bec4,0x3f463f0e,0xbf553f35,0x3f7bbec4,0x3f55bf35,0xbf7b3ec4,0xbf7f3ec4,0x3f623e48,0x3dc93f6d,0x3ef1bf7b
.long 0xbf6d248d,0x3ec43f35,0xbf6d248d,0x3ec43f35,0xbf22bec4,0xbe953f7b,0x3f46bf6d,0xbf753e48,0xbe48bf35,0xbf553f6d,0x3e483f35,0x3f55bf6d,0x3e95bf6d,0xbf7f3f0e,0xbf753ec4,0xbdc93f55
.long 0x3f35bf80,0xbf35248d,0x3f35bf80,0xbf35248d,0x3f75bf6d,0xbdc9bf0e,0x3e953ec4,0x3f7fbf55,0x3f7bbf35,0x3f0ebf6d,0xbf7b3f35,0xbf0e3f6d,0x3f46bec4,0x3f75bf7b,0x3f22bf6d,0xbe95be48
.long 0x3ec4a554,0x3f6dbf35,0x3ec4a554,0x3f6dbf35,0xbdc93ec4,0x3ef1be48,0xbf7f3f6d,0xbf623f7b,0xbf0e3f35,0xbe483ec4,0x3f0ebf35,0x3e48bec4,0xbf623f6d,0xbf463f55,0x3ef1bec4,0x3f22bf0e
.long 0x248d3f80,0xa554bf80,0x248d3f80,0xa554bf80,0xbf463f35,0x3f62bf0e,0xbf22bf35,0x3ef13f55,0xbf7b248d,0x3f553ec4,0x3f7ba554,0xbf55bec4,0xbef1bf35,0xbdc93f7b,0xbf623f35,0x3f7fbe48
.long 0x3ec4bf80,0xbf6d3f35,0x3ec4bf80,0xbf6d3f35,0x3f75bf35,0xbf46be48,0x3e953f35,0x3f22bf7b,0x3f55a554,0x3e48bf6d,0xbf55248d,0xbe483f6d,0x3dc93f35,0x3f75bf55,0x3f7fbf35,0xbe95bf0e
.long 0xbf353f80,0x3f35a554,0xbf353f80,0x3f35a554,0xbf7f3f35,0xbe953f55,0x3dc9bf35,0xbf753f0e,0xbf0e248d,0xbf7b3f6d,0x3f0ea554,0x3f7bbf6d,0x3e95bf35,0xbf223e48,0xbf753f35,0xbf463f7b
.long 0x3f6dbf80,0x3ec4bf35,0x3f6dbf80,0x3ec4bf35,0x3f62bf35,0x3f7fbf7b,0xbef13f35,0x3dc93e48,0x3e48a554,0x3f0ebec4,0xbe48248d,0xbf0e3ec4,0xbf223f35,0xbef13f0e,0x3f46bf35,0x3f62bf55
.long 0x248d3f80,0xa554bf80,0x248d3f80,0xa554bf80,0xbf753ec4,0x3f7fbe48,0xbe95bf6d,0x3dc93f7b,0xbf0ebf35,0x3e483f6d,0x3f0e3f35,0xbe48bf6d,0x3f22bf6d,0xbf753f0e,0xbf46bec4,0x3e953f55
.long 0x3f6da554,0xbec4bf35,0x3f6da554,0xbec4bf35,0xbdc93f6d,0x3f62bf55,0xbf7f3ec4,0x3ef13f0e,0xbf7b3f35,0x3f0e3ec4,0x3f7bbf35,0xbf0ebec4,0xbef1bec4,0xbf463f7b,0xbf623f6d,0x3f223e48
.long 0x3f35bf80,0xbf35248d,0x3f35bf80,0xbf35248d,0x3f62bec4,0x3f22bf7b,0xbef13f6d,0x3f46be48,0xbe483f35,0x3f55bec4,0x3e48bf35,0xbf553ec4,0xbf7f3f6d,0xbef13f55,0x3dc93ec4,0x3f62bf0e
.long 0xbec4248d,0xbf6d3f35,0xbec4248d,0xbf6d3f35,0x3f46bf6d,0x3e95bf0e,0x3f22bec4,0x3f75bf55,0x3f55bf35,0x3f7bbf6d,0xbf553f35,0xbf7b3f6d,0xbe953ec4,0xbdc93e48,0x3f75bf6d,0x3f7fbf7b
.long 0x248d3f80,0xa554bf80,0x248d3f80,0xa554bf80,0x3dc9bf80,0xbe953f7b,0x3f7fa554,0xbf75be48,0xbe483f80,0x3f0ebf6d,0x3e48bf80,0xbf0e3f6d,0x3e95bf80,0xbf463f55,0xbf75248d,0x3f223f0e
.long 0xbec43f80,0x3f6dbf35,0xbec43f80,0x3f6dbf35,0x3ef1bf80,0xbf7f3f0e,0x3f62a554,0xbdc9bf55,0xbf0e3f80,0x3f7bbec4,0x3f0ebf80,0xbf7b3ec4,0x3f22bf80,0xbf623e48,0xbf46248d,0xbef13f7b
.long 0xbf353f80,0x3f35a554,0xbf353f80,0x3f35a554,0x3f46bf80,0xbef1be48,0x3f22a554,0x3f62bf7b,0xbf553f80,0x3e483ec4,0x3f55bf80,0xbe48bec4,0x3f62bf80,0x3dc9bf0e,0xbef1248d,0xbf7f3f55
.long 0xbf6d3f80,0xbec43f35,0xbf6d3f80,0xbec43f35,0x3f75bf80,0x3f22bf55,0x3e95a554,0x3f46bf0e,0xbf7b3f80,0xbf553f6d,0x3f7bbf80,0x3f55bf6d,0x3f7fbf80,0x3f75bf7b,0xbdc9248d,0xbe953e48
.long 0x248d3f80,0xa554bf80,0x248d3f80,0xa554bf80,0x3ef1bf6d,0xbf223f55,0x3f623ec4,0xbf46bf0e,0xbf553f35,0x3f7bbec4,0x3f55bf35,0xbf7b3ec4,0x3f7fbec4,0xbf62be48,0xbdc9bf6d,0xbef13f7b
.long 0xbf6d248d,0x3ec43f35,0xbf6d248d,0x3ec43f35,0x3f223ec4,0x3e95bf7b,0xbf463f6d,0x3f75be48,0xbe48bf35,0xbf553f6d,0x3e483f35,0x3f55bf6d,0xbe953f6d,0x3f7fbf0e,0x3f75bec4,0x3dc9bf55
.long 0x3f35bf80,0xbf35248d,0x3f35bf80,0xbf35248d,0xbf753f6d,0x3dc93f0e,0xbe95bec4,0xbf7f3f55,0x3f7bbf35,0x3f0ebf6d,0xbf7b3f35,0xbf0e3f6d,0xbf463ec4,0xbf753f7b,0xbf223f6d,0x3e953e48
.long 0x3ec4a554,0x3f6dbf35,0x3ec4a554,0x3f6dbf35,0x3dc9bec4,0xbef13e48,0x3f7fbf6d,0x3f62bf7b,0xbf0e3f35,0xbe483ec4,0x3f0ebf35,0x3e48bec4,0x3f62bf6d,0x3f46bf55,0xbef13ec4,0xbf223f0e
.long 0x248d3f80,0xa554bf80,0x248d3f80,0xa554bf80,0x3f46bf35,0xbf623f0e,0x3f223f35,0xbef1bf55,0xbf7b248d,0x3f553ec4,0x3f7ba554,0xbf55bec4,0x3ef13f35,0x3dc9bf7b,0x3f62bf35,0xbf7f3e48
.long 0x3ec4bf80,0xbf6d3f35,0x3ec4bf80,0xbf6d3f35,0xbf753f35,0x3f463e48,0xbe95bf35,0xbf223f7b,0x3f55a554,0x3e48bf6d,0xbf55248d,0xbe483f6d,0xbdc9bf35,0xbf753f55,0xbf7f3f35,0x3e953f0e
.long 0xbf353f80,0x3f35a554,0xbf353f80,0x3f35a554,0x3f7fbf35,0x3e95bf55,0xbdc93f35,0x3f75bf0e,0xbf0e248d,0xbf7b3f6d,0x3f0ea554,0x3f7bbf6d,0xbe953f35,0x3f22be48,0x3f75bf35,0x3f46bf7b
.long 0x3f6dbf80,0x3ec4bf35,0x3f6dbf80,0x3ec4bf35,0xbf623f35,0xbf7f3f7b,0x3ef1bf35,0xbdc9be48,0x3e48a554,0x3f0ebec4,0xbe48248d,0xbf0e3ec4,0x3f22bf35,0x3ef1bf0e,0xbf463f35,0xbf623f55
.long 0x248d3f80,0xa554bf80,0x248d3f80,0xa554bf80,0x3f75bec4,0xbf7f3e48,0x3e953f6d,0xbdc9bf7b,0xbf0ebf35,0x3e483f6d,0x3f0e3f35,0xbe48bf6d,0xbf223f6d,0x3f75bf0e,0x3f463ec4,0xbe95bf55
.long 0x3f6da554,0xbec4bf35,0x3f6da554,0xbec4bf35,0x3dc9bf6d,0xbf623f55,0x3f7fbec4,0xbef1bf0e,0xbf7b3f35,0x3f0e3ec4,0x3f7bbf35,0xbf0ebec4,0x3ef13ec4,0x3f46bf7b,0x3f62bf6d,0xbf22be48
.long 0x3f35bf80,0xbf35248d,0x3f35bf80,0xbf35248d,0xbf623ec4,0xbf223f7b,0x3ef1bf6d,0xbf463e48,0xbe483f35,0x3f55bec4,0x3e48bf35,0xbf553ec4,0x3f7fbf6d,0x3ef1bf55,0xbdc9bec4,0xbf623f0e
.long 0xbec4248d,0xbf6d3f35,0xbec4248d,0xbf6d3f35,0xbf463f6d,0xbe953f0e,0xbf223ec4,0xbf753f55,0x3f55bf35,0x3f7bbf6d,0xbf553f35,0xbf7b3f6d,0x3e95bec4,0x3dc9be48,0xbf753f6d,0xbf7f3f7b
.long 0xbf803f80,0xbf803f80,0xbf803f80,0xbf803f80,0xbf7f3f80,0xbf753f7b,0x3dc9248d,0x3e95be48,0xbf7b3f80,0xbf553f6d,0x3f7bbf80,0x3f55bf6d,0xbf753f80,0xbf223f55,0xbe95a554,0xbf463f0e
.long 0xbf6d3f80,0xbec43f35,0xbf6d3f80,0xbec43f35,0xbf623f80,0xbdc93f0e,0x3ef1248d,0x3f7fbf55,0xbf553f80,0x3e483ec4,0x3f55bf80,0xbe48bec4,0xbf463f80,0x3ef13e48,0xbf22a554,0xbf623f7b
.long 0xbf353f80,0x3f35248d,0xbf353f80,0x3f35248d,0xbf223f80,0x3f62be48,0x3f46248d,0x3ef1bf7b,0xbf0e3f80,0x3f7bbec4,0x3f0ebf80,0xbf7b3ec4,0xbef13f80,0x3f7fbf0e,0xbf62a554,0x3dc93f55
.long 0xbec43f80,0x3f6dbf35,0xbec43f80,0x3f6dbf35,0xbe953f80,0x3f46bf55,0x3f75248d,0xbf22bf0e,0xbe483f80,0x3f0ebf6d,0x3e48bf80,0xbf0e3f6d,0xbdc93f80,0x3e95bf7b,0xbf7fa554,0x3f753e48
.long 0xbf803f80,0xbf803f80,0xbf803f80,0xbf803f80,0xbf623f6d,0xbf463f55,0x3ef1bec4,0x3f22bf0e,0xbf0e3f35,0xbe483ec4,0x3f0ebf35,0x3e48bec4,0xbdc93ec4,0x3ef1be48,0xbf7f3f6d,0xbf623f7b
.long 0x3ec4248d,0x3f6dbf35,0x3ec4248d,0x3f6dbf35,0x3f46bec4,0x3f75bf7b,0x3f22bf6d,0xbe95be48,0x3f7bbf35,0x3f0ebf6d,0xbf7b3f35,0xbf0e3f6d,0x3f75bf6d,0xbdc9bf0e,0x3e953ec4,0x3f7fbf55
.long 0x3f35bf80,0xbf35a554,0x3f35bf80,0xbf35a554,0x3e95bf6d,0xbf7f3f0e,0xbf753ec4,0xbdc93f55,0xbe48bf35,0xbf553f6d,0x3e483f35,0x3f55bf6d,0xbf22bec4,0xbe953f7b,0x3f46bf6d,0xbf753e48
.long 0xbf6da554,0x3ec43f35,0xbf6da554,0x3ec43f35,0xbf7f3ec4,0x3f623e48,0x3dc93f6d,0x3ef1bf7b,0xbf553f35,0x3f7bbec4,0x3f55bf35,0xbf7b3ec4,0xbef13f6d,0x3f22bf55,0xbf62bec4,0x3f463f0e
.long 0xbf803f80,0xbf803f80,0xbf803f80,0xbf803f80,0xbf223f35,0xbef13f0e,0x3f46bf35,0x3f62bf55,0x3e48248d,0x3f0ebec4,0xbe48a554,0xbf0e3ec4,0x3f62bf35,0x3f7fbf7b,0xbef13f35,0x3dc93e48
.long 0x3f6dbf80,0x3ec4bf35,0x3f6dbf80,0x3ec4bf35,0x3e95bf35,0xbf223e48,0xbf753f35,0xbf463f7b,0xbf0ea554,0xbf7b3f6d,0x3f0e248d,0x3f7bbf6d,0xbf7f3f35,0xbe953f55,0x3dc9bf35,0xbf753f0e
.long 0xbf353f80,0x3f35248d,0xbf353f80,0x3f35248d,0x3dc93f35,0x3f75bf55,0x3f7fbf35,0xbe95bf0e,0x3f55248d,0x3e48bf6d,0xbf55a554,0xbe483f6d,0x3f75bf35,0xbf46be48,0x3e953f35,0x3f22bf7b
.long 0x3ec4bf80,0xbf6d3f35,0x3ec4bf80,0xbf6d3f35,0xbef1bf35,0xbdc93f7b,0xbf623f35,0x3f7fbe48,0xbf7ba554,0x3f553ec4,0x3f7b248d,0xbf55bec4,0xbf463f35,0x3f62bf0e,0xbf22bf35,0x3ef13f55
.long 0xbf803f80,0xbf803f80,0xbf803f80,0xbf803f80,0xbe953ec4,0xbdc93e48,0x3f75bf6d,0x3f7fbf7b,0x3f55bf35,0x3f7bbf6d,0xbf553f35,0xbf7b3f6d,0x3f46bf6d,0x3e95bf0e,0x3f22bec4,0x3f75bf55
.long 0xbec4a554,0xbf6d3f35,0xbec4a554,0xbf6d3f35,0xbf7f3f6d,0xbef13f55,0x3dc93ec4,0x3f62bf0e,0xbe483f35,0x3f55bec4,0x3e48bf35,0xbf553ec4,0x3f62bec4,0x3f22bf7b,0xbef13f6d,0x3f46be48
.long 0x3f35bf80,0xbf35a554,0x3f35bf80,0xbf35a554,0xbef1bec4,0xbf463f7b,0xbf623f6d,0x3f223e48,0xbf7b3f35,0x3f0e3ec4,0x3f7bbf35,0xbf0ebec4,0xbdc93f6d,0x3f62bf55,0xbf7f3ec4,0x3ef13f0e
.long 0x3f6d248d,0xbec4bf35,0x3f6d248d,0xbec4bf35,0x3f22bf6d,0xbf753f0e,0xbf46bec4,0x3e953f55,0xbf0ebf35,0x3e483f6d,0x3f0e3f35,0xbe48bf6d,0xbf753ec4,0x3f7fbe48,0xbe95bf6d,0x3dc93f7b
.long 0xbf803f80,0xbf803f80,0xbf803f80,0xbf803f80,0x3f7fbf80,0x3f75bf7b,0xbdc9a554,0xbe953e48,0xbf7b3f80,0xbf553f6d,0x3f7bbf80,0x3f55bf6d,0x3f75bf80,0x3f22bf55,0x3e95248d,0x3f46bf0e
.long 0xbf6d3f80,0xbec43f35,0xbf6d3f80,0xbec43f35,0x3f62bf80,0x3dc9bf0e,0xbef1a554,0xbf7f3f55,0xbf553f80,0x3e483ec4,0x3f55bf80,0xbe48bec4,0x3f46bf80,0xbef1be48,0x3f22248d,0x3f62bf7b
.long 0xbf353f80,0x3f35248d,0xbf353f80,0x3f35248d,0x3f22bf80,0xbf623e48,0xbf46a554,0xbef13f7b,0xbf0e3f80,0x3f7bbec4,0x3f0ebf80,0xbf7b3ec4,0x3ef1bf80,0xbf7f3f0e,0x3f62248d,0xbdc9bf55
.long 0xbec43f80,0x3f6dbf35,0xbec43f80,0x3f6dbf35,0x3e95bf80,0xbf463f55,0xbf75a554,0x3f223f0e,0xbe483f80,0x3f0ebf6d,0x3e48bf80,0xbf0e3f6d,0x3dc9bf80,0xbe953f7b,0x3f7f248d,0xbf75be48
.long 0xbf803f80,0xbf803f80,0xbf803f80,0xbf803f80,0x3f62bf6d,0x3f46bf55,0xbef13ec4,0xbf223f0e,0xbf0e3f35,0xbe483ec4,0x3f0ebf35,0x3e48bec4,0x3dc9bec4,0xbef13e48,0x3f7fbf6d,0x3f62bf7b
.long 0x3ec4248d,0x3f6dbf35,0x3ec4248d,0x3f6dbf35,0xbf463ec4,0xbf753f7b,0xbf223f6d,0x3e953e48,0x3f7bbf35,0x3f0ebf6d,0xbf7b3f35,0xbf0e3f6d,0xbf753f6d,0x3dc93f0e,0xbe95bec4,0xbf7f3f55
.long 0x3f35bf80,0xbf35a554,0x3f35bf80,0xbf35a554,0xbe953f6d,0x3f7fbf0e,0x3f75bec4,0x3dc9bf55,0xbe48bf35,0xbf553f6d,0x3e483f35,0x3f55bf6d,0x3f223ec4,0x3e95bf7b,0xbf463f6d,0x3f75be48
.long 0xbf6da554,0x3ec43f35,0xbf6da554,0x3ec43f35,0x3f7fbec4,0xbf62be48,0xbdc9bf6d,0xbef13f7b,0xbf553f35,0x3f7bbec4,0x3f55bf35,0xbf7b3ec4,0x3ef1bf6d,0xbf223f55,0x3f623ec4,0xbf46bf0e
.long 0xbf803f80,0xbf803f80,0xbf803f80,0xbf803f80,0x3f22bf35,0x3ef1bf0e,0xbf463f35,0xbf623f55,0x3e48248d,0x3f0ebec4,0xbe48a554,0xbf0e3ec4,0xbf623f35,0xbf7f3f7b,0x3ef1bf35,0xbdc9be48
.long 0x3f6dbf80,0x3ec4bf35,0x3f6dbf80,0x3ec4bf35,0xbe953f35,0x3f22be48,0x3f75bf35,0x3f46bf7b,0xbf0ea554,0xbf7b3f6d,0x3f0e248d,0x3f7bbf6d,0x3f7fbf35,0x3e95bf55,0xbdc93f35,0x3f75bf0e
.long 0xbf353f80,0x3f35248d,0xbf353f80,0x3f35248d,0xbdc9bf35,0xbf753f55,0xbf7f3f35,0x3e953f0e,0x3f55248d,0x3e48bf6d,0xbf55a554,0xbe483f6d,0xbf753f35,0x3f463e48,0xbe95bf35,0xbf223f7b
.long 0x3ec4bf80,0xbf6d3f35,0x3ec4bf80,0xbf6d3f35,0x3ef13f35,0x3dc9bf7b,0x3f62bf35,0xbf7f3e48,0xbf7ba554,0x3f553ec4,0x3f7b248d,0xbf55bec4,0x3f46bf35,0xbf623f0e,0x3f223f35,0xbef1bf55
.long 0xbf803f80,0xbf803f80,0xbf803f80,0xbf803f80,0x3e95bec4,0x3dc9be48,0xbf753f6d,0xbf7f3f7b,0x3f55bf35,0x3f7bbf6d,0xbf553f35,0xbf7b3f6d,0xbf463f6d,0xbe953f0e,0xbf223ec4,0xbf753f55
.long 0xbec4a554,0xbf6d3f35,0xbec4a554,0xbf6d3f35,0x3f7fbf6d,0x3ef1bf55,0xbdc9bec4,0xbf623f0e,0xbe483f35,0x3f55bec4,0x3e48bf35,0xbf553ec4,0xbf623ec4,0xbf223f7b,0x3ef1bf6d,0xbf463e48
.long 0x3f35bf80,0xbf35a554,0x3f35bf80,0xbf35a554,0x3ef13ec4,0x3f46bf7b,0x3f62bf6d,0xbf22be48,0xbf7b3f35,0x3f0e3ec4,0x3f7bbf35,0xbf0ebec4,0x3dc9bf6d,0xbf623f55,0x3f7fbec4,0xbef1bf0e
.long 0x3f6d248d,0xbec4bf35,0x3f6d248d,0xbec4bf35,0xbf223f6d,0x3f75bf0e,0x3f463ec4,0xbe95bf55,0xbf0ebf35,0x3e483f6d,0x3f0e3f35,0xbe48bf6d,0x3f75bec4,0xbf7f3e48,0x3e953f6d,0xbdc9bf7b
.long 0xa5543f80,0x248dbf80,0xa5543f80,0x248dbf80,0x3dc93f80,0xbe95bf7b,0x3f7f248d,0xbf753e48,0x3e483f80,0xbf0ebf6d,0xbe48bf80,0x3f0e3f6d,0x3e953f80,0xbf46bf55,0xbf75a554,0x3f22bf0e
.long 0x3ec43f80,0xbf6dbf35,0x3ec43f80,0xbf6dbf35,0x3ef13f80,0xbf7fbf0e,0x3f62248d,0xbdc93f55,0x3f0e3f80,0xbf7bbec4,0xbf0ebf80,0x3f7b3ec4,0x3f223f80,0xbf62be48,0xbf46a554,0xbef1bf7b
.long 0x3f353f80,0xbf35a554,0x3f353f80,0xbf35a554,0x3f463f80,0xbef13e48,0x3f22248d,0x3f623f7b,0x3f553f80,0xbe483ec4,0xbf55bf80,0x3e48bec4,0x3f623f80,0x3dc93f0e,0xbef1a554,0xbf7fbf55
.long 0x3f6d3f80,0x3ec43f35,0x3f6d3f80,0x3ec43f35,0x3f753f80,0x3f223f55,0x3e95248d,0x3f463f0e,0x3f7b3f80,0x3f553f6d,0xbf7bbf80,0xbf55bf6d,0x3f7f3f80,0x3f753f7b,0xbdc9a554,0xbe95be48
.long 0xa5543f80,0x248dbf80,0xa5543f80,0x248dbf80,0x3ef13f6d,0xbf22bf55,0x3f62bec4,0xbf463f0e,0x3f553f35,0xbf7bbec4,0xbf55bf35,0x3f7b3ec4,0x3f7f3ec4,0xbf623e48,0xbdc93f6d,0xbef1bf7b
.long 0x3f6d248d,0xbec43f35,0x3f6d248d,0xbec43f35,0x3f22bec4,0x3e953f7b,0xbf46bf6d,0x3f753e48,0x3e48bf35,0x3f553f6d,0xbe483f35,0xbf55bf6d,0xbe95bf6d,0x3f7f3f0e,0x3f753ec4,0x3dc93f55
.long 0xbf35bf80,0x3f35248d,0xbf35bf80,0x3f35248d,0xbf75bf6d,0x3dc9bf0e,0xbe953ec4,0xbf7fbf55,0xbf7bbf35,0xbf0ebf6d,0x3f7b3f35,0x3f0e3f6d,0xbf46bec4,0xbf75bf7b,0xbf22bf6d,0x3e95be48
.long 0xbec4a554,0xbf6dbf35,0xbec4a554,0xbf6dbf35,0x3dc93ec4,0xbef1be48,0x3f7f3f6d,0x3f623f7b,0x3f0e3f35,0x3e483ec4,0xbf0ebf35,0xbe48bec4,0x3f623f6d,0x3f463f55,0xbef1bec4,0xbf22bf0e
.long 0xa5543f80,0x248dbf80,0xa5543f80,0x248dbf80,0x3f463f35,0xbf62bf0e,0x3f22bf35,0xbef13f55,0x3f7b248d,0xbf553ec4,0xbf7ba554,0x3f55bec4,0x3ef1bf35,0x3dc93f7b,0x3f623f35,0xbf7fbe48
.long 0xbec4bf80,0x3f6d3f35,0xbec4bf80,0x3f6d3f35,0xbf75bf35,0x3f46be48,0xbe953f35,0xbf22bf7b,0xbf55a554,0xbe48bf6d,0x3f55248d,0x3e483f6d,0xbdc93f35,0xbf75bf55,0xbf7fbf35,0x3e95bf0e
.long 0x3f353f80,0xbf35a554,0x3f353f80,0xbf35a554,0x3f7f3f35,0x3e953f55,0xbdc9bf35,0x3f753f0e,0x3f0e248d,0x3f7b3f6d,0xbf0ea554,0xbf7bbf6d,0xbe95bf35,0x3f223e48,0x3f753f35,0x3f463f7b
.long 0xbf6dbf80,0xbec4bf35,0xbf6dbf80,0xbec4bf35,0xbf62bf35,0xbf7fbf7b,0x3ef13f35,0xbdc93e48,0xbe48a554,0xbf0ebec4,0x3e48248d,0x3f0e3ec4,0x3f223f35,0x3ef13f0e,0xbf46bf35,0xbf62bf55
.long 0xa5543f80,0x248dbf80,0xa5543f80,0x248dbf80,0x3f753ec4,0xbf7fbe48,0x3e95bf6d,0xbdc93f7b,0x3f0ebf35,0xbe483f6d,0xbf0e3f35,0x3e48bf6d,0xbf22bf6d,0x3f753f0e,0x3f46bec4,0xbe953f55
.long 0xbf6da554,0x3ec4bf35,0xbf6da554,0x3ec4bf35,0x3dc93f6d,0xbf62bf55,0x3f7f3ec4,0xbef13f0e,0x3f7b3f35,0xbf0e3ec4,0xbf7bbf35,0x3f0ebec4,0x3ef1bec4,0x3f463f7b,0x3f623f6d,0xbf223e48
.long 0xbf35bf80,0x3f35248d,0xbf35bf80,0x3f35248d,0xbf62bec4,0xbf22bf7b,0x3ef13f6d,0xbf46be48,0x3e483f35,0xbf55bec4,0xbe48bf35,0x3f553ec4,0x3f7f3f6d,0x3ef13f55,0xbdc93ec4,0xbf62bf0e
.long 0x3ec4248d,0x3f6d3f35,0x3ec4248d,0x3f6d3f35,0xbf46bf6d,0xbe95bf0e,0xbf22bec4,0xbf75bf55,0xbf55bf35,0xbf7bbf6d,0x3f553f35,0x3f7b3f6d,0x3e953ec4,0x3dc93e48,0xbf75bf6d,0xbf7fbf7b
.long 0xa5543f80,0x248dbf80,0xa5543f80,0x248dbf80,0xbdc9bf80,0x3e953f7b,0xbf7fa554,0x3f75be48,0x3e483f80,0xbf0ebf6d,0xbe48bf80,0x3f0e3f6d,0xbe95bf80,0x3f463f55,0x3f75248d,0xbf223f0e
.long 0x3ec43f80,0xbf6dbf35,0x3ec43f80,0xbf6dbf35,0xbef1bf80,0x3f7f3f0e,0xbf62a554,0x3dc9bf55,0x3f0e3f80,0xbf7bbec4,0xbf0ebf80,0x3f7b3ec4,0xbf22bf80,0x3f623e48,0x3f46248d,0x3ef13f7b
.long 0x3f353f80,0xbf35a554,0x3f353f80,0xbf35a554,0xbf46bf80,0x3ef1be48,0xbf22a554,0xbf62bf7b,0x3f553f80,0xbe483ec4,0xbf55bf80,0x3e48bec4,0xbf62bf80,0xbdc9bf0e,0x3ef1248d,0x3f7f3f55
.long 0x3f6d3f80,0x3ec43f35,0x3f6d3f80,0x3ec43f35,0xbf75bf80,0xbf22bf55,0xbe95a554,0xbf46bf0e,0x3f7b3f80,0x3f553f6d,0xbf7bbf80,0xbf55bf6d,0xbf7fbf80,0xbf75bf7b,0x3dc9248d,0x3e953e48
.long 0xa5543f80,0x248dbf80,0xa5543f80,0x248dbf80,0xbef1bf6d,0x3f223f55,0xbf623ec4,0x3f46bf0e,0x3f553f35,0xbf7bbec4,0xbf55bf35,0x3f7b3ec4,0xbf7fbec4,0x3f62be48,0x3dc9bf6d,0x3ef13f7b
.long 0x3f6d248d,0xbec43f35,0x3f6d248d,0xbec43f35,0xbf223ec4,0xbe95bf7b,0x3f463f6d,0xbf75be48,0x3e48bf35,0x3f553f6d,0xbe483f35,0xbf55bf6d,0x3e953f6d,0xbf7fbf0e,0xbf75bec4,0xbdc9bf55
.long 0xbf35bf80,0x3f35248d,0xbf35bf80,0x3f35248d,0x3f753f6d,0xbdc93f0e,0x3e95bec4,0x3f7f3f55,0xbf7bbf35,0xbf0ebf6d,0x3f7b3f35,0x3f0e3f6d,0x3f463ec4,0x3f753f7b,0x3f223f6d,0xbe953e48
.long 0xbec4a554,0xbf6dbf35,0xbec4a554,0xbf6dbf35,0xbdc9bec4,0x3ef13e48,0xbf7fbf6d,0xbf62bf7b,0x3f0e3f35,0x3e483ec4,0xbf0ebf35,0xbe48bec4,0xbf62bf6d,0xbf46bf55,0x3ef13ec4,0x3f223f0e
.long 0xa5543f80,0x248dbf80,0xa5543f80,0x248dbf80,0xbf46bf35,0x3f623f0e,0xbf223f35,0x3ef1bf55,0x3f7b248d,0xbf553ec4,0xbf7ba554,0x3f55bec4,0xbef13f35,0xbdc9bf7b,0xbf62bf35,0x3f7f3e48
.long 0xbec4bf80,0x3f6d3f35,0xbec4bf80,0x3f6d3f35,0x3f753f35,0xbf463e48,0x3e95bf35,0x3f223f7b,0xbf55a554,0xbe48bf6d,0x3f55248d,0x3e483f6d,0x3dc9bf35,0x3f753f55,0x3f7f3f35,0xbe953f0e
.long 0x3f353f80,0xbf35a554,0x3f353f80,0xbf35a554,0xbf7fbf35,0xbe95bf55,0x3dc93f35,0xbf75bf0e,0x3f0e248d,0x3f7b3f6d,0xbf0ea554,0xbf7bbf6d,0x3e953f35,0xbf22be48,0xbf75bf35,0xbf46bf7b
.long 0xbf6dbf80,0xbec4bf35,0xbf6dbf80,0xbec4bf35,0x3f623f35,0x3f7f3f7b,0xbef1bf35,0x3dc9be48,0xbe48a554,0xbf0ebec4,0x3e48248d,0x3f0e3ec4,0xbf22bf35,0xbef1bf0e,0x3f463f35,0x3f623f55
.long 0xa5543f80,0x248dbf80,0xa5543f80,0x248dbf80,0xbf75bec4,0x3f7f3e48,0xbe953f6d,0x3dc9bf7b,0x3f0ebf35,0xbe483f6d,0xbf0e3f35,0x3e48bf6d,0x3f223f6d,0xbf75bf0e,0xbf463ec4,0x3e95bf55
.long 0xbf6da554,0x3ec4bf35,0xbf6da554,0x3ec4bf35,0xbdc9bf6d,0x3f623f55,0xbf7fbec4,0x3ef1bf0e,0x3f7b3f35,0xbf0e3ec4,0xbf7bbf35,0x3f0ebec4,0xbef13ec4,0xbf46bf7b,0xbf62bf6d,0x3f22be48
.long 0xbf35bf80,0x3f35248d,0xbf35bf80,0x3f35248d,0x3f623ec4,0x3f223f7b,0xbef1bf6d,0x3f463e48,0x3e483f35,0xbf55bec4,0xbe48bf35,0x3f553ec4,0xbf7fbf6d,0xbef1bf55,0x3dc9bec4,0x3f623f0e
.long 0x3ec4248d,0x3f6d3f35,0x3ec4248d,0x3f6d3f35,0x3f463f6d,0x3e953f0e,0x3f223ec4,0x3f753f55,0xbf55bf35,0xbf7bbf6d,0x3f553f35,0x3f7b3f6d,0xbe95bec4,0xbdc9be48,0x3f753f6d,0x3f7f3f7b
.long 0x0,0x0,0x0,0x0,0xbdc90000,0xbe95be48,0xbf7fbf80,0xbf75bf7b,0xbe480000,0xbf0ebec4,0x3e48a50d,0x3f0e3ec4,0xbe950000,0xbf46bf0e,0x3f753f80,0x3f223f55
.long 0xbec40000,0xbf6dbf35,0xbec40000,0xbf6dbf35,0xbef10000,0xbf7fbf55,0xbf62bf80,0xbdc9bf0e,0xbf0e0000,0xbf7bbf6d,0x3f0ea50d,0x3f7b3f6d,0xbf220000,0xbf62bf7b,0x3f463f80,0xbef13e48
.long 0xbf350000,0xbf35bf80,0xbf350000,0xbf35bf80,0xbf460000,0xbef1bf7b,0xbf22bf80,0x3f623e48,0xbf550000,0xbe48bf6d,0x3f55a50d,0x3e483f6d,0xbf620000,0x3dc9bf55,0x3ef13f80,0xbf7fbf0e
.long 0xbf6d0000,0x3ec4bf35,0xbf6d0000,0x3ec4bf35,0xbf750000,0x3f22bf0e,0xbe95bf80,0x3f463f55,0xbf7b0000,0x3f55bec4,0x3f7ba50d,0xbf553ec4,0xbf7f0000,0x3f75be48,0x3dc93f80,0xbe95bf7b
.long 0x0,0x0,0x0,0x0,0xbef1bec4,0xbf22bf0e,0xbf62bf6d,0xbf46bf55,0xbf55bf35,0xbf7bbf6d,0x3f553f35,0x3f7b3f6d,0xbf7fbf6d,0xbf62bf7b,0x3dc93ec4,0xbef1be48
.long 0xbf6dbf80,0xbec4bf35,0xbf6dbf80,0xbec4bf35,0xbf22bf6d,0x3e95be48,0x3f463ec4,0x3f753f7b,0xbe48bf35,0x3f553ec4,0x3e483f35,0xbf55bec4,0x3e95bec4,0x3f7f3f55,0xbf75bf6d,0x3dc9bf0e
.long 0x3f35a50d,0x3f353f80,0x3f35a50d,0x3f353f80,0x3f753ec4,0x3dc93f55,0x3e953f6d,0xbf7fbf0e,0x3f7b3f35,0xbf0e3ec4,0xbf7bbf35,0x3f0ebec4,0x3f463f6d,0xbf75be48,0x3f22bec4,0x3e953f7b
.long 0x3ec43f80,0xbf6dbf35,0x3ec43f80,0xbf6dbf35,0xbdc93f6d,0xbef1bf7b,0xbf7fbec4,0x3f62be48,0xbf0e3f35,0x3e48bf6d,0x3f0ebf35,0xbe483f6d,0xbf623ec4,0x3f46bf0e,0x3ef13f6d,0xbf22bf55
.long 0x0,0x0,0x0,0x0,0xbf46bf35,0xbf62bf55,0xbf22bf35,0xbef1bf0e,0xbf7bbf80,0xbf55bf6d,0x3f7b3f80,0x3f553f6d,0xbef1bf35,0x3dc9be48,0xbf62bf35,0xbf7fbf7b
.long 0x3ec4a50d,0x3f6d3f35,0x3ec4a50d,0x3f6d3f35,0x3f753f35,0x3f463f7b,0x3e953f35,0xbf22be48,0x3f553f80,0xbe483ec4,0xbf55bf80,0x3e48bec4,0x3dc93f35,0xbf75bf0e,0x3f7f3f35,0x3e953f55
.long 0xbf350000,0xbf35bf80,0xbf350000,0xbf35bf80,0xbf7fbf35,0x3e95bf0e,0x3dc9bf35,0x3f753f55,0xbf0ebf80,0x3f7b3ec4,0x3f0e3f80,0xbf7bbec4,0x3e95bf35,0x3f223f7b,0xbf75bf35,0x3f46be48
.long 0x3f6da50d,0xbec43f35,0x3f6da50d,0xbec43f35,0x3f623f35,0xbf7fbe48,0xbef13f35,0xbdc9bf7b,0x3e483f80,0xbf0ebf6d,0xbe48bf80,0x3f0e3f6d,0xbf223f35,0x3ef1bf55,0x3f463f35,0xbf62bf0e
.long 0x0,0x0,0x0,0x0,0xbf75bf6d,0xbf7fbf7b,0xbe95bec4,0xbdc9be48,0xbf0ebf35,0xbe48bec4,0x3f0e3f35,0x3e483ec4,0x3f223ec4,0x3f753f55,0xbf46bf6d,0xbe95bf0e
.long 0x3f6d3f80,0x3ec43f35,0x3f6d3f80,0x3ec43f35,0xbdc93ec4,0xbf62bf0e,0xbf7fbf6d,0xbef1bf55,0xbf7bbf35,0xbf0ebf6d,0x3f7b3f35,0x3f0e3f6d,0xbef1bf6d,0x3f463e48,0xbf62bec4,0xbf22bf7b
.long 0x3f35a50d,0x3f353f80,0x3f35a50d,0x3f353f80,0x3f623f6d,0xbf223e48,0xbef13ec4,0xbf46bf7b,0xbe483f35,0xbf55bf6d,0x3e48bf35,0x3f553f6d,0xbf7fbec4,0x3ef1bf0e,0x3dc93f6d,0xbf62bf55
.long 0xbec4bf80,0x3f6d3f35,0xbec4bf80,0x3f6d3f35,0x3f46bec4,0xbe953f55,0x3f223f6d,0xbf75bf0e,0x3f553f35,0xbf7bbec4,0xbf55bf35,0x3f7b3ec4,0xbe953f6d,0x3dc9bf7b,0x3f753ec4,0xbf7fbe48
.long 0x0,0x0,0x0,0x0,0x3dc9a50d,0x3e953e48,0x3f7f3f80,0x3f753f7b,0xbe480000,0xbf0ebec4,0x3e48a50d,0x3f0e3ec4,0x3e95a50d,0x3f463f0e,0xbf75bf80,0xbf22bf55
.long 0xbec40000,0xbf6dbf35,0xbec40000,0xbf6dbf35,0x3ef1a50d,0x3f7f3f55,0x3f623f80,0x3dc93f0e,0xbf0e0000,0xbf7bbf6d,0x3f0ea50d,0x3f7b3f6d,0x3f22a50d,0x3f623f7b,0xbf46bf80,0x3ef1be48
.long 0xbf350000,0xbf35bf80,0xbf350000,0xbf35bf80,0x3f46a50d,0x3ef13f7b,0x3f223f80,0xbf62be48,0xbf550000,0xbe48bf6d,0x3f55a50d,0x3e483f6d,0x3f62a50d,0xbdc93f55,0xbef1bf80,0x3f7f3f0e
.long 0xbf6d0000,0x3ec4bf35,0xbf6d0000,0x3ec4bf35,0x3f75a50d,0xbf223f0e,0x3e953f80,0xbf46bf55,0xbf7b0000,0x3f55bec4,0x3f7ba50d,0xbf553ec4,0x3f7fa50d,0xbf753e48,0xbdc9bf80,0x3e953f7b
.long 0x0,0x0,0x0,0x0,0x3ef13ec4,0x3f223f0e,0x3f623f6d,0x3f463f55,0xbf55bf35,0xbf7bbf6d,0x3f553f35,0x3f7b3f6d,0x3f7f3f6d,0x3f623f7b,0xbdc9bec4,0x3ef13e48
.long 0xbf6dbf80,0xbec4bf35,0xbf6dbf80,0xbec4bf35,0x3f223f6d,0xbe953e48,0xbf46bec4,0xbf75bf7b,0xbe48bf35,0x3f553ec4,0x3e483f35,0xbf55bec4,0xbe953ec4,0xbf7fbf55,0x3f753f6d,0xbdc93f0e
.long 0x3f35a50d,0x3f353f80,0x3f35a50d,0x3f353f80,0xbf75bec4,0xbdc9bf55,0xbe95bf6d,0x3f7f3f0e,0x3f7b3f35,0xbf0e3ec4,0xbf7bbf35,0x3f0ebec4,0xbf46bf6d,0x3f753e48,0xbf223ec4,0xbe95bf7b
.long 0x3ec43f80,0xbf6dbf35,0x3ec43f80,0xbf6dbf35,0x3dc9bf6d,0x3ef13f7b,0x3f7f3ec4,0xbf623e48,0xbf0e3f35,0x3e48bf6d,0x3f0ebf35,0xbe483f6d,0x3f62bec4,0xbf463f0e,0xbef1bf6d,0x3f223f55
.long 0x0,0x0,0x0,0x0,0x3f463f35,0x3f623f55,0x3f223f35,0x3ef13f0e,0xbf7bbf80,0xbf55bf6d,0x3f7b3f80,0x3f553f6d,0x3ef13f35,0xbdc93e48,0x3f623f35,0x3f7f3f7b
.long 0x3ec4a50d,0x3f6d3f35,0x3ec4a50d,0x3f6d3f35,0xbf75bf35,0xbf46bf7b,0xbe95bf35,0x3f223e48,0x3f553f80,0xbe483ec4,0xbf55bf80,0x3e48bec4,0xbdc9bf35,0x3f753f0e,0xbf7fbf35,0xbe95bf55
.long 0xbf350000,0xbf35bf80,0xbf350000,0xbf35bf80,0x3f7f3f35,0xbe953f0e,0xbdc93f35,0xbf75bf55,0xbf0ebf80,0x3f7b3ec4,0x3f0e3f80,0xbf7bbec4,0xbe953f35,0xbf22bf7b,0x3f753f35,0xbf463e48
.long 0x3f6da50d,0xbec43f35,0x3f6da50d,0xbec43f35,0xbf62bf35,0x3f7f3e48,0x3ef1bf35,0x3dc93f7b,0x3e483f80,0xbf0ebf6d,0xbe48bf80,0x3f0e3f6d,0x3f22bf35,0xbef13f55,0xbf46bf35,0x3f623f0e
.long 0x0,0x0,0x0,0x0,0x3f753f6d,0x3f7f3f7b,0x3e953ec4,0x3dc93e48,0xbf0ebf35,0xbe48bec4,0x3f0e3f35,0x3e483ec4,0xbf22bec4,0xbf75bf55,0x3f463f6d,0x3e953f0e
.long 0x3f6d3f80,0x3ec43f35,0x3f6d3f80,0x3ec43f35,0x3dc9bec4,0x3f623f0e,0x3f7f3f6d,0x3ef13f55,0xbf7bbf35,0xbf0ebf6d,0x3f7b3f35,0x3f0e3f6d,0x3ef13f6d,0xbf46be48,0x3f623ec4,0x3f223f7b
.long 0x3f35a50d,0x3f353f80,0x3f35a50d,0x3f353f80,0xbf62bf6d,0x3f22be48,0x3ef1bec4,0x3f463f7b,0xbe483f35,0xbf55bf6d,0x3e48bf35,0x3f553f6d,0x3f7f3ec4,0xbef13f0e,0xbdc9bf6d,0x3f623f55
.long 0xbec4bf80,0x3f6d3f35,0xbec4bf80,0x3f6d3f35,0xbf463ec4,0x3e95bf55,0xbf22bf6d,0x3f753f0e,0x3f553f35,0xbf7bbec4,0xbf55bf35,0x3f7b3ec4,0x3e95bf6d,0xbdc93f7b,0xbf75bec4,0x3f7f3e48
.long 0xbf800000,0x3f80a50d,0xbf800000,0x3f80a50d,0xbf7f0000,0x3f753e48,0x3dc9bf80,0xbe953f7b,0xbf7b0000,0x3f553ec4,0x3f7ba50d,0xbf55bec4,0xbf750000,0x3f223f0e,0xbe953f80,0x3f46bf55
.long 0xbf6d0000,0x3ec43f35,0xbf6d0000,0x3ec43f35,0xbf620000,0x3dc93f55,0x3ef1bf80,0xbf7f3f0e,0xbf550000,0xbe483f6d,0x3f55a50d,0x3e48bf6d,0xbf460000,0xbef13f7b,0xbf223f80,0x3f62be48
.long 0xbf350000,0xbf353f80,0xbf350000,0xbf353f80,0xbf220000,0xbf623f7b,0x3f46bf80,0xbef1be48,0xbf0e0000,0xbf7b3f6d,0x3f0ea50d,0x3f7bbf6d,0xbef10000,0xbf7f3f55,0xbf623f80,0xbdc93f0e
.long 0xbec40000,0xbf6d3f35,0xbec40000,0xbf6d3f35,0xbe950000,0xbf463f0e,0x3f75bf80,0x3f22bf55,0xbe480000,0xbf0e3ec4,0x3e48a50d,0x3f0ebec4,0xbdc90000,0xbe953e48,0xbf7f3f80,0xbf753f7b
.long 0xbf800000,0x3f80a50d,0xbf800000,0x3f80a50d,0xbf62bec4,0x3f463f0e,0x3ef1bf6d,0xbf223f55,0xbf0ebf35,0x3e483f6d,0x3f0e3f35,0xbe48bf6d,0xbdc9bf6d,0xbef13f7b,0xbf7f3ec4,0x3f623e48
.long 0x3ec4bf80,0xbf6d3f35,0x3ec4bf80,0xbf6d3f35,0x3f46bf6d,0xbf753e48,0x3f223ec4,0x3e95bf7b,0x3f7bbf35,0xbf0ebec4,0xbf7b3f35,0x3f0e3ec4,0x3f75bec4,0x3dc9bf55,0x3e95bf6d,0xbf7f3f0e
.long 0x3f35a50d,0x3f35bf80,0x3f35a50d,0x3f35bf80,0x3e953ec4,0x3f7fbf55,0xbf753f6d,0x3dc93f0e,0xbe483f35,0x3f55bec4,0x3e48bf35,0xbf553ec4,0xbf223f6d,0x3e953e48,0x3f46bec4,0x3f75bf7b
.long 0xbf6d3f80,0xbec43f35,0xbf6d3f80,0xbec43f35,0xbf7f3f6d,0xbf623f7b,0x3dc9bec4,0xbef13e48,0xbf553f35,0xbf7b3f6d,0x3f55bf35,0x3f7bbf6d,0xbef13ec4,0xbf223f0e,0xbf623f6d,0xbf463f55
.long 0xbf800000,0x3f80a50d,0xbf800000,0x3f80a50d,0xbf22bf35,0x3ef13f55,0x3f46bf35,0xbf623f0e,0x3e48bf80,0xbf0e3f6d,0xbe483f80,0x3f0ebf6d,0x3f62bf35,0xbf7f3e48,0xbef1bf35,0xbdc93f7b
.long 0x3f6da50d,0xbec4bf35,0x3f6da50d,0xbec4bf35,0x3e953f35,0x3f22bf7b,0xbf753f35,0x3f463e48,0xbf0e3f80,0x3f7bbec4,0x3f0ebf80,0xbf7b3ec4,0xbf7f3f35,0x3e953f0e,0x3dc93f35,0x3f75bf55
.long 0xbf350000,0xbf353f80,0xbf350000,0xbf353f80,0x3dc9bf35,0xbf753f0e,0x3f7fbf35,0x3e95bf55,0x3f55bf80,0xbe48bec4,0xbf553f80,0x3e483ec4,0x3f75bf35,0x3f46bf7b,0x3e95bf35,0xbf223e48
.long 0x3ec4a50d,0x3f6dbf35,0x3ec4a50d,0x3f6dbf35,0xbef13f35,0x3dc93e48,0xbf623f35,0xbf7f3f7b,0xbf7b3f80,0xbf553f6d,0x3f7bbf80,0x3f55bf6d,0xbf463f35,0xbf623f55,0xbf223f35,0xbef13f0e
.long 0xbf800000,0x3f80a50d,0xbf800000,0x3f80a50d,0xbe95bf6d,0x3dc93f7b,0x3f75bec4,0xbf7f3e48,0x3f55bf35,0xbf7b3ec4,0xbf553f35,0x3f7bbec4,0x3f463ec4,0xbe95bf55,0x3f22bf6d,0xbf753f0e
.long 0xbec43f80,0x3f6dbf35,0xbec43f80,0x3f6dbf35,0xbf7f3ec4,0x3ef13f0e,0x3dc9bf6d,0xbf623f55,0xbe48bf35,0xbf553f6d,0x3e483f35,0x3f55bf6d,0x3f62bf6d,0xbf22be48,0xbef1bec4,0xbf463f7b
.long 0x3f35a50d,0x3f35bf80,0x3f35a50d,0x3f35bf80,0xbef13f6d,0x3f46be48,0xbf623ec4,0xbf223f7b,0xbf7b3f35,0xbf0e3f6d,0x3f7bbf35,0x3f0ebf6d,0xbdc9bec4,0xbf623f0e,0xbf7f3f6d,0xbef13f55
.long 0x3f6dbf80,0x3ec4bf35,0x3f6dbf80,0x3ec4bf35,0x3f22bec4,0x3f75bf55,0xbf463f6d,0xbe953f0e,0xbf0e3f35,0xbe483ec4,0x3f0ebf35,0x3e48bec4,0xbf753f6d,0xbf7f3f7b,0xbe953ec4,0xbdc93e48
.long 0xbf800000,0x3f80a50d,0xbf800000,0x3f80a50d,0x3f7fa50d,0xbf75be48,0xbdc93f80,0x3e95bf7b,0xbf7b0000,0x3f553ec4,0x3f7ba50d,0xbf55bec4,0x3f75a50d,0xbf22bf0e,0x3e95bf80,0xbf463f55
.long 0xbf6d0000,0x3ec43f35,0xbf6d0000,0x3ec43f35,0x3f62a50d,0xbdc9bf55,0xbef13f80,0x3f7fbf0e,0xbf550000,0xbe483f6d,0x3f55a50d,0x3e48bf6d,0x3f46a50d,0x3ef1bf7b,0x3f22bf80,0xbf623e48
.long 0xbf350000,0xbf353f80,0xbf350000,0xbf353f80,0x3f22a50d,0x3f62bf7b,0xbf463f80,0x3ef13e48,0xbf0e0000,0xbf7b3f6d,0x3f0ea50d,0x3f7bbf6d,0x3ef1a50d,0x3f7fbf55,0x3f62bf80,0x3dc9bf0e
.long 0xbec40000,0xbf6d3f35,0xbec40000,0xbf6d3f35,0x3e95a50d,0x3f46bf0e,0xbf753f80,0xbf223f55,0xbe480000,0xbf0e3ec4,0x3e48a50d,0x3f0ebec4,0x3dc9a50d,0x3e95be48,0x3f7fbf80,0x3f75bf7b
.long 0xbf800000,0x3f80a50d,0xbf800000,0x3f80a50d,0x3f623ec4,0xbf46bf0e,0xbef13f6d,0x3f22bf55,0xbf0ebf35,0x3e483f6d,0x3f0e3f35,0xbe48bf6d,0x3dc93f6d,0x3ef1bf7b,0x3f7fbec4,0xbf62be48
.long 0x3ec4bf80,0xbf6d3f35,0x3ec4bf80,0xbf6d3f35,0xbf463f6d,0x3f75be48,0xbf22bec4,0xbe953f7b,0x3f7bbf35,0xbf0ebec4,0xbf7b3f35,0x3f0e3ec4,0xbf753ec4,0xbdc93f55,0xbe953f6d,0x3f7fbf0e
.long 0x3f35a50d,0x3f35bf80,0x3f35a50d,0x3f35bf80,0xbe95bec4,0xbf7f3f55,0x3f75bf6d,0xbdc9bf0e,0xbe483f35,0x3f55bec4,0x3e48bf35,0xbf553ec4,0x3f22bf6d,0xbe95be48,0xbf463ec4,0xbf753f7b
.long 0xbf6d3f80,0xbec43f35,0xbf6d3f80,0xbec43f35,0x3f7fbf6d,0x3f62bf7b,0xbdc93ec4,0x3ef1be48,0xbf553f35,0xbf7b3f6d,0x3f55bf35,0x3f7bbf6d,0x3ef1bec4,0x3f22bf0e,0x3f62bf6d,0x3f46bf55
.long 0xbf800000,0x3f80a50d,0xbf800000,0x3f80a50d,0x3f223f35,0xbef1bf55,0xbf463f35,0x3f62bf0e,0x3e48bf80,0xbf0e3f6d,0xbe483f80,0x3f0ebf6d,0xbf623f35,0x3f7fbe48,0x3ef13f35,0x3dc9bf7b
.long 0x3f6da50d,0xbec4bf35,0x3f6da50d,0xbec4bf35,0xbe95bf35,0xbf223f7b,0x3f75bf35,0xbf46be48,0xbf0e3f80,0x3f7bbec4,0x3f0ebf80,0xbf7b3ec4,0x3f7fbf35,0xbe95bf0e,0xbdc9bf35,0xbf753f55
.long 0xbf350000,0xbf353f80,0xbf350000,0xbf353f80,0xbdc93f35,0x3f75bf0e,0xbf7f3f35,0xbe953f55,0x3f55bf80,0xbe48bec4,0xbf553f80,0x3e483ec4,0xbf753f35,0xbf463f7b,0xbe953f35,0x3f22be48
.long 0x3ec4a50d,0x3f6dbf35,0x3ec4a50d,0x3f6dbf35,0x3ef1bf35,0xbdc9be48,0x3f62bf35,0x3f7fbf7b,0xbf7b3f80,0xbf553f6d,0x3f7bbf80,0x3f55bf6d,0x3f46bf35,0x3f62bf55,0x3f22bf35,0x3ef1bf0e
.long 0xbf800000,0x3f80a50d,0xbf800000,0x3f80a50d,0x3e953f6d,0xbdc9bf7b,0xbf753ec4,0x3f7fbe48,0x3f55bf35,0xbf7b3ec4,0xbf553f35,0x3f7bbec4,0xbf46bec4,0x3e953f55,0xbf223f6d,0x3f75bf0e
.long 0xbec43f80,0x3f6dbf35,0xbec43f80,0x3f6dbf35,0x3f7fbec4,0xbef1bf0e,0xbdc93f6d,0x3f62bf55,0xbe48bf35,0xbf553f6d,0x3e483f35,0x3f55bf6d,0xbf623f6d,0x3f223e48,0x3ef13ec4,0x3f46bf7b
.long 0x3f35a50d,0x3f35bf80,0x3f35a50d,0x3f35bf80,0x3ef1bf6d,0xbf463e48,0x3f62bec4,0x3f22bf7b,0xbf7b3f35,0xbf0e3f6d,0x3f7bbf35,0x3f0ebf6d,0x3dc93ec4,0x3f62bf0e,0x3f7fbf6d,0x3ef1bf55
.long 0x3f6dbf80,0x3ec4bf35,0x3f6dbf80,0x3ec4bf35,0xbf223ec4,0xbf753f55,0x3f46bf6d,0x3e95bf0e,0xbf0e3f35,0xbe483ec4,0x3f0ebf35,0x3e48bec4,0x3f75bf6d,0x3f7fbf7b,0x3e95bec4,0x3dc9be48
.long 0xa50d0000,0xa50d0000,0xa50d0000,0xa50d0000,0x3dc90000,0x3e95be48,0x3f7fbf80,0x3f75bf7b,0x3e480000,0x3f0ebec4,0xbe48a50d,0xbf0e3ec4,0x3e950000,0x3f46bf0e,0xbf753f80,0xbf223f55
.long 0x3ec40000,0x3f6dbf35,0x3ec40000,0x3f6dbf35,0x3ef10000,0x3f7fbf55,0x3f62bf80,0x3dc9bf0e,0x3f0e0000,0x3f7bbf6d,0xbf0ea50d,0xbf7b3f6d,0x3f220000,0x3f62bf7b,0xbf463f80,0x3ef13e48
.long 0x3f350000,0x3f35bf80,0x3f350000,0x3f35bf80,0x3f460000,0x3ef1bf7b,0x3f22bf80,0xbf623e48,0x3f550000,0x3e48bf6d,0xbf55a50d,0xbe483f6d,0x3f620000,0xbdc9bf55,0xbef13f80,0x3f7fbf0e
.long 0x3f6d0000,0xbec4bf35,0x3f6d0000,0xbec4bf35,0x3f750000,0xbf22bf0e,0x3e95bf80,0xbf463f55,0x3f7b0000,0xbf55bec4,0xbf7ba50d,0x3f553ec4,0x3f7f0000,0xbf75be48,0xbdc93f80,0x3e95bf7b
.long 0xa50d0000,0xa50d0000,0xa50d0000,0xa50d0000,0x3ef1bec4,0x3f22bf0e,0x3f62bf6d,0x3f46bf55,0x3f55bf35,0x3f7bbf6d,0xbf553f35,0xbf7b3f6d,0x3f7fbf6d,0x3f62bf7b,0xbdc93ec4,0x3ef1be48
.long 0x3f6dbf80,0x3ec4bf35,0x3f6dbf80,0x3ec4bf35,0x3f22bf6d,0xbe95be48,0xbf463ec4,0xbf753f7b,0x3e48bf35,0xbf553ec4,0xbe483f35,0x3f55bec4,0xbe95bec4,0xbf7f3f55,0x3f75bf6d,0xbdc9bf0e
.long 0xbf35a50d,0xbf353f80,0xbf35a50d,0xbf353f80,0xbf753ec4,0xbdc93f55,0xbe953f6d,0x3f7fbf0e,0xbf7b3f35,0x3f0e3ec4,0x3f7bbf35,0xbf0ebec4,0xbf463f6d,0x3f75be48,0xbf22bec4,0xbe953f7b
.long 0xbec43f80,0x3f6dbf35,0xbec43f80,0x3f6dbf35,0x3dc93f6d,0x3ef1bf7b,0x3f7fbec4,0xbf62be48,0x3f0e3f35,0xbe48bf6d,0xbf0ebf35,0x3e483f6d,0x3f623ec4,0xbf46bf0e,0xbef13f6d,0x3f22bf55
.long 0xa50d0000,0xa50d0000,0xa50d0000,0xa50d0000,0x3f46bf35,0x3f62bf55,0x3f22bf35,0x3ef1bf0e,0x3f7bbf80,0x3f55bf6d,0xbf7b3f80,0xbf553f6d,0x3ef1bf35,0xbdc9be48,0x3f62bf35,0x3f7fbf7b
.long 0xbec4a50d,0xbf6d3f35,0xbec4a50d,0xbf6d3f35,0xbf753f35,0xbf463f7b,0xbe953f35,0x3f22be48,0xbf553f80,0x3e483ec4,0x3f55bf80,0xbe48bec4,0xbdc93f35,0x3f75bf0e,0xbf7f3f35,0xbe953f55
.long 0x3f350000,0x3f35bf80,0x3f350000,0x3f35bf80,0x3f7fbf35,0xbe95bf0e,0xbdc9bf35,0xbf753f55,0x3f0ebf80,0xbf7b3ec4,0xbf0e3f80,0x3f7bbec4,0xbe95bf35,0xbf223f7b,0x3f75bf35,0xbf46be48
.long 0xbf6da50d,0x3ec43f35,0xbf6da50d,0x3ec43f35,0xbf623f35,0x3f7fbe48,0x3ef13f35,0x3dc9bf7b,0xbe483f80,0x3f0ebf6d,0x3e48bf80,0xbf0e3f6d,0x3f223f35,0xbef1bf55,0xbf463f35,0x3f62bf0e
.long 0xa50d0000,0xa50d0000,0xa50d0000,0xa50d0000,0x3f75bf6d,0x3f7fbf7b,0x3e95bec4,0x3dc9be48,0x3f0ebf35,0x3e48bec4,0xbf0e3f35,0xbe483ec4,0xbf223ec4,0xbf753f55,0x3f46bf6d,0x3e95bf0e
.long 0xbf6d3f80,0xbec43f35,0xbf6d3f80,0xbec43f35,0x3dc93ec4,0x3f62bf0e,0x3f7fbf6d,0x3ef1bf55,0x3f7bbf35,0x3f0ebf6d,0xbf7b3f35,0xbf0e3f6d,0x3ef1bf6d,0xbf463e48,0x3f62bec4,0x3f22bf7b
.long 0xbf35a50d,0xbf353f80,0xbf35a50d,0xbf353f80,0xbf623f6d,0x3f223e48,0x3ef13ec4,0x3f46bf7b,0x3e483f35,0x3f55bf6d,0xbe48bf35,0xbf553f6d,0x3f7fbec4,0xbef1bf0e,0xbdc93f6d,0x3f62bf55
.long 0x3ec4bf80,0xbf6d3f35,0x3ec4bf80,0xbf6d3f35,0xbf46bec4,0x3e953f55,0xbf223f6d,0x3f75bf0e,0xbf553f35,0x3f7bbec4,0x3f55bf35,0xbf7b3ec4,0x3e953f6d,0xbdc9bf7b,0xbf753ec4,0x3f7fbe48
.long 0xa50d0000,0xa50d0000,0xa50d0000,0xa50d0000,0xbdc9a50d,0xbe953e48,0xbf7f3f80,0xbf753f7b,0x3e480000,0x3f0ebec4,0xbe48a50d,0xbf0e3ec4,0xbe95a50d,0xbf463f0e,0x3f75bf80,0x3f22bf55
.long 0x3ec40000,0x3f6dbf35,0x3ec40000,0x3f6dbf35,0xbef1a50d,0xbf7f3f55,0xbf623f80,0xbdc93f0e,0x3f0e0000,0x3f7bbf6d,0xbf0ea50d,0xbf7b3f6d,0xbf22a50d,0xbf623f7b,0x3f46bf80,0xbef1be48
.long 0x3f350000,0x3f35bf80,0x3f350000,0x3f35bf80,0xbf46a50d,0xbef13f7b,0xbf223f80,0x3f62be48,0x3f550000,0x3e48bf6d,0xbf55a50d,0xbe483f6d,0xbf62a50d,0x3dc93f55,0x3ef1bf80,0xbf7f3f0e
.long 0x3f6d0000,0xbec4bf35,0x3f6d0000,0xbec4bf35,0xbf75a50d,0x3f223f0e,0xbe953f80,0x3f46bf55,0x3f7b0000,0xbf55bec4,0xbf7ba50d,0x3f553ec4,0xbf7fa50d,0x3f753e48,0x3dc9bf80,0xbe953f7b
.long 0xa50d0000,0xa50d0000,0xa50d0000,0xa50d0000,0xbef13ec4,0xbf223f0e,0xbf623f6d,0xbf463f55,0x3f55bf35,0x3f7bbf6d,0xbf553f35,0xbf7b3f6d,0xbf7f3f6d,0xbf623f7b,0x3dc9bec4,0xbef13e48
.long 0x3f6dbf80,0x3ec4bf35,0x3f6dbf80,0x3ec4bf35,0xbf223f6d,0x3e953e48,0x3f46bec4,0x3f75bf7b,0x3e48bf35,0xbf553ec4,0xbe483f35,0x3f55bec4,0x3e953ec4,0x3f7fbf55,0xbf753f6d,0x3dc93f0e
.long 0xbf35a50d,0xbf353f80,0xbf35a50d,0xbf353f80,0x3f75bec4,0x3dc9bf55,0x3e95bf6d,0xbf7f3f0e,0xbf7b3f35,0x3f0e3ec4,0x3f7bbf35,0xbf0ebec4,0x3f46bf6d,0xbf753e48,0x3f223ec4,0x3e95bf7b
.long 0xbec43f80,0x3f6dbf35,0xbec43f80,0x3f6dbf35,0xbdc9bf6d,0xbef13f7b,0xbf7f3ec4,0x3f623e48,0x3f0e3f35,0xbe48bf6d,0xbf0ebf35,0x3e483f6d,0xbf62bec4,0x3f463f0e,0x3ef1bf6d,0xbf223f55
.long 0xa50d0000,0xa50d0000,0xa50d0000,0xa50d0000,0xbf463f35,0xbf623f55,0xbf223f35,0xbef13f0e,0x3f7bbf80,0x3f55bf6d,0xbf7b3f80,0xbf553f6d,0xbef13f35,0x3dc93e48,0xbf623f35,0xbf7f3f7b
.long 0xbec4a50d,0xbf6d3f35,0xbec4a50d,0xbf6d3f35,0x3f75bf35,0x3f46bf7b,0x3e95bf35,0xbf223e48,0xbf553f80,0x3e483ec4,0x3f55bf80,0xbe48bec4,0x3dc9bf35,0xbf753f0e,0x3f7fbf35,0x3e95bf55
.long 0x3f350000,0x3f35bf80,0x3f350000,0x3f35bf80,0xbf7f3f35,0x3e953f0e,0x3dc93f35,0x3f75bf55,0x3f0ebf80,0xbf7b3ec4,0xbf0e3f80,0x3f7bbec4,0x3e953f35,0x3f22bf7b,0xbf753f35,0x3f463e48
.long 0xbf6da50d,0x3ec43f35,0xbf6da50d,0x3ec43f35,0x3f62bf35,0xbf7f3e48,0xbef1bf35,0xbdc93f7b,0xbe483f80,0x3f0ebf6d,0x3e48bf80,0xbf0e3f6d,0xbf22bf35,0x3ef13f55,0x3f46bf35,0xbf623f0e
.long 0xa50d0000,0xa50d0000,0xa50d0000,0xa50d0000,0xbf753f6d,0xbf7f3f7b,0xbe953ec4,0xbdc93e48,0x3f0ebf35,0x3e48bec4,0xbf0e3f35,0xbe483ec4,0x3f22bec4,0x3f75bf55,0xbf463f6d,0xbe953f0e
.long 0xbf6d3f80,0xbec43f35,0xbf6d3f80,0xbec43f35,0xbdc9bec4,0xbf623f0e,0xbf7f3f6d,0xbef13f55,0x3f7bbf35,0x3f0ebf6d,0xbf7b3f35,0xbf0e3f6d,0xbef13f6d,0x3f46be48,0xbf623ec4,0xbf223f7b
.long 0xbf35a50d,0xbf353f80,0xbf35a50d,0xbf353f80,0x3f62bf6d,0xbf22be48,0xbef1bec4,0xbf463f7b,0x3e483f35,0x3f55bf6d,0xbe48bf35,0xbf553f6d,0xbf7f3ec4,0x3ef13f0e,0x3dc9bf6d,0xbf623f55
.long 0x3ec4bf80,0xbf6d3f35,0x3ec4bf80,0xbf6d3f35,0x3f463ec4,0xbe95bf55,0x3f22bf6d,0xbf753f0e,0xbf553f35,0x3f7bbec4,0x3f55bf35,0xbf7b3ec4,0xbe95bf6d,0x3dc93f7b,0x3f75bec4,0xbf7f3e48
.long 0x3f800000,0xbf80a50d,0x3f800000,0xbf80a50d,0x3f7f0000,0xbf753e48,0xbdc9bf80,0x3e953f7b,0x3f7b0000,0xbf553ec4,0xbf7ba50d,0x3f55bec4,0x3f750000,0xbf223f0e,0x3e953f80,0xbf46bf55
.long 0x3f6d0000,0xbec43f35,0x3f6d0000,0xbec43f35,0x3f620000,0xbdc93f55,0xbef1bf80,0x3f7f3f0e,0x3f550000,0x3e483f6d,0xbf55a50d,0xbe48bf6d,0x3f460000,0x3ef13f7b,0x3f223f80,0xbf62be48
.long 0x3f350000,0x3f353f80,0x3f350000,0x3f353f80,0x3f220000,0x3f623f7b,0xbf46bf80,0x3ef1be48,0x3f0e0000,0x3f7b3f6d,0xbf0ea50d,0xbf7bbf6d,0x3ef10000,0x3f7f3f55,0x3f623f80,0x3dc93f0e
.long 0x3ec40000,0x3f6d3f35,0x3ec40000,0x3f6d3f35,0x3e950000,0x3f463f0e,0xbf75bf80,0xbf22bf55,0x3e480000,0x3f0e3ec4,0xbe48a50d,0xbf0ebec4,0x3dc90000,0x3e953e48,0x3f7f3f80,0x3f753f7b
.long 0x3f800000,0xbf80a50d,0x3f800000,0xbf80a50d,0x3f62bec4,0xbf463f0e,0xbef1bf6d,0x3f223f55,0x3f0ebf35,0xbe483f6d,0xbf0e3f35,0x3e48bf6d,0x3dc9bf6d,0x3ef13f7b,0x3f7f3ec4,0xbf623e48
.long 0xbec4bf80,0x3f6d3f35,0xbec4bf80,0x3f6d3f35,0xbf46bf6d,0x3f753e48,0xbf223ec4,0xbe95bf7b,0xbf7bbf35,0x3f0ebec4,0x3f7b3f35,0xbf0e3ec4,0xbf75bec4,0xbdc9bf55,0xbe95bf6d,0x3f7f3f0e
.long 0xbf35a50d,0xbf35bf80,0xbf35a50d,0xbf35bf80,0xbe953ec4,0xbf7fbf55,0x3f753f6d,0xbdc93f0e,0x3e483f35,0xbf55bec4,0xbe48bf35,0x3f553ec4,0x3f223f6d,0xbe953e48,0xbf46bec4,0xbf75bf7b
.long 0x3f6d3f80,0x3ec43f35,0x3f6d3f80,0x3ec43f35,0x3f7f3f6d,0x3f623f7b,0xbdc9bec4,0x3ef13e48,0x3f553f35,0x3f7b3f6d,0xbf55bf35,0xbf7bbf6d,0x3ef13ec4,0x3f223f0e,0x3f623f6d,0x3f463f55
.long 0x3f800000,0xbf80a50d,0x3f800000,0xbf80a50d,0x3f22bf35,0xbef13f55,0xbf46bf35,0x3f623f0e,0xbe48bf80,0x3f0e3f6d,0x3e483f80,0xbf0ebf6d,0xbf62bf35,0x3f7f3e48,0x3ef1bf35,0x3dc93f7b
.long 0xbf6da50d,0x3ec4bf35,0xbf6da50d,0x3ec4bf35,0xbe953f35,0xbf22bf7b,0x3f753f35,0xbf463e48,0x3f0e3f80,0xbf7bbec4,0xbf0ebf80,0x3f7b3ec4,0x3f7f3f35,0xbe953f0e,0xbdc93f35,0xbf75bf55
.long 0x3f350000,0x3f353f80,0x3f350000,0x3f353f80,0xbdc9bf35,0x3f753f0e,0xbf7fbf35,0xbe95bf55,0xbf55bf80,0x3e48bec4,0x3f553f80,0xbe483ec4,0xbf75bf35,0xbf46bf7b,0xbe95bf35,0x3f223e48
.long 0xbec4a50d,0xbf6dbf35,0xbec4a50d,0xbf6dbf35,0x3ef13f35,0xbdc93e48,0x3f623f35,0x3f7f3f7b,0x3f7b3f80,0x3f553f6d,0xbf7bbf80,0xbf55bf6d,0x3f463f35,0x3f623f55,0x3f223f35,0x3ef13f0e
.long 0x3f800000,0xbf80a50d,0x3f800000,0xbf80a50d,0x3e95bf6d,0xbdc93f7b,0xbf75bec4,0x3f7f3e48,0xbf55bf35,0x3f7b3ec4,0x3f553f35,0xbf7bbec4,0xbf463ec4,0x3e95bf55,0xbf22bf6d,0x3f753f0e
.long 0x3ec43f80,0xbf6dbf35,0x3ec43f80,0xbf6dbf35,0x3f7f3ec4,0xbef13f0e,0xbdc9bf6d,0x3f623f55,0x3e48bf35,0x3f553f6d,0xbe483f35,0xbf55bf6d,0xbf62bf6d,0x3f22be48,0x3ef1bec4,0x3f463f7b
.long 0xbf35a50d,0xbf35bf80,0xbf35a50d,0xbf35bf80,0x3ef13f6d,0xbf46be48,0x3f623ec4,0x3f223f7b,0x3f7b3f35,0x3f0e3f6d,0xbf7bbf35,0xbf0ebf6d,0x3dc9bec4,0x3f623f0e,0x3f7f3f6d,0x3ef13f55
.long 0xbf6dbf80,0xbec4bf35,0xbf6dbf80,0xbec4bf35,0xbf22bec4,0xbf75bf55,0x3f463f6d,0x3e953f0e,0x3f0e3f35,0x3e483ec4,0xbf0ebf35,0xbe48bec4,0x3f753f6d,0x3f7f3f7b,0x3e953ec4,0x3dc93e48
.long 0x3f800000,0xbf80a50d,0x3f800000,0xbf80a50d,0xbf7fa50d,0x3f75be48,0x3dc93f80,0xbe95bf7b,0x3f7b0000,0xbf553ec4,0xbf7ba50d,0x3f55bec4,0xbf75a50d,0x3f22bf0e,0xbe95bf80,0x3f463f55
.long 0x3f6d0000,0xbec43f35,0x3f6d0000,0xbec43f35,0xbf62a50d,0x3dc9bf55,0x3ef13f80,0xbf7fbf0e,0x3f550000,0x3e483f6d,0xbf55a50d,0xbe48bf6d,0xbf46a50d,0xbef1bf7b,0xbf22bf80,0x3f623e48
.long 0x3f350000,0x3f353f80,0x3f350000,0x3f353f80,0xbf22a50d,0xbf62bf7b,0x3f463f80,0xbef13e48,0x3f0e0000,0x3f7b3f6d,0xbf0ea50d,0xbf7bbf6d,0xbef1a50d,0xbf7fbf55,0xbf62bf80,0xbdc9bf0e
.long 0x3ec40000,0x3f6d3f35,0x3ec40000,0x3f6d3f35,0xbe95a50d,0xbf46bf0e,0x3f753f80,0x3f223f55,0x3e480000,0x3f0e3ec4,0xbe48a50d,0xbf0ebec4,0xbdc9a50d,0xbe95be48,0xbf7fbf80,0xbf75bf7b
.long 0x3f800000,0xbf80a50d,0x3f800000,0xbf80a50d,0xbf623ec4,0x3f46bf0e,0x3ef13f6d,0xbf22bf55,0x3f0ebf35,0xbe483f6d,0xbf0e3f35,0x3e48bf6d,0xbdc93f6d,0xbef1bf7b,0xbf7fbec4,0x3f62be48
.long 0xbec4bf80,0x3f6d3f35,0xbec4bf80,0x3f6d3f35,0x3f463f6d,0xbf75be48,0x3f22bec4,0x3e953f7b,0xbf7bbf35,0x3f0ebec4,0x3f7b3f35,0xbf0e3ec4,0x3f753ec4,0x3dc93f55,0x3e953f6d,0xbf7fbf0e
.long 0xbf35a50d,0xbf35bf80,0xbf35a50d,0xbf35bf80,0x3e95bec4,0x3f7f3f55,0xbf75bf6d,0x3dc9bf0e,0x3e483f35,0xbf55bec4,0xbe48bf35,0x3f553ec4,0xbf22bf6d,0x3e95be48,0x3f463ec4,0x3f753f7b
.long 0x3f6d3f80,0x3ec43f35,0x3f6d3f80,0x3ec43f35,0xbf7fbf6d,0xbf62bf7b,0x3dc93ec4,0xbef1be48,0x3f553f35,0x3f7b3f6d,0xbf55bf35,0xbf7bbf6d,0xbef1bec4,0xbf22bf0e,0xbf62bf6d,0xbf46bf55
.long 0x3f800000,0xbf80a50d,0x3f800000,0xbf80a50d,0xbf223f35,0x3ef1bf55,0x3f463f35,0xbf62bf0e,0xbe48bf80,0x3f0e3f6d,0x3e483f80,0xbf0ebf6d,0x3f623f35,0xbf7fbe48,0xbef13f35,0xbdc9bf7b
.long 0xbf6da50d,0x3ec4bf35,0xbf6da50d,0x3ec4bf35,0x3e95bf35,0x3f223f7b,0xbf75bf35,0x3f46be48,0x3f0e3f80,0xbf7bbec4,0xbf0ebf80,0x3f7b3ec4,0xbf7fbf35,0x3e95bf0e,0x3dc9bf35,0x3f753f55
.long 0x3f350000,0x3f353f80,0x3f350000,0x3f353f80,0x3dc93f35,0xbf75bf0e,0x3f7f3f35,0x3e953f55,0xbf55bf80,0x3e48bec4,0x3f553f80,0xbe483ec4,0x3f753f35,0x3f463f7b,0x3e953f35,0xbf22be48
.long 0xbec4a50d,0xbf6dbf35,0xbec4a50d,0xbf6dbf35,0xbef1bf35,0x3dc9be48,0xbf62bf35,0xbf7fbf7b,0x3f7b3f80,0x3f553f6d,0xbf7bbf80,0xbf55bf6d,0xbf46bf35,0xbf62bf55,0xbf22bf35,0xbef1bf0e
.long 0x3f800000,0xbf80a50d,0x3f800000,0xbf80a50d,0xbe953f6d,0x3dc9bf7b,0x3f753ec4,0xbf7fbe48,0xbf55bf35,0x3f7b3ec4,0x3f553f35,0xbf7bbec4,0x3f46bec4,0xbe953f55,0x3f223f6d,0xbf75bf0e
.long 0x3ec43f80,0xbf6dbf35,0x3ec43f80,0xbf6dbf35,0xbf7fbec4,0x3ef1bf0e,0x3dc93f6d,0xbf62bf55,0x3e48bf35,0x3f553f6d,0xbe483f35,0xbf55bf6d,0x3f623f6d,0xbf223e48,0xbef13ec4,0xbf46bf7b
.long 0xbf35a50d,0xbf35bf80,0xbf35a50d,0xbf35bf80,0xbef1bf6d,0x3f463e48,0xbf62bec4,0xbf22bf7b,0x3f7b3f35,0x3f0e3f6d,0xbf7bbf35,0xbf0ebf6d,0xbdc93ec4,0xbf62bf0e,0xbf7fbf6d,0xbef1bf55
.long 0xbf6dbf80,0xbec4bf35,0xbf6dbf80,0xbec4bf35,0x3f223ec4,0x3f753f55,0xbf46bf6d,0xbe95bf0e,0x3f0e3f35,0x3e483ec4,0xbf0ebf35,0xbe48bec4,0xbf75bf6d,0xbf7fbf7b,0xbe95bec4,0xbdc9be48
.long 0x80008000,0x80008000,0x80008000,0x80008000,0x3dc98000,0x3e953e48,0x3f7f3f80,0x3f753f7b,0x3e488000,0x3f0e3ec4,0xbe48250d,0xbf0ebec4,0x3e958000,0x3f463f0e,0xbf75bf80,0xbf22bf55
.long 0x3ec48000,0x3f6d3f35,0x3ec48000,0x3f6d3f35,0x3ef18000,0x3f7f3f55,0x3f623f80,0x3dc93f0e,0x3f0e8000,0x3f7b3f6d,0xbf0e250d,0xbf7bbf6d,0x3f228000,0x3f623f7b,0xbf46bf80,0x3ef1be48
.long 0x3f358000,0x3f353f80,0x3f358000,0x3f353f80,0x3f468000,0x3ef13f7b,0x3f223f80,0xbf62be48,0x3f558000,0x3e483f6d,0xbf55250d,0xbe48bf6d,0x3f628000,0xbdc93f55,0xbef1bf80,0x3f7f3f0e
.long 0x3f6d8000,0xbec43f35,0x3f6d8000,0xbec43f35,0x3f758000,0xbf223f0e,0x3e953f80,0xbf46bf55,0x3f7b8000,0xbf553ec4,0xbf7b250d,0x3f55bec4,0x3f7f8000,0xbf753e48,0xbdc9bf80,0x3e953f7b
.long 0x80008000,0x80008000,0x80008000,0x80008000,0x3ef13ec4,0x3f223f0e,0x3f623f6d,0x3f463f55,0x3f553f35,0x3f7b3f6d,0xbf55bf35,0xbf7bbf6d,0x3f7f3f6d,0x3f623f7b,0xbdc9bec4,0x3ef13e48
.long 0x3f6d3f80,0x3ec43f35,0x3f6d3f80,0x3ec43f35,0x3f223f6d,0xbe953e48,0xbf46bec4,0xbf75bf7b,0x3e483f35,0xbf55bec4,0xbe48bf35,0x3f553ec4,0xbe953ec4,0xbf7fbf55,0x3f753f6d,0xbdc93f0e
.long 0xbf35250d,0xbf35bf80,0xbf35250d,0xbf35bf80,0xbf75bec4,0xbdc9bf55,0xbe95bf6d,0x3f7f3f0e,0xbf7bbf35,0x3f0ebec4,0x3f7b3f35,0xbf0e3ec4,0xbf46bf6d,0x3f753e48,0xbf223ec4,0xbe95bf7b
.long 0xbec4bf80,0x3f6d3f35,0xbec4bf80,0x3f6d3f35,0x3dc9bf6d,0x3ef13f7b,0x3f7f3ec4,0xbf623e48,0x3f0ebf35,0xbe483f6d,0xbf0e3f35,0x3e48bf6d,0x3f62bec4,0xbf463f0e,0xbef1bf6d,0x3f223f55
.long 0x80008000,0x80008000,0x80008000,0x80008000,0x3f463f35,0x3f623f55,0x3f223f35,0x3ef13f0e,0x3f7b3f80,0x3f553f6d,0xbf7bbf80,0xbf55bf6d,0x3ef13f35,0xbdc93e48,0x3f623f35,0x3f7f3f7b
.long 0xbec4250d,0xbf6dbf35,0xbec4250d,0xbf6dbf35,0xbf75bf35,0xbf46bf7b,0xbe95bf35,0x3f223e48,0xbf55bf80,0x3e48bec4,0x3f553f80,0xbe483ec4,0xbdc9bf35,0x3f753f0e,0xbf7fbf35,0xbe95bf55
.long 0x3f358000,0x3f353f80,0x3f358000,0x3f353f80,0x3f7f3f35,0xbe953f0e,0xbdc93f35,0xbf75bf55,0x3f0e3f80,0xbf7bbec4,0xbf0ebf80,0x3f7b3ec4,0xbe953f35,0xbf22bf7b,0x3f753f35,0xbf463e48
.long 0xbf6d250d,0x3ec4bf35,0xbf6d250d,0x3ec4bf35,0xbf62bf35,0x3f7f3e48,0x3ef1bf35,0x3dc93f7b,0xbe48bf80,0x3f0e3f6d,0x3e483f80,0xbf0ebf6d,0x3f22bf35,0xbef13f55,0xbf46bf35,0x3f623f0e
.long 0x80008000,0x80008000,0x80008000,0x80008000,0x3f753f6d,0x3f7f3f7b,0x3e953ec4,0x3dc93e48,0x3f0e3f35,0x3e483ec4,0xbf0ebf35,0xbe48bec4,0xbf22bec4,0xbf75bf55,0x3f463f6d,0x3e953f0e
.long 0xbf6dbf80,0xbec4bf35,0xbf6dbf80,0xbec4bf35,0x3dc9bec4,0x3f623f0e,0x3f7f3f6d,0x3ef13f55,0x3f7b3f35,0x3f0e3f6d,0xbf7bbf35,0xbf0ebf6d,0x3ef13f6d,0xbf46be48,0x3f623ec4,0x3f223f7b
.long 0xbf35250d,0xbf35bf80,0xbf35250d,0xbf35bf80,0xbf62bf6d,0x3f22be48,0x3ef1bec4,0x3f463f7b,0x3e48bf35,0x3f553f6d,0xbe483f35,0xbf55bf6d,0x3f7f3ec4,0xbef13f0e,0xbdc9bf6d,0x3f623f55
.long 0x3ec43f80,0xbf6dbf35,0x3ec43f80,0xbf6dbf35,0xbf463ec4,0x3e95bf55,0xbf22bf6d,0x3f753f0e,0xbf55bf35,0x3f7b3ec4,0x3f553f35,0xbf7bbec4,0x3e95bf6d,0xbdc93f7b,0xbf75bec4,0x3f7f3e48
.long 0x80008000,0x80008000,0x80008000,0x80008000,0xbdc9250d,0xbe95be48,0xbf7fbf80,0xbf75bf7b,0x3e488000,0x3f0e3ec4,0xbe48250d,0xbf0ebec4,0xbe95250d,0xbf46bf0e,0x3f753f80,0x3f223f55
.long 0x3ec48000,0x3f6d3f35,0x3ec48000,0x3f6d3f35,0xbef1250d,0xbf7fbf55,0xbf62bf80,0xbdc9bf0e,0x3f0e8000,0x3f7b3f6d,0xbf0e250d,0xbf7bbf6d,0xbf22250d,0xbf62bf7b,0x3f463f80,0xbef13e48
.long 0x3f358000,0x3f353f80,0x3f358000,0x3f353f80,0xbf46250d,0xbef1bf7b,0xbf22bf80,0x3f623e48,0x3f558000,0x3e483f6d,0xbf55250d,0xbe48bf6d,0xbf62250d,0x3dc9bf55,0x3ef13f80,0xbf7fbf0e
.long 0x3f6d8000,0xbec43f35,0x3f6d8000,0xbec43f35,0xbf75250d,0x3f22bf0e,0xbe95bf80,0x3f463f55,0x3f7b8000,0xbf553ec4,0xbf7b250d,0x3f55bec4,0xbf7f250d,0x3f75be48,0x3dc93f80,0xbe95bf7b
.long 0x80008000,0x80008000,0x80008000,0x80008000,0xbef1bec4,0xbf22bf0e,0xbf62bf6d,0xbf46bf55,0x3f553f35,0x3f7b3f6d,0xbf55bf35,0xbf7bbf6d,0xbf7fbf6d,0xbf62bf7b,0x3dc93ec4,0xbef1be48
.long 0x3f6d3f80,0x3ec43f35,0x3f6d3f80,0x3ec43f35,0xbf22bf6d,0x3e95be48,0x3f463ec4,0x3f753f7b,0x3e483f35,0xbf55bec4,0xbe48bf35,0x3f553ec4,0x3e95bec4,0x3f7f3f55,0xbf75bf6d,0x3dc9bf0e
.long 0xbf35250d,0xbf35bf80,0xbf35250d,0xbf35bf80,0x3f753ec4,0x3dc93f55,0x3e953f6d,0xbf7fbf0e,0xbf7bbf35,0x3f0ebec4,0x3f7b3f35,0xbf0e3ec4,0x3f463f6d,0xbf75be48,0x3f22bec4,0x3e953f7b
.long 0xbec4bf80,0x3f6d3f35,0xbec4bf80,0x3f6d3f35,0xbdc93f6d,0xbef1bf7b,0xbf7fbec4,0x3f62be48,0x3f0ebf35,0xbe483f6d,0xbf0e3f35,0x3e48bf6d,0xbf623ec4,0x3f46bf0e,0x3ef13f6d,0xbf22bf55
.long 0x80008000,0x80008000,0x80008000,0x80008000,0xbf46bf35,0xbf62bf55,0xbf22bf35,0xbef1bf0e,0x3f7b3f80,0x3f553f6d,0xbf7bbf80,0xbf55bf6d,0xbef1bf35,0x3dc9be48,0xbf62bf35,0xbf7fbf7b
.long 0xbec4250d,0xbf6dbf35,0xbec4250d,0xbf6dbf35,0x3f753f35,0x3f463f7b,0x3e953f35,0xbf22be48,0xbf55bf80,0x3e48bec4,0x3f553f80,0xbe483ec4,0x3dc93f35,0xbf75bf0e,0x3f7f3f35,0x3e953f55
.long 0x3f358000,0x3f353f80,0x3f358000,0x3f353f80,0xbf7fbf35,0x3e95bf0e,0x3dc9bf35,0x3f753f55,0x3f0e3f80,0xbf7bbec4,0xbf0ebf80,0x3f7b3ec4,0x3e95bf35,0x3f223f7b,0xbf75bf35,0x3f46be48
.long 0xbf6d250d,0x3ec4bf35,0xbf6d250d,0x3ec4bf35,0x3f623f35,0xbf7fbe48,0xbef13f35,0xbdc9bf7b,0xbe48bf80,0x3f0e3f6d,0x3e483f80,0xbf0ebf6d,0xbf223f35,0x3ef1bf55,0x3f463f35,0xbf62bf0e
.long 0x80008000,0x80008000,0x80008000,0x80008000,0xbf75bf6d,0xbf7fbf7b,0xbe95bec4,0xbdc9be48,0x3f0e3f35,0x3e483ec4,0xbf0ebf35,0xbe48bec4,0x3f223ec4,0x3f753f55,0xbf46bf6d,0xbe95bf0e
.long 0xbf6dbf80,0xbec4bf35,0xbf6dbf80,0xbec4bf35,0xbdc93ec4,0xbf62bf0e,0xbf7fbf6d,0xbef1bf55,0x3f7b3f35,0x3f0e3f6d,0xbf7bbf35,0xbf0ebf6d,0xbef1bf6d,0x3f463e48,0xbf62bec4,0xbf22bf7b
.long 0xbf35250d,0xbf35bf80,0xbf35250d,0xbf35bf80,0x3f623f6d,0xbf223e48,0xbef13ec4,0xbf46bf7b,0x3e48bf35,0x3f553f6d,0xbe483f35,0xbf55bf6d,0xbf7fbec4,0x3ef1bf0e,0x3dc93f6d,0xbf62bf55
.long 0x3ec43f80,0xbf6dbf35,0x3ec43f80,0xbf6dbf35,0x3f46bec4,0xbe953f55,0x3f223f6d,0xbf75bf0e,0xbf55bf35,0x3f7b3ec4,0x3f553f35,0xbf7bbec4,0xbe953f6d,0x3dc9bf7b,0x3f753ec4,0xbf7fbe48
.long 0x3f808000,0xbf80250d,0x3f808000,0xbf80250d,0x3f7f8000,0xbf75be48,0xbdc93f80,0x3e95bf7b,0x3f7b8000,0xbf55bec4,0xbf7b250d,0x3f553ec4,0x3f758000,0xbf22bf0e,0x3e95bf80,0xbf463f55
.long 0x3f6d8000,0xbec4bf35,0x3f6d8000,0xbec4bf35,0x3f628000,0xbdc9bf55,0xbef13f80,0x3f7fbf0e,0x3f558000,0x3e48bf6d,0xbf55250d,0xbe483f6d,0x3f468000,0x3ef1bf7b,0x3f22bf80,0xbf623e48
.long 0x3f358000,0x3f35bf80,0x3f358000,0x3f35bf80,0x3f228000,0x3f62bf7b,0xbf463f80,0x3ef13e48,0x3f0e8000,0x3f7bbf6d,0xbf0e250d,0xbf7b3f6d,0x3ef18000,0x3f7fbf55,0x3f62bf80,0x3dc9bf0e
.long 0x3ec48000,0x3f6dbf35,0x3ec48000,0x3f6dbf35,0x3e958000,0x3f46bf0e,0xbf753f80,0xbf223f55,0x3e488000,0x3f0ebec4,0xbe48250d,0xbf0e3ec4,0x3dc98000,0x3e95be48,0x3f7fbf80,0x3f75bf7b
.long 0x3f808000,0xbf80250d,0x3f808000,0xbf80250d,0x3f623ec4,0xbf46bf0e,0xbef13f6d,0x3f22bf55,0x3f0e3f35,0xbe48bf6d,0xbf0ebf35,0x3e483f6d,0x3dc93f6d,0x3ef1bf7b,0x3f7fbec4,0xbf62be48
.long 0xbec43f80,0x3f6dbf35,0xbec43f80,0x3f6dbf35,0xbf463f6d,0x3f75be48,0xbf22bec4,0xbe953f7b,0xbf7b3f35,0x3f0e3ec4,0x3f7bbf35,0xbf0ebec4,0xbf753ec4,0xbdc93f55,0xbe953f6d,0x3f7fbf0e
.long 0xbf35250d,0xbf353f80,0xbf35250d,0xbf353f80,0xbe95bec4,0xbf7f3f55,0x3f75bf6d,0xbdc9bf0e,0x3e48bf35,0xbf553ec4,0xbe483f35,0x3f55bec4,0x3f22bf6d,0xbe95be48,0xbf463ec4,0xbf753f7b
.long 0x3f6dbf80,0x3ec4bf35,0x3f6dbf80,0x3ec4bf35,0x3f7fbf6d,0x3f62bf7b,0xbdc93ec4,0x3ef1be48,0x3f55bf35,0x3f7bbf6d,0xbf553f35,0xbf7b3f6d,0x3ef1bec4,0x3f22bf0e,0x3f62bf6d,0x3f46bf55
.long 0x3f808000,0xbf80250d,0x3f808000,0xbf80250d,0x3f223f35,0xbef1bf55,0xbf463f35,0x3f62bf0e,0xbe483f80,0x3f0ebf6d,0x3e48bf80,0xbf0e3f6d,0xbf623f35,0x3f7fbe48,0x3ef13f35,0x3dc9bf7b
.long 0xbf6d250d,0x3ec43f35,0xbf6d250d,0x3ec43f35,0xbe95bf35,0xbf223f7b,0x3f75bf35,0xbf46be48,0x3f0ebf80,0xbf7b3ec4,0xbf0e3f80,0x3f7bbec4,0x3f7fbf35,0xbe95bf0e,0xbdc9bf35,0xbf753f55
.long 0x3f358000,0x3f35bf80,0x3f358000,0x3f35bf80,0xbdc93f35,0x3f75bf0e,0xbf7f3f35,0xbe953f55,0xbf553f80,0x3e483ec4,0x3f55bf80,0xbe48bec4,0xbf753f35,0xbf463f7b,0xbe953f35,0x3f22be48
.long 0xbec4250d,0xbf6d3f35,0xbec4250d,0xbf6d3f35,0x3ef1bf35,0xbdc9be48,0x3f62bf35,0x3f7fbf7b,0x3f7bbf80,0x3f55bf6d,0xbf7b3f80,0xbf553f6d,0x3f46bf35,0x3f62bf55,0x3f22bf35,0x3ef1bf0e
.long 0x3f808000,0xbf80250d,0x3f808000,0xbf80250d,0x3e953f6d,0xbdc9bf7b,0xbf753ec4,0x3f7fbe48,0xbf553f35,0x3f7bbec4,0x3f55bf35,0xbf7b3ec4,0xbf46bec4,0x3e953f55,0xbf223f6d,0x3f75bf0e
.long 0x3ec4bf80,0xbf6d3f35,0x3ec4bf80,0xbf6d3f35,0x3f7fbec4,0xbef1bf0e,0xbdc93f6d,0x3f62bf55,0x3e483f35,0x3f55bf6d,0xbe48bf35,0xbf553f6d,0xbf623f6d,0x3f223e48,0x3ef13ec4,0x3f46bf7b
.long 0xbf35250d,0xbf353f80,0xbf35250d,0xbf353f80,0x3ef1bf6d,0xbf463e48,0x3f62bec4,0x3f22bf7b,0x3f7bbf35,0x3f0ebf6d,0xbf7b3f35,0xbf0e3f6d,0x3dc93ec4,0x3f62bf0e,0x3f7fbf6d,0x3ef1bf55
.long 0xbf6d3f80,0xbec43f35,0xbf6d3f80,0xbec43f35,0xbf223ec4,0xbf753f55,0x3f46bf6d,0x3e95bf0e,0x3f0ebf35,0x3e48bec4,0xbf0e3f35,0xbe483ec4,0x3f75bf6d,0x3f7fbf7b,0x3e95bec4,0x3dc9be48
.long 0x3f808000,0xbf80250d,0x3f808000,0xbf80250d,0xbf7f250d,0x3f753e48,0x3dc9bf80,0xbe953f7b,0x3f7b8000,0xbf55bec4,0xbf7b250d,0x3f553ec4,0xbf75250d,0x3f223f0e,0xbe953f80,0x3f46bf55
.long 0x3f6d8000,0xbec4bf35,0x3f6d8000,0xbec4bf35,0xbf62250d,0x3dc93f55,0x3ef1bf80,0xbf7f3f0e,0x3f558000,0x3e48bf6d,0xbf55250d,0xbe483f6d,0xbf46250d,0xbef13f7b,0xbf223f80,0x3f62be48
.long 0x3f358000,0x3f35bf80,0x3f358000,0x3f35bf80,0xbf22250d,0xbf623f7b,0x3f46bf80,0xbef1be48,0x3f0e8000,0x3f7bbf6d,0xbf0e250d,0xbf7b3f6d,0xbef1250d,0xbf7f3f55,0xbf623f80,0xbdc93f0e
.long 0x3ec48000,0x3f6dbf35,0x3ec48000,0x3f6dbf35,0xbe95250d,0xbf463f0e,0x3f75bf80,0x3f22bf55,0x3e488000,0x3f0ebec4,0xbe48250d,0xbf0e3ec4,0xbdc9250d,0xbe953e48,0xbf7f3f80,0xbf753f7b
.long 0x3f808000,0xbf80250d,0x3f808000,0xbf80250d,0xbf62bec4,0x3f463f0e,0x3ef1bf6d,0xbf223f55,0x3f0e3f35,0xbe48bf6d,0xbf0ebf35,0x3e483f6d,0xbdc9bf6d,0xbef13f7b,0xbf7f3ec4,0x3f623e48
.long 0xbec43f80,0x3f6dbf35,0xbec43f80,0x3f6dbf35,0x3f46bf6d,0xbf753e48,0x3f223ec4,0x3e95bf7b,0xbf7b3f35,0x3f0e3ec4,0x3f7bbf35,0xbf0ebec4,0x3f75bec4,0x3dc9bf55,0x3e95bf6d,0xbf7f3f0e
.long 0xbf35250d,0xbf353f80,0xbf35250d,0xbf353f80,0x3e953ec4,0x3f7fbf55,0xbf753f6d,0x3dc93f0e,0x3e48bf35,0xbf553ec4,0xbe483f35,0x3f55bec4,0xbf223f6d,0x3e953e48,0x3f46bec4,0x3f75bf7b
.long 0x3f6dbf80,0x3ec4bf35,0x3f6dbf80,0x3ec4bf35,0xbf7f3f6d,0xbf623f7b,0x3dc9bec4,0xbef13e48,0x3f55bf35,0x3f7bbf6d,0xbf553f35,0xbf7b3f6d,0xbef13ec4,0xbf223f0e,0xbf623f6d,0xbf463f55
.long 0x3f808000,0xbf80250d,0x3f808000,0xbf80250d,0xbf22bf35,0x3ef13f55,0x3f46bf35,0xbf623f0e,0xbe483f80,0x3f0ebf6d,0x3e48bf80,0xbf0e3f6d,0x3f62bf35,0xbf7f3e48,0xbef1bf35,0xbdc93f7b
.long 0xbf6d250d,0x3ec43f35,0xbf6d250d,0x3ec43f35,0x3e953f35,0x3f22bf7b,0xbf753f35,0x3f463e48,0x3f0ebf80,0xbf7b3ec4,0xbf0e3f80,0x3f7bbec4,0xbf7f3f35,0x3e953f0e,0x3dc93f35,0x3f75bf55
.long 0x3f358000,0x3f35bf80,0x3f358000,0x3f35bf80,0x3dc9bf35,0xbf753f0e,0x3f7fbf35,0x3e95bf55,0xbf553f80,0x3e483ec4,0x3f55bf80,0xbe48bec4,0x3f75bf35,0x3f46bf7b,0x3e95bf35,0xbf223e48
.long 0xbec4250d,0xbf6d3f35,0xbec4250d,0xbf6d3f35,0xbef13f35,0x3dc93e48,0xbf623f35,0xbf7f3f7b,0x3f7bbf80,0x3f55bf6d,0xbf7b3f80,0xbf553f6d,0xbf463f35,0xbf623f55,0xbf223f35,0xbef13f0e
.long 0x3f808000,0xbf80250d,0x3f808000,0xbf80250d,0xbe95bf6d,0x3dc93f7b,0x3f75bec4,0xbf7f3e48,0xbf553f35,0x3f7bbec4,0x3f55bf35,0xbf7b3ec4,0x3f463ec4,0xbe95bf55,0x3f22bf6d,0xbf753f0e
.long 0x3ec4bf80,0xbf6d3f35,0x3ec4bf80,0xbf6d3f35,0xbf7f3ec4,0x3ef13f0e,0x3dc9bf6d,0xbf623f55,0x3e483f35,0x3f55bf6d,0xbe48bf35,0xbf553f6d,0x3f62bf6d,0xbf22be48,0xbef1bec4,0xbf463f7b
.long 0xbf35250d,0xbf353f80,0xbf35250d,0xbf353f80,0xbef13f6d,0x3f46be48,0xbf623ec4,0xbf223f7b,0x3f7bbf35,0x3f0ebf6d,0xbf7b3f35,0xbf0e3f6d,0xbdc9bec4,0xbf623f0e,0xbf7f3f6d,0xbef13f55
.long 0xbf6d3f80,0xbec43f35,0xbf6d3f80,0xbec43f35,0x3f22bec4,0x3f75bf55,0xbf463f6d,0xbe953f0e,0x3f0ebf35,0x3e48bec4,0xbf0e3f35,0xbe483ec4,0xbf753f6d,0xbf7f3f7b,0xbe953ec4,0xbdc93e48
.long 0x250d8000,0x250d8000,0x250d8000,0x250d8000,0xbdc98000,0xbe953e48,0xbf7f3f80,0xbf753f7b,0xbe488000,0xbf0e3ec4,0x3e48250d,0x3f0ebec4,0xbe958000,0xbf463f0e,0x3f75bf80,0x3f22bf55
.long 0xbec48000,0xbf6d3f35,0xbec48000,0xbf6d3f35,0xbef18000,0xbf7f3f55,0xbf623f80,0xbdc93f0e,0xbf0e8000,0xbf7b3f6d,0x3f0e250d,0x3f7bbf6d,0xbf228000,0xbf623f7b,0x3f46bf80,0xbef1be48
.long 0xbf358000,0xbf353f80,0xbf358000,0xbf353f80,0xbf468000,0xbef13f7b,0xbf223f80,0x3f62be48,0xbf558000,0xbe483f6d,0x3f55250d,0x3e48bf6d,0xbf628000,0x3dc93f55,0x3ef1bf80,0xbf7f3f0e
.long 0xbf6d8000,0x3ec43f35,0xbf6d8000,0x3ec43f35,0xbf758000,0x3f223f0e,0xbe953f80,0x3f46bf55,0xbf7b8000,0x3f553ec4,0x3f7b250d,0xbf55bec4,0xbf7f8000,0x3f753e48,0x3dc9bf80,0xbe953f7b
.long 0x250d8000,0x250d8000,0x250d8000,0x250d8000,0xbef13ec4,0xbf223f0e,0xbf623f6d,0xbf463f55,0xbf553f35,0xbf7b3f6d,0x3f55bf35,0x3f7bbf6d,0xbf7f3f6d,0xbf623f7b,0x3dc9bec4,0xbef13e48
.long 0xbf6d3f80,0xbec43f35,0xbf6d3f80,0xbec43f35,0xbf223f6d,0x3e953e48,0x3f46bec4,0x3f75bf7b,0xbe483f35,0x3f55bec4,0x3e48bf35,0xbf553ec4,0x3e953ec4,0x3f7fbf55,0xbf753f6d,0x3dc93f0e
.long 0x3f35250d,0x3f35bf80,0x3f35250d,0x3f35bf80,0x3f75bec4,0x3dc9bf55,0x3e95bf6d,0xbf7f3f0e,0x3f7bbf35,0xbf0ebec4,0xbf7b3f35,0x3f0e3ec4,0x3f46bf6d,0xbf753e48,0x3f223ec4,0x3e95bf7b
.long 0x3ec4bf80,0xbf6d3f35,0x3ec4bf80,0xbf6d3f35,0xbdc9bf6d,0xbef13f7b,0xbf7f3ec4,0x3f623e48,0xbf0ebf35,0x3e483f6d,0x3f0e3f35,0xbe48bf6d,0xbf62bec4,0x3f463f0e,0x3ef1bf6d,0xbf223f55
.long 0x250d8000,0x250d8000,0x250d8000,0x250d8000,0xbf463f35,0xbf623f55,0xbf223f35,0xbef13f0e,0xbf7b3f80,0xbf553f6d,0x3f7bbf80,0x3f55bf6d,0xbef13f35,0x3dc93e48,0xbf623f35,0xbf7f3f7b
.long 0x3ec4250d,0x3f6dbf35,0x3ec4250d,0x3f6dbf35,0x3f75bf35,0x3f46bf7b,0x3e95bf35,0xbf223e48,0x3f55bf80,0xbe48bec4,0xbf553f80,0x3e483ec4,0x3dc9bf35,0xbf753f0e,0x3f7fbf35,0x3e95bf55
.long 0xbf358000,0xbf353f80,0xbf358000,0xbf353f80,0xbf7f3f35,0x3e953f0e,0x3dc93f35,0x3f75bf55,0xbf0e3f80,0x3f7bbec4,0x3f0ebf80,0xbf7b3ec4,0x3e953f35,0x3f22bf7b,0xbf753f35,0x3f463e48
.long 0x3f6d250d,0xbec4bf35,0x3f6d250d,0xbec4bf35,0x3f62bf35,0xbf7f3e48,0xbef1bf35,0xbdc93f7b,0x3e48bf80,0xbf0e3f6d,0xbe483f80,0x3f0ebf6d,0xbf22bf35,0x3ef13f55,0x3f46bf35,0xbf623f0e
.long 0x250d8000,0x250d8000,0x250d8000,0x250d8000,0xbf753f6d,0xbf7f3f7b,0xbe953ec4,0xbdc93e48,0xbf0e3f35,0xbe483ec4,0x3f0ebf35,0x3e48bec4,0x3f22bec4,0x3f75bf55,0xbf463f6d,0xbe953f0e
.long 0x3f6dbf80,0x3ec4bf35,0x3f6dbf80,0x3ec4bf35,0xbdc9bec4,0xbf623f0e,0xbf7f3f6d,0xbef13f55,0xbf7b3f35,0xbf0e3f6d,0x3f7bbf35,0x3f0ebf6d,0xbef13f6d,0x3f46be48,0xbf623ec4,0xbf223f7b
.long 0x3f35250d,0x3f35bf80,0x3f35250d,0x3f35bf80,0x3f62bf6d,0xbf22be48,0xbef1bec4,0xbf463f7b,0xbe48bf35,0xbf553f6d,0x3e483f35,0x3f55bf6d,0xbf7f3ec4,0x3ef13f0e,0x3dc9bf6d,0xbf623f55
.long 0xbec43f80,0x3f6dbf35,0xbec43f80,0x3f6dbf35,0x3f463ec4,0xbe95bf55,0x3f22bf6d,0xbf753f0e,0x3f55bf35,0xbf7b3ec4,0xbf553f35,0x3f7bbec4,0xbe95bf6d,0x3dc93f7b,0x3f75bec4,0xbf7f3e48
.long 0x250d8000,0x250d8000,0x250d8000,0x250d8000,0x3dc9250d,0x3e95be48,0x3f7fbf80,0x3f75bf7b,0xbe488000,0xbf0e3ec4,0x3e48250d,0x3f0ebec4,0x3e95250d,0x3f46bf0e,0xbf753f80,0xbf223f55
.long 0xbec48000,0xbf6d3f35,0xbec48000,0xbf6d3f35,0x3ef1250d,0x3f7fbf55,0x3f62bf80,0x3dc9bf0e,0xbf0e8000,0xbf7b3f6d,0x3f0e250d,0x3f7bbf6d,0x3f22250d,0x3f62bf7b,0xbf463f80,0x3ef13e48
.long 0xbf358000,0xbf353f80,0xbf358000,0xbf353f80,0x3f46250d,0x3ef1bf7b,0x3f22bf80,0xbf623e48,0xbf558000,0xbe483f6d,0x3f55250d,0x3e48bf6d,0x3f62250d,0xbdc9bf55,0xbef13f80,0x3f7fbf0e
.long 0xbf6d8000,0x3ec43f35,0xbf6d8000,0x3ec43f35,0x3f75250d,0xbf22bf0e,0x3e95bf80,0xbf463f55,0xbf7b8000,0x3f553ec4,0x3f7b250d,0xbf55bec4,0x3f7f250d,0xbf75be48,0xbdc93f80,0x3e95bf7b
.long 0x250d8000,0x250d8000,0x250d8000,0x250d8000,0x3ef1bec4,0x3f22bf0e,0x3f62bf6d,0x3f46bf55,0xbf553f35,0xbf7b3f6d,0x3f55bf35,0x3f7bbf6d,0x3f7fbf6d,0x3f62bf7b,0xbdc93ec4,0x3ef1be48
.long 0xbf6d3f80,0xbec43f35,0xbf6d3f80,0xbec43f35,0x3f22bf6d,0xbe95be48,0xbf463ec4,0xbf753f7b,0xbe483f35,0x3f55bec4,0x3e48bf35,0xbf553ec4,0xbe95bec4,0xbf7f3f55,0x3f75bf6d,0xbdc9bf0e
.long 0x3f35250d,0x3f35bf80,0x3f35250d,0x3f35bf80,0xbf753ec4,0xbdc93f55,0xbe953f6d,0x3f7fbf0e,0x3f7bbf35,0xbf0ebec4,0xbf7b3f35,0x3f0e3ec4,0xbf463f6d,0x3f75be48,0xbf22bec4,0xbe953f7b
.long 0x3ec4bf80,0xbf6d3f35,0x3ec4bf80,0xbf6d3f35,0x3dc93f6d,0x3ef1bf7b,0x3f7fbec4,0xbf62be48,0xbf0ebf35,0x3e483f6d,0x3f0e3f35,0xbe48bf6d,0x3f623ec4,0xbf46bf0e,0xbef13f6d,0x3f22bf55
.long 0x250d8000,0x250d8000,0x250d8000,0x250d8000,0x3f46bf35,0x3f62bf55,0x3f22bf35,0x3ef1bf0e,0xbf7b3f80,0xbf553f6d,0x3f7bbf80,0x3f55bf6d,0x3ef1bf35,0xbdc9be48,0x3f62bf35,0x3f7fbf7b
.long 0x3ec4250d,0x3f6dbf35,0x3ec4250d,0x3f6dbf35,0xbf753f35,0xbf463f7b,0xbe953f35,0x3f22be48,0x3f55bf80,0xbe48bec4,0xbf553f80,0x3e483ec4,0xbdc93f35,0x3f75bf0e,0xbf7f3f35,0xbe953f55
.long 0xbf358000,0xbf353f80,0xbf358000,0xbf353f80,0x3f7fbf35,0xbe95bf0e,0xbdc9bf35,0xbf753f55,0xbf0e3f80,0x3f7bbec4,0x3f0ebf80,0xbf7b3ec4,0xbe95bf35,0xbf223f7b,0x3f75bf35,0xbf46be48
.long 0x3f6d250d,0xbec4bf35,0x3f6d250d,0xbec4bf35,0xbf623f35,0x3f7fbe48,0x3ef13f35,0x3dc9bf7b,0x3e48bf80,0xbf0e3f6d,0xbe483f80,0x3f0ebf6d,0x3f223f35,0xbef1bf55,0xbf463f35,0x3f62bf0e
.long 0x250d8000,0x250d8000,0x250d8000,0x250d8000,0x3f75bf6d,0x3f7fbf7b,0x3e95bec4,0x3dc9be48,0xbf0e3f35,0xbe483ec4,0x3f0ebf35,0x3e48bec4,0xbf223ec4,0xbf753f55,0x3f46bf6d,0x3e95bf0e
.long 0x3f6dbf80,0x3ec4bf35,0x3f6dbf80,0x3ec4bf35,0x3dc93ec4,0x3f62bf0e,0x3f7fbf6d,0x3ef1bf55,0xbf7b3f35,0xbf0e3f6d,0x3f7bbf35,0x3f0ebf6d,0x3ef1bf6d,0xbf463e48,0x3f62bec4,0x3f22bf7b
.long 0x3f35250d,0x3f35bf80,0x3f35250d,0x3f35bf80,0xbf623f6d,0x3f223e48,0x3ef13ec4,0x3f46bf7b,0xbe48bf35,0xbf553f6d,0x3e483f35,0x3f55bf6d,0x3f7fbec4,0xbef1bf0e,0xbdc93f6d,0x3f62bf55
.long 0xbec43f80,0x3f6dbf35,0xbec43f80,0x3f6dbf35,0xbf46bec4,0x3e953f55,0xbf223f6d,0x3f75bf0e,0x3f55bf35,0xbf7b3ec4,0xbf553f35,0x3f7bbec4,0x3e953f6d,0xbdc9bf7b,0xbf753ec4,0x3f7fbe48
.long 0xbf808000,0x3f80250d,0xbf808000,0x3f80250d,0xbf7f8000,0x3f75be48,0x3dc93f80,0xbe95bf7b,0xbf7b8000,0x3f55bec4,0x3f7b250d,0xbf553ec4,0xbf758000,0x3f22bf0e,0xbe95bf80,0x3f463f55
.long 0xbf6d8000,0x3ec4bf35,0xbf6d8000,0x3ec4bf35,0xbf628000,0x3dc9bf55,0x3ef13f80,0xbf7fbf0e,0xbf558000,0xbe48bf6d,0x3f55250d,0x3e483f6d,0xbf468000,0xbef1bf7b,0xbf22bf80,0x3f623e48
.long 0xbf358000,0xbf35bf80,0xbf358000,0xbf35bf80,0xbf228000,0xbf62bf7b,0x3f463f80,0xbef13e48,0xbf0e8000,0xbf7bbf6d,0x3f0e250d,0x3f7b3f6d,0xbef18000,0xbf7fbf55,0xbf62bf80,0xbdc9bf0e
.long 0xbec48000,0xbf6dbf35,0xbec48000,0xbf6dbf35,0xbe958000,0xbf46bf0e,0x3f753f80,0x3f223f55,0xbe488000,0xbf0ebec4,0x3e48250d,0x3f0e3ec4,0xbdc98000,0xbe95be48,0xbf7fbf80,0xbf75bf7b
.long 0xbf808000,0x3f80250d,0xbf808000,0x3f80250d,0xbf623ec4,0x3f46bf0e,0x3ef13f6d,0xbf22bf55,0xbf0e3f35,0x3e48bf6d,0x3f0ebf35,0xbe483f6d,0xbdc93f6d,0xbef1bf7b,0xbf7fbec4,0x3f62be48
.long 0x3ec43f80,0xbf6dbf35,0x3ec43f80,0xbf6dbf35,0x3f463f6d,0xbf75be48,0x3f22bec4,0x3e953f7b,0x3f7b3f35,0xbf0e3ec4,0xbf7bbf35,0x3f0ebec4,0x3f753ec4,0x3dc93f55,0x3e953f6d,0xbf7fbf0e
.long 0x3f35250d,0x3f353f80,0x3f35250d,0x3f353f80,0x3e95bec4,0x3f7f3f55,0xbf75bf6d,0x3dc9bf0e,0xbe48bf35,0x3f553ec4,0x3e483f35,0xbf55bec4,0xbf22bf6d,0x3e95be48,0x3f463ec4,0x3f753f7b
.long 0xbf6dbf80,0xbec4bf35,0xbf6dbf80,0xbec4bf35,0xbf7fbf6d,0xbf62bf7b,0x3dc93ec4,0xbef1be48,0xbf55bf35,0xbf7bbf6d,0x3f553f35,0x3f7b3f6d,0xbef1bec4,0xbf22bf0e,0xbf62bf6d,0xbf46bf55
.long 0xbf808000,0x3f80250d,0xbf808000,0x3f80250d,0xbf223f35,0x3ef1bf55,0x3f463f35,0xbf62bf0e,0x3e483f80,0xbf0ebf6d,0xbe48bf80,0x3f0e3f6d,0x3f623f35,0xbf7fbe48,0xbef13f35,0xbdc9bf7b
.long 0x3f6d250d,0xbec43f35,0x3f6d250d,0xbec43f35,0x3e95bf35,0x3f223f7b,0xbf75bf35,0x3f46be48,0xbf0ebf80,0x3f7b3ec4,0x3f0e3f80,0xbf7bbec4,0xbf7fbf35,0x3e95bf0e,0x3dc9bf35,0x3f753f55
.long 0xbf358000,0xbf35bf80,0xbf358000,0xbf35bf80,0x3dc93f35,0xbf75bf0e,0x3f7f3f35,0x3e953f55,0x3f553f80,0xbe483ec4,0xbf55bf80,0x3e48bec4,0x3f753f35,0x3f463f7b,0x3e953f35,0xbf22be48
.long 0x3ec4250d,0x3f6d3f35,0x3ec4250d,0x3f6d3f35,0xbef1bf35,0x3dc9be48,0xbf62bf35,0xbf7fbf7b,0xbf7bbf80,0xbf55bf6d,0x3f7b3f80,0x3f553f6d,0xbf46bf35,0xbf62bf55,0xbf22bf35,0xbef1bf0e
.long 0xbf808000,0x3f80250d,0xbf808000,0x3f80250d,0xbe953f6d,0x3dc9bf7b,0x3f753ec4,0xbf7fbe48,0x3f553f35,0xbf7bbec4,0xbf55bf35,0x3f7b3ec4,0x3f46bec4,0xbe953f55,0x3f223f6d,0xbf75bf0e
.long 0xbec4bf80,0x3f6d3f35,0xbec4bf80,0x3f6d3f35,0xbf7fbec4,0x3ef1bf0e,0x3dc93f6d,0xbf62bf55,0xbe483f35,0xbf55bf6d,0x3e48bf35,0x3f553f6d,0x3f623f6d,0xbf223e48,0xbef13ec4,0xbf46bf7b
.long 0x3f35250d,0x3f353f80,0x3f35250d,0x3f353f80,0xbef1bf6d,0x3f463e48,0xbf62bec4,0xbf22bf7b,0xbf7bbf35,0xbf0ebf6d,0x3f7b3f35,0x3f0e3f6d,0xbdc93ec4,0xbf62bf0e,0xbf7fbf6d,0xbef1bf55
.long 0x3f6d3f80,0x3ec43f35,0x3f6d3f80,0x3ec43f35,0x3f223ec4,0x3f753f55,0xbf46bf6d,0xbe95bf0e,0xbf0ebf35,0xbe48bec4,0x3f0e3f35,0x3e483ec4,0xbf75bf6d,0xbf7fbf7b,0xbe95bec4,0xbdc9be48
.long 0xbf808000,0x3f80250d,0xbf808000,0x3f80250d,0x3f7f250d,0xbf753e48,0xbdc9bf80,0x3e953f7b,0xbf7b8000,0x3f55bec4,0x3f7b250d,0xbf553ec4,0x3f75250d,0xbf223f0e,0x3e953f80,0xbf46bf55
.long 0xbf6d8000,0x3ec4bf35,0xbf6d8000,0x3ec4bf35,0x3f62250d,0xbdc93f55,0xbef1bf80,0x3f7f3f0e,0xbf558000,0xbe48bf6d,0x3f55250d,0x3e483f6d,0x3f46250d,0x3ef13f7b,0x3f223f80,0xbf62be48
.long 0xbf358000,0xbf35bf80,0xbf358000,0xbf35bf80,0x3f22250d,0x3f623f7b,0xbf46bf80,0x3ef1be48,0xbf0e8000,0xbf7bbf6d,0x3f0e250d,0x3f7b3f6d,0x3ef1250d,0x3f7f3f55,0x3f623f80,0x3dc93f0e
.long 0xbec48000,0xbf6dbf35,0xbec48000,0xbf6dbf35,0x3e95250d,0x3f463f0e,0xbf75bf80,0xbf22bf55,0xbe488000,0xbf0ebec4,0x3e48250d,0x3f0e3ec4,0x3dc9250d,0x3e953e48,0x3f7f3f80,0x3f753f7b
.long 0xbf808000,0x3f80250d,0xbf808000,0x3f80250d,0x3f62bec4,0xbf463f0e,0xbef1bf6d,0x3f223f55,0xbf0e3f35,0x3e48bf6d,0x3f0ebf35,0xbe483f6d,0x3dc9bf6d,0x3ef13f7b,0x3f7f3ec4,0xbf623e48
.long 0x3ec43f80,0xbf6dbf35,0x3ec43f80,0xbf6dbf35,0xbf46bf6d,0x3f753e48,0xbf223ec4,0xbe95bf7b,0x3f7b3f35,0xbf0e3ec4,0xbf7bbf35,0x3f0ebec4,0xbf75bec4,0xbdc9bf55,0xbe95bf6d,0x3f7f3f0e
.long 0x3f35250d,0x3f353f80,0x3f35250d,0x3f353f80,0xbe953ec4,0xbf7fbf55,0x3f753f6d,0xbdc93f0e,0xbe48bf35,0x3f553ec4,0x3e483f35,0xbf55bec4,0x3f223f6d,0xbe953e48,0xbf46bec4,0xbf75bf7b
.long 0xbf6dbf80,0xbec4bf35,0xbf6dbf80,0xbec4bf35,0x3f7f3f6d,0x3f623f7b,0xbdc9bec4,0x3ef13e48,0xbf55bf35,0xbf7bbf6d,0x3f553f35,0x3f7b3f6d,0x3ef13ec4,0x3f223f0e,0x3f623f6d,0x3f463f55
.long 0xbf808000,0x3f80250d,0xbf808000,0x3f80250d,0x3f22bf35,0xbef13f55,0xbf46bf35,0x3f623f0e,0x3e483f80,0xbf0ebf6d,0xbe48bf80,0x3f0e3f6d,0xbf62bf35,0x3f7f3e48,0x3ef1bf35,0x3dc93f7b
.long 0x3f6d250d,0xbec43f35,0x3f6d250d,0xbec43f35,0xbe953f35,0xbf22bf7b,0x3f753f35,0xbf463e48,0xbf0ebf80,0x3f7b3ec4,0x3f0e3f80,0xbf7bbec4,0x3f7f3f35,0xbe953f0e,0xbdc93f35,0xbf75bf55
.long 0xbf358000,0xbf35bf80,0xbf358000,0xbf35bf80,0xbdc9bf35,0x3f753f0e,0xbf7fbf35,0xbe95bf55,0x3f553f80,0xbe483ec4,0xbf55bf80,0x3e48bec4,0xbf75bf35,0xbf46bf7b,0xbe95bf35,0x3f223e48
.long 0x3ec4250d,0x3f6d3f35,0x3ec4250d,0x3f6d3f35,0x3ef13f35,0xbdc93e48,0x3f623f35,0x3f7f3f7b,0xbf7bbf80,0xbf55bf6d,0x3f7b3f80,0x3f553f6d,0x3f463f35,0x3f623f55,0x3f223f35,0x3ef13f0e
.long 0xbf808000,0x3f80250d,0xbf808000,0x3f80250d,0x3e95bf6d,0xbdc93f7b,0xbf75bec4,0x3f7f3e48,0x3f553f35,0xbf7bbec4,0xbf55bf35,0x3f7b3ec4,0xbf463ec4,0x3e95bf55,0xbf22bf6d,0x3f753f0e
.long 0xbec4bf80,0x3f6d3f35,0xbec4bf80,0x3f6d3f35,0x3f7f3ec4,0xbef13f0e,0xbdc9bf6d,0x3f623f55,0xbe483f35,0xbf55bf6d,0x3e48bf35,0x3f553f6d,0xbf62bf6d,0x3f22be48,0x3ef1bec4,0x3f463f7b
.long 0x3f35250d,0x3f353f80,0x3f35250d,0x3f353f80,0x3ef13f6d,0xbf46be48,0x3f623ec4,0x3f223f7b,0xbf7bbf35,0xbf0ebf6d,0x3f7b3f35,0x3f0e3f6d,0x3dc9bec4,0x3f623f0e,0x3f7f3f6d,0x3ef13f55
.long 0x3f6d3f80,0x3ec43f35,0x3f6d3f80,0x3ec43f35,0xbf22bec4,0xbf75bf55,0x3f463f6d,0x3e953f0e,0xbf0ebf35,0xbe48bec4,0x3f0e3f35,0x3e483ec4,0x3f753f6d,0x3f7f3f7b,0x3e953ec4,0x3dc93e48
.long 0x3f803f80,0x3f803f80,0x3f803f80,0x3f803f80,0x3f7b3f80,0x3f553f6d,0x3f0e3f35,0x3e483ec4,0x3f6d3f80,0x3ec43f35,0xbec4248d,0xbf6dbf35,0x3f553f80,0xbe483ec4,0xbf7bbf35,0xbf0ebf6d
.long 0x3f353f80,0xbf35248d,0xbf35bf80,0x3f35a554,0x3f0e3f80,0xbf7bbec4,0x3e48bf35,0x3f553f6d,0x3ec43f80,0xbf6dbf35,0x3f6da554,0xbec43f35,0x3e483f80,0xbf0ebf6d,0x3f553f35,0xbf7bbec4
.long 0x248d3f80,0xa554bf80,0x248d3f80,0xa554bf80,0xbe483f80,0x3f0ebf6d,0xbf553f35,0x3f7bbec4,0xbec43f80,0x3f6dbf35,0xbf6d248d,0x3ec43f35,0xbf0e3f80,0x3f7bbec4,0xbe48bf35,0xbf553f6d
.long 0xbf353f80,0x3f35a554,0x3f35bf80,0xbf35248d,0xbf553f80,0x3e483ec4,0x3f7bbf35,0x3f0ebf6d,0xbf6d3f80,0xbec43f35,0x3ec4a554,0x3f6dbf35,0xbf7b3f80,0xbf553f6d,0xbf0e3f35,0xbe483ec4
.long 0x3f803f80,0x3f803f80,0x3f803f80,0x3f803f80,0xbe48248d,0xbf0ebec4,0xbf55bf35,0xbf7bbf6d,0xbf6dbf80,0xbec4bf35,0x3ec4a554,0x3f6d3f35,0x3f0ea554,0x3f7b3f6d,0x3e483f35,0xbf55bec4
.long 0x3f353f80,0xbf35248d,0xbf35bf80,0x3f35a554,0xbf55248d,0xbe48bf6d,0x3f7b3f35,0xbf0e3ec4,0xbec4bf80,0x3f6d3f35,0xbf6d248d,0x3ec4bf35,0x3f7ba554,0xbf553ec4,0x3f0ebf35,0xbe483f6d
.long 0x248d3f80,0xa554bf80,0x248d3f80,0xa554bf80,0xbf7b248d,0x3f553ec4,0xbf0ebf35,0x3e483f6d,0x3ec4bf80,0xbf6d3f35,0x3f6da554,0xbec4bf35,0x3f55a554,0x3e48bf6d,0xbf7b3f35,0x3f0e3ec4
.long 0xbf353f80,0x3f35a554,0x3f35bf80,0xbf35248d,0xbf0e248d,0xbf7b3f6d,0xbe483f35,0x3f55bec4,0x3f6dbf80,0x3ec4bf35,0xbec4248d,0xbf6d3f35,0x3e48a554,0x3f0ebec4,0x3f55bf35,0x3f7bbf6d
.long 0x3f803f80,0x3f803f80,0x3f803f80,0x3f803f80,0xbf7bbf80,0xbf55bf6d,0xbf0ebf35,0xbe48bec4,0x3f6d3f80,0x3ec43f35,0xbec4248d,0xbf6dbf35,0xbf55bf80,0x3e48bec4,0x3f7b3f35,0x3f0e3f6d
.long 0x3f353f80,0xbf35248d,0xbf35bf80,0x3f35a554,0xbf0ebf80,0x3f7b3ec4,0xbe483f35,0xbf55bf6d,0x3ec43f80,0xbf6dbf35,0x3f6da554,0xbec43f35,0xbe48bf80,0x3f0e3f6d,0xbf55bf35,0x3f7b3ec4
.long 0x248d3f80,0xa554bf80,0x248d3f80,0xa554bf80,0x3e48bf80,0xbf0e3f6d,0x3f55bf35,0xbf7b3ec4,0xbec43f80,0x3f6dbf35,0xbf6d248d,0x3ec43f35,0x3f0ebf80,0xbf7b3ec4,0x3e483f35,0x3f55bf6d
.long 0xbf353f80,0x3f35a554,0x3f35bf80,0xbf35248d,0x3f55bf80,0xbe48bec4,0xbf7b3f35,0xbf0e3f6d,0xbf6d3f80,0xbec43f35,0x3ec4a554,0x3f6dbf35,0x3f7bbf80,0x3f55bf6d,0x3f0ebf35,0x3e48bec4
.long 0x3f803f80,0x3f803f80,0x3f803f80,0x3f803f80,0x3e48a554,0x3f0e3ec4,0x3f553f35,0x3f7b3f6d,0xbf6dbf80,0xbec4bf35,0x3ec4a554,0x3f6d3f35,0xbf0e248d,0xbf7bbf6d,0xbe48bf35,0x3f553ec4
.long 0x3f353f80,0xbf35248d,0xbf35bf80,0x3f35a554,0x3f55a554,0x3e483f6d,0xbf7bbf35,0x3f0ebec4,0xbec4bf80,0x3f6d3f35,0xbf6d248d,0x3ec4bf35,0xbf7b248d,0x3f55bec4,0xbf0e3f35,0x3e48bf6d
.long 0x248d3f80,0xa554bf80,0x248d3f80,0xa554bf80,0x3f7ba554,0xbf55bec4,0x3f0e3f35,0xbe48bf6d,0x3ec4bf80,0xbf6d3f35,0x3f6da554,0xbec4bf35,0xbf55248d,0xbe483f6d,0x3f7bbf35,0xbf0ebec4
.long 0xbf353f80,0x3f35a554,0x3f35bf80,0xbf35248d,0x3f0ea554,0x3f7bbf6d,0x3e48bf35,0xbf553ec4,0x3f6dbf80,0x3ec4bf35,0xbec4248d,0xbf6d3f35,0xbe48248d,0xbf0e3ec4,0xbf553f35,0xbf7b3f6d
.long 0x0,0x0,0x0,0x0,0xbe480000,0xbf0ebec4,0xbf55bf35,0xbf7bbf6d,0xbec40000,0xbf6dbf35,0xbf6dbf80,0xbec4bf35,0xbf0e0000,0xbf7bbf6d,0xbe48bf35,0x3f553ec4
.long 0xbf350000,0xbf35bf80,0x3f35a50d,0x3f353f80,0xbf550000,0xbe48bf6d,0x3f7b3f35,0xbf0e3ec4,0xbf6d0000,0x3ec4bf35,0x3ec43f80,0xbf6dbf35,0xbf7b0000,0x3f55bec4,0xbf0e3f35,0x3e48bf6d
.long 0xbf800000,0x3f80a50d,0xbf800000,0x3f80a50d,0xbf7b0000,0x3f553ec4,0xbf0ebf35,0x3e483f6d,0xbf6d0000,0x3ec43f35,0x3ec4bf80,0xbf6d3f35,0xbf550000,0xbe483f6d,0x3f7bbf35,0xbf0ebec4
.long 0xbf350000,0xbf353f80,0x3f35a50d,0x3f35bf80,0xbf0e0000,0xbf7b3f6d,0xbe483f35,0x3f55bec4,0xbec40000,0xbf6d3f35,0xbf6d3f80,0xbec43f35,0xbe480000,0xbf0e3ec4,0xbf553f35,0xbf7b3f6d
.long 0x0,0x0,0x0,0x0,0xbf7bbf80,0xbf55bf6d,0xbf0ebf35,0xbe48bec4,0x3ec4a50d,0x3f6d3f35,0x3f6d3f80,0x3ec43f35,0x3f553f80,0xbe483ec4,0xbf7bbf35,0xbf0ebf6d
.long 0xbf350000,0xbf35bf80,0x3f35a50d,0x3f353f80,0xbf0ebf80,0x3f7b3ec4,0xbe483f35,0xbf55bf6d,0x3f6da50d,0xbec43f35,0xbec4bf80,0x3f6d3f35,0x3e483f80,0xbf0ebf6d,0x3f553f35,0xbf7bbec4
.long 0xbf800000,0x3f80a50d,0xbf800000,0x3f80a50d,0x3e48bf80,0xbf0e3f6d,0x3f55bf35,0xbf7b3ec4,0x3f6da50d,0xbec4bf35,0xbec43f80,0x3f6dbf35,0xbf0e3f80,0x3f7bbec4,0xbe48bf35,0xbf553f6d
.long 0xbf350000,0xbf353f80,0x3f35a50d,0x3f35bf80,0x3f55bf80,0xbe48bec4,0xbf7b3f35,0xbf0e3f6d,0x3ec4a50d,0x3f6dbf35,0x3f6dbf80,0x3ec4bf35,0xbf7b3f80,0xbf553f6d,0xbf0e3f35,0xbe483ec4
.long 0x0,0x0,0x0,0x0,0x3e48a50d,0x3f0e3ec4,0x3f553f35,0x3f7b3f6d,0xbec40000,0xbf6dbf35,0xbf6dbf80,0xbec4bf35,0x3f0ea50d,0x3f7b3f6d,0x3e483f35,0xbf55bec4
.long 0xbf350000,0xbf35bf80,0x3f35a50d,0x3f353f80,0x3f55a50d,0x3e483f6d,0xbf7bbf35,0x3f0ebec4,0xbf6d0000,0x3ec4bf35,0x3ec43f80,0xbf6dbf35,0x3f7ba50d,0xbf553ec4,0x3f0ebf35,0xbe483f6d
.long 0xbf800000,0x3f80a50d,0xbf800000,0x3f80a50d,0x3f7ba50d,0xbf55bec4,0x3f0e3f35,0xbe48bf6d,0xbf6d0000,0x3ec43f35,0x3ec4bf80,0xbf6d3f35,0x3f55a50d,0x3e48bf6d,0xbf7b3f35,0x3f0e3ec4
.long 0xbf350000,0xbf353f80,0x3f35a50d,0x3f35bf80,0x3f0ea50d,0x3f7bbf6d,0x3e48bf35,0xbf553ec4,0xbec40000,0xbf6d3f35,0xbf6d3f80,0xbec43f35,0x3e48a50d,0x3f0ebec4,0x3f55bf35,0x3f7bbf6d
.long 0x0,0x0,0x0,0x0,0x3f7b3f80,0x3f553f6d,0x3f0e3f35,0x3e483ec4,0x3ec4a50d,0x3f6d3f35,0x3f6d3f80,0x3ec43f35,0xbf55bf80,0x3e48bec4,0x3f7b3f35,0x3f0e3f6d
.long 0xbf350000,0xbf35bf80,0x3f35a50d,0x3f353f80,0x3f0e3f80,0xbf7bbec4,0x3e48bf35,0x3f553f6d,0x3f6da50d,0xbec43f35,0xbec4bf80,0x3f6d3f35,0xbe48bf80,0x3f0e3f6d,0xbf55bf35,0x3f7b3ec4
.long 0xbf800000,0x3f80a50d,0xbf800000,0x3f80a50d,0xbe483f80,0x3f0ebf6d,0xbf553f35,0x3f7bbec4,0x3f6da50d,0xbec4bf35,0xbec43f80,0x3f6dbf35,0x3f0ebf80,0xbf7b3ec4,0x3e483f35,0x3f55bf6d
.long 0xbf350000,0xbf353f80,0x3f35a50d,0x3f35bf80,0xbf553f80,0x3e483ec4,0x3f7bbf35,0x3f0ebf6d,0x3ec4a50d,0x3f6dbf35,0x3f6dbf80,0x3ec4bf35,0x3f7bbf80,0x3f55bf6d,0x3f0ebf35,0x3e48bec4
.long 0x80008000,0x80008000,0x80008000,0x80008000,0x3e488000,0x3f0e3ec4,0x3f553f35,0x3f7b3f6d,0x3ec48000,0x3f6d3f35,0x3f6d3f80,0x3ec43f35,0x3f0e8000,0x3f7b3f6d,0x3e483f35,0xbf55bec4
.long 0x3f358000,0x3f353f80,0xbf35250d,0xbf35bf80,0x3f558000,0x3e483f6d,0xbf7bbf35,0x3f0ebec4,0x3f6d8000,0xbec43f35,0xbec4bf80,0x3f6d3f35,0x3f7b8000,0xbf553ec4,0x3f0ebf35,0xbe483f6d
.long 0x3f808000,0xbf80250d,0x3f808000,0xbf80250d,0x3f7b8000,0xbf55bec4,0x3f0e3f35,0xbe48bf6d,0x3f6d8000,0xbec4bf35,0xbec43f80,0x3f6dbf35,0x3f558000,0x3e48bf6d,0xbf7b3f35,0x3f0e3ec4
.long 0x3f358000,0x3f35bf80,0xbf35250d,0xbf353f80,0x3f0e8000,0x3f7bbf6d,0x3e48bf35,0xbf553ec4,0x3ec48000,0x3f6dbf35,0x3f6dbf80,0x3ec4bf35,0x3e488000,0x3f0ebec4,0x3f55bf35,0x3f7bbf6d
.long 0x80008000,0x80008000,0x80008000,0x80008000,0x3f7b3f80,0x3f553f6d,0x3f0e3f35,0x3e483ec4,0xbec4250d,0xbf6dbf35,0xbf6dbf80,0xbec4bf35,0xbf55bf80,0x3e48bec4,0x3f7b3f35,0x3f0e3f6d
.long 0x3f358000,0x3f353f80,0xbf35250d,0xbf35bf80,0x3f0e3f80,0xbf7bbec4,0x3e48bf35,0x3f553f6d,0xbf6d250d,0x3ec4bf35,0x3ec43f80,0xbf6dbf35,0xbe48bf80,0x3f0e3f6d,0xbf55bf35,0x3f7b3ec4
.long 0x3f808000,0xbf80250d,0x3f808000,0xbf80250d,0xbe483f80,0x3f0ebf6d,0xbf553f35,0x3f7bbec4,0xbf6d250d,0x3ec43f35,0x3ec4bf80,0xbf6d3f35,0x3f0ebf80,0xbf7b3ec4,0x3e483f35,0x3f55bf6d
.long 0x3f358000,0x3f35bf80,0xbf35250d,0xbf353f80,0xbf553f80,0x3e483ec4,0x3f7bbf35,0x3f0ebf6d,0xbec4250d,0xbf6d3f35,0xbf6d3f80,0xbec43f35,0x3f7bbf80,0x3f55bf6d,0x3f0ebf35,0x3e48bec4
.long 0x80008000,0x80008000,0x80008000,0x80008000,0xbe48250d,0xbf0ebec4,0xbf55bf35,0xbf7bbf6d,0x3ec48000,0x3f6d3f35,0x3f6d3f80,0x3ec43f35,0xbf0e250d,0xbf7bbf6d,0xbe48bf35,0x3f553ec4
.long 0x3f358000,0x3f353f80,0xbf35250d,0xbf35bf80,0xbf55250d,0xbe48bf6d,0x3f7b3f35,0xbf0e3ec4,0x3f6d8000,0xbec43f35,0xbec4bf80,0x3f6d3f35,0xbf7b250d,0x3f55bec4,0xbf0e3f35,0x3e48bf6d
.long 0x3f808000,0xbf80250d,0x3f808000,0xbf80250d,0xbf7b250d,0x3f553ec4,0xbf0ebf35,0x3e483f6d,0x3f6d8000,0xbec4bf35,0xbec43f80,0x3f6dbf35,0xbf55250d,0xbe483f6d,0x3f7bbf35,0xbf0ebec4
.long 0x3f358000,0x3f35bf80,0xbf35250d,0xbf353f80,0xbf0e250d,0xbf7b3f6d,0xbe483f35,0x3f55bec4,0x3ec48000,0x3f6dbf35,0x3f6dbf80,0x3ec4bf35,0xbe48250d,0xbf0e3ec4,0xbf553f35,0xbf7b3f6d
.long 0x80008000,0x80008000,0x80008000,0x80008000,0xbf7bbf80,0xbf55bf6d,0xbf0ebf35,0xbe48bec4,0xbec4250d,0xbf6dbf35,0xbf6dbf80,0xbec4bf35,0x3f553f80,0xbe483ec4,0xbf7bbf35,0xbf0ebf6d
.long 0x3f358000,0x3f353f80,0xbf35250d,0xbf35bf80,0xbf0ebf80,0x3f7b3ec4,0xbe483f35,0xbf55bf6d,0xbf6d250d,0x3ec4bf35,0x3ec43f80,0xbf6dbf35,0x3e483f80,0xbf0ebf6d,0x3f553f35,0xbf7bbec4
.long 0x3f808000,0xbf80250d,0x3f808000,0xbf80250d,0x3e48bf80,0xbf0e3f6d,0x3f55bf35,0xbf7b3ec4,0xbf6d250d,0x3ec43f35,0x3ec4bf80,0xbf6d3f35,0xbf0e3f80,0x3f7bbec4,0xbe48bf35,0xbf553f6d
.long 0x3f358000,0x3f35bf80,0xbf35250d,0xbf353f80,0x3f55bf80,0xbe48bec4,0xbf7b3f35,0xbf0e3f6d,0xbec4250d,0xbf6d3f35,0xbf6d3f80,0xbec43f35,0xbf7b3f80,0xbf553f6d,0xbf0e3f35,0xbe483ec4
.long 0x3f800000,0x3f800000,0x3f800000,0x3f800000,0x3f800000,0x3f7fffb1,0x3f7ffec4,0x3f7ffd39,0x3f800000,0x3f7ffec4,0x3f7ffb11,0x3f7ff4e6,0x3f800000,0x3f7ffd39,0x3f7ff4e6,0x3f7fe705
.long 0x3f800000,0x3f7ffb11,0x3f7fec43,0x3f7fd397,0x3f800000,0x3f7ff84a,0x3f7fe129,0x3f7fba9e,0x3f800000,0x3f7ff4e6,0x3f7fd397,0x3f7f9c18,0x3f800000,0x3f7ff0e3,0x3f7fc38f,0x3f7f7808
.long 0x3f800000,0x3f7fec43,0x3f7fb10f,0x3f7f4e6d,0x3f800000,0x3f7fe705,0x3f7f9c18,0x3f7f1f49,0x3f800000,0x3f7fe129,0x3f7f84ab,0x3f7eea9d,0x3f800000,0x3f7fdaaf,0x3f7f6ac7,0x3f7eb069
.long 0x3f800000,0x3f7fd397,0x3f7f4e6d,0x3f7e70b0,0x3f800000,0x3f7fcbe2,0x3f7f2f9d,0x3f7e2b72,0x3f800000,0x3f7fc38f,0x3f7f0e58,0x3f7de0b1,0x3f800000,0x3f7fba9e,0x3f7eea9d,0x3f7d906e
.long 0x3f800000,0x3f800000,0x3f800000,0x3f800000,0x3f7ffb11,0x3f7ff84a,0x3f7ff4e6,0x3f7ff0e3,0x3f7fec43,0x3f7fe129,0x3f7fd397,0x3f7fc38f,0x3f7fd397,0x3f7fba9e,0x3f7f9c18,0x3f7f7808
.long 0x3f7fb10f,0x3f7f84ab,0x3f7f4e6d,0x3f7f0e58,0x3f7f84ab,0x3f7f3f54,0x3f7eea9d,0x3f7e868b,0x3f7f4e6d,0x3f7eea9d,0x3f7e70b0,0x3f7de0b1,0x3f7f0e58,0x3f7e868b,0x3f7de0b1,0x3f7d1cdd
.long 0x3f7ec46d,0x3f7e1324,0x3f7d3aac,0x3f7c3b28,0x3f7e70b0,0x3f7d906e,0x3f7c7eb0,0x3f7b3bab,0x3f7e1324,0x3f7cfe73,0x3f7baccd,0x3f7a1e84,0x3f7dabcc,0x3f7c5d3a,0x3f7ac516,0x3f78e3d6
.long 0x3f7d3aac,0x3f7baccd,0x3f79c79d,0x3f778bc5,0x3f7cbfc9,0x3f7aed37,0x3f78b47b,0x3f76167a,0x3f7c3b28,0x3f7a1e84,0x3f778bc5,0x3f748422,0x3f7baccd,0x3f7940c0,0x3f764d97,0x3f72d4eb
.long 0x3f800000,0x3f800000,0x3f800000,0x3f800000,0x3f7fec43,0x3f7fe705,0x3f7fe129,0x3f7fdaaf,0x3f7fb10f,0x3f7f9c18,0x3f7f84ab,0x3f7f6ac7,0x3f7f4e6d,0x3f7f1f49,0x3f7eea9d,0x3f7eb069
.long 0x3f7ec46d,0x3f7e70b0,0x3f7e1324,0x3f7dabcc,0x3f7e1324,0x3f7d906e,0x3f7cfe73,0x3f7c5d3a,0x3f7d3aac,0x3f7c7eb0,0x3f7baccd,0x3f7ac516,0x3f7c3b28,0x3f7b3bab,0x3f7a1e84,0x3f78e3d6
.long 0x3f7b14be,0x3f79c79d,0x3f7853f8,0x3f76ba07,0x3f79c79d,0x3f7822d1,0x3f764d97,0x3f74484b,0x3f7853f8,0x3f764d97,0x3f740bdd,0x3f718f57,0x3f76ba07,0x3f74484b,0x3f718f57,0x3f6e8ff8
.long 0x3f74fa0b,0x3f721352,0x3f6ed89e,0x3f6b4b0c,0x3f731447,0x3f6faf1b,0x3f6be858,0x3f67c187,0x3f710908,0x3f6d1c1d,0x3f68bf3c,0x3f63f473,0x3f6ed89e,0x3f6a5ad9,0x3f655e0b,0x3f5fe4e9
.long 0x3f800000,0x3f800000,0x3f800000,0x3f800000,0x3f7fd397,0x3f7fcbe2,0x3f7fc38f,0x3f7fba9e,0x3f7f4e6d,0x3f7f2f9d,0x3f7f0e58,0x3f7eea9d,0x3f7e70b0,0x3f7e2b72,0x3f7de0b1,0x3f7d906e
.long 0x3f7d3aac,0x3f7cbfc9,0x3f7c3b28,0x3f7baccd,0x3f7baccd,0x3f7aed37,0x3f7a1e84,0x3f7940c0,0x3f79c79d,0x3f78b47b,0x3f778bc5,0x3f764d97,0x3f778bc5,0x3f76167a,0x3f748422,0x3f72d4eb
.long 0x3f74fa0b,0x3f731447,0x3f710908,0x3f6ed89e,0x3f721352,0x3f6faf1b,0x3f6d1c1d,0x3f6a5ad9,0x3f6ed89e,0x3f6be858,0x3f68bf3c,0x3f655e0b,0x3f6b4b0c,0x3f67c187,0x3f63f473,0x3f5fe4e9
.long 0x3f676bd8,0x3f633c5a,0x3f5ebe05,0x3f59f26a,0x3f633c5a,0x3f5e5aa6,0x3f591e6a,0x3f5389c7,0x3f5ebe05,0x3f591e6a,0x3f531849,0x3f4cae79,0x3f59f26a,0x3f5389c7,0x3f4cae79,0x3f456439
.long 0x0,0x0,0x0,0x0,0x0,0xbb490fc6,0xbbc90f88,0xbc16cb58,0x0,0xbbc90f88,0xbc490e90,0xbc96c9b6,0x0,0xbc16cb58,0xbc96c9b6,0xbce22a7a
.long 0x0,0xbc490e90,0xbcc90ab0,0xbd16c32c,0x0,0xbc7b514b,0xbcfb49ba,0xbd3c6dd5,0x0,0xbc96c9b6,0xbd16c32c,0xbd621469,0x0,0xbcafea69,0xbd2fe007,0xbd83db0a
.long 0x0,0xbcc90ab0,0xbd48fb30,0xbd96a905,0x0,0xbce22a7a,0xbd621469,0xbda973ba,0x0,0xbcfb49ba,0xbd7b2b74,0xbdbc3ac3,0x0,0xbd0a342f,0xbd8a200a,0xbdcefdb7
.long 0x0,0xbd16c32c,0xbd96a905,0xbde1bc2e,0x0,0xbd2351cb,0xbda3308c,0xbdf475c0,0x0,0xbd2fe007,0xbdafb680,0xbe039502,0x0,0xbd3c6dd5,0xbdbc3ac3,0xbe0cec4a
.long 0x0,0x0,0x0,0x0,0xbc490e90,0xbc7b514b,0xbc96c9b6,0xbcafea69,0xbcc90ab0,0xbcfb49ba,0xbd16c32c,0xbd2fe007,0xbd16c32c,0xbd3c6dd5,0xbd621469,0xbd83db0a
.long 0xbd48fb30,0xbd7b2b74,0xbd96a905,0xbdafb680,0xbd7b2b74,0xbd9cecf9,0xbdbc3ac3,0xbddb7d37,0xbd96a905,0xbdbc3ac3,0xbde1bc2e,0xbe039502,0xbdafb680,0xbddb7d37,0xbe039502,0xbe195be0
.long 0xbdc8bd36,0xbdfab273,0xbe164083,0xbe2f10a2,0xbde1bc2e,0xbe0cec4a,0xbe28defc,0xbe44b0b9,0xbdfab273,0xbe1c76de,0xbe3b6ecf,0xbe5a3997,0xbe09cf86,0xbe2bf804,0xbe4dee60,0xbe6fa8b2
.long 0xbe164083,0xbe3b6ecf,0xbe605c13,0xbe827dc0,0xbe22abb6,0xbe4ada4f,0xbe72b651,0xbe8d17c0,0xbe2f10a2,0xbe5a3997,0xbe827dc0,0xbe97a117,0xbe3b6ecf,0xbe698bba,0xbe8b9507,0xbea21887
.long 0x0,0x0,0x0,0x0,0xbcc90ab0,0xbce22a7a,0xbcfb49ba,0xbd0a342f,0xbd48fb30,0xbd621469,0xbd7b2b74,0xbd8a200a,0xbd96a905,0xbda973ba,0xbdbc3ac3,0xbdcefdb7
.long 0xbdc8bd36,0xbde1bc2e,0xbdfab273,0xbe09cf86,0xbdfab273,0xbe0cec4a,0xbe1c76de,0xbe2bf804,0xbe164083,0xbe28defc,0xbe3b6ecf,0xbe4dee60,0xbe2f10a2,0xbe44b0b9,0xbe5a3997,0xbe6fa8b2
.long 0xbe47c5c2,0xbe605c13,0xbe78cfcc,0xbe888e93,0xbe605c13,0xbe7bdba4,0xbe8b9507,0xbe9920fe,0xbe78cfcc,0xbe8b9507,0xbe9aa086,0xbea986c4,0xbe888e93,0xbe9920fe,0xbea986c4,0xbeb9bb1e
.long 0xbe94a031,0xbea68f12,0xbeb8442a,0xbec9b953,0xbea09ae5,0xbeb3dca5,0xbec6d529,0xbed97cb9,0xbeac7cd4,0xbec1071e,0xbed53641,0xbee900b7,0xbeb8442a,0xbece0bea,0xbee363fa,0xbef840c8
.long 0x0,0x0,0x0,0x0,0xbd16c32c,0xbd2351cb,0xbd2fe007,0xbd3c6dd5,0xbd96a905,0xbda3308c,0xbdafb680,0xbdbc3ac3,0xbde1bc2e,0xbdf475c0,0xbe039502,0xbe0cec4a
.long 0xbe164083,0xbe22abb6,0xbe2f10a2,0xbe3b6ecf,0xbe3b6ecf,0xbe4ada4f,0xbe5a3997,0xbe698bba,0xbe605c13,0xbe72b651,0xbe827dc0,0xbe8b9507,0xbe827dc0,0xbe8d17c0,0xbe97a117,0xbea21887
.long 0xbe94a031,0xbea09ae5,0xbeac7cd4,0xbeb8442a,0xbea68f12,0xbeb3dca5,0xbec1071e,0xbece0bea,0xbeb8442a,0xbec6d529,0xbed53641,0xbee363fa,0xbec9b953,0xbed97cb9,0xbee900b7,0xbef840c8
.long 0xbedae880,0xbeebcbbb,0xbefc5d27,0xbf064b82,0xbeebcbbb,0xbefdbabb,0xbf07a136,0xbf102dd5,0xbefc5d27,0xbf07a136,0xbf10d3cd,0xbf19c200,0xbf064b82,0xbf102dd5,0xbf19c200,0xbf2302d3
.long 0x3f800000,0x3f800000,0x3f800000,0x3f800000,0x3f7fb10f,0x3f7fa6e3,0x3f7f9c18,0x3f7f90b1,0x3f7ec46d,0x3f7e9bc9,0x3f7e70b0,0x3f7e4323,0x3f7d3aac,0x3f7cdf6c,0x3f7c7eb0,0x3f7c187a
.long 0x3f7b14be,0x3f7a7302,0x3f79c79d,0x3f791298,0x3f7853f8,0x3f77583a,0x3f764d97,0x3f75341d,0x3f74fa0b,0x3f73913f,0x3f721352,0x3f708066,0x3f710908,0x3f6f20b0,0x3f6d1c1d,0x3f6afb8c
.long 0x3f6c835e,0x3f6a09a7,0x3f676bd8,0x3f64aa59,0x3f676bd8,0x3f644fac,0x3f6106f2,0x3f5d924d,0x3f61c598,0x3f5df6be,0x3f59f26a,0x3f55b993,0x3f5b941a,0x3f570348,0x3f5233c6,0x3f4d26fd
.long 0x3f54db31,0x3f4f7a1f,0x3f49d112,0x3f43e200,0x3f4d9f02,0x3f476085,0x3f40d0da,0x3f39f2ac,0x3f45e403,0x3f3ebc1b,0x3f373a23,0x3f2f61a5,0x3f3daef9,0x3f3592e7,0x3f2d1469,0x3f24381a
.long 0x3f800000,0x3f800000,0x3f800000,0x3f800000,0x3f7f84ab,0x3f7f7808,0x3f7f6ac7,0x3f7f5ce9,0x3f7e1324,0x3f7de0b1,0x3f7dabcc,0x3f7d7474,0x3f7baccd,0x3f7b3bab,0x3f7ac516,0x3f7a4910
.long 0x3f7853f8,0x3f778bc5,0x3f76ba07,0x3f75dec6,0x3f740bdd,0x3f72d4eb,0x3f718f57,0x3f703b37,0x3f6ed89e,0x3f6d1c1d,0x3f6b4b0c,0x3f696591,0x3f68bf3c,0x3f666771,0x3f63f473,0x3f61668a
.long 0x3f61c598,0x3f5ebe05,0x3f5b941a,0x3f584853,0x3f59f26a,0x3f5627fe,0x3f5233c6,0x3f4e1689,0x3f514d3d,0x3f4cae79,0x3f47de65,0x3f42de29,0x3f47de65,0x3f425b89,0x3f3ca003,0x3f36ad7f
.long 0x3f3daef9,0x3f373a23,0x3f3085bb,0x3f299415,0x3f32c8c9,0x3f2b561b,0x3f239da9,0x3f1ba299,0x3f273656,0x3f1ebc12,0x3f15f6d9,0x3f0cead0,0x3f1b02c6,0x3f11796b,0x3f07a136,0x3efafef7
.long 0x3f800000,0x3f800000,0x3f800000,0x3f800000,0x3f7f4e6d,0x3f7f3f54,0x3f7f2f9d,0x3f7f1f49,0x3f7d3aac,0x3f7cfe73,0x3f7cbfc9,0x3f7c7eb0,0x3f79c79d,0x3f7940c0,0x3f78b47b,0x3f7822d1
.long 0x3f74fa0b,0x3f740bdd,0x3f731447,0x3f721352,0x3f6ed89e,0x3f6d67a1,0x3f6be858,0x3f6a5ad9,0x3f676bd8,0x3f655e0b,0x3f633c5a,0x3f6106f2,0x3f5ebe05,0x3f5bfb34,0x3f591e6a,0x3f5627fe
.long 0x3f54db31,0x3f514d3d,0x3f4d9f02,0x3f49d112,0x3f49d112,0x3f456439,0x3f40d0da,0x3f3c17d9,0x3f3daef9,0x3f385216,0x3f32c8c9,0x3f2d1469,0x3f3085bb,0x3f2a2a80,0x3f239da9,0x3f1ce11f
.long 0x3f226799,0x3f1b02c6,0x3f13682a,0x3f0b9a6b,0x3f13682a,0x3f0af1b7,0x3f0242b1,0x3ef2bd43,0x3f039c3d,0x3ef41f07,0x3ee0924f,0x3ecc9b8b,0x3ee63375,0x3ed0eb2a,0x3ebb31a0,0x3ea5129f
.long 0x3f800000,0x3f800000,0x3f800000,0x3f800000,0x3f7f0e58,0x3f7efcc9,0x3f7eea9d,0x3f7ed7d4,0x3f7c3b28,0x3f7bf531,0x3f7baccd,0x3f7b61fc,0x3f778bc5,0x3f76ef5b,0x3f764d97,0x3f75a67b
.long 0x3f710908,0x3f6ff573,0x3f6ed89e,0x3f6db293,0x3f68bf3c,0x3f671599,0x3f655e0b,0x3f6398ac,0x3f5ebe05,0x3f5c61c7,0x3f59f26a,0x3f577026,0x3f531849,0x3f4fefa8,0x3f4cae79,0x3f495521
.long 0x3f45e403,0x3f41d870,0x3f3daef9,0x3f396842,0x3f373a23,0x3f3238aa,0x3f2d1469,0x3f27ce61,0x3f273656,0x3f212ff9,0x3f1b02c6,0x3f14b039,0x3f15f6d9,0x3f0ee0db,0x3f07a136,0x3f003a06
.long 0x3f039c3d,0x3ef6e0cb,0x3ee63375,0x3ed53641,0x3ee0924f,0x3ece0bea,0x3ebb31a0,0x3ea80b1f,0x3eb8442a,0x3ea395c5,0x3e8e9a22,0x3e72b651,0x3e8e9a22,0x3e6fa8b2,0x3e419b37,0x3e1324ca
.long 0x0,0x0,0x0,0x0,0xbd48fb30,0xbd55880e,0xbd621469,0xbd6ea038,0xbdc8bd36,0xbdd53db9,0xbde1bc2e,0xbdee3876,0xbe164083,0xbe1f917b,0xbe28defc,0xbe3228d4
.long 0xbe47c5c2,0xbe541501,0xbe605c13,0xbe6c9a7f,0xbe78cfcc,0xbe840270,0xbe8b9507,0xbe931f35,0xbe94a031,0xbe9d9e78,0xbea68f12,0xbeaf713a,0xbeac7cd4,0xbeb6ccc3,0xbec1071e,0xbecb2aae
.long 0xbec3ef15,0xbecf7bca,0xbedae880,0xbee63375,0xbedae880,0xbee79a5d,0xbef41f07,0xbf003a06,0xbef15aea,0xbeff17b2,0xbf064b82,0xbf0cead0,0xbf039c3d,0xbf0af1b7,0xbf121eb0,0xbf19210f
.long 0xbf0e39da,0xbf15f6d9,0xbf1d7fd1,0xbf24d225,0xbf187fc0,0xbf209393,0xbf286605,0xbf2ff3e6,0xbf226799,0xbf2ac082,0xbf32c8c9,0xbf3a7ca4,0xbf2beb4a,0xbf34768f,0xbf3ca003,0xbf446337
.long 0x0,0x0,0x0,0x0,0xbd7b2b74,0xbd83db0a,0xbd8a200a,0xbd9064b4,0xbdfab273,0xbe039502,0xbe09cf86,0xbe1008b7,0xbe3b6ecf,0xbe44b0b9,0xbe4dee60,0xbe57278f
.long 0xbe78cfcc,0xbe827dc0,0xbe888e93,0xbe8e9a22,0xbe9aa086,0xbea21887,0xbea986c4,0xbeb0eacb,0xbeb8442a,0xbec1071e,0xbec9b953,0xbed25a09,0xbed53641,0xbedf28a9,0xbee900b7,0xbef2bd43
.long 0xbef15aea,0xbefc5d27,0xbf039c3d,0xbf08f59b,0xbf064b82,0xbf0c42c9,0xbf121eb0,0xbf17de12,0xbf13682a,0xbf19c200,0xbf1ff6cb,0xbf26050a,0xbf1ff6cb,0xbf269de3,0xbf2d1469,0xbf33587a
.long 0xbf2beb4a,0xbf32c8c9,0xbf396842,0xbf3fc767,0xbf373a23,0xbf3e35c5,0xbf44e3f5,0xbf4b41fa,0xbf41d870,0xbf48d8b3,0xbf4f7a1f,0xbf55b993,0xbf4bbbf8,0xbf52a649,0xbf591e6a,0xbf5f20db
.long 0x0,0x0,0x0,0x0,0xbd96a905,0xbd9cecf9,0xbda3308c,0xbda973ba,0xbe164083,0xbe1c76de,0xbe22abb6,0xbe28defc,0xbe605c13,0xbe698bba,0xbe72b651,0xbe7bdba4
.long 0xbe94a031,0xbe9aa086,0xbea09ae5,0xbea68f12,0xbeb8442a,0xbebf926f,0xbec6d529,0xbece0bea,0xbedae880,0xbee363fa,0xbeebcbbb,0xbef41f07,0xbefc5d27,0xbf02ef9f,0xbf07a136,0xbf0c42c9
.long 0xbf0e39da,0xbf13682a,0xbf187fc0,0xbf1d7fd1,0xbf1d7fd1,0xbf2302d3,0xbf286605,0xbf2da859,0xbf2beb4a,0xbf31a81d,0xbf373a23,0xbf3ca003,0xbf396842,0xbf3f41fc,0xbf44e3f5,0xbf4a4c87
.long 0xbf45e403,0xbf4bbbf8,0xbf514d3d,0xbf5695e5,0xbf514d3d,0xbf570348,0xbf5c61c7,0xbf61668a,0xbf5b941a,0xbf6106f2,0xbf660f88,0xbf6aab7b,0xbf64aa59,0xbf69b7e4,0xbf6e46be,0xbf725470
.long 0x0,0x0,0x0,0x0,0xbdafb680,0xbdb5f8da,0xbdbc3ac3,0xbdc27c39,0xbe2f10a2,0xbe354098,0xbe3b6ecf,0xbe419b37,0xbe827dc0,0xbe870ada,0xbe8b9507,0xbe901c2c
.long 0xbeac7cd4,0xbeb263ef,0xbeb8442a,0xbebe1d4a,0xbed53641,0xbedc53c1,0xbee363fa,0xbeea6681,0xbefc5d27,0xbf0242b1,0xbf064b82,0xbf0a48ad,0xbf10d3cd,0xbf1553b7,0xbf19c200,0xbf1e1e22
.long 0xbf226799,0xbf273656,0xbf2beb4a,0xbf3085bb,0xbf32c8c9,0xbf37c655,0xbf3ca003,0xbf4154e1,0xbf41d870,0xbf46e22a,0xbf4bbbf8,0xbf5064af,0xbf4f7a1f,0xbf546b3b,0xbf591e6a,0xbf5d924d
.long 0xbf5b941a,0xbf604621,0xbf64aa59,0xbf68bf3c,0xbf660f88,0xbf6a5ad9,0xbf6e46be,0xbf71d19f,0xbf6ed89e,0xbf7294f8,0xbf75dec6,0xbf78b47b,0xbf75dec6,0xbf78e3d6,0xbf7b61fc,0xbf7d57de
.long 0x3f800000,0x3f800000,0x3f800000,0x3f800000,0x3f7ec46d,0x3f7eb069,0x3f7e9bc9,0x3f7e868b,0x3f7b14be,0x3f7ac516,0x3f7a7302,0x3f7a1e84,0x3f74fa0b,0x3f74484b,0x3f73913f,0x3f72d4eb
.long 0x3f6c835e,0x3f6b4b0c,0x3f6a09a7,0x3f68bf3c,0x3f61c598,0x3f5fe4e9,0x3f5df6be,0x3f5bfb34,0x3f54db31,0x3f5233c6,0x3f4f7a1f,0x3f4cae79,0x3f45e403,0x3f425b89,0x3f3ebc1b,0x3f3b0629
.long 0x3f3504f3,0x3f3085bb,0x3f2beb4a,0x3f273656,0x3f226799,0x3f1ce11f,0x3f173c07,0x3f11796b,0x3f0e39da,0x3f07a136,0x3f00e7e4,0x3ef41f07,0x3ef15aea,0x3ee1fb6a,0x3ed25a09,0x3ec27b55
.long 0x3ec3ef15,0x3eb263ef,0x3ea09ae5,0x3e8e9a22,0x3e94a031,0x3e80f8c0,0x3e5a3997,0x3e3228d4,0x3e47c5c2,0x3e1c76de,0x3de1bc2e,0x3d8a200a,0x3dc8bd36,0x3d55880e,0x3bc90f88,0xbd2351cb
.long 0x3f800000,0x3f800000,0x3f800000,0x3f800000,0x3f7e70b0,0x3f7e5a38,0x3f7e4323,0x3f7e2b72,0x3f79c79d,0x3f796e4e,0x3f791298,0x3f78b47b,0x3f721352,0x3f714c7a,0x3f708066,0x3f6faf1b
.long 0x3f676bd8,0x3f660f88,0x3f64aa59,0x3f633c5a,0x3f59f26a,0x3f57dc7f,0x3f55b993,0x3f5389c7,0x3f49d112,0x3f46e22a,0x3f43e200,0x3f40d0da,0x3f373a23,0x3f33587a,0x3f2f61a5,0x3f2b561b
.long 0x3f226799,0x3f1d7fd1,0x3f187fc0,0x3f13682a,0x3f0b9a6b,0x3f05a02c,0x3eff17b2,0x3ef2bd43,0x3ee63375,0x3ed8106b,0x3ec9b953,0x3ebb31a0,0x3eb263ef,0x3ea21887,0x3e919ddd,0x3e80f8c0
.long 0x3e78cfcc,0x3e541501,0x3e2f10a2,0x3e09cf86,0x3e09cf86,0x3dc27c39,0x3d621469,0x3c7b514b,0x3cc90ab0,0xbc96c9b6,0xbd7b2b74,0xbdd53db9,0xbdafb680,0xbe06b26e,0xbe354098,0xbe636c83
.long 0x3f800000,0x3f800000,0x3f800000,0x3f800000,0x3f7e1324,0x3f7dfa38,0x3f7de0b1,0x3f7dc68c,0x3f7853f8,0x3f77f110,0x3f778bc5,0x3f772417,0x3f6ed89e,0x3f6dfcf2,0x3f6d1c1d,0x3f6c3624
.long 0x3f61c598,0x3f604621,0x3f5ebe05,0x3f5d2d53,0x3f514d3d,0x3f4f0417,0x3f4cae79,0x3f4a4c87,0x3f3daef9,0x3f3a7ca4,0x3f373a23,0x3f33e7bc,0x3f273656,0x3f2302d3,0x3f1ebc12,0x3f1a6293
.long 0x3f0e39da,0x3f08f59b,0x3f039c3d,0x3efc5d27,0x3ee63375,0x3ed97cb9,0x3ecc9b8b,0x3ebf926f,0x3eac7cd4,0x3e9d9e78,0x3e8e9a22,0x3e7ee6e1,0x3e605c13,0x3e3e853e,0x3e1c76de,0x3df475c0
.long 0x3dc8bd36,0x3d7b2b74,0x3cc90ab0,0xbc490e90,0xbcc90ab0,0xbd83db0a,0xbdd53db9,0xbe1324ca,0xbe164083,0xbe419b37,0xbe6c9a7f,0xbe8b9507,0xbe888e93,0xbe9f1cdf,0xbeb554ec,0xbecb2aae
.long 0x3f800000,0x3f800000,0x3f800000,0x3f800000,0x3f7dabcc,0x3f7d906e,0x3f7d7474,0x3f7d57de,0x3f76ba07,0x3f764d97,0x3f75dec6,0x3f756d97,0x3f6b4b0c,0x3f6a5ad9,0x3f696591,0x3f686b39
.long 0x3f5b941a,0x3f59f26a,0x3f584853,0x3f5695e5,0x3f47de65,0x3f456439,0x3f42de29,0x3f404c5c,0x3f3085bb,0x3f2d1469,0x3f299415,0x3f26050a,0x3f15f6d9,0x3f11796b,0x3f0cead0,0x3f084b92
.long 0x3ef15aea,0x3ee63375,0x3edae880,0x3ecf7bca,0x3eb263ef,0x3ea5129f,0x3e97a117,0x3e8a11f7,0x3e605c13,0x3e419b37,0x3e22abb6,0x3e039502,0x3dafb680,0x3d55880e,0x3c96c9b6,0xbc7b514b
.long 0xbd48fb30,0xbdafb680,0xbdfab273,0xbe22abb6,0xbe3b6ecf,0xbe636c83,0xbe8586ce,0xbe9920fe,0xbea09ae5,0xbeb554ec,0xbec9b953,0xbeddbe79,0xbee0924f,0xbef58035,0xbf04f484,0xbf0ee0db
.long 0x0,0x0,0x0,0x0,0xbdc8bd36,0xbdcefdb7,0xbdd53db9,0xbddb7d37,0xbe47c5c2,0xbe4dee60,0xbe541501,0xbe5a3997,0xbe94a031,0xbe9920fe,0xbe9d9e78,0xbea21887
.long 0xbec3ef15,0xbec9b953,0xbecf7bca,0xbed53641,0xbef15aea,0xbef840c8,0xbeff17b2,0xbf02ef9f,0xbf0e39da,0xbf121eb0,0xbf15f6d9,0xbf19c200,0xbf226799,0xbf269de3,0xbf2ac082,0xbf2ecef7
.long 0xbf3504f3,0xbf396842,0xbf3daef9,0xbf41d870,0xbf45e403,0xbf4a4c87,0xbf4e8d90,0xbf52a649,0xbf54db31,0xbf591e6a,0xbf5d2d53,0xbf6106f2,0xbf61c598,0xbf65b710,0xbf696591,0xbf6cd007
.long 0xbf6c835e,0xbf6ff573,0xbf731447,0xbf75dec6,0xbf74fa0b,0xbf77beb7,0xbf7a1e84,0xbf7c187a,0xbf7b14be,0xbf7cfe73,0xbf7e70b0,0xbf7f6ac7,0xbf7ec46d,0xbf7fa6e3,0xbf7ffec4,0xbf7fcbe2
.long 0x0,0x0,0x0,0x0,0xbde1bc2e,0xbde7fa9a,0xbdee3876,0xbdf475c0,0xbe605c13,0xbe667c66,0xbe6c9a7f,0xbe72b651,0xbea68f12,0xbeab0201,0xbeaf713a,0xbeb3dca5
.long 0xbedae880,0xbee0924f,0xbee63375,0xbeebcbbb,0xbf064b82,0xbf099f4e,0xbf0cead0,0xbf102dd5,0xbf1d7fd1,0xbf212ff9,0xbf24d225,0xbf286605,0xbf32c8c9,0xbf36ad7f,0xbf3a7ca4,0xbf3e35c5
.long 0xbf45e403,0xbf49d112,0xbf4d9f02,0xbf514d3d,0xbf5695e5,0xbf5a5ba0,0xbf5df6be,0xbf61668a,0xbf64aa59,0xbf6816a8,0xbf6b4b0c,0xbf6e46be,0xbf6ff573,0xbf72d4eb,0xbf756d97,0xbf77beb7
.long 0xbf7853f8,0xbf7a7302,0xbf7c3b28,0xbf7dabcc,0xbf7dabcc,0xbf7ed7d4,0xbf7f9c18,0xbf7ff84a,0xbf7fec43,0xbf7ff4e6,0xbf7f84ab,0xbf7e9bc9,0xbf7f0e58,0xbf7dc68c,0xbf7bf531,0xbf799b43
.long 0x0,0x0,0x0,0x0,0xbdfab273,0xbe007745,0xbe039502,0xbe06b26e,0xbe78cfcc,0xbe7ee6e1,0xbe827dc0,0xbe8586ce,0xbeb8442a,0xbebca7af,0xbec1071e,0xbec5625c
.long 0xbef15aea,0xbef6e0cb,0xbefc5d27,0xbf00e7e4,0xbf13682a,0xbf16999f,0xbf19c200,0xbf1ce11f,0xbf2beb4a,0xbf2f61a5,0xbf32c8c9,0xbf36206c,0xbf41d870,0xbf456439,0xbf48d8b3,0xbf4c3578
.long 0xbf54db31,0xbf584853,0xbf5b941a,0xbf5ebe05,0xbf64aa59,0xbf67c187,0xbf6aab7b,0xbf6d67a1,0xbf710908,0xbf73913f,0xbf75dec6,0xbf77f110,0xbf79c79d,0xbf7b87b2,0xbf7cfe73,0xbf7e2b72
.long 0xbf7ec46d,0xbf7f84ab,0xbf7fec43,0xbf7ffb11,0xbf7fec43,0xbf7f7808,0xbf7e9bc9,0xbf7d57de,0xbf7d3aac,0xbf7b61fc,0xbf791298,0xbf764d97,0xbf76ba07,0xbf73530e,0xbf6f6830,0xbf6afb8c
.long 0x0,0x0,0x0,0x0,0xbe09cf86,0xbe0cec4a,0xbe1008b7,0xbe1324ca,0xbe888e93,0xbe8b9507,0xbe8e9a22,0xbe919ddd,0xbec9b953,0xbece0bea,0xbed25a09,0xbed6a399
.long 0xbf039c3d,0xbf064b82,0xbf08f59b,0xbf0b9a6b,0xbf1ff6cb,0xbf2302d3,0xbf26050a,0xbf28fd41,0xbf396842,0xbf3ca003,0xbf3fc767,0xbf42de29,0xbf4f7a1f,0xbf52a649,0xbf55b993,0xbf58b3a1
.long 0xbf61c598,0xbf64aa59,0xbf676bd8,0xbf6a09a7,0xbf6ff573,0xbf725470,0xbf748422,0xbf76841b,0xbf79c79d,0xbf7b61fc,0xbf7cbfc9,0xbf7de0b1,0xbf7f0e58,0xbf7fa6e3,0xbf7ff4e6,0xbf7ff84a
.long 0xbf7fb10f,0xbf7f0e58,0xbf7e1324,0xbf7cbfc9,0xbf7baccd,0xbf799b43,0xbf772417,0xbf74484b,0xbf731447,0xbf6f6830,0xbf6b4b0c,0xbf66becc,0xbf660f88,0xbf60a6cf,0xbf5ac450,0xbf546b3b
.long 0x3f800000,0x3f800000,0x3f800000,0x3f800000,0x3f7d3aac,0x3f7d1cdd,0x3f7cfe73,0x3f7cdf6c,0x3f74fa0b,0x3f748422,0x3f740bdd,0x3f73913f,0x3f676bd8,0x3f666771,0x3f655e0b,0x3f644fac
.long 0x3f54db31,0x3f531849,0x3f514d3d,0x3f4f7a1f,0x3f3daef9,0x3f3b0629,0x3f385216,0x3f3592e7,0x3f226799,0x3f1ebc12,0x3f1b02c6,0x3f173c07,0x3f039c3d,0x3efdbabb,0x3ef41f07,0x3eea6681
.long 0x3ec3ef15,0x3eb8442a,0x3eac7cd4,0x3ea09ae5,0x3e78cfcc,0x3e5d4b1a,0x3e419b37,0x3e25c58c,0x3dc8bd36,0x3d8a200a,0x3d16c32c,0x3bc90f88,0xbd48fb30,0xbda973ba,0xbdee3876,0xbe195be0
.long 0xbe47c5c2,0xbe6c9a7f,0xbe888e93,0xbe9aa086,0xbeac7cd4,0xbebf926f,0xbed25a09,0xbee4cbfe,0xbef15aea,0xbf0242b1,0xbf0b9a6b,0xbf14b039,0xbf187fc0,0xbf21cbfb,0xbf2ac082,0xbf33587a
.long 0x3f800000,0x3f800000,0x3f800000,0x3f800000,0x3f7cbfc9,0x3f7c9f8a,0x3f7c7eb0,0x3f7c5d3a,0x3f731447,0x3f7294f8,0x3f721352,0x3f718f57,0x3f633c5a,0x3f62241a,0x3f6106f2,0x3f5fe4e9
.long 0x3f4d9f02,0x3f4bbbf8,0x3f49d112,0x3f47de65,0x3f32c8c9,0x3f2ff3e6,0x3f2d1469,0x3f2a2a80,0x3f13682a,0x3f0f8784,0x3f0b9a6b,0x3f07a136,0x3ee0924f,0x3ed6a399,0x3ecc9b8b,0x3ec27b55
.long 0x3e94a031,0x3e888e93,0x3e78cfcc,0x3e605c13,0x3e09cf86,0x3ddb7d37,0x3da3308c,0x3d55880e,0xbcc90ab0,0xbd621469,0xbdafb680,0xbdee3876,0xbe3b6ecf,0xbe5d4b1a,0xbe7ee6e1,0xbe901c2c
.long 0xbeac7cd4,0xbebe1d4a,0xbecf7bca,0xbee0924f,0xbef6e0cb,0xbf044889,0xbf0cead0,0xbf1553b7,0xbf1d7fd1,0xbf26050a,0xbf2e3bde,0xbf36206c,0xbf3b8f3b,0xbf436051,0xbf4ac77f,0xbf51c0c2
.long 0x3f800000,0x3f800000,0x3f800000,0x3f800000,0x3f7c3b28,0x3f7c187a,0x3f7bf531,0x3f7bd14d,0x3f710908,0x3f708066,0x3f6ff573,0x3f6f6830,0x3f5ebe05,0x3f5d924d,0x3f5c61c7,0x3f5b2c79
.long 0x3f45e403,0x3f43e200,0x3f41d870,0x3f3fc767,0x3f273656,0x3f24381a,0x3f212ff9,0x3f1e1e22,0x3f039c3d,0x3eff17b2,0x3ef6e0cb,0x3eee9479,0x3eb8442a,0x3eadf73c,0x3ea395c5,0x3e9920fe
.long 0x3e47c5c2,0x3e2f10a2,0x3e164083,0x3dfab273,0x3cc90ab0,0xbb490fc6,0xbcfb49ba,0xbd6ea038,0xbe164083,0xbe354098,0xbe541501,0xbe72b651,0xbea09ae5,0xbeb0eacb,0xbec1071e,0xbed0eb2a
.long 0xbef15aea,0xbf00e7e4,0xbf08f59b,0xbf10d3cd,0xbf1d7fd1,0xbf256bcb,0xbf2d1469,0xbf34768f,0xbf3daef9,0xbf44e3f5,0xbf4bbbf8,0xbf5233c6,0xbf584853,0xbf5e5aa6,0xbf63f473,0xbf6912ae
.long 0x3f800000,0x3f800000,0x3f800000,0x3f800000,0x3f7baccd,0x3f7b87b2,0x3f7b61fc,0x3f7b3bab,0x3f6ed89e,0x3f6e46be,0x3f6db293,0x3f6d1c1d,0x3f59f26a,0x3f58b3a1,0x3f577026,0x3f5627fe
.long 0x3f3daef9,0x3f3b8f3b,0x3f396842,0x3f373a23,0x3f1b02c6,0x3f17de12,0x3f14b039,0x3f11796b,0x3ee63375,0x3eddbe79,0x3ed53641,0x3ecc9b8b,0x3e8e9a22,0x3e840270,0x3e72b651,0x3e5d4b1a
.long 0x3dc8bd36,0x3d96a905,0x3d48fb30,0x3cc90ab0,0xbdafb680,0xbde7fa9a,0xbe1008b7,0xbe2bf804,0xbe888e93,0xbe97a117,0xbea68f12,0xbeb554ec,0xbee0924f,0xbeeff7fb,0xbeff17b2,0xbf06f686
.long 0xbf187fc0,0xbf1ff6cb,0xbf273656,0xbf2e3bde,0xbf3b8f3b,0xbf425b89,0xbf48d8b3,0xbf4f0417,0xbf584853,0xbf5df6be,0xbf633c5a,0xbf6816a8,0xbf6db293,0xbf71d19f,0xbf756d97,0xbf788486
.long 0x0,0x0,0x0,0x0,0xbe164083,0xbe195be0,0xbe1c76de,0xbe1f917b,0xbe94a031,0xbe97a117,0xbe9aa086,0xbe9d9e78,0xbedae880,0xbedf28a9,0xbee363fa,0xbee79a5d
.long 0xbf0e39da,0xbf10d3cd,0xbf13682a,0xbf15f6d9,0xbf2beb4a,0xbf2ecef7,0xbf31a81d,0xbf34768f,0xbf45e403,0xbf48d8b3,0xbf4bbbf8,0xbf4e8d90,0xbf5b941a,0xbf5e5aa6,0xbf6106f2,0xbf6398ac
.long 0xbf6c835e,0xbf6ed89e,0xbf710908,0xbf731447,0xbf7853f8,0xbf79f35e,0xbf7b61fc,0xbf7c9f8a,0xbf7ec46d,0xbf7f6ac7,0xbf7fd397,0xbf7ffec4,0xbf7fb10f,0xbf7f1f49,0xbf7e4323,0xbf7d1cdd
.long 0xbf7b14be,0xbf791298,0xbf76ba07,0xbf740bdd,0xbf710908,0xbf6d67a1,0xbf696591,0xbf650479,0xbf61c598,0xbf5c61c7,0xbf5695e5,0xbf5064af,0xbf4d9f02,0xbf466354,0xbf3ebc1b,0xbf36ad7f
.long 0x0,0x0,0x0,0x0,0xbe22abb6,0xbe25c58c,0xbe28defc,0xbe2bf804,0xbea09ae5,0xbea395c5,0xbea68f12,0xbea986c4,0xbeebcbbb,0xbeeff7fb,0xbef41f07,0xbef840c8
.long 0xbf187fc0,0xbf1b02c6,0xbf1d7fd1,0xbf1ff6cb,0xbf373a23,0xbf39f2ac,0xbf3ca003,0xbf3f41fc,0xbf514d3d,0xbf53fac3,0xbf5695e5,0xbf591e6a,0xbf660f88,0xbf686b39,0xbf6aab7b,0xbf6cd007
.long 0xbf74fa0b,0xbf76ba07,0xbf7853f8,0xbf79c79d,0xbf7dabcc,0xbf7e868b,0xbf7f2f9d,0xbf7fa6e3,0xbf7fec43,0xbf7f9c18,0xbf7f0e58,0xbf7e4323,0xbf7baccd,0xbf79f35e,0xbf77f110,0xbf75a67b
.long 0xbf710908,0xbf6db293,0xbf6a09a7,0xbf660f88,0xbf604621,0xbf5b2c79,0xbf55b993,0xbf4fefa8,0xbf49d112,0xbf42de29,0xbf3b8f3b,0xbf33e7bc,0xbf2e3bde,0xbf256bcb,0xbf1c420c,0xbf12c39a
.long 0x0,0x0,0x0,0x0,0xbe2f10a2,0xbe3228d4,0xbe354098,0xbe3857ec,0xbeac7cd4,0xbeaf713a,0xbeb263ef,0xbeb554ec,0xbefc5d27,0xbf003a06,0xbf0242b1,0xbf044889
.long 0xbf226799,0xbf24d225,0xbf273656,0xbf299415,0xbf41d870,0xbf446337,0xbf46e22a,0xbf495521,0xbf5b941a,0xbf5df6be,0xbf604621,0xbf628210,0xbf6ed89e,0xbf70c501,0xbf7294f8,0xbf74484b
.long 0xbf7b14be,0xbf7c3b28,0xbf7d3aac,0xbf7e1324,0xbf7fec43,0xbf7fffb1,0xbf7fe129,0xbf7f90b1,0xbf7d3aac,0xbf7bf531,0xbf7a7302,0xbf78b47b,0xbf731447,0xbf703b37,0xbf6d1c1d,0xbf69b7e4
.long 0xbf61c598,0xbf5d2d53,0xbf584853,0xbf531849,0xbf49d112,0xbf436051,0xbf3ca003,0xbf3592e7,0xbf2beb4a,0xbf239da9,0xbf1b02c6,0xbf121eb0,0xbf08f59b,0xbefdbabb,0xbee900b7,0xbed3c867
.long 0x0,0x0,0x0,0x0,0xbe3b6ecf,0xbe3e853e,0xbe419b37,0xbe44b0b9,0xbeb8442a,0xbebb31a0,0xbebe1d4a,0xbec1071e,0xbf064b82,0xbf084b92,0xbf0a48ad,0xbf0c42c9
.long 0xbf2beb4a,0xbf2e3bde,0xbf3085bb,0xbf32c8c9,0xbf4bbbf8,0xbf4e1689,0xbf5064af,0xbf52a649,0xbf64aa59,0xbf66becc,0xbf68bf3c,0xbf6aab7b,0xbf75dec6,0xbf77583a,0xbf78b47b,0xbf79f35e
.long 0xbf7ec46d,0xbf7f4e6d,0xbf7fb10f,0xbf7fec43,0xbf7f0e58,0xbf7e5a38,0xbf7d7474,0xbf7c5d3a,0xbf76ba07,0xbf748422,0xbf721352,0xbf6f6830,0xbf660f88,0xbf62241a,0xbf5df6be,0xbf5988ad
.long 0xbf4d9f02,0xbf47de65,0xbf41d870,0xbf3b8f3b,0xbf2e3bde,0xbf269de3,0xbf1ebc12,0xbf16999f,0xbf08f59b,0xbeff17b2,0xbeebcbbb,0xbed8106b,0xbebe1d4a,0xbea80b1f,0xbe919ddd,0xbe75c35a
.long 0x3f800000,0x3f800000,0x3f800000,0x3f800000,0x3f800000,0x3f7fffb1,0x3f7ffec4,0x3f7ffd39,0x3f800000,0x3f7ffec4,0x3f7ffb11,0x3f7ff4e6,0x3f800000,0x3f7ffd39,0x3f7ff4e6,0x3f7fe705
.long 0x3f800000,0x3f7ffb11,0x3f7fec43,0x3f7fd397,0x3f800000,0x3f7ff84a,0x3f7fe129,0x3f7fba9e,0x3f800000,0x3f7ff4e6,0x3f7fd397,0x3f7f9c18,0x3f800000,0x3f7ff0e3,0x3f7fc38f,0x3f7f7808
.long 0x3f800000,0x3f7fec43,0x3f7fb10f,0x3f7f4e6d,0x3f800000,0x3f7fe705,0x3f7f9c18,0x3f7f1f49,0x3f800000,0x3f7fe129,0x3f7f84ab,0x3f7eea9d,0x3f800000,0x3f7fdaaf,0x3f7f6ac7,0x3f7eb069
.long 0x3f800000,0x3f7fd397,0x3f7f4e6d,0x3f7e70b0,0x3f800000,0x3f7fcbe2,0x3f7f2f9d,0x3f7e2b72,0x3f800000,0x3f7fc38f,0x3f7f0e58,0x3f7de0b1,0x3f800000,0x3f7fba9e,0x3f7eea9d,0x3f7d906e
.long 0x3f800000,0x3f800000,0x3f800000,0x3f800000,0x3f7ffb11,0x3f7ff84a,0x3f7ff4e6,0x3f7ff0e3,0x3f7fec43,0x3f7fe129,0x3f7fd397,0x3f7fc38f,0x3f7fd397,0x3f7fba9e,0x3f7f9c18,0x3f7f7808
.long 0x3f7fb10f,0x3f7f84ab,0x3f7f4e6d,0x3f7f0e58,0x3f7f84ab,0x3f7f3f54,0x3f7eea9d,0x3f7e868b,0x3f7f4e6d,0x3f7eea9d,0x3f7e70b0,0x3f7de0b1,0x3f7f0e58,0x3f7e868b,0x3f7de0b1,0x3f7d1cdd
.long 0x3f7ec46d,0x3f7e1324,0x3f7d3aac,0x3f7c3b28,0x3f7e70b0,0x3f7d906e,0x3f7c7eb0,0x3f7b3bab,0x3f7e1324,0x3f7cfe73,0x3f7baccd,0x3f7a1e84,0x3f7dabcc,0x3f7c5d3a,0x3f7ac516,0x3f78e3d6
.long 0x3f7d3aac,0x3f7baccd,0x3f79c79d,0x3f778bc5,0x3f7cbfc9,0x3f7aed37,0x3f78b47b,0x3f76167a,0x3f7c3b28,0x3f7a1e84,0x3f778bc5,0x3f748422,0x3f7baccd,0x3f7940c0,0x3f764d97,0x3f72d4eb
.long 0x3f800000,0x3f800000,0x3f800000,0x3f800000,0x3f7fec43,0x3f7fe705,0x3f7fe129,0x3f7fdaaf,0x3f7fb10f,0x3f7f9c18,0x3f7f84ab,0x3f7f6ac7,0x3f7f4e6d,0x3f7f1f49,0x3f7eea9d,0x3f7eb069
.long 0x3f7ec46d,0x3f7e70b0,0x3f7e1324,0x3f7dabcc,0x3f7e1324,0x3f7d906e,0x3f7cfe73,0x3f7c5d3a,0x3f7d3aac,0x3f7c7eb0,0x3f7baccd,0x3f7ac516,0x3f7c3b28,0x3f7b3bab,0x3f7a1e84,0x3f78e3d6
.long 0x3f7b14be,0x3f79c79d,0x3f7853f8,0x3f76ba07,0x3f79c79d,0x3f7822d1,0x3f764d97,0x3f74484b,0x3f7853f8,0x3f764d97,0x3f740bdd,0x3f718f57,0x3f76ba07,0x3f74484b,0x3f718f57,0x3f6e8ff8
.long 0x3f74fa0b,0x3f721352,0x3f6ed89e,0x3f6b4b0c,0x3f731447,0x3f6faf1b,0x3f6be858,0x3f67c187,0x3f710908,0x3f6d1c1d,0x3f68bf3c,0x3f63f473,0x3f6ed89e,0x3f6a5ad9,0x3f655e0b,0x3f5fe4e9
.long 0x3f800000,0x3f800000,0x3f800000,0x3f800000,0x3f7fd397,0x3f7fcbe2,0x3f7fc38f,0x3f7fba9e,0x3f7f4e6d,0x3f7f2f9d,0x3f7f0e58,0x3f7eea9d,0x3f7e70b0,0x3f7e2b72,0x3f7de0b1,0x3f7d906e
.long 0x3f7d3aac,0x3f7cbfc9,0x3f7c3b28,0x3f7baccd,0x3f7baccd,0x3f7aed37,0x3f7a1e84,0x3f7940c0,0x3f79c79d,0x3f78b47b,0x3f778bc5,0x3f764d97,0x3f778bc5,0x3f76167a,0x3f748422,0x3f72d4eb
.long 0x3f74fa0b,0x3f731447,0x3f710908,0x3f6ed89e,0x3f721352,0x3f6faf1b,0x3f6d1c1d,0x3f6a5ad9,0x3f6ed89e,0x3f6be858,0x3f68bf3c,0x3f655e0b,0x3f6b4b0c,0x3f67c187,0x3f63f473,0x3f5fe4e9
.long 0x3f676bd8,0x3f633c5a,0x3f5ebe05,0x3f59f26a,0x3f633c5a,0x3f5e5aa6,0x3f591e6a,0x3f5389c7,0x3f5ebe05,0x3f591e6a,0x3f531849,0x3f4cae79,0x3f59f26a,0x3f5389c7,0x3f4cae79,0x3f456439
.long 0x80000000,0x80000000,0x80000000,0x80000000,0x80000000,0x3b490fc6,0x3bc90f88,0x3c16cb58,0x80000000,0x3bc90f88,0x3c490e90,0x3c96c9b6,0x80000000,0x3c16cb58,0x3c96c9b6,0x3ce22a7a
.long 0x80000000,0x3c490e90,0x3cc90ab0,0x3d16c32c,0x80000000,0x3c7b514b,0x3cfb49ba,0x3d3c6dd5,0x80000000,0x3c96c9b6,0x3d16c32c,0x3d621469,0x80000000,0x3cafea69,0x3d2fe007,0x3d83db0a
.long 0x80000000,0x3cc90ab0,0x3d48fb30,0x3d96a905,0x80000000,0x3ce22a7a,0x3d621469,0x3da973ba,0x80000000,0x3cfb49ba,0x3d7b2b74,0x3dbc3ac3,0x80000000,0x3d0a342f,0x3d8a200a,0x3dcefdb7
.long 0x80000000,0x3d16c32c,0x3d96a905,0x3de1bc2e,0x80000000,0x3d2351cb,0x3da3308c,0x3df475c0,0x80000000,0x3d2fe007,0x3dafb680,0x3e039502,0x80000000,0x3d3c6dd5,0x3dbc3ac3,0x3e0cec4a
.long 0x80000000,0x80000000,0x80000000,0x80000000,0x3c490e90,0x3c7b514b,0x3c96c9b6,0x3cafea69,0x3cc90ab0,0x3cfb49ba,0x3d16c32c,0x3d2fe007,0x3d16c32c,0x3d3c6dd5,0x3d621469,0x3d83db0a
.long 0x3d48fb30,0x3d7b2b74,0x3d96a905,0x3dafb680,0x3d7b2b74,0x3d9cecf9,0x3dbc3ac3,0x3ddb7d37,0x3d96a905,0x3dbc3ac3,0x3de1bc2e,0x3e039502,0x3dafb680,0x3ddb7d37,0x3e039502,0x3e195be0
.long 0x3dc8bd36,0x3dfab273,0x3e164083,0x3e2f10a2,0x3de1bc2e,0x3e0cec4a,0x3e28defc,0x3e44b0b9,0x3dfab273,0x3e1c76de,0x3e3b6ecf,0x3e5a3997,0x3e09cf86,0x3e2bf804,0x3e4dee60,0x3e6fa8b2
.long 0x3e164083,0x3e3b6ecf,0x3e605c13,0x3e827dc0,0x3e22abb6,0x3e4ada4f,0x3e72b651,0x3e8d17c0,0x3e2f10a2,0x3e5a3997,0x3e827dc0,0x3e97a117,0x3e3b6ecf,0x3e698bba,0x3e8b9507,0x3ea21887
.long 0x80000000,0x80000000,0x80000000,0x80000000,0x3cc90ab0,0x3ce22a7a,0x3cfb49ba,0x3d0a342f,0x3d48fb30,0x3d621469,0x3d7b2b74,0x3d8a200a,0x3d96a905,0x3da973ba,0x3dbc3ac3,0x3dcefdb7
.long 0x3dc8bd36,0x3de1bc2e,0x3dfab273,0x3e09cf86,0x3dfab273,0x3e0cec4a,0x3e1c76de,0x3e2bf804,0x3e164083,0x3e28defc,0x3e3b6ecf,0x3e4dee60,0x3e2f10a2,0x3e44b0b9,0x3e5a3997,0x3e6fa8b2
.long 0x3e47c5c2,0x3e605c13,0x3e78cfcc,0x3e888e93,0x3e605c13,0x3e7bdba4,0x3e8b9507,0x3e9920fe,0x3e78cfcc,0x3e8b9507,0x3e9aa086,0x3ea986c4,0x3e888e93,0x3e9920fe,0x3ea986c4,0x3eb9bb1e
.long 0x3e94a031,0x3ea68f12,0x3eb8442a,0x3ec9b953,0x3ea09ae5,0x3eb3dca5,0x3ec6d529,0x3ed97cb9,0x3eac7cd4,0x3ec1071e,0x3ed53641,0x3ee900b7,0x3eb8442a,0x3ece0bea,0x3ee363fa,0x3ef840c8
.long 0x80000000,0x80000000,0x80000000,0x80000000,0x3d16c32c,0x3d2351cb,0x3d2fe007,0x3d3c6dd5,0x3d96a905,0x3da3308c,0x3dafb680,0x3dbc3ac3,0x3de1bc2e,0x3df475c0,0x3e039502,0x3e0cec4a
.long 0x3e164083,0x3e22abb6,0x3e2f10a2,0x3e3b6ecf,0x3e3b6ecf,0x3e4ada4f,0x3e5a3997,0x3e698bba,0x3e605c13,0x3e72b651,0x3e827dc0,0x3e8b9507,0x3e827dc0,0x3e8d17c0,0x3e97a117,0x3ea21887
.long 0x3e94a031,0x3ea09ae5,0x3eac7cd4,0x3eb8442a,0x3ea68f12,0x3eb3dca5,0x3ec1071e,0x3ece0bea,0x3eb8442a,0x3ec6d529,0x3ed53641,0x3ee363fa,0x3ec9b953,0x3ed97cb9,0x3ee900b7,0x3ef840c8
.long 0x3edae880,0x3eebcbbb,0x3efc5d27,0x3f064b82,0x3eebcbbb,0x3efdbabb,0x3f07a136,0x3f102dd5,0x3efc5d27,0x3f07a136,0x3f10d3cd,0x3f19c200,0x3f064b82,0x3f102dd5,0x3f19c200,0x3f2302d3
.long 0x3f800000,0x3f7fb10f,0x3f7ec46d,0x3f7d3aac,0x3f800000,0x3f7fa6e3,0x3f7e9bc9,0x3f7cdf6c,0x3f800000,0x3f7f9c18,0x3f7e70b0,0x3f7c7eb0,0x3f800000,0x3f7f90b1,0x3f7e4323,0x3f7c187a
.long 0x3f800000,0x3f7f84ab,0x3f7e1324,0x3f7baccd,0x3f800000,0x3f7f7808,0x3f7de0b1,0x3f7b3bab,0x3f800000,0x3f7f6ac7,0x3f7dabcc,0x3f7ac516,0x3f800000,0x3f7f5ce9,0x3f7d7474,0x3f7a4910
.long 0x3f800000,0x3f7f4e6d,0x3f7d3aac,0x3f79c79d,0x3f800000,0x3f7f3f54,0x3f7cfe73,0x3f7940c0,0x3f800000,0x3f7f2f9d,0x3f7cbfc9,0x3f78b47b,0x3f800000,0x3f7f1f49,0x3f7c7eb0,0x3f7822d1
.long 0x3f800000,0x3f7f0e58,0x3f7c3b28,0x3f778bc5,0x3f800000,0x3f7efcc9,0x3f7bf531,0x3f76ef5b,0x3f800000,0x3f7eea9d,0x3f7baccd,0x3f764d97,0x3f800000,0x3f7ed7d4,0x3f7b61fc,0x3f75a67b
.long 0x3f7b14be,0x3f7853f8,0x3f74fa0b,0x3f710908,0x3f7a7302,0x3f77583a,0x3f73913f,0x3f6f20b0,0x3f79c79d,0x3f764d97,0x3f721352,0x3f6d1c1d,0x3f791298,0x3f75341d,0x3f708066,0x3f6afb8c
.long 0x3f7853f8,0x3f740bdd,0x3f6ed89e,0x3f68bf3c,0x3f778bc5,0x3f72d4eb,0x3f6d1c1d,0x3f666771,0x3f76ba07,0x3f718f57,0x3f6b4b0c,0x3f63f473,0x3f75dec6,0x3f703b37,0x3f696591,0x3f61668a
.long 0x3f74fa0b,0x3f6ed89e,0x3f676bd8,0x3f5ebe05,0x3f740bdd,0x3f6d67a1,0x3f655e0b,0x3f5bfb34,0x3f731447,0x3f6be858,0x3f633c5a,0x3f591e6a,0x3f721352,0x3f6a5ad9,0x3f6106f2,0x3f5627fe
.long 0x3f710908,0x3f68bf3c,0x3f5ebe05,0x3f531849,0x3f6ff573,0x3f671599,0x3f5c61c7,0x3f4fefa8,0x3f6ed89e,0x3f655e0b,0x3f59f26a,0x3f4cae79,0x3f6db293,0x3f6398ac,0x3f577026,0x3f495521
.long 0x3f6c835e,0x3f676bd8,0x3f61c598,0x3f5b941a,0x3f6a09a7,0x3f644fac,0x3f5df6be,0x3f570348,0x3f676bd8,0x3f6106f2,0x3f59f26a,0x3f5233c6,0x3f64aa59,0x3f5d924d,0x3f55b993,0x3f4d26fd
.long 0x3f61c598,0x3f59f26a,0x3f514d3d,0x3f47de65,0x3f5ebe05,0x3f5627fe,0x3f4cae79,0x3f425b89,0x3f5b941a,0x3f5233c6,0x3f47de65,0x3f3ca003,0x3f584853,0x3f4e1689,0x3f42de29,0x3f36ad7f
.long 0x3f54db31,0x3f49d112,0x3f3daef9,0x3f3085bb,0x3f514d3d,0x3f456439,0x3f385216,0x3f2a2a80,0x3f4d9f02,0x3f40d0da,0x3f32c8c9,0x3f239da9,0x3f49d112,0x3f3c17d9,0x3f2d1469,0x3f1ce11f
.long 0x3f45e403,0x3f373a23,0x3f273656,0x3f15f6d9,0x3f41d870,0x3f3238aa,0x3f212ff9,0x3f0ee0db,0x3f3daef9,0x3f2d1469,0x3f1b02c6,0x3f07a136,0x3f396842,0x3f27ce61,0x3f14b039,0x3f003a06
.long 0x3f54db31,0x3f4d9f02,0x3f45e403,0x3f3daef9,0x3f4f7a1f,0x3f476085,0x3f3ebc1b,0x3f3592e7,0x3f49d112,0x3f40d0da,0x3f373a23,0x3f2d1469,0x3f43e200,0x3f39f2ac,0x3f2f61a5,0x3f24381a
.long 0x3f3daef9,0x3f32c8c9,0x3f273656,0x3f1b02c6,0x3f373a23,0x3f2b561b,0x3f1ebc12,0x3f11796b,0x3f3085bb,0x3f239da9,0x3f15f6d9,0x3f07a136,0x3f299415,0x3f1ba299,0x3f0cead0,0x3efafef7
.long 0x3f226799,0x3f13682a,0x3f039c3d,0x3ee63375,0x3f1b02c6,0x3f0af1b7,0x3ef41f07,0x3ed0eb2a,0x3f13682a,0x3f0242b1,0x3ee0924f,0x3ebb31a0,0x3f0b9a6b,0x3ef2bd43,0x3ecc9b8b,0x3ea5129f
.long 0x3f039c3d,0x3ee0924f,0x3eb8442a,0x3e8e9a22,0x3ef6e0cb,0x3ece0bea,0x3ea395c5,0x3e6fa8b2,0x3ee63375,0x3ebb31a0,0x3e8e9a22,0x3e419b37,0x3ed53641,0x3ea80b1f,0x3e72b651,0x3e1324ca
.long 0x80000000,0x3d48fb30,0x3dc8bd36,0x3e164083,0x80000000,0x3d55880e,0x3dd53db9,0x3e1f917b,0x80000000,0x3d621469,0x3de1bc2e,0x3e28defc,0x80000000,0x3d6ea038,0x3dee3876,0x3e3228d4
.long 0x80000000,0x3d7b2b74,0x3dfab273,0x3e3b6ecf,0x80000000,0x3d83db0a,0x3e039502,0x3e44b0b9,0x80000000,0x3d8a200a,0x3e09cf86,0x3e4dee60,0x80000000,0x3d9064b4,0x3e1008b7,0x3e57278f
.long 0x80000000,0x3d96a905,0x3e164083,0x3e605c13,0x80000000,0x3d9cecf9,0x3e1c76de,0x3e698bba,0x80000000,0x3da3308c,0x3e22abb6,0x3e72b651,0x80000000,0x3da973ba,0x3e28defc,0x3e7bdba4
.long 0x80000000,0x3dafb680,0x3e2f10a2,0x3e827dc0,0x80000000,0x3db5f8da,0x3e354098,0x3e870ada,0x80000000,0x3dbc3ac3,0x3e3b6ecf,0x3e8b9507,0x80000000,0x3dc27c39,0x3e419b37,0x3e901c2c
.long 0x3e47c5c2,0x3e78cfcc,0x3e94a031,0x3eac7cd4,0x3e541501,0x3e840270,0x3e9d9e78,0x3eb6ccc3,0x3e605c13,0x3e8b9507,0x3ea68f12,0x3ec1071e,0x3e6c9a7f,0x3e931f35,0x3eaf713a,0x3ecb2aae
.long 0x3e78cfcc,0x3e9aa086,0x3eb8442a,0x3ed53641,0x3e827dc0,0x3ea21887,0x3ec1071e,0x3edf28a9,0x3e888e93,0x3ea986c4,0x3ec9b953,0x3ee900b7,0x3e8e9a22,0x3eb0eacb,0x3ed25a09,0x3ef2bd43
.long 0x3e94a031,0x3eb8442a,0x3edae880,0x3efc5d27,0x3e9aa086,0x3ebf926f,0x3ee363fa,0x3f02ef9f,0x3ea09ae5,0x3ec6d529,0x3eebcbbb,0x3f07a136,0x3ea68f12,0x3ece0bea,0x3ef41f07,0x3f0c42c9
.long 0x3eac7cd4,0x3ed53641,0x3efc5d27,0x3f10d3cd,0x3eb263ef,0x3edc53c1,0x3f0242b1,0x3f1553b7,0x3eb8442a,0x3ee363fa,0x3f064b82,0x3f19c200,0x3ebe1d4a,0x3eea6681,0x3f0a48ad,0x3f1e1e22
.long 0x3ec3ef15,0x3edae880,0x3ef15aea,0x3f039c3d,0x3ecf7bca,0x3ee79a5d,0x3eff17b2,0x3f0af1b7,0x3edae880,0x3ef41f07,0x3f064b82,0x3f121eb0,0x3ee63375,0x3f003a06,0x3f0cead0,0x3f19210f
.long 0x3ef15aea,0x3f064b82,0x3f13682a,0x3f1ff6cb,0x3efc5d27,0x3f0c42c9,0x3f19c200,0x3f269de3,0x3f039c3d,0x3f121eb0,0x3f1ff6cb,0x3f2d1469,0x3f08f59b,0x3f17de12,0x3f26050a,0x3f33587a
.long 0x3f0e39da,0x3f1d7fd1,0x3f2beb4a,0x3f396842,0x3f13682a,0x3f2302d3,0x3f31a81d,0x3f3f41fc,0x3f187fc0,0x3f286605,0x3f373a23,0x3f44e3f5,0x3f1d7fd1,0x3f2da859,0x3f3ca003,0x3f4a4c87
.long 0x3f226799,0x3f32c8c9,0x3f41d870,0x3f4f7a1f,0x3f273656,0x3f37c655,0x3f46e22a,0x3f546b3b,0x3f2beb4a,0x3f3ca003,0x3f4bbbf8,0x3f591e6a,0x3f3085bb,0x3f4154e1,0x3f5064af,0x3f5d924d
.long 0x3f0e39da,0x3f187fc0,0x3f226799,0x3f2beb4a,0x3f15f6d9,0x3f209393,0x3f2ac082,0x3f34768f,0x3f1d7fd1,0x3f286605,0x3f32c8c9,0x3f3ca003,0x3f24d225,0x3f2ff3e6,0x3f3a7ca4,0x3f446337
.long 0x3f2beb4a,0x3f373a23,0x3f41d870,0x3f4bbbf8,0x3f32c8c9,0x3f3e35c5,0x3f48d8b3,0x3f52a649,0x3f396842,0x3f44e3f5,0x3f4f7a1f,0x3f591e6a,0x3f3fc767,0x3f4b41fa,0x3f55b993,0x3f5f20db
.long 0x3f45e403,0x3f514d3d,0x3f5b941a,0x3f64aa59,0x3f4bbbf8,0x3f570348,0x3f6106f2,0x3f69b7e4,0x3f514d3d,0x3f5c61c7,0x3f660f88,0x3f6e46be,0x3f5695e5,0x3f61668a,0x3f6aab7b,0x3f725470
.long 0x3f5b941a,0x3f660f88,0x3f6ed89e,0x3f75dec6,0x3f604621,0x3f6a5ad9,0x3f7294f8,0x3f78e3d6,0x3f64aa59,0x3f6e46be,0x3f75dec6,0x3f7b61fc,0x3f68bf3c,0x3f71d19f,0x3f78b47b,0x3f7d57de
.long 0x3f800000,0x3f7ec46d,0x3f7b14be,0x3f74fa0b,0x3f800000,0x3f7eb069,0x3f7ac516,0x3f74484b,0x3f800000,0x3f7e9bc9,0x3f7a7302,0x3f73913f,0x3f800000,0x3f7e868b,0x3f7a1e84,0x3f72d4eb
.long 0x3f800000,0x3f7e70b0,0x3f79c79d,0x3f721352,0x3f800000,0x3f7e5a38,0x3f796e4e,0x3f714c7a,0x3f800000,0x3f7e4323,0x3f791298,0x3f708066,0x3f800000,0x3f7e2b72,0x3f78b47b,0x3f6faf1b
.long 0x3f800000,0x3f7e1324,0x3f7853f8,0x3f6ed89e,0x3f800000,0x3f7dfa38,0x3f77f110,0x3f6dfcf2,0x3f800000,0x3f7de0b1,0x3f778bc5,0x3f6d1c1d,0x3f800000,0x3f7dc68c,0x3f772417,0x3f6c3624
.long 0x3f800000,0x3f7dabcc,0x3f76ba07,0x3f6b4b0c,0x3f800000,0x3f7d906e,0x3f764d97,0x3f6a5ad9,0x3f800000,0x3f7d7474,0x3f75dec6,0x3f696591,0x3f800000,0x3f7d57de,0x3f756d97,0x3f686b39
.long 0x3f6c835e,0x3f61c598,0x3f54db31,0x3f45e403,0x3f6b4b0c,0x3f5fe4e9,0x3f5233c6,0x3f425b89,0x3f6a09a7,0x3f5df6be,0x3f4f7a1f,0x3f3ebc1b,0x3f68bf3c,0x3f5bfb34,0x3f4cae79,0x3f3b0629
.long 0x3f676bd8,0x3f59f26a,0x3f49d112,0x3f373a23,0x3f660f88,0x3f57dc7f,0x3f46e22a,0x3f33587a,0x3f64aa59,0x3f55b993,0x3f43e200,0x3f2f61a5,0x3f633c5a,0x3f5389c7,0x3f40d0da,0x3f2b561b
.long 0x3f61c598,0x3f514d3d,0x3f3daef9,0x3f273656,0x3f604621,0x3f4f0417,0x3f3a7ca4,0x3f2302d3,0x3f5ebe05,0x3f4cae79,0x3f373a23,0x3f1ebc12,0x3f5d2d53,0x3f4a4c87,0x3f33e7bc,0x3f1a6293
.long 0x3f5b941a,0x3f47de65,0x3f3085bb,0x3f15f6d9,0x3f59f26a,0x3f456439,0x3f2d1469,0x3f11796b,0x3f584853,0x3f42de29,0x3f299415,0x3f0cead0,0x3f5695e5,0x3f404c5c,0x3f26050a,0x3f084b92
.long 0x3f3504f3,0x3f226799,0x3f0e39da,0x3ef15aea,0x3f3085bb,0x3f1ce11f,0x3f07a136,0x3ee1fb6a,0x3f2beb4a,0x3f173c07,0x3f00e7e4,0x3ed25a09,0x3f273656,0x3f11796b,0x3ef41f07,0x3ec27b55
.long 0x3f226799,0x3f0b9a6b,0x3ee63375,0x3eb263ef,0x3f1d7fd1,0x3f05a02c,0x3ed8106b,0x3ea21887,0x3f187fc0,0x3eff17b2,0x3ec9b953,0x3e919ddd,0x3f13682a,0x3ef2bd43,0x3ebb31a0,0x3e80f8c0
.long 0x3f0e39da,0x3ee63375,0x3eac7cd4,0x3e605c13,0x3f08f59b,0x3ed97cb9,0x3e9d9e78,0x3e3e853e,0x3f039c3d,0x3ecc9b8b,0x3e8e9a22,0x3e1c76de,0x3efc5d27,0x3ebf926f,0x3e7ee6e1,0x3df475c0
.long 0x3ef15aea,0x3eb263ef,0x3e605c13,0x3dafb680,0x3ee63375,0x3ea5129f,0x3e419b37,0x3d55880e,0x3edae880,0x3e97a117,0x3e22abb6,0x3c96c9b6,0x3ecf7bca,0x3e8a11f7,0x3e039502,0xbc7b514b
.long 0x3ec3ef15,0x3e94a031,0x3e47c5c2,0x3dc8bd36,0x3eb263ef,0x3e80f8c0,0x3e1c76de,0x3d55880e,0x3ea09ae5,0x3e5a3997,0x3de1bc2e,0x3bc90f88,0x3e8e9a22,0x3e3228d4,0x3d8a200a,0xbd2351cb
.long 0x3e78cfcc,0x3e09cf86,0x3cc90ab0,0xbdafb680,0x3e541501,0x3dc27c39,0xbc96c9b6,0xbe06b26e,0x3e2f10a2,0x3d621469,0xbd7b2b74,0xbe354098,0x3e09cf86,0x3c7b514b,0xbdd53db9,0xbe636c83
.long 0x3dc8bd36,0xbcc90ab0,0xbe164083,0xbe888e93,0x3d7b2b74,0xbd83db0a,0xbe419b37,0xbe9f1cdf,0x3cc90ab0,0xbdd53db9,0xbe6c9a7f,0xbeb554ec,0xbc490e90,0xbe1324ca,0xbe8b9507,0xbecb2aae
.long 0xbd48fb30,0xbe3b6ecf,0xbea09ae5,0xbee0924f,0xbdafb680,0xbe636c83,0xbeb554ec,0xbef58035,0xbdfab273,0xbe8586ce,0xbec9b953,0xbf04f484,0xbe22abb6,0xbe9920fe,0xbeddbe79,0xbf0ee0db
.long 0x80000000,0x3dc8bd36,0x3e47c5c2,0x3e94a031,0x80000000,0x3dcefdb7,0x3e4dee60,0x3e9920fe,0x80000000,0x3dd53db9,0x3e541501,0x3e9d9e78,0x80000000,0x3ddb7d37,0x3e5a3997,0x3ea21887
.long 0x80000000,0x3de1bc2e,0x3e605c13,0x3ea68f12,0x80000000,0x3de7fa9a,0x3e667c66,0x3eab0201,0x80000000,0x3dee3876,0x3e6c9a7f,0x3eaf713a,0x80000000,0x3df475c0,0x3e72b651,0x3eb3dca5
.long 0x80000000,0x3dfab273,0x3e78cfcc,0x3eb8442a,0x80000000,0x3e007745,0x3e7ee6e1,0x3ebca7af,0x80000000,0x3e039502,0x3e827dc0,0x3ec1071e,0x80000000,0x3e06b26e,0x3e8586ce,0x3ec5625c
.long 0x80000000,0x3e09cf86,0x3e888e93,0x3ec9b953,0x80000000,0x3e0cec4a,0x3e8b9507,0x3ece0bea,0x80000000,0x3e1008b7,0x3e8e9a22,0x3ed25a09,0x80000000,0x3e1324ca,0x3e919ddd,0x3ed6a399
.long 0x3ec3ef15,0x3ef15aea,0x3f0e39da,0x3f226799,0x3ec9b953,0x3ef840c8,0x3f121eb0,0x3f269de3,0x3ecf7bca,0x3eff17b2,0x3f15f6d9,0x3f2ac082,0x3ed53641,0x3f02ef9f,0x3f19c200,0x3f2ecef7
.long 0x3edae880,0x3f064b82,0x3f1d7fd1,0x3f32c8c9,0x3ee0924f,0x3f099f4e,0x3f212ff9,0x3f36ad7f,0x3ee63375,0x3f0cead0,0x3f24d225,0x3f3a7ca4,0x3eebcbbb,0x3f102dd5,0x3f286605,0x3f3e35c5
.long 0x3ef15aea,0x3f13682a,0x3f2beb4a,0x3f41d870,0x3ef6e0cb,0x3f16999f,0x3f2f61a5,0x3f456439,0x3efc5d27,0x3f19c200,0x3f32c8c9,0x3f48d8b3,0x3f00e7e4,0x3f1ce11f,0x3f36206c,0x3f4c3578
.long 0x3f039c3d,0x3f1ff6cb,0x3f396842,0x3f4f7a1f,0x3f064b82,0x3f2302d3,0x3f3ca003,0x3f52a649,0x3f08f59b,0x3f26050a,0x3f3fc767,0x3f55b993,0x3f0b9a6b,0x3f28fd41,0x3f42de29,0x3f58b3a1
.long 0x3f3504f3,0x3f45e403,0x3f54db31,0x3f61c598,0x3f396842,0x3f4a4c87,0x3f591e6a,0x3f65b710,0x3f3daef9,0x3f4e8d90,0x3f5d2d53,0x3f696591,0x3f41d870,0x3f52a649,0x3f6106f2,0x3f6cd007
.long 0x3f45e403,0x3f5695e5,0x3f64aa59,0x3f6ff573,0x3f49d112,0x3f5a5ba0,0x3f6816a8,0x3f72d4eb,0x3f4d9f02,0x3f5df6be,0x3f6b4b0c,0x3f756d97,0x3f514d3d,0x3f61668a,0x3f6e46be,0x3f77beb7
.long 0x3f54db31,0x3f64aa59,0x3f710908,0x3f79c79d,0x3f584853,0x3f67c187,0x3f73913f,0x3f7b87b2,0x3f5b941a,0x3f6aab7b,0x3f75dec6,0x3f7cfe73,0x3f5ebe05,0x3f6d67a1,0x3f77f110,0x3f7e2b72
.long 0x3f61c598,0x3f6ff573,0x3f79c79d,0x3f7f0e58,0x3f64aa59,0x3f725470,0x3f7b61fc,0x3f7fa6e3,0x3f676bd8,0x3f748422,0x3f7cbfc9,0x3f7ff4e6,0x3f6a09a7,0x3f76841b,0x3f7de0b1,0x3f7ff84a
.long 0x3f6c835e,0x3f74fa0b,0x3f7b14be,0x3f7ec46d,0x3f6ff573,0x3f77beb7,0x3f7cfe73,0x3f7fa6e3,0x3f731447,0x3f7a1e84,0x3f7e70b0,0x3f7ffec4,0x3f75dec6,0x3f7c187a,0x3f7f6ac7,0x3f7fcbe2
.long 0x3f7853f8,0x3f7dabcc,0x3f7fec43,0x3f7f0e58,0x3f7a7302,0x3f7ed7d4,0x3f7ff4e6,0x3f7dc68c,0x3f7c3b28,0x3f7f9c18,0x3f7f84ab,0x3f7bf531,0x3f7dabcc,0x3f7ff84a,0x3f7e9bc9,0x3f799b43
.long 0x3f7ec46d,0x3f7fec43,0x3f7d3aac,0x3f76ba07,0x3f7f84ab,0x3f7f7808,0x3f7b61fc,0x3f73530e,0x3f7fec43,0x3f7e9bc9,0x3f791298,0x3f6f6830,0x3f7ffb11,0x3f7d57de,0x3f764d97,0x3f6afb8c
.long 0x3f7fb10f,0x3f7baccd,0x3f731447,0x3f660f88,0x3f7f0e58,0x3f799b43,0x3f6f6830,0x3f60a6cf,0x3f7e1324,0x3f772417,0x3f6b4b0c,0x3f5ac450,0x3f7cbfc9,0x3f74484b,0x3f66becc,0x3f546b3b
.long 0x3f800000,0x3f7d3aac,0x3f74fa0b,0x3f676bd8,0x3f800000,0x3f7d1cdd,0x3f748422,0x3f666771,0x3f800000,0x3f7cfe73,0x3f740bdd,0x3f655e0b,0x3f800000,0x3f7cdf6c,0x3f73913f,0x3f644fac
.long 0x3f800000,0x3f7cbfc9,0x3f731447,0x3f633c5a,0x3f800000,0x3f7c9f8a,0x3f7294f8,0x3f62241a,0x3f800000,0x3f7c7eb0,0x3f721352,0x3f6106f2,0x3f800000,0x3f7c5d3a,0x3f718f57,0x3f5fe4e9
.long 0x3f800000,0x3f7c3b28,0x3f710908,0x3f5ebe05,0x3f800000,0x3f7c187a,0x3f708066,0x3f5d924d,0x3f800000,0x3f7bf531,0x3f6ff573,0x3f5c61c7,0x3f800000,0x3f7bd14d,0x3f6f6830,0x3f5b2c79
.long 0x3f800000,0x3f7baccd,0x3f6ed89e,0x3f59f26a,0x3f800000,0x3f7b87b2,0x3f6e46be,0x3f58b3a1,0x3f800000,0x3f7b61fc,0x3f6db293,0x3f577026,0x3f800000,0x3f7b3bab,0x3f6d1c1d,0x3f5627fe
.long 0x3f54db31,0x3f3daef9,0x3f226799,0x3f039c3d,0x3f531849,0x3f3b0629,0x3f1ebc12,0x3efdbabb,0x3f514d3d,0x3f385216,0x3f1b02c6,0x3ef41f07,0x3f4f7a1f,0x3f3592e7,0x3f173c07,0x3eea6681
.long 0x3f4d9f02,0x3f32c8c9,0x3f13682a,0x3ee0924f,0x3f4bbbf8,0x3f2ff3e6,0x3f0f8784,0x3ed6a399,0x3f49d112,0x3f2d1469,0x3f0b9a6b,0x3ecc9b8b,0x3f47de65,0x3f2a2a80,0x3f07a136,0x3ec27b55
.long 0x3f45e403,0x3f273656,0x3f039c3d,0x3eb8442a,0x3f43e200,0x3f24381a,0x3eff17b2,0x3eadf73c,0x3f41d870,0x3f212ff9,0x3ef6e0cb,0x3ea395c5,0x3f3fc767,0x3f1e1e22,0x3eee9479,0x3e9920fe
.long 0x3f3daef9,0x3f1b02c6,0x3ee63375,0x3e8e9a22,0x3f3b8f3b,0x3f17de12,0x3eddbe79,0x3e840270,0x3f396842,0x3f14b039,0x3ed53641,0x3e72b651,0x3f373a23,0x3f11796b,0x3ecc9b8b,0x3e5d4b1a
.long 0x3ec3ef15,0x3e78cfcc,0x3dc8bd36,0xbd48fb30,0x3eb8442a,0x3e5d4b1a,0x3d8a200a,0xbda973ba,0x3eac7cd4,0x3e419b37,0x3d16c32c,0xbdee3876,0x3ea09ae5,0x3e25c58c,0x3bc90f88,0xbe195be0
.long 0x3e94a031,0x3e09cf86,0xbcc90ab0,0xbe3b6ecf,0x3e888e93,0x3ddb7d37,0xbd621469,0xbe5d4b1a,0x3e78cfcc,0x3da3308c,0xbdafb680,0xbe7ee6e1,0x3e605c13,0x3d55880e,0xbdee3876,0xbe901c2c
.long 0x3e47c5c2,0x3cc90ab0,0xbe164083,0xbea09ae5,0x3e2f10a2,0xbb490fc6,0xbe354098,0xbeb0eacb,0x3e164083,0xbcfb49ba,0xbe541501,0xbec1071e,0x3dfab273,0xbd6ea038,0xbe72b651,0xbed0eb2a
.long 0x3dc8bd36,0xbdafb680,0xbe888e93,0xbee0924f,0x3d96a905,0xbde7fa9a,0xbe97a117,0xbeeff7fb,0x3d48fb30,0xbe1008b7,0xbea68f12,0xbeff17b2,0x3cc90ab0,0xbe2bf804,0xbeb554ec,0xbf06f686
.long 0xbe47c5c2,0xbeac7cd4,0xbef15aea,0xbf187fc0,0xbe6c9a7f,0xbebf926f,0xbf0242b1,0xbf21cbfb,0xbe888e93,0xbed25a09,0xbf0b9a6b,0xbf2ac082,0xbe9aa086,0xbee4cbfe,0xbf14b039,0xbf33587a
.long 0xbeac7cd4,0xbef6e0cb,0xbf1d7fd1,0xbf3b8f3b,0xbebe1d4a,0xbf044889,0xbf26050a,0xbf436051,0xbecf7bca,0xbf0cead0,0xbf2e3bde,0xbf4ac77f,0xbee0924f,0xbf1553b7,0xbf36206c,0xbf51c0c2
.long 0xbef15aea,0xbf1d7fd1,0xbf3daef9,0xbf584853,0xbf00e7e4,0xbf256bcb,0xbf44e3f5,0xbf5e5aa6,0xbf08f59b,0xbf2d1469,0xbf4bbbf8,0xbf63f473,0xbf10d3cd,0xbf34768f,0xbf5233c6,0xbf6912ae
.long 0xbf187fc0,0xbf3b8f3b,0xbf584853,0xbf6db293,0xbf1ff6cb,0xbf425b89,0xbf5df6be,0xbf71d19f,0xbf273656,0xbf48d8b3,0xbf633c5a,0xbf756d97,0xbf2e3bde,0xbf4f0417,0xbf6816a8,0xbf788486
.long 0x80000000,0x3e164083,0x3e94a031,0x3edae880,0x80000000,0x3e195be0,0x3e97a117,0x3edf28a9,0x80000000,0x3e1c76de,0x3e9aa086,0x3ee363fa,0x80000000,0x3e1f917b,0x3e9d9e78,0x3ee79a5d
.long 0x80000000,0x3e22abb6,0x3ea09ae5,0x3eebcbbb,0x80000000,0x3e25c58c,0x3ea395c5,0x3eeff7fb,0x80000000,0x3e28defc,0x3ea68f12,0x3ef41f07,0x80000000,0x3e2bf804,0x3ea986c4,0x3ef840c8
.long 0x80000000,0x3e2f10a2,0x3eac7cd4,0x3efc5d27,0x80000000,0x3e3228d4,0x3eaf713a,0x3f003a06,0x80000000,0x3e354098,0x3eb263ef,0x3f0242b1,0x80000000,0x3e3857ec,0x3eb554ec,0x3f044889
.long 0x80000000,0x3e3b6ecf,0x3eb8442a,0x3f064b82,0x80000000,0x3e3e853e,0x3ebb31a0,0x3f084b92,0x80000000,0x3e419b37,0x3ebe1d4a,0x3f0a48ad,0x80000000,0x3e44b0b9,0x3ec1071e,0x3f0c42c9
.long 0x3f0e39da,0x3f2beb4a,0x3f45e403,0x3f5b941a,0x3f10d3cd,0x3f2ecef7,0x3f48d8b3,0x3f5e5aa6,0x3f13682a,0x3f31a81d,0x3f4bbbf8,0x3f6106f2,0x3f15f6d9,0x3f34768f,0x3f4e8d90,0x3f6398ac
.long 0x3f187fc0,0x3f373a23,0x3f514d3d,0x3f660f88,0x3f1b02c6,0x3f39f2ac,0x3f53fac3,0x3f686b39,0x3f1d7fd1,0x3f3ca003,0x3f5695e5,0x3f6aab7b,0x3f1ff6cb,0x3f3f41fc,0x3f591e6a,0x3f6cd007
.long 0x3f226799,0x3f41d870,0x3f5b941a,0x3f6ed89e,0x3f24d225,0x3f446337,0x3f5df6be,0x3f70c501,0x3f273656,0x3f46e22a,0x3f604621,0x3f7294f8,0x3f299415,0x3f495521,0x3f628210,0x3f74484b
.long 0x3f2beb4a,0x3f4bbbf8,0x3f64aa59,0x3f75dec6,0x3f2e3bde,0x3f4e1689,0x3f66becc,0x3f77583a,0x3f3085bb,0x3f5064af,0x3f68bf3c,0x3f78b47b,0x3f32c8c9,0x3f52a649,0x3f6aab7b,0x3f79f35e
.long 0x3f6c835e,0x3f7853f8,0x3f7ec46d,0x3f7fb10f,0x3f6ed89e,0x3f79f35e,0x3f7f6ac7,0x3f7f1f49,0x3f710908,0x3f7b61fc,0x3f7fd397,0x3f7e4323,0x3f731447,0x3f7c9f8a,0x3f7ffec4,0x3f7d1cdd
.long 0x3f74fa0b,0x3f7dabcc,0x3f7fec43,0x3f7baccd,0x3f76ba07,0x3f7e868b,0x3f7f9c18,0x3f79f35e,0x3f7853f8,0x3f7f2f9d,0x3f7f0e58,0x3f77f110,0x3f79c79d,0x3f7fa6e3,0x3f7e4323,0x3f75a67b
.long 0x3f7b14be,0x3f7fec43,0x3f7d3aac,0x3f731447,0x3f7c3b28,0x3f7fffb1,0x3f7bf531,0x3f703b37,0x3f7d3aac,0x3f7fe129,0x3f7a7302,0x3f6d1c1d,0x3f7e1324,0x3f7f90b1,0x3f78b47b,0x3f69b7e4
.long 0x3f7ec46d,0x3f7f0e58,0x3f76ba07,0x3f660f88,0x3f7f4e6d,0x3f7e5a38,0x3f748422,0x3f62241a,0x3f7fb10f,0x3f7d7474,0x3f721352,0x3f5df6be,0x3f7fec43,0x3f7c5d3a,0x3f6f6830,0x3f5988ad
.long 0x3f7b14be,0x3f710908,0x3f61c598,0x3f4d9f02,0x3f791298,0x3f6d67a1,0x3f5c61c7,0x3f466354,0x3f76ba07,0x3f696591,0x3f5695e5,0x3f3ebc1b,0x3f740bdd,0x3f650479,0x3f5064af,0x3f36ad7f
.long 0x3f710908,0x3f604621,0x3f49d112,0x3f2e3bde,0x3f6db293,0x3f5b2c79,0x3f42de29,0x3f256bcb,0x3f6a09a7,0x3f55b993,0x3f3b8f3b,0x3f1c420c,0x3f660f88,0x3f4fefa8,0x3f33e7bc,0x3f12c39a
.long 0x3f61c598,0x3f49d112,0x3f2beb4a,0x3f08f59b,0x3f5d2d53,0x3f436051,0x3f239da9,0x3efdbabb,0x3f584853,0x3f3ca003,0x3f1b02c6,0x3ee900b7,0x3f531849,0x3f3592e7,0x3f121eb0,0x3ed3c867
.long 0x3f4d9f02,0x3f2e3bde,0x3f08f59b,0x3ebe1d4a,0x3f47de65,0x3f269de3,0x3eff17b2,0x3ea80b1f,0x3f41d870,0x3f1ebc12,0x3eebcbbb,0x3e919ddd,0x3f3b8f3b,0x3f16999f,0x3ed8106b,0x3e75c35a
.long 0x3f803f80,0x3f803f80,0x3f803f80,0x3f803f80,0x3f7b3f80,0x3f553f6d,0xbf7bbf80,0xbf55bf6d,0x3f6d3f80,0x3ec43f35,0x3f6d3f80,0x3ec43f35,0x3f553f80,0xbe483ec4,0xbf55bf80,0x3e48bec4
.long 0x248d3f80,0xa554bf80,0x248d3f80,0xa554bf80,0xbe483f80,0x3f0ebf6d,0x3e48bf80,0xbf0e3f6d,0xbec43f80,0x3f6dbf35,0xbec43f80,0x3f6dbf35,0xbf0e3f80,0x3f7bbec4,0x3f0ebf80,0xbf7b3ec4
.long 0xbf803f80,0xbf803f80,0xbf803f80,0xbf803f80,0xbf7b3f80,0xbf553f6d,0x3f7bbf80,0x3f55bf6d,0xbf6d3f80,0xbec43f35,0xbf6d3f80,0xbec43f35,0xbf553f80,0x3e483ec4,0x3f55bf80,0xbe48bec4
.long 0xa5543f80,0x248dbf80,0xa5543f80,0x248dbf80,0x3e483f80,0xbf0ebf6d,0xbe48bf80,0x3f0e3f6d,0x3ec43f80,0xbf6dbf35,0x3ec43f80,0xbf6dbf35,0x3f0e3f80,0xbf7bbec4,0xbf0ebf80,0x3f7b3ec4
.long 0x3f803f80,0x3f803f80,0x3f803f80,0x3f803f80,0x3f0e3f35,0x3e483ec4,0xbf0ebf35,0xbe48bec4,0xbec4248d,0xbf6dbf35,0xbec4248d,0xbf6dbf35,0xbf7bbf35,0xbf0ebf6d,0x3f7b3f35,0x3f0e3f6d
.long 0x248d3f80,0xa554bf80,0x248d3f80,0xa554bf80,0xbf553f35,0x3f7bbec4,0x3f55bf35,0xbf7b3ec4,0xbf6d248d,0x3ec43f35,0xbf6d248d,0x3ec43f35,0xbe48bf35,0xbf553f6d,0x3e483f35,0x3f55bf6d
.long 0xbf803f80,0xbf803f80,0xbf803f80,0xbf803f80,0xbf0e3f35,0xbe483ec4,0x3f0ebf35,0x3e48bec4,0x3ec4248d,0x3f6dbf35,0x3ec4248d,0x3f6dbf35,0x3f7bbf35,0x3f0ebf6d,0xbf7b3f35,0xbf0e3f6d
.long 0xa5543f80,0x248dbf80,0xa5543f80,0x248dbf80,0x3f553f35,0xbf7bbec4,0xbf55bf35,0x3f7b3ec4,0x3f6d248d,0xbec43f35,0x3f6d248d,0xbec43f35,0x3e48bf35,0x3f553f6d,0xbe483f35,0xbf55bf6d
.long 0x3f803f80,0x3f803f80,0x3f803f80,0x3f803f80,0xbe48248d,0xbf0ebec4,0x3e48a554,0x3f0e3ec4,0xbf6dbf80,0xbec4bf35,0xbf6dbf80,0xbec4bf35,0x3f0ea554,0x3f7b3f6d,0xbf0e248d,0xbf7bbf6d
.long 0x248d3f80,0xa554bf80,0x248d3f80,0xa554bf80,0xbf7b248d,0x3f553ec4,0x3f7ba554,0xbf55bec4,0x3ec4bf80,0xbf6d3f35,0x3ec4bf80,0xbf6d3f35,0x3f55a554,0x3e48bf6d,0xbf55248d,0xbe483f6d
.long 0xbf803f80,0xbf803f80,0xbf803f80,0xbf803f80,0x3e48248d,0x3f0ebec4,0xbe48a554,0xbf0e3ec4,0x3f6dbf80,0x3ec4bf35,0x3f6dbf80,0x3ec4bf35,0xbf0ea554,0xbf7b3f6d,0x3f0e248d,0x3f7bbf6d
.long 0xa5543f80,0x248dbf80,0xa5543f80,0x248dbf80,0x3f7b248d,0xbf553ec4,0xbf7ba554,0x3f55bec4,0xbec4bf80,0x3f6d3f35,0xbec4bf80,0x3f6d3f35,0xbf55a554,0xbe48bf6d,0x3f55248d,0x3e483f6d
.long 0x3f803f80,0x3f803f80,0x3f803f80,0x3f803f80,0xbf55bf35,0xbf7bbf6d,0x3f553f35,0x3f7b3f6d,0x3ec4a554,0x3f6d3f35,0x3ec4a554,0x3f6d3f35,0x3e483f35,0xbf55bec4,0xbe48bf35,0x3f553ec4
.long 0x248d3f80,0xa554bf80,0x248d3f80,0xa554bf80,0xbf0ebf35,0x3e483f6d,0x3f0e3f35,0xbe48bf6d,0x3f6da554,0xbec4bf35,0x3f6da554,0xbec4bf35,0xbf7b3f35,0x3f0e3ec4,0x3f7bbf35,0xbf0ebec4
.long 0xbf803f80,0xbf803f80,0xbf803f80,0xbf803f80,0x3f55bf35,0x3f7bbf6d,0xbf553f35,0xbf7b3f6d,0xbec4a554,0xbf6d3f35,0xbec4a554,0xbf6d3f35,0xbe483f35,0x3f55bec4,0x3e48bf35,0xbf553ec4
.long 0xa5543f80,0x248dbf80,0xa5543f80,0x248dbf80,0x3f0ebf35,0xbe483f6d,0xbf0e3f35,0x3e48bf6d,0xbf6da554,0x3ec4bf35,0xbf6da554,0x3ec4bf35,0x3f7b3f35,0xbf0e3ec4,0xbf7bbf35,0x3f0ebec4
.long 0x3f353f80,0xbf35248d,0x3f353f80,0xbf35248d,0x3f0e3f80,0xbf7bbec4,0xbf0ebf80,0x3f7b3ec4,0x3ec43f80,0xbf6dbf35,0x3ec43f80,0xbf6dbf35,0x3e483f80,0xbf0ebf6d,0xbe48bf80,0x3f0e3f6d
.long 0xbf353f80,0x3f35a554,0xbf353f80,0x3f35a554,0xbf553f80,0x3e483ec4,0x3f55bf80,0xbe48bec4,0xbf6d3f80,0xbec43f35,0xbf6d3f80,0xbec43f35,0xbf7b3f80,0xbf553f6d,0x3f7bbf80,0x3f55bf6d
.long 0xbf353f80,0x3f35248d,0xbf353f80,0x3f35248d,0xbf0e3f80,0x3f7bbec4,0x3f0ebf80,0xbf7b3ec4,0xbec43f80,0x3f6dbf35,0xbec43f80,0x3f6dbf35,0xbe483f80,0x3f0ebf6d,0x3e48bf80,0xbf0e3f6d
.long 0x3f353f80,0xbf35a554,0x3f353f80,0xbf35a554,0x3f553f80,0xbe483ec4,0xbf55bf80,0x3e48bec4,0x3f6d3f80,0x3ec43f35,0x3f6d3f80,0x3ec43f35,0x3f7b3f80,0x3f553f6d,0xbf7bbf80,0xbf55bf6d
.long 0xbf35bf80,0x3f35a554,0xbf35bf80,0x3f35a554,0x3e48bf35,0x3f553f6d,0xbe483f35,0xbf55bf6d,0x3f6da554,0xbec43f35,0x3f6da554,0xbec43f35,0x3f553f35,0xbf7bbec4,0xbf55bf35,0x3f7b3ec4
.long 0x3f35bf80,0xbf35248d,0x3f35bf80,0xbf35248d,0x3f7bbf35,0x3f0ebf6d,0xbf7b3f35,0xbf0e3f6d,0x3ec4a554,0x3f6dbf35,0x3ec4a554,0x3f6dbf35,0xbf0e3f35,0xbe483ec4,0x3f0ebf35,0x3e48bec4
.long 0x3f35bf80,0xbf35a554,0x3f35bf80,0xbf35a554,0xbe48bf35,0xbf553f6d,0x3e483f35,0x3f55bf6d,0xbf6da554,0x3ec43f35,0xbf6da554,0x3ec43f35,0xbf553f35,0x3f7bbec4,0x3f55bf35,0xbf7b3ec4
.long 0xbf35bf80,0x3f35248d,0xbf35bf80,0x3f35248d,0xbf7bbf35,0xbf0ebf6d,0x3f7b3f35,0x3f0e3f6d,0xbec4a554,0xbf6dbf35,0xbec4a554,0xbf6dbf35,0x3f0e3f35,0x3e483ec4,0xbf0ebf35,0xbe48bec4
.long 0x3f353f80,0xbf35248d,0x3f353f80,0xbf35248d,0xbf55248d,0xbe48bf6d,0x3f55a554,0x3e483f6d,0xbec4bf80,0x3f6d3f35,0xbec4bf80,0x3f6d3f35,0x3f7ba554,0xbf553ec4,0xbf7b248d,0x3f55bec4
.long 0xbf353f80,0x3f35a554,0xbf353f80,0x3f35a554,0xbf0e248d,0xbf7b3f6d,0x3f0ea554,0x3f7bbf6d,0x3f6dbf80,0x3ec4bf35,0x3f6dbf80,0x3ec4bf35,0x3e48a554,0x3f0ebec4,0xbe48248d,0xbf0e3ec4
.long 0xbf353f80,0x3f35248d,0xbf353f80,0x3f35248d,0x3f55248d,0x3e48bf6d,0xbf55a554,0xbe483f6d,0x3ec4bf80,0xbf6d3f35,0x3ec4bf80,0xbf6d3f35,0xbf7ba554,0x3f553ec4,0x3f7b248d,0xbf55bec4
.long 0x3f353f80,0xbf35a554,0x3f353f80,0xbf35a554,0x3f0e248d,0x3f7b3f6d,0xbf0ea554,0xbf7bbf6d,0xbf6dbf80,0xbec4bf35,0xbf6dbf80,0xbec4bf35,0xbe48a554,0xbf0ebec4,0x3e48248d,0x3f0e3ec4
.long 0xbf35bf80,0x3f35a554,0xbf35bf80,0x3f35a554,0x3f7b3f35,0xbf0e3ec4,0xbf7bbf35,0x3f0ebec4,0xbf6d248d,0x3ec4bf35,0xbf6d248d,0x3ec4bf35,0x3f0ebf35,0xbe483f6d,0xbf0e3f35,0x3e48bf6d
.long 0x3f35bf80,0xbf35248d,0x3f35bf80,0xbf35248d,0xbe483f35,0x3f55bec4,0x3e48bf35,0xbf553ec4,0xbec4248d,0xbf6d3f35,0xbec4248d,0xbf6d3f35,0x3f55bf35,0x3f7bbf6d,0xbf553f35,0xbf7b3f6d
.long 0x3f35bf80,0xbf35a554,0x3f35bf80,0xbf35a554,0xbf7b3f35,0x3f0e3ec4,0x3f7bbf35,0xbf0ebec4,0x3f6d248d,0xbec4bf35,0x3f6d248d,0xbec4bf35,0xbf0ebf35,0x3e483f6d,0x3f0e3f35,0xbe48bf6d
.long 0xbf35bf80,0x3f35248d,0xbf35bf80,0x3f35248d,0x3e483f35,0xbf55bec4,0xbe48bf35,0x3f553ec4,0x3ec4248d,0x3f6d3f35,0x3ec4248d,0x3f6d3f35,0xbf55bf35,0xbf7bbf6d,0x3f553f35,0x3f7b3f6d
.long 0x0,0x0,0x0,0x0,0xbe480000,0xbf0ebec4,0x3e48a50d,0x3f0e3ec4,0xbec40000,0xbf6dbf35,0xbec40000,0xbf6dbf35,0xbf0e0000,0xbf7bbf6d,0x3f0ea50d,0x3f7b3f6d
.long 0xbf800000,0x3f80a50d,0xbf800000,0x3f80a50d,0xbf7b0000,0x3f553ec4,0x3f7ba50d,0xbf55bec4,0xbf6d0000,0x3ec43f35,0xbf6d0000,0x3ec43f35,0xbf550000,0xbe483f6d,0x3f55a50d,0x3e48bf6d
.long 0xa50d0000,0xa50d0000,0xa50d0000,0xa50d0000,0x3e480000,0x3f0ebec4,0xbe48a50d,0xbf0e3ec4,0x3ec40000,0x3f6dbf35,0x3ec40000,0x3f6dbf35,0x3f0e0000,0x3f7bbf6d,0xbf0ea50d,0xbf7b3f6d
.long 0x3f800000,0xbf80a50d,0x3f800000,0xbf80a50d,0x3f7b0000,0xbf553ec4,0xbf7ba50d,0x3f55bec4,0x3f6d0000,0xbec43f35,0x3f6d0000,0xbec43f35,0x3f550000,0x3e483f6d,0xbf55a50d,0xbe48bf6d
.long 0x0,0x0,0x0,0x0,0xbf55bf35,0xbf7bbf6d,0x3f553f35,0x3f7b3f6d,0xbf6dbf80,0xbec4bf35,0xbf6dbf80,0xbec4bf35,0xbe48bf35,0x3f553ec4,0x3e483f35,0xbf55bec4
.long 0xbf800000,0x3f80a50d,0xbf800000,0x3f80a50d,0xbf0ebf35,0x3e483f6d,0x3f0e3f35,0xbe48bf6d,0x3ec4bf80,0xbf6d3f35,0x3ec4bf80,0xbf6d3f35,0x3f7bbf35,0xbf0ebec4,0xbf7b3f35,0x3f0e3ec4
.long 0xa50d0000,0xa50d0000,0xa50d0000,0xa50d0000,0x3f55bf35,0x3f7bbf6d,0xbf553f35,0xbf7b3f6d,0x3f6dbf80,0x3ec4bf35,0x3f6dbf80,0x3ec4bf35,0x3e48bf35,0xbf553ec4,0xbe483f35,0x3f55bec4
.long 0x3f800000,0xbf80a50d,0x3f800000,0xbf80a50d,0x3f0ebf35,0xbe483f6d,0xbf0e3f35,0x3e48bf6d,0xbec4bf80,0x3f6d3f35,0xbec4bf80,0x3f6d3f35,0xbf7bbf35,0x3f0ebec4,0x3f7b3f35,0xbf0e3ec4
.long 0x0,0x0,0x0,0x0,0xbf7bbf80,0xbf55bf6d,0x3f7b3f80,0x3f553f6d,0x3ec4a50d,0x3f6d3f35,0x3ec4a50d,0x3f6d3f35,0x3f553f80,0xbe483ec4,0xbf55bf80,0x3e48bec4
.long 0xbf800000,0x3f80a50d,0xbf800000,0x3f80a50d,0x3e48bf80,0xbf0e3f6d,0xbe483f80,0x3f0ebf6d,0x3f6da50d,0xbec4bf35,0x3f6da50d,0xbec4bf35,0xbf0e3f80,0x3f7bbec4,0x3f0ebf80,0xbf7b3ec4
.long 0xa50d0000,0xa50d0000,0xa50d0000,0xa50d0000,0x3f7bbf80,0x3f55bf6d,0xbf7b3f80,0xbf553f6d,0xbec4a50d,0xbf6d3f35,0xbec4a50d,0xbf6d3f35,0xbf553f80,0x3e483ec4,0x3f55bf80,0xbe48bec4
.long 0x3f800000,0xbf80a50d,0x3f800000,0xbf80a50d,0xbe48bf80,0x3f0e3f6d,0x3e483f80,0xbf0ebf6d,0xbf6da50d,0x3ec4bf35,0xbf6da50d,0x3ec4bf35,0x3f0e3f80,0xbf7bbec4,0xbf0ebf80,0x3f7b3ec4
.long 0x0,0x0,0x0,0x0,0xbf0ebf35,0xbe48bec4,0x3f0e3f35,0x3e483ec4,0x3f6d3f80,0x3ec43f35,0x3f6d3f80,0x3ec43f35,0xbf7bbf35,0xbf0ebf6d,0x3f7b3f35,0x3f0e3f6d
.long 0xbf800000,0x3f80a50d,0xbf800000,0x3f80a50d,0x3f55bf35,0xbf7b3ec4,0xbf553f35,0x3f7bbec4,0xbec43f80,0x3f6dbf35,0xbec43f80,0x3f6dbf35,0xbe48bf35,0xbf553f6d,0x3e483f35,0x3f55bf6d
.long 0xa50d0000,0xa50d0000,0xa50d0000,0xa50d0000,0x3f0ebf35,0x3e48bec4,0xbf0e3f35,0xbe483ec4,0xbf6d3f80,0xbec43f35,0xbf6d3f80,0xbec43f35,0x3f7bbf35,0x3f0ebf6d,0xbf7b3f35,0xbf0e3f6d
.long 0x3f800000,0xbf80a50d,0x3f800000,0xbf80a50d,0xbf55bf35,0x3f7b3ec4,0x3f553f35,0xbf7bbec4,0x3ec43f80,0xbf6dbf35,0x3ec43f80,0xbf6dbf35,0x3e48bf35,0x3f553f6d,0xbe483f35,0xbf55bf6d
.long 0xbf350000,0xbf35bf80,0xbf350000,0xbf35bf80,0xbf550000,0xbe48bf6d,0x3f55a50d,0x3e483f6d,0xbf6d0000,0x3ec4bf35,0xbf6d0000,0x3ec4bf35,0xbf7b0000,0x3f55bec4,0x3f7ba50d,0xbf553ec4
.long 0xbf350000,0xbf353f80,0xbf350000,0xbf353f80,0xbf0e0000,0xbf7b3f6d,0x3f0ea50d,0x3f7bbf6d,0xbec40000,0xbf6d3f35,0xbec40000,0xbf6d3f35,0xbe480000,0xbf0e3ec4,0x3e48a50d,0x3f0ebec4
.long 0x3f350000,0x3f35bf80,0x3f350000,0x3f35bf80,0x3f550000,0x3e48bf6d,0xbf55a50d,0xbe483f6d,0x3f6d0000,0xbec4bf35,0x3f6d0000,0xbec4bf35,0x3f7b0000,0xbf55bec4,0xbf7ba50d,0x3f553ec4
.long 0x3f350000,0x3f353f80,0x3f350000,0x3f353f80,0x3f0e0000,0x3f7b3f6d,0xbf0ea50d,0xbf7bbf6d,0x3ec40000,0x3f6d3f35,0x3ec40000,0x3f6d3f35,0x3e480000,0x3f0e3ec4,0xbe48a50d,0xbf0ebec4
.long 0x3f35a50d,0x3f353f80,0x3f35a50d,0x3f353f80,0x3f7b3f35,0xbf0e3ec4,0xbf7bbf35,0x3f0ebec4,0x3ec43f80,0xbf6dbf35,0x3ec43f80,0xbf6dbf35,0xbf0e3f35,0x3e48bf6d,0x3f0ebf35,0xbe483f6d
.long 0x3f35a50d,0x3f35bf80,0x3f35a50d,0x3f35bf80,0xbe483f35,0x3f55bec4,0x3e48bf35,0xbf553ec4,0xbf6d3f80,0xbec43f35,0xbf6d3f80,0xbec43f35,0xbf553f35,0xbf7b3f6d,0x3f55bf35,0x3f7bbf6d
.long 0xbf35a50d,0xbf353f80,0xbf35a50d,0xbf353f80,0xbf7b3f35,0x3f0e3ec4,0x3f7bbf35,0xbf0ebec4,0xbec43f80,0x3f6dbf35,0xbec43f80,0x3f6dbf35,0x3f0e3f35,0xbe48bf6d,0xbf0ebf35,0x3e483f6d
.long 0xbf35a50d,0xbf35bf80,0xbf35a50d,0xbf35bf80,0x3e483f35,0xbf55bec4,0xbe48bf35,0x3f553ec4,0x3f6d3f80,0x3ec43f35,0x3f6d3f80,0x3ec43f35,0x3f553f35,0x3f7b3f6d,0xbf55bf35,0xbf7bbf6d
.long 0xbf350000,0xbf35bf80,0xbf350000,0xbf35bf80,0xbf0ebf80,0x3f7b3ec4,0x3f0e3f80,0xbf7bbec4,0x3f6da50d,0xbec43f35,0x3f6da50d,0xbec43f35,0x3e483f80,0xbf0ebf6d,0xbe48bf80,0x3f0e3f6d
.long 0xbf350000,0xbf353f80,0xbf350000,0xbf353f80,0x3f55bf80,0xbe48bec4,0xbf553f80,0x3e483ec4,0x3ec4a50d,0x3f6dbf35,0x3ec4a50d,0x3f6dbf35,0xbf7b3f80,0xbf553f6d,0x3f7bbf80,0x3f55bf6d
.long 0x3f350000,0x3f35bf80,0x3f350000,0x3f35bf80,0x3f0ebf80,0xbf7b3ec4,0xbf0e3f80,0x3f7bbec4,0xbf6da50d,0x3ec43f35,0xbf6da50d,0x3ec43f35,0xbe483f80,0x3f0ebf6d,0x3e48bf80,0xbf0e3f6d
.long 0x3f350000,0x3f353f80,0x3f350000,0x3f353f80,0xbf55bf80,0x3e48bec4,0x3f553f80,0xbe483ec4,0xbec4a50d,0xbf6dbf35,0xbec4a50d,0xbf6dbf35,0x3f7b3f80,0x3f553f6d,0xbf7bbf80,0xbf55bf6d
.long 0x3f35a50d,0x3f353f80,0x3f35a50d,0x3f353f80,0xbe483f35,0xbf55bf6d,0x3e48bf35,0x3f553f6d,0xbec4bf80,0x3f6d3f35,0xbec4bf80,0x3f6d3f35,0x3f553f35,0xbf7bbec4,0xbf55bf35,0x3f7b3ec4
.long 0x3f35a50d,0x3f35bf80,0x3f35a50d,0x3f35bf80,0xbf7b3f35,0xbf0e3f6d,0x3f7bbf35,0x3f0ebf6d,0x3f6dbf80,0x3ec4bf35,0x3f6dbf80,0x3ec4bf35,0xbf0e3f35,0xbe483ec4,0x3f0ebf35,0x3e48bec4
.long 0xbf35a50d,0xbf353f80,0xbf35a50d,0xbf353f80,0x3e483f35,0x3f55bf6d,0xbe48bf35,0xbf553f6d,0x3ec4bf80,0xbf6d3f35,0x3ec4bf80,0xbf6d3f35,0xbf553f35,0x3f7bbec4,0x3f55bf35,0xbf7b3ec4
.long 0xbf35a50d,0xbf35bf80,0xbf35a50d,0xbf35bf80,0x3f7b3f35,0x3f0e3f6d,0xbf7bbf35,0xbf0ebf6d,0xbf6dbf80,0xbec4bf35,0xbf6dbf80,0xbec4bf35,0x3f0e3f35,0x3e483ec4,0xbf0ebf35,0xbe48bec4
.long 0x80008000,0x80008000,0x80008000,0x80008000,0x3e488000,0x3f0e3ec4,0xbe48250d,0xbf0ebec4,0x3ec48000,0x3f6d3f35,0x3ec48000,0x3f6d3f35,0x3f0e8000,0x3f7b3f6d,0xbf0e250d,0xbf7bbf6d
.long 0x3f808000,0xbf80250d,0x3f808000,0xbf80250d,0x3f7b8000,0xbf55bec4,0xbf7b250d,0x3f553ec4,0x3f6d8000,0xbec4bf35,0x3f6d8000,0xbec4bf35,0x3f558000,0x3e48bf6d,0xbf55250d,0xbe483f6d
.long 0x250d8000,0x250d8000,0x250d8000,0x250d8000,0xbe488000,0xbf0e3ec4,0x3e48250d,0x3f0ebec4,0xbec48000,0xbf6d3f35,0xbec48000,0xbf6d3f35,0xbf0e8000,0xbf7b3f6d,0x3f0e250d,0x3f7bbf6d
.long 0xbf808000,0x3f80250d,0xbf808000,0x3f80250d,0xbf7b8000,0x3f55bec4,0x3f7b250d,0xbf553ec4,0xbf6d8000,0x3ec4bf35,0xbf6d8000,0x3ec4bf35,0xbf558000,0xbe48bf6d,0x3f55250d,0x3e483f6d
.long 0x80008000,0x80008000,0x80008000,0x80008000,0x3f553f35,0x3f7b3f6d,0xbf55bf35,0xbf7bbf6d,0x3f6d3f80,0x3ec43f35,0x3f6d3f80,0x3ec43f35,0x3e483f35,0xbf55bec4,0xbe48bf35,0x3f553ec4
.long 0x3f808000,0xbf80250d,0x3f808000,0xbf80250d,0x3f0e3f35,0xbe48bf6d,0xbf0ebf35,0x3e483f6d,0xbec43f80,0x3f6dbf35,0xbec43f80,0x3f6dbf35,0xbf7b3f35,0x3f0e3ec4,0x3f7bbf35,0xbf0ebec4
.long 0x250d8000,0x250d8000,0x250d8000,0x250d8000,0xbf553f35,0xbf7b3f6d,0x3f55bf35,0x3f7bbf6d,0xbf6d3f80,0xbec43f35,0xbf6d3f80,0xbec43f35,0xbe483f35,0x3f55bec4,0x3e48bf35,0xbf553ec4
.long 0xbf808000,0x3f80250d,0xbf808000,0x3f80250d,0xbf0e3f35,0x3e48bf6d,0x3f0ebf35,0xbe483f6d,0x3ec43f80,0xbf6dbf35,0x3ec43f80,0xbf6dbf35,0x3f7b3f35,0xbf0e3ec4,0xbf7bbf35,0x3f0ebec4
.long 0x80008000,0x80008000,0x80008000,0x80008000,0x3f7b3f80,0x3f553f6d,0xbf7bbf80,0xbf55bf6d,0xbec4250d,0xbf6dbf35,0xbec4250d,0xbf6dbf35,0xbf55bf80,0x3e48bec4,0x3f553f80,0xbe483ec4
.long 0x3f808000,0xbf80250d,0x3f808000,0xbf80250d,0xbe483f80,0x3f0ebf6d,0x3e48bf80,0xbf0e3f6d,0xbf6d250d,0x3ec43f35,0xbf6d250d,0x3ec43f35,0x3f0ebf80,0xbf7b3ec4,0xbf0e3f80,0x3f7bbec4
.long 0x250d8000,0x250d8000,0x250d8000,0x250d8000,0xbf7b3f80,0xbf553f6d,0x3f7bbf80,0x3f55bf6d,0x3ec4250d,0x3f6dbf35,0x3ec4250d,0x3f6dbf35,0x3f55bf80,0xbe48bec4,0xbf553f80,0x3e483ec4
.long 0xbf808000,0x3f80250d,0xbf808000,0x3f80250d,0x3e483f80,0xbf0ebf6d,0xbe48bf80,0x3f0e3f6d,0x3f6d250d,0xbec43f35,0x3f6d250d,0xbec43f35,0xbf0ebf80,0x3f7b3ec4,0x3f0e3f80,0xbf7bbec4
.long 0x80008000,0x80008000,0x80008000,0x80008000,0x3f0e3f35,0x3e483ec4,0xbf0ebf35,0xbe48bec4,0xbf6dbf80,0xbec4bf35,0xbf6dbf80,0xbec4bf35,0x3f7b3f35,0x3f0e3f6d,0xbf7bbf35,0xbf0ebf6d
.long 0x3f808000,0xbf80250d,0x3f808000,0xbf80250d,0xbf553f35,0x3f7bbec4,0x3f55bf35,0xbf7b3ec4,0x3ec4bf80,0xbf6d3f35,0x3ec4bf80,0xbf6d3f35,0x3e483f35,0x3f55bf6d,0xbe48bf35,0xbf553f6d
.long 0x250d8000,0x250d8000,0x250d8000,0x250d8000,0xbf0e3f35,0xbe483ec4,0x3f0ebf35,0x3e48bec4,0x3f6dbf80,0x3ec4bf35,0x3f6dbf80,0x3ec4bf35,0xbf7b3f35,0xbf0e3f6d,0x3f7bbf35,0x3f0ebf6d
.long 0xbf808000,0x3f80250d,0xbf808000,0x3f80250d,0x3f553f35,0xbf7bbec4,0xbf55bf35,0x3f7b3ec4,0xbec4bf80,0x3f6d3f35,0xbec4bf80,0x3f6d3f35,0xbe483f35,0xbf55bf6d,0x3e48bf35,0x3f553f6d
.long 0x3f358000,0x3f353f80,0x3f358000,0x3f353f80,0x3f558000,0x3e483f6d,0xbf55250d,0xbe48bf6d,0x3f6d8000,0xbec43f35,0x3f6d8000,0xbec43f35,0x3f7b8000,0xbf553ec4,0xbf7b250d,0x3f55bec4
.long 0x3f358000,0x3f35bf80,0x3f358000,0x3f35bf80,0x3f0e8000,0x3f7bbf6d,0xbf0e250d,0xbf7b3f6d,0x3ec48000,0x3f6dbf35,0x3ec48000,0x3f6dbf35,0x3e488000,0x3f0ebec4,0xbe48250d,0xbf0e3ec4
.long 0xbf358000,0xbf353f80,0xbf358000,0xbf353f80,0xbf558000,0xbe483f6d,0x3f55250d,0x3e48bf6d,0xbf6d8000,0x3ec43f35,0xbf6d8000,0x3ec43f35,0xbf7b8000,0x3f553ec4,0x3f7b250d,0xbf55bec4
.long 0xbf358000,0xbf35bf80,0xbf358000,0xbf35bf80,0xbf0e8000,0xbf7bbf6d,0x3f0e250d,0x3f7b3f6d,0xbec48000,0xbf6dbf35,0xbec48000,0xbf6dbf35,0xbe488000,0xbf0ebec4,0x3e48250d,0x3f0e3ec4
.long 0xbf35250d,0xbf35bf80,0xbf35250d,0xbf35bf80,0xbf7bbf35,0x3f0ebec4,0x3f7b3f35,0xbf0e3ec4,0xbec4bf80,0x3f6d3f35,0xbec4bf80,0x3f6d3f35,0x3f0ebf35,0xbe483f6d,0xbf0e3f35,0x3e48bf6d
.long 0xbf35250d,0xbf353f80,0xbf35250d,0xbf353f80,0x3e48bf35,0xbf553ec4,0xbe483f35,0x3f55bec4,0x3f6dbf80,0x3ec4bf35,0x3f6dbf80,0x3ec4bf35,0x3f55bf35,0x3f7bbf6d,0xbf553f35,0xbf7b3f6d
.long 0x3f35250d,0x3f35bf80,0x3f35250d,0x3f35bf80,0x3f7bbf35,0xbf0ebec4,0xbf7b3f35,0x3f0e3ec4,0x3ec4bf80,0xbf6d3f35,0x3ec4bf80,0xbf6d3f35,0xbf0ebf35,0x3e483f6d,0x3f0e3f35,0xbe48bf6d
.long 0x3f35250d,0x3f353f80,0x3f35250d,0x3f353f80,0xbe48bf35,0x3f553ec4,0x3e483f35,0xbf55bec4,0xbf6dbf80,0xbec4bf35,0xbf6dbf80,0xbec4bf35,0xbf55bf35,0xbf7bbf6d,0x3f553f35,0x3f7b3f6d
.long 0x3f358000,0x3f353f80,0x3f358000,0x3f353f80,0x3f0e3f80,0xbf7bbec4,0xbf0ebf80,0x3f7b3ec4,0xbf6d250d,0x3ec4bf35,0xbf6d250d,0x3ec4bf35,0xbe48bf80,0x3f0e3f6d,0x3e483f80,0xbf0ebf6d
.long 0x3f358000,0x3f35bf80,0x3f358000,0x3f35bf80,0xbf553f80,0x3e483ec4,0x3f55bf80,0xbe48bec4,0xbec4250d,0xbf6d3f35,0xbec4250d,0xbf6d3f35,0x3f7bbf80,0x3f55bf6d,0xbf7b3f80,0xbf553f6d
.long 0xbf358000,0xbf353f80,0xbf358000,0xbf353f80,0xbf0e3f80,0x3f7bbec4,0x3f0ebf80,0xbf7b3ec4,0x3f6d250d,0xbec4bf35,0x3f6d250d,0xbec4bf35,0x3e48bf80,0xbf0e3f6d,0xbe483f80,0x3f0ebf6d
.long 0xbf358000,0xbf35bf80,0xbf358000,0xbf35bf80,0x3f553f80,0xbe483ec4,0xbf55bf80,0x3e48bec4,0x3ec4250d,0x3f6d3f35,0x3ec4250d,0x3f6d3f35,0xbf7bbf80,0xbf55bf6d,0x3f7b3f80,0x3f553f6d
.long 0xbf35250d,0xbf35bf80,0xbf35250d,0xbf35bf80,0x3e48bf35,0x3f553f6d,0xbe483f35,0xbf55bf6d,0x3ec43f80,0xbf6dbf35,0x3ec43f80,0xbf6dbf35,0xbf55bf35,0x3f7b3ec4,0x3f553f35,0xbf7bbec4
.long 0xbf35250d,0xbf353f80,0xbf35250d,0xbf353f80,0x3f7bbf35,0x3f0ebf6d,0xbf7b3f35,0xbf0e3f6d,0xbf6d3f80,0xbec43f35,0xbf6d3f80,0xbec43f35,0x3f0ebf35,0x3e48bec4,0xbf0e3f35,0xbe483ec4
.long 0x3f35250d,0x3f35bf80,0x3f35250d,0x3f35bf80,0xbe48bf35,0xbf553f6d,0x3e483f35,0x3f55bf6d,0xbec43f80,0x3f6dbf35,0xbec43f80,0x3f6dbf35,0x3f55bf35,0xbf7b3ec4,0xbf553f35,0x3f7bbec4
.long 0x3f35250d,0x3f353f80,0x3f35250d,0x3f353f80,0xbf7bbf35,0xbf0ebf6d,0x3f7b3f35,0x3f0e3f6d,0x3f6d3f80,0x3ec43f35,0x3f6d3f80,0x3ec43f35,0xbf0ebf35,0xbe48bec4,0x3f0e3f35,0x3e483ec4
.long 0xbf803f80,0xbf803f80,0xbf803f80,0xbf803f80,0x3f7fbf80,0x3f75bf7b,0xbdc9a554,0xbe953e48,0xbf7b3f80,0xbf553f6d,0x3f7bbf80,0x3f55bf6d,0x3f75bf80,0x3f22bf55,0x3e95248d,0x3f46bf0e
.long 0xbf6d3f80,0xbec43f35,0xbf6d3f80,0xbec43f35,0x3f62bf80,0x3dc9bf0e,0xbef1a554,0xbf7f3f55,0xbf553f80,0x3e483ec4,0x3f55bf80,0xbe48bec4,0x3f46bf80,0xbef1be48,0x3f22248d,0x3f62bf7b
.long 0xbf353f80,0x3f35248d,0xbf353f80,0x3f35248d,0x3f22bf80,0xbf623e48,0xbf46a554,0xbef13f7b,0xbf0e3f80,0x3f7bbec4,0x3f0ebf80,0xbf7b3ec4,0x3ef1bf80,0xbf7f3f0e,0x3f62248d,0xbdc9bf55
.long 0xbec43f80,0x3f6dbf35,0xbec43f80,0x3f6dbf35,0x3e95bf80,0xbf463f55,0xbf75a554,0x3f223f0e,0xbe483f80,0x3f0ebf6d,0x3e48bf80,0xbf0e3f6d,0x3dc9bf80,0xbe953f7b,0x3f7f248d,0xbf75be48
.long 0xbf803f80,0xbf803f80,0xbf803f80,0xbf803f80,0x3f62bf6d,0x3f46bf55,0xbef13ec4,0xbf223f0e,0xbf0e3f35,0xbe483ec4,0x3f0ebf35,0x3e48bec4,0x3dc9bec4,0xbef13e48,0x3f7fbf6d,0x3f62bf7b
.long 0x3ec4248d,0x3f6dbf35,0x3ec4248d,0x3f6dbf35,0xbf463ec4,0xbf753f7b,0xbf223f6d,0x3e953e48,0x3f7bbf35,0x3f0ebf6d,0xbf7b3f35,0xbf0e3f6d,0xbf753f6d,0x3dc93f0e,0xbe95bec4,0xbf7f3f55
.long 0x3f35bf80,0xbf35a554,0x3f35bf80,0xbf35a554,0xbe953f6d,0x3f7fbf0e,0x3f75bec4,0x3dc9bf55,0xbe48bf35,0xbf553f6d,0x3e483f35,0x3f55bf6d,0x3f223ec4,0x3e95bf7b,0xbf463f6d,0x3f75be48
.long 0xbf6da554,0x3ec43f35,0xbf6da554,0x3ec43f35,0x3f7fbec4,0xbf62be48,0xbdc9bf6d,0xbef13f7b,0xbf553f35,0x3f7bbec4,0x3f55bf35,0xbf7b3ec4,0x3ef1bf6d,0xbf223f55,0x3f623ec4,0xbf46bf0e
.long 0xbf803f80,0xbf803f80,0xbf803f80,0xbf803f80,0x3f22bf35,0x3ef1bf0e,0xbf463f35,0xbf623f55,0x3e48248d,0x3f0ebec4,0xbe48a554,0xbf0e3ec4,0xbf623f35,0xbf7f3f7b,0x3ef1bf35,0xbdc9be48
.long 0x3f6dbf80,0x3ec4bf35,0x3f6dbf80,0x3ec4bf35,0xbe953f35,0x3f22be48,0x3f75bf35,0x3f46bf7b,0xbf0ea554,0xbf7b3f6d,0x3f0e248d,0x3f7bbf6d,0x3f7fbf35,0x3e95bf55,0xbdc93f35,0x3f75bf0e
.long 0xbf353f80,0x3f35248d,0xbf353f80,0x3f35248d,0xbdc9bf35,0xbf753f55,0xbf7f3f35,0x3e953f0e,0x3f55248d,0x3e48bf6d,0xbf55a554,0xbe483f6d,0xbf753f35,0x3f463e48,0xbe95bf35,0xbf223f7b
.long 0x3ec4bf80,0xbf6d3f35,0x3ec4bf80,0xbf6d3f35,0x3ef13f35,0x3dc9bf7b,0x3f62bf35,0xbf7f3e48,0xbf7ba554,0x3f553ec4,0x3f7b248d,0xbf55bec4,0x3f46bf35,0xbf623f0e,0x3f223f35,0xbef1bf55
.long 0xbf803f80,0xbf803f80,0xbf803f80,0xbf803f80,0x3e95bec4,0x3dc9be48,0xbf753f6d,0xbf7f3f7b,0x3f55bf35,0x3f7bbf6d,0xbf553f35,0xbf7b3f6d,0xbf463f6d,0xbe953f0e,0xbf223ec4,0xbf753f55
.long 0xbec4a554,0xbf6d3f35,0xbec4a554,0xbf6d3f35,0x3f7fbf6d,0x3ef1bf55,0xbdc9bec4,0xbf623f0e,0xbe483f35,0x3f55bec4,0x3e48bf35,0xbf553ec4,0xbf623ec4,0xbf223f7b,0x3ef1bf6d,0xbf463e48
.long 0x3f35bf80,0xbf35a554,0x3f35bf80,0xbf35a554,0x3ef13ec4,0x3f46bf7b,0x3f62bf6d,0xbf22be48,0xbf7b3f35,0x3f0e3ec4,0x3f7bbf35,0xbf0ebec4,0x3dc9bf6d,0xbf623f55,0x3f7fbec4,0xbef1bf0e
.long 0x3f6d248d,0xbec4bf35,0x3f6d248d,0xbec4bf35,0xbf223f6d,0x3f75bf0e,0x3f463ec4,0xbe95bf55,0xbf0ebf35,0x3e483f6d,0x3f0e3f35,0xbe48bf6d,0x3f75bec4,0xbf7f3e48,0x3e953f6d,0xbdc9bf7b
.long 0xbf803f80,0xbf803f80,0xbf803f80,0xbf803f80,0xbf7f3f80,0xbf753f7b,0x3dc9248d,0x3e95be48,0xbf7b3f80,0xbf553f6d,0x3f7bbf80,0x3f55bf6d,0xbf753f80,0xbf223f55,0xbe95a554,0xbf463f0e
.long 0xbf6d3f80,0xbec43f35,0xbf6d3f80,0xbec43f35,0xbf623f80,0xbdc93f0e,0x3ef1248d,0x3f7fbf55,0xbf553f80,0x3e483ec4,0x3f55bf80,0xbe48bec4,0xbf463f80,0x3ef13e48,0xbf22a554,0xbf623f7b
.long 0xbf353f80,0x3f35248d,0xbf353f80,0x3f35248d,0xbf223f80,0x3f62be48,0x3f46248d,0x3ef1bf7b,0xbf0e3f80,0x3f7bbec4,0x3f0ebf80,0xbf7b3ec4,0xbef13f80,0x3f7fbf0e,0xbf62a554,0x3dc93f55
.long 0xbec43f80,0x3f6dbf35,0xbec43f80,0x3f6dbf35,0xbe953f80,0x3f46bf55,0x3f75248d,0xbf22bf0e,0xbe483f80,0x3f0ebf6d,0x3e48bf80,0xbf0e3f6d,0xbdc93f80,0x3e95bf7b,0xbf7fa554,0x3f753e48
.long 0xbf803f80,0xbf803f80,0xbf803f80,0xbf803f80,0xbf623f6d,0xbf463f55,0x3ef1bec4,0x3f22bf0e,0xbf0e3f35,0xbe483ec4,0x3f0ebf35,0x3e48bec4,0xbdc93ec4,0x3ef1be48,0xbf7f3f6d,0xbf623f7b
.long 0x3ec4248d,0x3f6dbf35,0x3ec4248d,0x3f6dbf35,0x3f46bec4,0x3f75bf7b,0x3f22bf6d,0xbe95be48,0x3f7bbf35,0x3f0ebf6d,0xbf7b3f35,0xbf0e3f6d,0x3f75bf6d,0xbdc9bf0e,0x3e953ec4,0x3f7fbf55
.long 0x3f35bf80,0xbf35a554,0x3f35bf80,0xbf35a554,0x3e95bf6d,0xbf7f3f0e,0xbf753ec4,0xbdc93f55,0xbe48bf35,0xbf553f6d,0x3e483f35,0x3f55bf6d,0xbf22bec4,0xbe953f7b,0x3f46bf6d,0xbf753e48
.long 0xbf6da554,0x3ec43f35,0xbf6da554,0x3ec43f35,0xbf7f3ec4,0x3f623e48,0x3dc93f6d,0x3ef1bf7b,0xbf553f35,0x3f7bbec4,0x3f55bf35,0xbf7b3ec4,0xbef13f6d,0x3f22bf55,0xbf62bec4,0x3f463f0e
.long 0xbf803f80,0xbf803f80,0xbf803f80,0xbf803f80,0xbf223f35,0xbef13f0e,0x3f46bf35,0x3f62bf55,0x3e48248d,0x3f0ebec4,0xbe48a554,0xbf0e3ec4,0x3f62bf35,0x3f7fbf7b,0xbef13f35,0x3dc93e48
.long 0x3f6dbf80,0x3ec4bf35,0x3f6dbf80,0x3ec4bf35,0x3e95bf35,0xbf223e48,0xbf753f35,0xbf463f7b,0xbf0ea554,0xbf7b3f6d,0x3f0e248d,0x3f7bbf6d,0xbf7f3f35,0xbe953f55,0x3dc9bf35,0xbf753f0e
.long 0xbf353f80,0x3f35248d,0xbf353f80,0x3f35248d,0x3dc93f35,0x3f75bf55,0x3f7fbf35,0xbe95bf0e,0x3f55248d,0x3e48bf6d,0xbf55a554,0xbe483f6d,0x3f75bf35,0xbf46be48,0x3e953f35,0x3f22bf7b
.long 0x3ec4bf80,0xbf6d3f35,0x3ec4bf80,0xbf6d3f35,0xbef1bf35,0xbdc93f7b,0xbf623f35,0x3f7fbe48,0xbf7ba554,0x3f553ec4,0x3f7b248d,0xbf55bec4,0xbf463f35,0x3f62bf0e,0xbf22bf35,0x3ef13f55
.long 0xbf803f80,0xbf803f80,0xbf803f80,0xbf803f80,0xbe953ec4,0xbdc93e48,0x3f75bf6d,0x3f7fbf7b,0x3f55bf35,0x3f7bbf6d,0xbf553f35,0xbf7b3f6d,0x3f46bf6d,0x3e95bf0e,0x3f22bec4,0x3f75bf55
.long 0xbec4a554,0xbf6d3f35,0xbec4a554,0xbf6d3f35,0xbf7f3f6d,0xbef13f55,0x3dc93ec4,0x3f62bf0e,0xbe483f35,0x3f55bec4,0x3e48bf35,0xbf553ec4,0x3f62bec4,0x3f22bf7b,0xbef13f6d,0x3f46be48
.long 0x3f35bf80,0xbf35a554,0x3f35bf80,0xbf35a554,0xbef1bec4,0xbf463f7b,0xbf623f6d,0x3f223e48,0xbf7b3f35,0x3f0e3ec4,0x3f7bbf35,0xbf0ebec4,0xbdc93f6d,0x3f62bf55,0xbf7f3ec4,0x3ef13f0e
.long 0x3f6d248d,0xbec4bf35,0x3f6d248d,0xbec4bf35,0x3f22bf6d,0xbf753f0e,0xbf46bec4,0x3e953f55,0xbf0ebf35,0x3e483f6d,0x3f0e3f35,0xbe48bf6d,0xbf753ec4,0x3f7fbe48,0xbe95bf6d,0x3dc93f7b
.long 0xa5543f80,0x248dbf80,0xa5543f80,0x248dbf80,0xbdc9bf80,0x3e953f7b,0xbf7fa554,0x3f75be48,0x3e483f80,0xbf0ebf6d,0xbe48bf80,0x3f0e3f6d,0xbe95bf80,0x3f463f55,0x3f75248d,0xbf223f0e
.long 0x3ec43f80,0xbf6dbf35,0x3ec43f80,0xbf6dbf35,0xbef1bf80,0x3f7f3f0e,0xbf62a554,0x3dc9bf55,0x3f0e3f80,0xbf7bbec4,0xbf0ebf80,0x3f7b3ec4,0xbf22bf80,0x3f623e48,0x3f46248d,0x3ef13f7b
.long 0x3f353f80,0xbf35a554,0x3f353f80,0xbf35a554,0xbf46bf80,0x3ef1be48,0xbf22a554,0xbf62bf7b,0x3f553f80,0xbe483ec4,0xbf55bf80,0x3e48bec4,0xbf62bf80,0xbdc9bf0e,0x3ef1248d,0x3f7f3f55
.long 0x3f6d3f80,0x3ec43f35,0x3f6d3f80,0x3ec43f35,0xbf75bf80,0xbf22bf55,0xbe95a554,0xbf46bf0e,0x3f7b3f80,0x3f553f6d,0xbf7bbf80,0xbf55bf6d,0xbf7fbf80,0xbf75bf7b,0x3dc9248d,0x3e953e48
.long 0xa5543f80,0x248dbf80,0xa5543f80,0x248dbf80,0xbef1bf6d,0x3f223f55,0xbf623ec4,0x3f46bf0e,0x3f553f35,0xbf7bbec4,0xbf55bf35,0x3f7b3ec4,0xbf7fbec4,0x3f62be48,0x3dc9bf6d,0x3ef13f7b
.long 0x3f6d248d,0xbec43f35,0x3f6d248d,0xbec43f35,0xbf223ec4,0xbe95bf7b,0x3f463f6d,0xbf75be48,0x3e48bf35,0x3f553f6d,0xbe483f35,0xbf55bf6d,0x3e953f6d,0xbf7fbf0e,0xbf75bec4,0xbdc9bf55
.long 0xbf35bf80,0x3f35248d,0xbf35bf80,0x3f35248d,0x3f753f6d,0xbdc93f0e,0x3e95bec4,0x3f7f3f55,0xbf7bbf35,0xbf0ebf6d,0x3f7b3f35,0x3f0e3f6d,0x3f463ec4,0x3f753f7b,0x3f223f6d,0xbe953e48
.long 0xbec4a554,0xbf6dbf35,0xbec4a554,0xbf6dbf35,0xbdc9bec4,0x3ef13e48,0xbf7fbf6d,0xbf62bf7b,0x3f0e3f35,0x3e483ec4,0xbf0ebf35,0xbe48bec4,0xbf62bf6d,0xbf46bf55,0x3ef13ec4,0x3f223f0e
.long 0xa5543f80,0x248dbf80,0xa5543f80,0x248dbf80,0xbf46bf35,0x3f623f0e,0xbf223f35,0x3ef1bf55,0x3f7b248d,0xbf553ec4,0xbf7ba554,0x3f55bec4,0xbef13f35,0xbdc9bf7b,0xbf62bf35,0x3f7f3e48
.long 0xbec4bf80,0x3f6d3f35,0xbec4bf80,0x3f6d3f35,0x3f753f35,0xbf463e48,0x3e95bf35,0x3f223f7b,0xbf55a554,0xbe48bf6d,0x3f55248d,0x3e483f6d,0x3dc9bf35,0x3f753f55,0x3f7f3f35,0xbe953f0e
.long 0x3f353f80,0xbf35a554,0x3f353f80,0xbf35a554,0xbf7fbf35,0xbe95bf55,0x3dc93f35,0xbf75bf0e,0x3f0e248d,0x3f7b3f6d,0xbf0ea554,0xbf7bbf6d,0x3e953f35,0xbf22be48,0xbf75bf35,0xbf46bf7b
.long 0xbf6dbf80,0xbec4bf35,0xbf6dbf80,0xbec4bf35,0x3f623f35,0x3f7f3f7b,0xbef1bf35,0x3dc9be48,0xbe48a554,0xbf0ebec4,0x3e48248d,0x3f0e3ec4,0xbf22bf35,0xbef1bf0e,0x3f463f35,0x3f623f55
.long 0xa5543f80,0x248dbf80,0xa5543f80,0x248dbf80,0xbf75bec4,0x3f7f3e48,0xbe953f6d,0x3dc9bf7b,0x3f0ebf35,0xbe483f6d,0xbf0e3f35,0x3e48bf6d,0x3f223f6d,0xbf75bf0e,0xbf463ec4,0x3e95bf55
.long 0xbf6da554,0x3ec4bf35,0xbf6da554,0x3ec4bf35,0xbdc9bf6d,0x3f623f55,0xbf7fbec4,0x3ef1bf0e,0x3f7b3f35,0xbf0e3ec4,0xbf7bbf35,0x3f0ebec4,0xbef13ec4,0xbf46bf7b,0xbf62bf6d,0x3f22be48
.long 0xbf35bf80,0x3f35248d,0xbf35bf80,0x3f35248d,0x3f623ec4,0x3f223f7b,0xbef1bf6d,0x3f463e48,0x3e483f35,0xbf55bec4,0xbe48bf35,0x3f553ec4,0xbf7fbf6d,0xbef1bf55,0x3dc9bec4,0x3f623f0e
.long 0x3ec4248d,0x3f6d3f35,0x3ec4248d,0x3f6d3f35,0x3f463f6d,0x3e953f0e,0x3f223ec4,0x3f753f55,0xbf55bf35,0xbf7bbf6d,0x3f553f35,0x3f7b3f6d,0xbe95bec4,0xbdc9be48,0x3f753f6d,0x3f7f3f7b
.long 0xa5543f80,0x248dbf80,0xa5543f80,0x248dbf80,0x3dc93f80,0xbe95bf7b,0x3f7f248d,0xbf753e48,0x3e483f80,0xbf0ebf6d,0xbe48bf80,0x3f0e3f6d,0x3e953f80,0xbf46bf55,0xbf75a554,0x3f22bf0e
.long 0x3ec43f80,0xbf6dbf35,0x3ec43f80,0xbf6dbf35,0x3ef13f80,0xbf7fbf0e,0x3f62248d,0xbdc93f55,0x3f0e3f80,0xbf7bbec4,0xbf0ebf80,0x3f7b3ec4,0x3f223f80,0xbf62be48,0xbf46a554,0xbef1bf7b
.long 0x3f353f80,0xbf35a554,0x3f353f80,0xbf35a554,0x3f463f80,0xbef13e48,0x3f22248d,0x3f623f7b,0x3f553f80,0xbe483ec4,0xbf55bf80,0x3e48bec4,0x3f623f80,0x3dc93f0e,0xbef1a554,0xbf7fbf55
.long 0x3f6d3f80,0x3ec43f35,0x3f6d3f80,0x3ec43f35,0x3f753f80,0x3f223f55,0x3e95248d,0x3f463f0e,0x3f7b3f80,0x3f553f6d,0xbf7bbf80,0xbf55bf6d,0x3f7f3f80,0x3f753f7b,0xbdc9a554,0xbe95be48
.long 0xa5543f80,0x248dbf80,0xa5543f80,0x248dbf80,0x3ef13f6d,0xbf22bf55,0x3f62bec4,0xbf463f0e,0x3f553f35,0xbf7bbec4,0xbf55bf35,0x3f7b3ec4,0x3f7f3ec4,0xbf623e48,0xbdc93f6d,0xbef1bf7b
.long 0x3f6d248d,0xbec43f35,0x3f6d248d,0xbec43f35,0x3f22bec4,0x3e953f7b,0xbf46bf6d,0x3f753e48,0x3e48bf35,0x3f553f6d,0xbe483f35,0xbf55bf6d,0xbe95bf6d,0x3f7f3f0e,0x3f753ec4,0x3dc93f55
.long 0xbf35bf80,0x3f35248d,0xbf35bf80,0x3f35248d,0xbf75bf6d,0x3dc9bf0e,0xbe953ec4,0xbf7fbf55,0xbf7bbf35,0xbf0ebf6d,0x3f7b3f35,0x3f0e3f6d,0xbf46bec4,0xbf75bf7b,0xbf22bf6d,0x3e95be48
.long 0xbec4a554,0xbf6dbf35,0xbec4a554,0xbf6dbf35,0x3dc93ec4,0xbef1be48,0x3f7f3f6d,0x3f623f7b,0x3f0e3f35,0x3e483ec4,0xbf0ebf35,0xbe48bec4,0x3f623f6d,0x3f463f55,0xbef1bec4,0xbf22bf0e
.long 0xa5543f80,0x248dbf80,0xa5543f80,0x248dbf80,0x3f463f35,0xbf62bf0e,0x3f22bf35,0xbef13f55,0x3f7b248d,0xbf553ec4,0xbf7ba554,0x3f55bec4,0x3ef1bf35,0x3dc93f7b,0x3f623f35,0xbf7fbe48
.long 0xbec4bf80,0x3f6d3f35,0xbec4bf80,0x3f6d3f35,0xbf75bf35,0x3f46be48,0xbe953f35,0xbf22bf7b,0xbf55a554,0xbe48bf6d,0x3f55248d,0x3e483f6d,0xbdc93f35,0xbf75bf55,0xbf7fbf35,0x3e95bf0e
.long 0x3f353f80,0xbf35a554,0x3f353f80,0xbf35a554,0x3f7f3f35,0x3e953f55,0xbdc9bf35,0x3f753f0e,0x3f0e248d,0x3f7b3f6d,0xbf0ea554,0xbf7bbf6d,0xbe95bf35,0x3f223e48,0x3f753f35,0x3f463f7b
.long 0xbf6dbf80,0xbec4bf35,0xbf6dbf80,0xbec4bf35,0xbf62bf35,0xbf7fbf7b,0x3ef13f35,0xbdc93e48,0xbe48a554,0xbf0ebec4,0x3e48248d,0x3f0e3ec4,0x3f223f35,0x3ef13f0e,0xbf46bf35,0xbf62bf55
.long 0xa5543f80,0x248dbf80,0xa5543f80,0x248dbf80,0x3f753ec4,0xbf7fbe48,0x3e95bf6d,0xbdc93f7b,0x3f0ebf35,0xbe483f6d,0xbf0e3f35,0x3e48bf6d,0xbf22bf6d,0x3f753f0e,0x3f46bec4,0xbe953f55
.long 0xbf6da554,0x3ec4bf35,0xbf6da554,0x3ec4bf35,0x3dc93f6d,0xbf62bf55,0x3f7f3ec4,0xbef13f0e,0x3f7b3f35,0xbf0e3ec4,0xbf7bbf35,0x3f0ebec4,0x3ef1bec4,0x3f463f7b,0x3f623f6d,0xbf223e48
.long 0xbf35bf80,0x3f35248d,0xbf35bf80,0x3f35248d,0xbf62bec4,0xbf22bf7b,0x3ef13f6d,0xbf46be48,0x3e483f35,0xbf55bec4,0xbe48bf35,0x3f553ec4,0x3f7f3f6d,0x3ef13f55,0xbdc93ec4,0xbf62bf0e
.long 0x3ec4248d,0x3f6d3f35,0x3ec4248d,0x3f6d3f35,0xbf46bf6d,0xbe95bf0e,0xbf22bec4,0xbf75bf55,0xbf55bf35,0xbf7bbf6d,0x3f553f35,0x3f7b3f6d,0x3e953ec4,0x3dc93e48,0xbf75bf6d,0xbf7fbf7b
.long 0x3f803f80,0x3f803f80,0x3f803f80,0x3f803f80,0xbf7fbf80,0xbf75bf7b,0x3dc9a554,0x3e953e48,0x3f7b3f80,0x3f553f6d,0xbf7bbf80,0xbf55bf6d,0xbf75bf80,0xbf22bf55,0xbe95248d,0xbf46bf0e
.long 0x3f6d3f80,0x3ec43f35,0x3f6d3f80,0x3ec43f35,0xbf62bf80,0xbdc9bf0e,0x3ef1a554,0x3f7f3f55,0x3f553f80,0xbe483ec4,0xbf55bf80,0x3e48bec4,0xbf46bf80,0x3ef1be48,0xbf22248d,0xbf62bf7b
.long 0x3f353f80,0xbf35248d,0x3f353f80,0xbf35248d,0xbf22bf80,0x3f623e48,0x3f46a554,0x3ef13f7b,0x3f0e3f80,0xbf7bbec4,0xbf0ebf80,0x3f7b3ec4,0xbef1bf80,0x3f7f3f0e,0xbf62248d,0x3dc9bf55
.long 0x3ec43f80,0xbf6dbf35,0x3ec43f80,0xbf6dbf35,0xbe95bf80,0x3f463f55,0x3f75a554,0xbf223f0e,0x3e483f80,0xbf0ebf6d,0xbe48bf80,0x3f0e3f6d,0xbdc9bf80,0x3e953f7b,0xbf7f248d,0x3f75be48
.long 0x3f803f80,0x3f803f80,0x3f803f80,0x3f803f80,0xbf62bf6d,0xbf46bf55,0x3ef13ec4,0x3f223f0e,0x3f0e3f35,0x3e483ec4,0xbf0ebf35,0xbe48bec4,0xbdc9bec4,0x3ef13e48,0xbf7fbf6d,0xbf62bf7b
.long 0xbec4248d,0xbf6dbf35,0xbec4248d,0xbf6dbf35,0x3f463ec4,0x3f753f7b,0x3f223f6d,0xbe953e48,0xbf7bbf35,0xbf0ebf6d,0x3f7b3f35,0x3f0e3f6d,0x3f753f6d,0xbdc93f0e,0x3e95bec4,0x3f7f3f55
.long 0xbf35bf80,0x3f35a554,0xbf35bf80,0x3f35a554,0x3e953f6d,0xbf7fbf0e,0xbf75bec4,0xbdc9bf55,0x3e48bf35,0x3f553f6d,0xbe483f35,0xbf55bf6d,0xbf223ec4,0xbe95bf7b,0x3f463f6d,0xbf75be48
.long 0x3f6da554,0xbec43f35,0x3f6da554,0xbec43f35,0xbf7fbec4,0x3f62be48,0x3dc9bf6d,0x3ef13f7b,0x3f553f35,0xbf7bbec4,0xbf55bf35,0x3f7b3ec4,0xbef1bf6d,0x3f223f55,0xbf623ec4,0x3f46bf0e
.long 0x3f803f80,0x3f803f80,0x3f803f80,0x3f803f80,0xbf22bf35,0xbef1bf0e,0x3f463f35,0x3f623f55,0xbe48248d,0xbf0ebec4,0x3e48a554,0x3f0e3ec4,0x3f623f35,0x3f7f3f7b,0xbef1bf35,0x3dc9be48
.long 0xbf6dbf80,0xbec4bf35,0xbf6dbf80,0xbec4bf35,0x3e953f35,0xbf22be48,0xbf75bf35,0xbf46bf7b,0x3f0ea554,0x3f7b3f6d,0xbf0e248d,0xbf7bbf6d,0xbf7fbf35,0xbe95bf55,0x3dc93f35,0xbf75bf0e
.long 0x3f353f80,0xbf35248d,0x3f353f80,0xbf35248d,0x3dc9bf35,0x3f753f55,0x3f7f3f35,0xbe953f0e,0xbf55248d,0xbe48bf6d,0x3f55a554,0x3e483f6d,0x3f753f35,0xbf463e48,0x3e95bf35,0x3f223f7b
.long 0xbec4bf80,0x3f6d3f35,0xbec4bf80,0x3f6d3f35,0xbef13f35,0xbdc9bf7b,0xbf62bf35,0x3f7f3e48,0x3f7ba554,0xbf553ec4,0xbf7b248d,0x3f55bec4,0xbf46bf35,0x3f623f0e,0xbf223f35,0x3ef1bf55
.long 0x3f803f80,0x3f803f80,0x3f803f80,0x3f803f80,0xbe95bec4,0xbdc9be48,0x3f753f6d,0x3f7f3f7b,0xbf55bf35,0xbf7bbf6d,0x3f553f35,0x3f7b3f6d,0x3f463f6d,0x3e953f0e,0x3f223ec4,0x3f753f55
.long 0x3ec4a554,0x3f6d3f35,0x3ec4a554,0x3f6d3f35,0xbf7fbf6d,0xbef1bf55,0x3dc9bec4,0x3f623f0e,0x3e483f35,0xbf55bec4,0xbe48bf35,0x3f553ec4,0x3f623ec4,0x3f223f7b,0xbef1bf6d,0x3f463e48
.long 0xbf35bf80,0x3f35a554,0xbf35bf80,0x3f35a554,0xbef13ec4,0xbf46bf7b,0xbf62bf6d,0x3f22be48,0x3f7b3f35,0xbf0e3ec4,0xbf7bbf35,0x3f0ebec4,0xbdc9bf6d,0x3f623f55,0xbf7fbec4,0x3ef1bf0e
.long 0xbf6d248d,0x3ec4bf35,0xbf6d248d,0x3ec4bf35,0x3f223f6d,0xbf75bf0e,0xbf463ec4,0x3e95bf55,0x3f0ebf35,0xbe483f6d,0xbf0e3f35,0x3e48bf6d,0xbf75bec4,0x3f7f3e48,0xbe953f6d,0x3dc9bf7b
.long 0x3f803f80,0x3f803f80,0x3f803f80,0x3f803f80,0x3f7f3f80,0x3f753f7b,0xbdc9248d,0xbe95be48,0x3f7b3f80,0x3f553f6d,0xbf7bbf80,0xbf55bf6d,0x3f753f80,0x3f223f55,0x3e95a554,0x3f463f0e
.long 0x3f6d3f80,0x3ec43f35,0x3f6d3f80,0x3ec43f35,0x3f623f80,0x3dc93f0e,0xbef1248d,0xbf7fbf55,0x3f553f80,0xbe483ec4,0xbf55bf80,0x3e48bec4,0x3f463f80,0xbef13e48,0x3f22a554,0x3f623f7b
.long 0x3f353f80,0xbf35248d,0x3f353f80,0xbf35248d,0x3f223f80,0xbf62be48,0xbf46248d,0xbef1bf7b,0x3f0e3f80,0xbf7bbec4,0xbf0ebf80,0x3f7b3ec4,0x3ef13f80,0xbf7fbf0e,0x3f62a554,0xbdc93f55
.long 0x3ec43f80,0xbf6dbf35,0x3ec43f80,0xbf6dbf35,0x3e953f80,0xbf46bf55,0xbf75248d,0x3f22bf0e,0x3e483f80,0xbf0ebf6d,0xbe48bf80,0x3f0e3f6d,0x3dc93f80,0xbe95bf7b,0x3f7fa554,0xbf753e48
.long 0x3f803f80,0x3f803f80,0x3f803f80,0x3f803f80,0x3f623f6d,0x3f463f55,0xbef1bec4,0xbf22bf0e,0x3f0e3f35,0x3e483ec4,0xbf0ebf35,0xbe48bec4,0x3dc93ec4,0xbef1be48,0x3f7f3f6d,0x3f623f7b
.long 0xbec4248d,0xbf6dbf35,0xbec4248d,0xbf6dbf35,0xbf46bec4,0xbf75bf7b,0xbf22bf6d,0x3e95be48,0xbf7bbf35,0xbf0ebf6d,0x3f7b3f35,0x3f0e3f6d,0xbf75bf6d,0x3dc9bf0e,0xbe953ec4,0xbf7fbf55
.long 0xbf35bf80,0x3f35a554,0xbf35bf80,0x3f35a554,0xbe95bf6d,0x3f7f3f0e,0x3f753ec4,0x3dc93f55,0x3e48bf35,0x3f553f6d,0xbe483f35,0xbf55bf6d,0x3f22bec4,0x3e953f7b,0xbf46bf6d,0x3f753e48
.long 0x3f6da554,0xbec43f35,0x3f6da554,0xbec43f35,0x3f7f3ec4,0xbf623e48,0xbdc93f6d,0xbef1bf7b,0x3f553f35,0xbf7bbec4,0xbf55bf35,0x3f7b3ec4,0x3ef13f6d,0xbf22bf55,0x3f62bec4,0xbf463f0e
.long 0x3f803f80,0x3f803f80,0x3f803f80,0x3f803f80,0x3f223f35,0x3ef13f0e,0xbf46bf35,0xbf62bf55,0xbe48248d,0xbf0ebec4,0x3e48a554,0x3f0e3ec4,0xbf62bf35,0xbf7fbf7b,0x3ef13f35,0xbdc93e48
.long 0xbf6dbf80,0xbec4bf35,0xbf6dbf80,0xbec4bf35,0xbe95bf35,0x3f223e48,0x3f753f35,0x3f463f7b,0x3f0ea554,0x3f7b3f6d,0xbf0e248d,0xbf7bbf6d,0x3f7f3f35,0x3e953f55,0xbdc9bf35,0x3f753f0e
.long 0x3f353f80,0xbf35248d,0x3f353f80,0xbf35248d,0xbdc93f35,0xbf75bf55,0xbf7fbf35,0x3e95bf0e,0xbf55248d,0xbe48bf6d,0x3f55a554,0x3e483f6d,0xbf75bf35,0x3f46be48,0xbe953f35,0xbf22bf7b
.long 0xbec4bf80,0x3f6d3f35,0xbec4bf80,0x3f6d3f35,0x3ef1bf35,0x3dc93f7b,0x3f623f35,0xbf7fbe48,0x3f7ba554,0xbf553ec4,0xbf7b248d,0x3f55bec4,0x3f463f35,0xbf62bf0e,0x3f22bf35,0xbef13f55
.long 0x3f803f80,0x3f803f80,0x3f803f80,0x3f803f80,0x3e953ec4,0x3dc93e48,0xbf75bf6d,0xbf7fbf7b,0xbf55bf35,0xbf7bbf6d,0x3f553f35,0x3f7b3f6d,0xbf46bf6d,0xbe95bf0e,0xbf22bec4,0xbf75bf55
.long 0x3ec4a554,0x3f6d3f35,0x3ec4a554,0x3f6d3f35,0x3f7f3f6d,0x3ef13f55,0xbdc93ec4,0xbf62bf0e,0x3e483f35,0xbf55bec4,0xbe48bf35,0x3f553ec4,0xbf62bec4,0xbf22bf7b,0x3ef13f6d,0xbf46be48
.long 0xbf35bf80,0x3f35a554,0xbf35bf80,0x3f35a554,0x3ef1bec4,0x3f463f7b,0x3f623f6d,0xbf223e48,0x3f7b3f35,0xbf0e3ec4,0xbf7bbf35,0x3f0ebec4,0x3dc93f6d,0xbf62bf55,0x3f7f3ec4,0xbef13f0e
.long 0xbf6d248d,0x3ec4bf35,0xbf6d248d,0x3ec4bf35,0xbf22bf6d,0x3f753f0e,0x3f46bec4,0xbe953f55,0x3f0ebf35,0xbe483f6d,0xbf0e3f35,0x3e48bf6d,0x3f753ec4,0xbf7fbe48,0x3e95bf6d,0xbdc93f7b
.long 0x248d3f80,0xa554bf80,0x248d3f80,0xa554bf80,0x3dc9bf80,0xbe953f7b,0x3f7fa554,0xbf75be48,0xbe483f80,0x3f0ebf6d,0x3e48bf80,0xbf0e3f6d,0x3e95bf80,0xbf463f55,0xbf75248d,0x3f223f0e
.long 0xbec43f80,0x3f6dbf35,0xbec43f80,0x3f6dbf35,0x3ef1bf80,0xbf7f3f0e,0x3f62a554,0xbdc9bf55,0xbf0e3f80,0x3f7bbec4,0x3f0ebf80,0xbf7b3ec4,0x3f22bf80,0xbf623e48,0xbf46248d,0xbef13f7b
.long 0xbf353f80,0x3f35a554,0xbf353f80,0x3f35a554,0x3f46bf80,0xbef1be48,0x3f22a554,0x3f62bf7b,0xbf553f80,0x3e483ec4,0x3f55bf80,0xbe48bec4,0x3f62bf80,0x3dc9bf0e,0xbef1248d,0xbf7f3f55
.long 0xbf6d3f80,0xbec43f35,0xbf6d3f80,0xbec43f35,0x3f75bf80,0x3f22bf55,0x3e95a554,0x3f46bf0e,0xbf7b3f80,0xbf553f6d,0x3f7bbf80,0x3f55bf6d,0x3f7fbf80,0x3f75bf7b,0xbdc9248d,0xbe953e48
.long 0x248d3f80,0xa554bf80,0x248d3f80,0xa554bf80,0x3ef1bf6d,0xbf223f55,0x3f623ec4,0xbf46bf0e,0xbf553f35,0x3f7bbec4,0x3f55bf35,0xbf7b3ec4,0x3f7fbec4,0xbf62be48,0xbdc9bf6d,0xbef13f7b
.long 0xbf6d248d,0x3ec43f35,0xbf6d248d,0x3ec43f35,0x3f223ec4,0x3e95bf7b,0xbf463f6d,0x3f75be48,0xbe48bf35,0xbf553f6d,0x3e483f35,0x3f55bf6d,0xbe953f6d,0x3f7fbf0e,0x3f75bec4,0x3dc9bf55
.long 0x3f35bf80,0xbf35248d,0x3f35bf80,0xbf35248d,0xbf753f6d,0x3dc93f0e,0xbe95bec4,0xbf7f3f55,0x3f7bbf35,0x3f0ebf6d,0xbf7b3f35,0xbf0e3f6d,0xbf463ec4,0xbf753f7b,0xbf223f6d,0x3e953e48
.long 0x3ec4a554,0x3f6dbf35,0x3ec4a554,0x3f6dbf35,0x3dc9bec4,0xbef13e48,0x3f7fbf6d,0x3f62bf7b,0xbf0e3f35,0xbe483ec4,0x3f0ebf35,0x3e48bec4,0x3f62bf6d,0x3f46bf55,0xbef13ec4,0xbf223f0e
.long 0x248d3f80,0xa554bf80,0x248d3f80,0xa554bf80,0x3f46bf35,0xbf623f0e,0x3f223f35,0xbef1bf55,0xbf7b248d,0x3f553ec4,0x3f7ba554,0xbf55bec4,0x3ef13f35,0x3dc9bf7b,0x3f62bf35,0xbf7f3e48
.long 0x3ec4bf80,0xbf6d3f35,0x3ec4bf80,0xbf6d3f35,0xbf753f35,0x3f463e48,0xbe95bf35,0xbf223f7b,0x3f55a554,0x3e48bf6d,0xbf55248d,0xbe483f6d,0xbdc9bf35,0xbf753f55,0xbf7f3f35,0x3e953f0e
.long 0xbf353f80,0x3f35a554,0xbf353f80,0x3f35a554,0x3f7fbf35,0x3e95bf55,0xbdc93f35,0x3f75bf0e,0xbf0e248d,0xbf7b3f6d,0x3f0ea554,0x3f7bbf6d,0xbe953f35,0x3f22be48,0x3f75bf35,0x3f46bf7b
.long 0x3f6dbf80,0x3ec4bf35,0x3f6dbf80,0x3ec4bf35,0xbf623f35,0xbf7f3f7b,0x3ef1bf35,0xbdc9be48,0x3e48a554,0x3f0ebec4,0xbe48248d,0xbf0e3ec4,0x3f22bf35,0x3ef1bf0e,0xbf463f35,0xbf623f55
.long 0x248d3f80,0xa554bf80,0x248d3f80,0xa554bf80,0x3f75bec4,0xbf7f3e48,0x3e953f6d,0xbdc9bf7b,0xbf0ebf35,0x3e483f6d,0x3f0e3f35,0xbe48bf6d,0xbf223f6d,0x3f75bf0e,0x3f463ec4,0xbe95bf55
.long 0x3f6da554,0xbec4bf35,0x3f6da554,0xbec4bf35,0x3dc9bf6d,0xbf623f55,0x3f7fbec4,0xbef1bf0e,0xbf7b3f35,0x3f0e3ec4,0x3f7bbf35,0xbf0ebec4,0x3ef13ec4,0x3f46bf7b,0x3f62bf6d,0xbf22be48
.long 0x3f35bf80,0xbf35248d,0x3f35bf80,0xbf35248d,0xbf623ec4,0xbf223f7b,0x3ef1bf6d,0xbf463e48,0xbe483f35,0x3f55bec4,0x3e48bf35,0xbf553ec4,0x3f7fbf6d,0x3ef1bf55,0xbdc9bec4,0xbf623f0e
.long 0xbec4248d,0xbf6d3f35,0xbec4248d,0xbf6d3f35,0xbf463f6d,0xbe953f0e,0xbf223ec4,0xbf753f55,0x3f55bf35,0x3f7bbf6d,0xbf553f35,0xbf7b3f6d,0x3e95bec4,0x3dc9be48,0xbf753f6d,0xbf7f3f7b
.long 0x248d3f80,0xa554bf80,0x248d3f80,0xa554bf80,0xbdc93f80,0x3e95bf7b,0xbf7f248d,0x3f753e48,0xbe483f80,0x3f0ebf6d,0x3e48bf80,0xbf0e3f6d,0xbe953f80,0x3f46bf55,0x3f75a554,0xbf22bf0e
.long 0xbec43f80,0x3f6dbf35,0xbec43f80,0x3f6dbf35,0xbef13f80,0x3f7fbf0e,0xbf62248d,0x3dc93f55,0xbf0e3f80,0x3f7bbec4,0x3f0ebf80,0xbf7b3ec4,0xbf223f80,0x3f62be48,0x3f46a554,0x3ef1bf7b
.long 0xbf353f80,0x3f35a554,0xbf353f80,0x3f35a554,0xbf463f80,0x3ef13e48,0xbf22248d,0xbf623f7b,0xbf553f80,0x3e483ec4,0x3f55bf80,0xbe48bec4,0xbf623f80,0xbdc93f0e,0x3ef1a554,0x3f7fbf55
.long 0xbf6d3f80,0xbec43f35,0xbf6d3f80,0xbec43f35,0xbf753f80,0xbf223f55,0xbe95248d,0xbf463f0e,0xbf7b3f80,0xbf553f6d,0x3f7bbf80,0x3f55bf6d,0xbf7f3f80,0xbf753f7b,0x3dc9a554,0x3e95be48
.long 0x248d3f80,0xa554bf80,0x248d3f80,0xa554bf80,0xbef13f6d,0x3f22bf55,0xbf62bec4,0x3f463f0e,0xbf553f35,0x3f7bbec4,0x3f55bf35,0xbf7b3ec4,0xbf7f3ec4,0x3f623e48,0x3dc93f6d,0x3ef1bf7b
.long 0xbf6d248d,0x3ec43f35,0xbf6d248d,0x3ec43f35,0xbf22bec4,0xbe953f7b,0x3f46bf6d,0xbf753e48,0xbe48bf35,0xbf553f6d,0x3e483f35,0x3f55bf6d,0x3e95bf6d,0xbf7f3f0e,0xbf753ec4,0xbdc93f55
.long 0x3f35bf80,0xbf35248d,0x3f35bf80,0xbf35248d,0x3f75bf6d,0xbdc9bf0e,0x3e953ec4,0x3f7fbf55,0x3f7bbf35,0x3f0ebf6d,0xbf7b3f35,0xbf0e3f6d,0x3f46bec4,0x3f75bf7b,0x3f22bf6d,0xbe95be48
.long 0x3ec4a554,0x3f6dbf35,0x3ec4a554,0x3f6dbf35,0xbdc93ec4,0x3ef1be48,0xbf7f3f6d,0xbf623f7b,0xbf0e3f35,0xbe483ec4,0x3f0ebf35,0x3e48bec4,0xbf623f6d,0xbf463f55,0x3ef1bec4,0x3f22bf0e
.long 0x248d3f80,0xa554bf80,0x248d3f80,0xa554bf80,0xbf463f35,0x3f62bf0e,0xbf22bf35,0x3ef13f55,0xbf7b248d,0x3f553ec4,0x3f7ba554,0xbf55bec4,0xbef1bf35,0xbdc93f7b,0xbf623f35,0x3f7fbe48
.long 0x3ec4bf80,0xbf6d3f35,0x3ec4bf80,0xbf6d3f35,0x3f75bf35,0xbf46be48,0x3e953f35,0x3f22bf7b,0x3f55a554,0x3e48bf6d,0xbf55248d,0xbe483f6d,0x3dc93f35,0x3f75bf55,0x3f7fbf35,0xbe95bf0e
.long 0xbf353f80,0x3f35a554,0xbf353f80,0x3f35a554,0xbf7f3f35,0xbe953f55,0x3dc9bf35,0xbf753f0e,0xbf0e248d,0xbf7b3f6d,0x3f0ea554,0x3f7bbf6d,0x3e95bf35,0xbf223e48,0xbf753f35,0xbf463f7b
.long 0x3f6dbf80,0x3ec4bf35,0x3f6dbf80,0x3ec4bf35,0x3f62bf35,0x3f7fbf7b,0xbef13f35,0x3dc93e48,0x3e48a554,0x3f0ebec4,0xbe48248d,0xbf0e3ec4,0xbf223f35,0xbef13f0e,0x3f46bf35,0x3f62bf55
.long 0x248d3f80,0xa554bf80,0x248d3f80,0xa554bf80,0xbf753ec4,0x3f7fbe48,0xbe95bf6d,0x3dc93f7b,0xbf0ebf35,0x3e483f6d,0x3f0e3f35,0xbe48bf6d,0x3f22bf6d,0xbf753f0e,0xbf46bec4,0x3e953f55
.long 0x3f6da554,0xbec4bf35,0x3f6da554,0xbec4bf35,0xbdc93f6d,0x3f62bf55,0xbf7f3ec4,0x3ef13f0e,0xbf7b3f35,0x3f0e3ec4,0x3f7bbf35,0xbf0ebec4,0xbef1bec4,0xbf463f7b,0xbf623f6d,0x3f223e48
.long 0x3f35bf80,0xbf35248d,0x3f35bf80,0xbf35248d,0x3f62bec4,0x3f22bf7b,0xbef13f6d,0x3f46be48,0xbe483f35,0x3f55bec4,0x3e48bf35,0xbf553ec4,0xbf7f3f6d,0xbef13f55,0x3dc93ec4,0x3f62bf0e
.long 0xbec4248d,0xbf6d3f35,0xbec4248d,0xbf6d3f35,0x3f46bf6d,0x3e95bf0e,0x3f22bec4,0x3f75bf55,0x3f55bf35,0x3f7bbf6d,0xbf553f35,0xbf7b3f6d,0xbe953ec4,0xbdc93e48,0x3f75bf6d,0x3f7fbf7b
.long 0xa50d0000,0xa50d0000,0xa50d0000,0xa50d0000,0xbdc9a50d,0xbe953e48,0xbf7f3f80,0xbf753f7b,0x3e480000,0x3f0ebec4,0xbe48a50d,0xbf0e3ec4,0xbe95a50d,0xbf463f0e,0x3f75bf80,0x3f22bf55
.long 0x3ec40000,0x3f6dbf35,0x3ec40000,0x3f6dbf35,0xbef1a50d,0xbf7f3f55,0xbf623f80,0xbdc93f0e,0x3f0e0000,0x3f7bbf6d,0xbf0ea50d,0xbf7b3f6d,0xbf22a50d,0xbf623f7b,0x3f46bf80,0xbef1be48
.long 0x3f350000,0x3f35bf80,0x3f350000,0x3f35bf80,0xbf46a50d,0xbef13f7b,0xbf223f80,0x3f62be48,0x3f550000,0x3e48bf6d,0xbf55a50d,0xbe483f6d,0xbf62a50d,0x3dc93f55,0x3ef1bf80,0xbf7f3f0e
.long 0x3f6d0000,0xbec4bf35,0x3f6d0000,0xbec4bf35,0xbf75a50d,0x3f223f0e,0xbe953f80,0x3f46bf55,0x3f7b0000,0xbf55bec4,0xbf7ba50d,0x3f553ec4,0xbf7fa50d,0x3f753e48,0x3dc9bf80,0xbe953f7b
.long 0xa50d0000,0xa50d0000,0xa50d0000,0xa50d0000,0xbef13ec4,0xbf223f0e,0xbf623f6d,0xbf463f55,0x3f55bf35,0x3f7bbf6d,0xbf553f35,0xbf7b3f6d,0xbf7f3f6d,0xbf623f7b,0x3dc9bec4,0xbef13e48
.long 0x3f6dbf80,0x3ec4bf35,0x3f6dbf80,0x3ec4bf35,0xbf223f6d,0x3e953e48,0x3f46bec4,0x3f75bf7b,0x3e48bf35,0xbf553ec4,0xbe483f35,0x3f55bec4,0x3e953ec4,0x3f7fbf55,0xbf753f6d,0x3dc93f0e
.long 0xbf35a50d,0xbf353f80,0xbf35a50d,0xbf353f80,0x3f75bec4,0x3dc9bf55,0x3e95bf6d,0xbf7f3f0e,0xbf7b3f35,0x3f0e3ec4,0x3f7bbf35,0xbf0ebec4,0x3f46bf6d,0xbf753e48,0x3f223ec4,0x3e95bf7b
.long 0xbec43f80,0x3f6dbf35,0xbec43f80,0x3f6dbf35,0xbdc9bf6d,0xbef13f7b,0xbf7f3ec4,0x3f623e48,0x3f0e3f35,0xbe48bf6d,0xbf0ebf35,0x3e483f6d,0xbf62bec4,0x3f463f0e,0x3ef1bf6d,0xbf223f55
.long 0xa50d0000,0xa50d0000,0xa50d0000,0xa50d0000,0xbf463f35,0xbf623f55,0xbf223f35,0xbef13f0e,0x3f7bbf80,0x3f55bf6d,0xbf7b3f80,0xbf553f6d,0xbef13f35,0x3dc93e48,0xbf623f35,0xbf7f3f7b
.long 0xbec4a50d,0xbf6d3f35,0xbec4a50d,0xbf6d3f35,0x3f75bf35,0x3f46bf7b,0x3e95bf35,0xbf223e48,0xbf553f80,0x3e483ec4,0x3f55bf80,0xbe48bec4,0x3dc9bf35,0xbf753f0e,0x3f7fbf35,0x3e95bf55
.long 0x3f350000,0x3f35bf80,0x3f350000,0x3f35bf80,0xbf7f3f35,0x3e953f0e,0x3dc93f35,0x3f75bf55,0x3f0ebf80,0xbf7b3ec4,0xbf0e3f80,0x3f7bbec4,0x3e953f35,0x3f22bf7b,0xbf753f35,0x3f463e48
.long 0xbf6da50d,0x3ec43f35,0xbf6da50d,0x3ec43f35,0x3f62bf35,0xbf7f3e48,0xbef1bf35,0xbdc93f7b,0xbe483f80,0x3f0ebf6d,0x3e48bf80,0xbf0e3f6d,0xbf22bf35,0x3ef13f55,0x3f46bf35,0xbf623f0e
.long 0xa50d0000,0xa50d0000,0xa50d0000,0xa50d0000,0xbf753f6d,0xbf7f3f7b,0xbe953ec4,0xbdc93e48,0x3f0ebf35,0x3e48bec4,0xbf0e3f35,0xbe483ec4,0x3f22bec4,0x3f75bf55,0xbf463f6d,0xbe953f0e
.long 0xbf6d3f80,0xbec43f35,0xbf6d3f80,0xbec43f35,0xbdc9bec4,0xbf623f0e,0xbf7f3f6d,0xbef13f55,0x3f7bbf35,0x3f0ebf6d,0xbf7b3f35,0xbf0e3f6d,0xbef13f6d,0x3f46be48,0xbf623ec4,0xbf223f7b
.long 0xbf35a50d,0xbf353f80,0xbf35a50d,0xbf353f80,0x3f62bf6d,0xbf22be48,0xbef1bec4,0xbf463f7b,0x3e483f35,0x3f55bf6d,0xbe48bf35,0xbf553f6d,0xbf7f3ec4,0x3ef13f0e,0x3dc9bf6d,0xbf623f55
.long 0x3ec4bf80,0xbf6d3f35,0x3ec4bf80,0xbf6d3f35,0x3f463ec4,0xbe95bf55,0x3f22bf6d,0xbf753f0e,0xbf553f35,0x3f7bbec4,0x3f55bf35,0xbf7b3ec4,0xbe95bf6d,0x3dc93f7b,0x3f75bec4,0xbf7f3e48
.long 0xa50d0000,0xa50d0000,0xa50d0000,0xa50d0000,0x3dc90000,0x3e95be48,0x3f7fbf80,0x3f75bf7b,0x3e480000,0x3f0ebec4,0xbe48a50d,0xbf0e3ec4,0x3e950000,0x3f46bf0e,0xbf753f80,0xbf223f55
.long 0x3ec40000,0x3f6dbf35,0x3ec40000,0x3f6dbf35,0x3ef10000,0x3f7fbf55,0x3f62bf80,0x3dc9bf0e,0x3f0e0000,0x3f7bbf6d,0xbf0ea50d,0xbf7b3f6d,0x3f220000,0x3f62bf7b,0xbf463f80,0x3ef13e48
.long 0x3f350000,0x3f35bf80,0x3f350000,0x3f35bf80,0x3f460000,0x3ef1bf7b,0x3f22bf80,0xbf623e48,0x3f550000,0x3e48bf6d,0xbf55a50d,0xbe483f6d,0x3f620000,0xbdc9bf55,0xbef13f80,0x3f7fbf0e
.long 0x3f6d0000,0xbec4bf35,0x3f6d0000,0xbec4bf35,0x3f750000,0xbf22bf0e,0x3e95bf80,0xbf463f55,0x3f7b0000,0xbf55bec4,0xbf7ba50d,0x3f553ec4,0x3f7f0000,0xbf75be48,0xbdc93f80,0x3e95bf7b
.long 0xa50d0000,0xa50d0000,0xa50d0000,0xa50d0000,0x3ef1bec4,0x3f22bf0e,0x3f62bf6d,0x3f46bf55,0x3f55bf35,0x3f7bbf6d,0xbf553f35,0xbf7b3f6d,0x3f7fbf6d,0x3f62bf7b,0xbdc93ec4,0x3ef1be48
.long 0x3f6dbf80,0x3ec4bf35,0x3f6dbf80,0x3ec4bf35,0x3f22bf6d,0xbe95be48,0xbf463ec4,0xbf753f7b,0x3e48bf35,0xbf553ec4,0xbe483f35,0x3f55bec4,0xbe95bec4,0xbf7f3f55,0x3f75bf6d,0xbdc9bf0e
.long 0xbf35a50d,0xbf353f80,0xbf35a50d,0xbf353f80,0xbf753ec4,0xbdc93f55,0xbe953f6d,0x3f7fbf0e,0xbf7b3f35,0x3f0e3ec4,0x3f7bbf35,0xbf0ebec4,0xbf463f6d,0x3f75be48,0xbf22bec4,0xbe953f7b
.long 0xbec43f80,0x3f6dbf35,0xbec43f80,0x3f6dbf35,0x3dc93f6d,0x3ef1bf7b,0x3f7fbec4,0xbf62be48,0x3f0e3f35,0xbe48bf6d,0xbf0ebf35,0x3e483f6d,0x3f623ec4,0xbf46bf0e,0xbef13f6d,0x3f22bf55
.long 0xa50d0000,0xa50d0000,0xa50d0000,0xa50d0000,0x3f46bf35,0x3f62bf55,0x3f22bf35,0x3ef1bf0e,0x3f7bbf80,0x3f55bf6d,0xbf7b3f80,0xbf553f6d,0x3ef1bf35,0xbdc9be48,0x3f62bf35,0x3f7fbf7b
.long 0xbec4a50d,0xbf6d3f35,0xbec4a50d,0xbf6d3f35,0xbf753f35,0xbf463f7b,0xbe953f35,0x3f22be48,0xbf553f80,0x3e483ec4,0x3f55bf80,0xbe48bec4,0xbdc93f35,0x3f75bf0e,0xbf7f3f35,0xbe953f55
.long 0x3f350000,0x3f35bf80,0x3f350000,0x3f35bf80,0x3f7fbf35,0xbe95bf0e,0xbdc9bf35,0xbf753f55,0x3f0ebf80,0xbf7b3ec4,0xbf0e3f80,0x3f7bbec4,0xbe95bf35,0xbf223f7b,0x3f75bf35,0xbf46be48
.long 0xbf6da50d,0x3ec43f35,0xbf6da50d,0x3ec43f35,0xbf623f35,0x3f7fbe48,0x3ef13f35,0x3dc9bf7b,0xbe483f80,0x3f0ebf6d,0x3e48bf80,0xbf0e3f6d,0x3f223f35,0xbef1bf55,0xbf463f35,0x3f62bf0e
.long 0xa50d0000,0xa50d0000,0xa50d0000,0xa50d0000,0x3f75bf6d,0x3f7fbf7b,0x3e95bec4,0x3dc9be48,0x3f0ebf35,0x3e48bec4,0xbf0e3f35,0xbe483ec4,0xbf223ec4,0xbf753f55,0x3f46bf6d,0x3e95bf0e
.long 0xbf6d3f80,0xbec43f35,0xbf6d3f80,0xbec43f35,0x3dc93ec4,0x3f62bf0e,0x3f7fbf6d,0x3ef1bf55,0x3f7bbf35,0x3f0ebf6d,0xbf7b3f35,0xbf0e3f6d,0x3ef1bf6d,0xbf463e48,0x3f62bec4,0x3f22bf7b
.long 0xbf35a50d,0xbf353f80,0xbf35a50d,0xbf353f80,0xbf623f6d,0x3f223e48,0x3ef13ec4,0x3f46bf7b,0x3e483f35,0x3f55bf6d,0xbe48bf35,0xbf553f6d,0x3f7fbec4,0xbef1bf0e,0xbdc93f6d,0x3f62bf55
.long 0x3ec4bf80,0xbf6d3f35,0x3ec4bf80,0xbf6d3f35,0xbf46bec4,0x3e953f55,0xbf223f6d,0x3f75bf0e,0xbf553f35,0x3f7bbec4,0x3f55bf35,0xbf7b3ec4,0x3e953f6d,0xbdc9bf7b,0xbf753ec4,0x3f7fbe48
.long 0x3f800000,0xbf80a50d,0x3f800000,0xbf80a50d,0xbf7fa50d,0x3f75be48,0x3dc93f80,0xbe95bf7b,0x3f7b0000,0xbf553ec4,0xbf7ba50d,0x3f55bec4,0xbf75a50d,0x3f22bf0e,0xbe95bf80,0x3f463f55
.long 0x3f6d0000,0xbec43f35,0x3f6d0000,0xbec43f35,0xbf62a50d,0x3dc9bf55,0x3ef13f80,0xbf7fbf0e,0x3f550000,0x3e483f6d,0xbf55a50d,0xbe48bf6d,0xbf46a50d,0xbef1bf7b,0xbf22bf80,0x3f623e48
.long 0x3f350000,0x3f353f80,0x3f350000,0x3f353f80,0xbf22a50d,0xbf62bf7b,0x3f463f80,0xbef13e48,0x3f0e0000,0x3f7b3f6d,0xbf0ea50d,0xbf7bbf6d,0xbef1a50d,0xbf7fbf55,0xbf62bf80,0xbdc9bf0e
.long 0x3ec40000,0x3f6d3f35,0x3ec40000,0x3f6d3f35,0xbe95a50d,0xbf46bf0e,0x3f753f80,0x3f223f55,0x3e480000,0x3f0e3ec4,0xbe48a50d,0xbf0ebec4,0xbdc9a50d,0xbe95be48,0xbf7fbf80,0xbf75bf7b
.long 0x3f800000,0xbf80a50d,0x3f800000,0xbf80a50d,0xbf623ec4,0x3f46bf0e,0x3ef13f6d,0xbf22bf55,0x3f0ebf35,0xbe483f6d,0xbf0e3f35,0x3e48bf6d,0xbdc93f6d,0xbef1bf7b,0xbf7fbec4,0x3f62be48
.long 0xbec4bf80,0x3f6d3f35,0xbec4bf80,0x3f6d3f35,0x3f463f6d,0xbf75be48,0x3f22bec4,0x3e953f7b,0xbf7bbf35,0x3f0ebec4,0x3f7b3f35,0xbf0e3ec4,0x3f753ec4,0x3dc93f55,0x3e953f6d,0xbf7fbf0e
.long 0xbf35a50d,0xbf35bf80,0xbf35a50d,0xbf35bf80,0x3e95bec4,0x3f7f3f55,0xbf75bf6d,0x3dc9bf0e,0x3e483f35,0xbf55bec4,0xbe48bf35,0x3f553ec4,0xbf22bf6d,0x3e95be48,0x3f463ec4,0x3f753f7b
.long 0x3f6d3f80,0x3ec43f35,0x3f6d3f80,0x3ec43f35,0xbf7fbf6d,0xbf62bf7b,0x3dc93ec4,0xbef1be48,0x3f553f35,0x3f7b3f6d,0xbf55bf35,0xbf7bbf6d,0xbef1bec4,0xbf22bf0e,0xbf62bf6d,0xbf46bf55
.long 0x3f800000,0xbf80a50d,0x3f800000,0xbf80a50d,0xbf223f35,0x3ef1bf55,0x3f463f35,0xbf62bf0e,0xbe48bf80,0x3f0e3f6d,0x3e483f80,0xbf0ebf6d,0x3f623f35,0xbf7fbe48,0xbef13f35,0xbdc9bf7b
.long 0xbf6da50d,0x3ec4bf35,0xbf6da50d,0x3ec4bf35,0x3e95bf35,0x3f223f7b,0xbf75bf35,0x3f46be48,0x3f0e3f80,0xbf7bbec4,0xbf0ebf80,0x3f7b3ec4,0xbf7fbf35,0x3e95bf0e,0x3dc9bf35,0x3f753f55
.long 0x3f350000,0x3f353f80,0x3f350000,0x3f353f80,0x3dc93f35,0xbf75bf0e,0x3f7f3f35,0x3e953f55,0xbf55bf80,0x3e48bec4,0x3f553f80,0xbe483ec4,0x3f753f35,0x3f463f7b,0x3e953f35,0xbf22be48
.long 0xbec4a50d,0xbf6dbf35,0xbec4a50d,0xbf6dbf35,0xbef1bf35,0x3dc9be48,0xbf62bf35,0xbf7fbf7b,0x3f7b3f80,0x3f553f6d,0xbf7bbf80,0xbf55bf6d,0xbf46bf35,0xbf62bf55,0xbf22bf35,0xbef1bf0e
.long 0x3f800000,0xbf80a50d,0x3f800000,0xbf80a50d,0xbe953f6d,0x3dc9bf7b,0x3f753ec4,0xbf7fbe48,0xbf55bf35,0x3f7b3ec4,0x3f553f35,0xbf7bbec4,0x3f46bec4,0xbe953f55,0x3f223f6d,0xbf75bf0e
.long 0x3ec43f80,0xbf6dbf35,0x3ec43f80,0xbf6dbf35,0xbf7fbec4,0x3ef1bf0e,0x3dc93f6d,0xbf62bf55,0x3e48bf35,0x3f553f6d,0xbe483f35,0xbf55bf6d,0x3f623f6d,0xbf223e48,0xbef13ec4,0xbf46bf7b
.long 0xbf35a50d,0xbf35bf80,0xbf35a50d,0xbf35bf80,0xbef1bf6d,0x3f463e48,0xbf62bec4,0xbf22bf7b,0x3f7b3f35,0x3f0e3f6d,0xbf7bbf35,0xbf0ebf6d,0xbdc93ec4,0xbf62bf0e,0xbf7fbf6d,0xbef1bf55
.long 0xbf6dbf80,0xbec4bf35,0xbf6dbf80,0xbec4bf35,0x3f223ec4,0x3f753f55,0xbf46bf6d,0xbe95bf0e,0x3f0e3f35,0x3e483ec4,0xbf0ebf35,0xbe48bec4,0xbf75bf6d,0xbf7fbf7b,0xbe95bec4,0xbdc9be48
.long 0x3f800000,0xbf80a50d,0x3f800000,0xbf80a50d,0x3f7f0000,0xbf753e48,0xbdc9bf80,0x3e953f7b,0x3f7b0000,0xbf553ec4,0xbf7ba50d,0x3f55bec4,0x3f750000,0xbf223f0e,0x3e953f80,0xbf46bf55
.long 0x3f6d0000,0xbec43f35,0x3f6d0000,0xbec43f35,0x3f620000,0xbdc93f55,0xbef1bf80,0x3f7f3f0e,0x3f550000,0x3e483f6d,0xbf55a50d,0xbe48bf6d,0x3f460000,0x3ef13f7b,0x3f223f80,0xbf62be48
.long 0x3f350000,0x3f353f80,0x3f350000,0x3f353f80,0x3f220000,0x3f623f7b,0xbf46bf80,0x3ef1be48,0x3f0e0000,0x3f7b3f6d,0xbf0ea50d,0xbf7bbf6d,0x3ef10000,0x3f7f3f55,0x3f623f80,0x3dc93f0e
.long 0x3ec40000,0x3f6d3f35,0x3ec40000,0x3f6d3f35,0x3e950000,0x3f463f0e,0xbf75bf80,0xbf22bf55,0x3e480000,0x3f0e3ec4,0xbe48a50d,0xbf0ebec4,0x3dc90000,0x3e953e48,0x3f7f3f80,0x3f753f7b
.long 0x3f800000,0xbf80a50d,0x3f800000,0xbf80a50d,0x3f62bec4,0xbf463f0e,0xbef1bf6d,0x3f223f55,0x3f0ebf35,0xbe483f6d,0xbf0e3f35,0x3e48bf6d,0x3dc9bf6d,0x3ef13f7b,0x3f7f3ec4,0xbf623e48
.long 0xbec4bf80,0x3f6d3f35,0xbec4bf80,0x3f6d3f35,0xbf46bf6d,0x3f753e48,0xbf223ec4,0xbe95bf7b,0xbf7bbf35,0x3f0ebec4,0x3f7b3f35,0xbf0e3ec4,0xbf75bec4,0xbdc9bf55,0xbe95bf6d,0x3f7f3f0e
.long 0xbf35a50d,0xbf35bf80,0xbf35a50d,0xbf35bf80,0xbe953ec4,0xbf7fbf55,0x3f753f6d,0xbdc93f0e,0x3e483f35,0xbf55bec4,0xbe48bf35,0x3f553ec4,0x3f223f6d,0xbe953e48,0xbf46bec4,0xbf75bf7b
.long 0x3f6d3f80,0x3ec43f35,0x3f6d3f80,0x3ec43f35,0x3f7f3f6d,0x3f623f7b,0xbdc9bec4,0x3ef13e48,0x3f553f35,0x3f7b3f6d,0xbf55bf35,0xbf7bbf6d,0x3ef13ec4,0x3f223f0e,0x3f623f6d,0x3f463f55
.long 0x3f800000,0xbf80a50d,0x3f800000,0xbf80a50d,0x3f22bf35,0xbef13f55,0xbf46bf35,0x3f623f0e,0xbe48bf80,0x3f0e3f6d,0x3e483f80,0xbf0ebf6d,0xbf62bf35,0x3f7f3e48,0x3ef1bf35,0x3dc93f7b
.long 0xbf6da50d,0x3ec4bf35,0xbf6da50d,0x3ec4bf35,0xbe953f35,0xbf22bf7b,0x3f753f35,0xbf463e48,0x3f0e3f80,0xbf7bbec4,0xbf0ebf80,0x3f7b3ec4,0x3f7f3f35,0xbe953f0e,0xbdc93f35,0xbf75bf55
.long 0x3f350000,0x3f353f80,0x3f350000,0x3f353f80,0xbdc9bf35,0x3f753f0e,0xbf7fbf35,0xbe95bf55,0xbf55bf80,0x3e48bec4,0x3f553f80,0xbe483ec4,0xbf75bf35,0xbf46bf7b,0xbe95bf35,0x3f223e48
.long 0xbec4a50d,0xbf6dbf35,0xbec4a50d,0xbf6dbf35,0x3ef13f35,0xbdc93e48,0x3f623f35,0x3f7f3f7b,0x3f7b3f80,0x3f553f6d,0xbf7bbf80,0xbf55bf6d,0x3f463f35,0x3f623f55,0x3f223f35,0x3ef13f0e
.long 0x3f800000,0xbf80a50d,0x3f800000,0xbf80a50d,0x3e95bf6d,0xbdc93f7b,0xbf75bec4,0x3f7f3e48,0xbf55bf35,0x3f7b3ec4,0x3f553f35,0xbf7bbec4,0xbf463ec4,0x3e95bf55,0xbf22bf6d,0x3f753f0e
.long 0x3ec43f80,0xbf6dbf35,0x3ec43f80,0xbf6dbf35,0x3f7f3ec4,0xbef13f0e,0xbdc9bf6d,0x3f623f55,0x3e48bf35,0x3f553f6d,0xbe483f35,0xbf55bf6d,0xbf62bf6d,0x3f22be48,0x3ef1bec4,0x3f463f7b
.long 0xbf35a50d,0xbf35bf80,0xbf35a50d,0xbf35bf80,0x3ef13f6d,0xbf46be48,0x3f623ec4,0x3f223f7b,0x3f7b3f35,0x3f0e3f6d,0xbf7bbf35,0xbf0ebf6d,0x3dc9bec4,0x3f623f0e,0x3f7f3f6d,0x3ef13f55
.long 0xbf6dbf80,0xbec4bf35,0xbf6dbf80,0xbec4bf35,0xbf22bec4,0xbf75bf55,0x3f463f6d,0x3e953f0e,0x3f0e3f35,0x3e483ec4,0xbf0ebf35,0xbe48bec4,0x3f753f6d,0x3f7f3f7b,0x3e953ec4,0x3dc93e48
.long 0x0,0x0,0x0,0x0,0x3dc9a50d,0x3e953e48,0x3f7f3f80,0x3f753f7b,0xbe480000,0xbf0ebec4,0x3e48a50d,0x3f0e3ec4,0x3e95a50d,0x3f463f0e,0xbf75bf80,0xbf22bf55
.long 0xbec40000,0xbf6dbf35,0xbec40000,0xbf6dbf35,0x3ef1a50d,0x3f7f3f55,0x3f623f80,0x3dc93f0e,0xbf0e0000,0xbf7bbf6d,0x3f0ea50d,0x3f7b3f6d,0x3f22a50d,0x3f623f7b,0xbf46bf80,0x3ef1be48
.long 0xbf350000,0xbf35bf80,0xbf350000,0xbf35bf80,0x3f46a50d,0x3ef13f7b,0x3f223f80,0xbf62be48,0xbf550000,0xbe48bf6d,0x3f55a50d,0x3e483f6d,0x3f62a50d,0xbdc93f55,0xbef1bf80,0x3f7f3f0e
.long 0xbf6d0000,0x3ec4bf35,0xbf6d0000,0x3ec4bf35,0x3f75a50d,0xbf223f0e,0x3e953f80,0xbf46bf55,0xbf7b0000,0x3f55bec4,0x3f7ba50d,0xbf553ec4,0x3f7fa50d,0xbf753e48,0xbdc9bf80,0x3e953f7b
.long 0x0,0x0,0x0,0x0,0x3ef13ec4,0x3f223f0e,0x3f623f6d,0x3f463f55,0xbf55bf35,0xbf7bbf6d,0x3f553f35,0x3f7b3f6d,0x3f7f3f6d,0x3f623f7b,0xbdc9bec4,0x3ef13e48
.long 0xbf6dbf80,0xbec4bf35,0xbf6dbf80,0xbec4bf35,0x3f223f6d,0xbe953e48,0xbf46bec4,0xbf75bf7b,0xbe48bf35,0x3f553ec4,0x3e483f35,0xbf55bec4,0xbe953ec4,0xbf7fbf55,0x3f753f6d,0xbdc93f0e
.long 0x3f35a50d,0x3f353f80,0x3f35a50d,0x3f353f80,0xbf75bec4,0xbdc9bf55,0xbe95bf6d,0x3f7f3f0e,0x3f7b3f35,0xbf0e3ec4,0xbf7bbf35,0x3f0ebec4,0xbf46bf6d,0x3f753e48,0xbf223ec4,0xbe95bf7b
.long 0x3ec43f80,0xbf6dbf35,0x3ec43f80,0xbf6dbf35,0x3dc9bf6d,0x3ef13f7b,0x3f7f3ec4,0xbf623e48,0xbf0e3f35,0x3e48bf6d,0x3f0ebf35,0xbe483f6d,0x3f62bec4,0xbf463f0e,0xbef1bf6d,0x3f223f55
.long 0x0,0x0,0x0,0x0,0x3f463f35,0x3f623f55,0x3f223f35,0x3ef13f0e,0xbf7bbf80,0xbf55bf6d,0x3f7b3f80,0x3f553f6d,0x3ef13f35,0xbdc93e48,0x3f623f35,0x3f7f3f7b
.long 0x3ec4a50d,0x3f6d3f35,0x3ec4a50d,0x3f6d3f35,0xbf75bf35,0xbf46bf7b,0xbe95bf35,0x3f223e48,0x3f553f80,0xbe483ec4,0xbf55bf80,0x3e48bec4,0xbdc9bf35,0x3f753f0e,0xbf7fbf35,0xbe95bf55
.long 0xbf350000,0xbf35bf80,0xbf350000,0xbf35bf80,0x3f7f3f35,0xbe953f0e,0xbdc93f35,0xbf75bf55,0xbf0ebf80,0x3f7b3ec4,0x3f0e3f80,0xbf7bbec4,0xbe953f35,0xbf22bf7b,0x3f753f35,0xbf463e48
.long 0x3f6da50d,0xbec43f35,0x3f6da50d,0xbec43f35,0xbf62bf35,0x3f7f3e48,0x3ef1bf35,0x3dc93f7b,0x3e483f80,0xbf0ebf6d,0xbe48bf80,0x3f0e3f6d,0x3f22bf35,0xbef13f55,0xbf46bf35,0x3f623f0e
.long 0x0,0x0,0x0,0x0,0x3f753f6d,0x3f7f3f7b,0x3e953ec4,0x3dc93e48,0xbf0ebf35,0xbe48bec4,0x3f0e3f35,0x3e483ec4,0xbf22bec4,0xbf75bf55,0x3f463f6d,0x3e953f0e
.long 0x3f6d3f80,0x3ec43f35,0x3f6d3f80,0x3ec43f35,0x3dc9bec4,0x3f623f0e,0x3f7f3f6d,0x3ef13f55,0xbf7bbf35,0xbf0ebf6d,0x3f7b3f35,0x3f0e3f6d,0x3ef13f6d,0xbf46be48,0x3f623ec4,0x3f223f7b
.long 0x3f35a50d,0x3f353f80,0x3f35a50d,0x3f353f80,0xbf62bf6d,0x3f22be48,0x3ef1bec4,0x3f463f7b,0xbe483f35,0xbf55bf6d,0x3e48bf35,0x3f553f6d,0x3f7f3ec4,0xbef13f0e,0xbdc9bf6d,0x3f623f55
.long 0xbec4bf80,0x3f6d3f35,0xbec4bf80,0x3f6d3f35,0xbf463ec4,0x3e95bf55,0xbf22bf6d,0x3f753f0e,0x3f553f35,0xbf7bbec4,0xbf55bf35,0x3f7b3ec4,0x3e95bf6d,0xbdc93f7b,0xbf75bec4,0x3f7f3e48
.long 0x0,0x0,0x0,0x0,0xbdc90000,0xbe95be48,0xbf7fbf80,0xbf75bf7b,0xbe480000,0xbf0ebec4,0x3e48a50d,0x3f0e3ec4,0xbe950000,0xbf46bf0e,0x3f753f80,0x3f223f55
.long 0xbec40000,0xbf6dbf35,0xbec40000,0xbf6dbf35,0xbef10000,0xbf7fbf55,0xbf62bf80,0xbdc9bf0e,0xbf0e0000,0xbf7bbf6d,0x3f0ea50d,0x3f7b3f6d,0xbf220000,0xbf62bf7b,0x3f463f80,0xbef13e48
.long 0xbf350000,0xbf35bf80,0xbf350000,0xbf35bf80,0xbf460000,0xbef1bf7b,0xbf22bf80,0x3f623e48,0xbf550000,0xbe48bf6d,0x3f55a50d,0x3e483f6d,0xbf620000,0x3dc9bf55,0x3ef13f80,0xbf7fbf0e
.long 0xbf6d0000,0x3ec4bf35,0xbf6d0000,0x3ec4bf35,0xbf750000,0x3f22bf0e,0xbe95bf80,0x3f463f55,0xbf7b0000,0x3f55bec4,0x3f7ba50d,0xbf553ec4,0xbf7f0000,0x3f75be48,0x3dc93f80,0xbe95bf7b
.long 0x0,0x0,0x0,0x0,0xbef1bec4,0xbf22bf0e,0xbf62bf6d,0xbf46bf55,0xbf55bf35,0xbf7bbf6d,0x3f553f35,0x3f7b3f6d,0xbf7fbf6d,0xbf62bf7b,0x3dc93ec4,0xbef1be48
.long 0xbf6dbf80,0xbec4bf35,0xbf6dbf80,0xbec4bf35,0xbf22bf6d,0x3e95be48,0x3f463ec4,0x3f753f7b,0xbe48bf35,0x3f553ec4,0x3e483f35,0xbf55bec4,0x3e95bec4,0x3f7f3f55,0xbf75bf6d,0x3dc9bf0e
.long 0x3f35a50d,0x3f353f80,0x3f35a50d,0x3f353f80,0x3f753ec4,0x3dc93f55,0x3e953f6d,0xbf7fbf0e,0x3f7b3f35,0xbf0e3ec4,0xbf7bbf35,0x3f0ebec4,0x3f463f6d,0xbf75be48,0x3f22bec4,0x3e953f7b
.long 0x3ec43f80,0xbf6dbf35,0x3ec43f80,0xbf6dbf35,0xbdc93f6d,0xbef1bf7b,0xbf7fbec4,0x3f62be48,0xbf0e3f35,0x3e48bf6d,0x3f0ebf35,0xbe483f6d,0xbf623ec4,0x3f46bf0e,0x3ef13f6d,0xbf22bf55
.long 0x0,0x0,0x0,0x0,0xbf46bf35,0xbf62bf55,0xbf22bf35,0xbef1bf0e,0xbf7bbf80,0xbf55bf6d,0x3f7b3f80,0x3f553f6d,0xbef1bf35,0x3dc9be48,0xbf62bf35,0xbf7fbf7b
.long 0x3ec4a50d,0x3f6d3f35,0x3ec4a50d,0x3f6d3f35,0x3f753f35,0x3f463f7b,0x3e953f35,0xbf22be48,0x3f553f80,0xbe483ec4,0xbf55bf80,0x3e48bec4,0x3dc93f35,0xbf75bf0e,0x3f7f3f35,0x3e953f55
.long 0xbf350000,0xbf35bf80,0xbf350000,0xbf35bf80,0xbf7fbf35,0x3e95bf0e,0x3dc9bf35,0x3f753f55,0xbf0ebf80,0x3f7b3ec4,0x3f0e3f80,0xbf7bbec4,0x3e95bf35,0x3f223f7b,0xbf75bf35,0x3f46be48
.long 0x3f6da50d,0xbec43f35,0x3f6da50d,0xbec43f35,0x3f623f35,0xbf7fbe48,0xbef13f35,0xbdc9bf7b,0x3e483f80,0xbf0ebf6d,0xbe48bf80,0x3f0e3f6d,0xbf223f35,0x3ef1bf55,0x3f463f35,0xbf62bf0e
.long 0x0,0x0,0x0,0x0,0xbf75bf6d,0xbf7fbf7b,0xbe95bec4,0xbdc9be48,0xbf0ebf35,0xbe48bec4,0x3f0e3f35,0x3e483ec4,0x3f223ec4,0x3f753f55,0xbf46bf6d,0xbe95bf0e
.long 0x3f6d3f80,0x3ec43f35,0x3f6d3f80,0x3ec43f35,0xbdc93ec4,0xbf62bf0e,0xbf7fbf6d,0xbef1bf55,0xbf7bbf35,0xbf0ebf6d,0x3f7b3f35,0x3f0e3f6d,0xbef1bf6d,0x3f463e48,0xbf62bec4,0xbf22bf7b
.long 0x3f35a50d,0x3f353f80,0x3f35a50d,0x3f353f80,0x3f623f6d,0xbf223e48,0xbef13ec4,0xbf46bf7b,0xbe483f35,0xbf55bf6d,0x3e48bf35,0x3f553f6d,0xbf7fbec4,0x3ef1bf0e,0x3dc93f6d,0xbf62bf55
.long 0xbec4bf80,0x3f6d3f35,0xbec4bf80,0x3f6d3f35,0x3f46bec4,0xbe953f55,0x3f223f6d,0xbf75bf0e,0x3f553f35,0xbf7bbec4,0xbf55bf35,0x3f7b3ec4,0xbe953f6d,0x3dc9bf7b,0x3f753ec4,0xbf7fbe48
.long 0xbf800000,0x3f80a50d,0xbf800000,0x3f80a50d,0x3f7fa50d,0xbf75be48,0xbdc93f80,0x3e95bf7b,0xbf7b0000,0x3f553ec4,0x3f7ba50d,0xbf55bec4,0x3f75a50d,0xbf22bf0e,0x3e95bf80,0xbf463f55
.long 0xbf6d0000,0x3ec43f35,0xbf6d0000,0x3ec43f35,0x3f62a50d,0xbdc9bf55,0xbef13f80,0x3f7fbf0e,0xbf550000,0xbe483f6d,0x3f55a50d,0x3e48bf6d,0x3f46a50d,0x3ef1bf7b,0x3f22bf80,0xbf623e48
.long 0xbf350000,0xbf353f80,0xbf350000,0xbf353f80,0x3f22a50d,0x3f62bf7b,0xbf463f80,0x3ef13e48,0xbf0e0000,0xbf7b3f6d,0x3f0ea50d,0x3f7bbf6d,0x3ef1a50d,0x3f7fbf55,0x3f62bf80,0x3dc9bf0e
.long 0xbec40000,0xbf6d3f35,0xbec40000,0xbf6d3f35,0x3e95a50d,0x3f46bf0e,0xbf753f80,0xbf223f55,0xbe480000,0xbf0e3ec4,0x3e48a50d,0x3f0ebec4,0x3dc9a50d,0x3e95be48,0x3f7fbf80,0x3f75bf7b
.long 0xbf800000,0x3f80a50d,0xbf800000,0x3f80a50d,0x3f623ec4,0xbf46bf0e,0xbef13f6d,0x3f22bf55,0xbf0ebf35,0x3e483f6d,0x3f0e3f35,0xbe48bf6d,0x3dc93f6d,0x3ef1bf7b,0x3f7fbec4,0xbf62be48
.long 0x3ec4bf80,0xbf6d3f35,0x3ec4bf80,0xbf6d3f35,0xbf463f6d,0x3f75be48,0xbf22bec4,0xbe953f7b,0x3f7bbf35,0xbf0ebec4,0xbf7b3f35,0x3f0e3ec4,0xbf753ec4,0xbdc93f55,0xbe953f6d,0x3f7fbf0e
.long 0x3f35a50d,0x3f35bf80,0x3f35a50d,0x3f35bf80,0xbe95bec4,0xbf7f3f55,0x3f75bf6d,0xbdc9bf0e,0xbe483f35,0x3f55bec4,0x3e48bf35,0xbf553ec4,0x3f22bf6d,0xbe95be48,0xbf463ec4,0xbf753f7b
.long 0xbf6d3f80,0xbec43f35,0xbf6d3f80,0xbec43f35,0x3f7fbf6d,0x3f62bf7b,0xbdc93ec4,0x3ef1be48,0xbf553f35,0xbf7b3f6d,0x3f55bf35,0x3f7bbf6d,0x3ef1bec4,0x3f22bf0e,0x3f62bf6d,0x3f46bf55
.long 0xbf800000,0x3f80a50d,0xbf800000,0x3f80a50d,0x3f223f35,0xbef1bf55,0xbf463f35,0x3f62bf0e,0x3e48bf80,0xbf0e3f6d,0xbe483f80,0x3f0ebf6d,0xbf623f35,0x3f7fbe48,0x3ef13f35,0x3dc9bf7b
.long 0x3f6da50d,0xbec4bf35,0x3f6da50d,0xbec4bf35,0xbe95bf35,0xbf223f7b,0x3f75bf35,0xbf46be48,0xbf0e3f80,0x3f7bbec4,0x3f0ebf80,0xbf7b3ec4,0x3f7fbf35,0xbe95bf0e,0xbdc9bf35,0xbf753f55
.long 0xbf350000,0xbf353f80,0xbf350000,0xbf353f80,0xbdc93f35,0x3f75bf0e,0xbf7f3f35,0xbe953f55,0x3f55bf80,0xbe48bec4,0xbf553f80,0x3e483ec4,0xbf753f35,0xbf463f7b,0xbe953f35,0x3f22be48
.long 0x3ec4a50d,0x3f6dbf35,0x3ec4a50d,0x3f6dbf35,0x3ef1bf35,0xbdc9be48,0x3f62bf35,0x3f7fbf7b,0xbf7b3f80,0xbf553f6d,0x3f7bbf80,0x3f55bf6d,0x3f46bf35,0x3f62bf55,0x3f22bf35,0x3ef1bf0e
.long 0xbf800000,0x3f80a50d,0xbf800000,0x3f80a50d,0x3e953f6d,0xbdc9bf7b,0xbf753ec4,0x3f7fbe48,0x3f55bf35,0xbf7b3ec4,0xbf553f35,0x3f7bbec4,0xbf46bec4,0x3e953f55,0xbf223f6d,0x3f75bf0e
.long 0xbec43f80,0x3f6dbf35,0xbec43f80,0x3f6dbf35,0x3f7fbec4,0xbef1bf0e,0xbdc93f6d,0x3f62bf55,0xbe48bf35,0xbf553f6d,0x3e483f35,0x3f55bf6d,0xbf623f6d,0x3f223e48,0x3ef13ec4,0x3f46bf7b
.long 0x3f35a50d,0x3f35bf80,0x3f35a50d,0x3f35bf80,0x3ef1bf6d,0xbf463e48,0x3f62bec4,0x3f22bf7b,0xbf7b3f35,0xbf0e3f6d,0x3f7bbf35,0x3f0ebf6d,0x3dc93ec4,0x3f62bf0e,0x3f7fbf6d,0x3ef1bf55
.long 0x3f6dbf80,0x3ec4bf35,0x3f6dbf80,0x3ec4bf35,0xbf223ec4,0xbf753f55,0x3f46bf6d,0x3e95bf0e,0xbf0e3f35,0xbe483ec4,0x3f0ebf35,0x3e48bec4,0x3f75bf6d,0x3f7fbf7b,0x3e95bec4,0x3dc9be48
.long 0xbf800000,0x3f80a50d,0xbf800000,0x3f80a50d,0xbf7f0000,0x3f753e48,0x3dc9bf80,0xbe953f7b,0xbf7b0000,0x3f553ec4,0x3f7ba50d,0xbf55bec4,0xbf750000,0x3f223f0e,0xbe953f80,0x3f46bf55
.long 0xbf6d0000,0x3ec43f35,0xbf6d0000,0x3ec43f35,0xbf620000,0x3dc93f55,0x3ef1bf80,0xbf7f3f0e,0xbf550000,0xbe483f6d,0x3f55a50d,0x3e48bf6d,0xbf460000,0xbef13f7b,0xbf223f80,0x3f62be48
.long 0xbf350000,0xbf353f80,0xbf350000,0xbf353f80,0xbf220000,0xbf623f7b,0x3f46bf80,0xbef1be48,0xbf0e0000,0xbf7b3f6d,0x3f0ea50d,0x3f7bbf6d,0xbef10000,0xbf7f3f55,0xbf623f80,0xbdc93f0e
.long 0xbec40000,0xbf6d3f35,0xbec40000,0xbf6d3f35,0xbe950000,0xbf463f0e,0x3f75bf80,0x3f22bf55,0xbe480000,0xbf0e3ec4,0x3e48a50d,0x3f0ebec4,0xbdc90000,0xbe953e48,0xbf7f3f80,0xbf753f7b
.long 0xbf800000,0x3f80a50d,0xbf800000,0x3f80a50d,0xbf62bec4,0x3f463f0e,0x3ef1bf6d,0xbf223f55,0xbf0ebf35,0x3e483f6d,0x3f0e3f35,0xbe48bf6d,0xbdc9bf6d,0xbef13f7b,0xbf7f3ec4,0x3f623e48
.long 0x3ec4bf80,0xbf6d3f35,0x3ec4bf80,0xbf6d3f35,0x3f46bf6d,0xbf753e48,0x3f223ec4,0x3e95bf7b,0x3f7bbf35,0xbf0ebec4,0xbf7b3f35,0x3f0e3ec4,0x3f75bec4,0x3dc9bf55,0x3e95bf6d,0xbf7f3f0e
.long 0x3f35a50d,0x3f35bf80,0x3f35a50d,0x3f35bf80,0x3e953ec4,0x3f7fbf55,0xbf753f6d,0x3dc93f0e,0xbe483f35,0x3f55bec4,0x3e48bf35,0xbf553ec4,0xbf223f6d,0x3e953e48,0x3f46bec4,0x3f75bf7b
.long 0xbf6d3f80,0xbec43f35,0xbf6d3f80,0xbec43f35,0xbf7f3f6d,0xbf623f7b,0x3dc9bec4,0xbef13e48,0xbf553f35,0xbf7b3f6d,0x3f55bf35,0x3f7bbf6d,0xbef13ec4,0xbf223f0e,0xbf623f6d,0xbf463f55
.long 0xbf800000,0x3f80a50d,0xbf800000,0x3f80a50d,0xbf22bf35,0x3ef13f55,0x3f46bf35,0xbf623f0e,0x3e48bf80,0xbf0e3f6d,0xbe483f80,0x3f0ebf6d,0x3f62bf35,0xbf7f3e48,0xbef1bf35,0xbdc93f7b
.long 0x3f6da50d,0xbec4bf35,0x3f6da50d,0xbec4bf35,0x3e953f35,0x3f22bf7b,0xbf753f35,0x3f463e48,0xbf0e3f80,0x3f7bbec4,0x3f0ebf80,0xbf7b3ec4,0xbf7f3f35,0x3e953f0e,0x3dc93f35,0x3f75bf55
.long 0xbf350000,0xbf353f80,0xbf350000,0xbf353f80,0x3dc9bf35,0xbf753f0e,0x3f7fbf35,0x3e95bf55,0x3f55bf80,0xbe48bec4,0xbf553f80,0x3e483ec4,0x3f75bf35,0x3f46bf7b,0x3e95bf35,0xbf223e48
.long 0x3ec4a50d,0x3f6dbf35,0x3ec4a50d,0x3f6dbf35,0xbef13f35,0x3dc93e48,0xbf623f35,0xbf7f3f7b,0xbf7b3f80,0xbf553f6d,0x3f7bbf80,0x3f55bf6d,0xbf463f35,0xbf623f55,0xbf223f35,0xbef13f0e
.long 0xbf800000,0x3f80a50d,0xbf800000,0x3f80a50d,0xbe95bf6d,0x3dc93f7b,0x3f75bec4,0xbf7f3e48,0x3f55bf35,0xbf7b3ec4,0xbf553f35,0x3f7bbec4,0x3f463ec4,0xbe95bf55,0x3f22bf6d,0xbf753f0e
.long 0xbec43f80,0x3f6dbf35,0xbec43f80,0x3f6dbf35,0xbf7f3ec4,0x3ef13f0e,0x3dc9bf6d,0xbf623f55,0xbe48bf35,0xbf553f6d,0x3e483f35,0x3f55bf6d,0x3f62bf6d,0xbf22be48,0xbef1bec4,0xbf463f7b
.long 0x3f35a50d,0x3f35bf80,0x3f35a50d,0x3f35bf80,0xbef13f6d,0x3f46be48,0xbf623ec4,0xbf223f7b,0xbf7b3f35,0xbf0e3f6d,0x3f7bbf35,0x3f0ebf6d,0xbdc9bec4,0xbf623f0e,0xbf7f3f6d,0xbef13f55
.long 0x3f6dbf80,0x3ec4bf35,0x3f6dbf80,0x3ec4bf35,0x3f22bec4,0x3f75bf55,0xbf463f6d,0xbe953f0e,0xbf0e3f35,0xbe483ec4,0x3f0ebf35,0x3e48bec4,0xbf753f6d,0xbf7f3f7b,0xbe953ec4,0xbdc93e48
.long 0x250d8000,0x250d8000,0x250d8000,0x250d8000,0x3dc9250d,0x3e95be48,0x3f7fbf80,0x3f75bf7b,0xbe488000,0xbf0e3ec4,0x3e48250d,0x3f0ebec4,0x3e95250d,0x3f46bf0e,0xbf753f80,0xbf223f55
.long 0xbec48000,0xbf6d3f35,0xbec48000,0xbf6d3f35,0x3ef1250d,0x3f7fbf55,0x3f62bf80,0x3dc9bf0e,0xbf0e8000,0xbf7b3f6d,0x3f0e250d,0x3f7bbf6d,0x3f22250d,0x3f62bf7b,0xbf463f80,0x3ef13e48
.long 0xbf358000,0xbf353f80,0xbf358000,0xbf353f80,0x3f46250d,0x3ef1bf7b,0x3f22bf80,0xbf623e48,0xbf558000,0xbe483f6d,0x3f55250d,0x3e48bf6d,0x3f62250d,0xbdc9bf55,0xbef13f80,0x3f7fbf0e
.long 0xbf6d8000,0x3ec43f35,0xbf6d8000,0x3ec43f35,0x3f75250d,0xbf22bf0e,0x3e95bf80,0xbf463f55,0xbf7b8000,0x3f553ec4,0x3f7b250d,0xbf55bec4,0x3f7f250d,0xbf75be48,0xbdc93f80,0x3e95bf7b
.long 0x250d8000,0x250d8000,0x250d8000,0x250d8000,0x3ef1bec4,0x3f22bf0e,0x3f62bf6d,0x3f46bf55,0xbf553f35,0xbf7b3f6d,0x3f55bf35,0x3f7bbf6d,0x3f7fbf6d,0x3f62bf7b,0xbdc93ec4,0x3ef1be48
.long 0xbf6d3f80,0xbec43f35,0xbf6d3f80,0xbec43f35,0x3f22bf6d,0xbe95be48,0xbf463ec4,0xbf753f7b,0xbe483f35,0x3f55bec4,0x3e48bf35,0xbf553ec4,0xbe95bec4,0xbf7f3f55,0x3f75bf6d,0xbdc9bf0e
.long 0x3f35250d,0x3f35bf80,0x3f35250d,0x3f35bf80,0xbf753ec4,0xbdc93f55,0xbe953f6d,0x3f7fbf0e,0x3f7bbf35,0xbf0ebec4,0xbf7b3f35,0x3f0e3ec4,0xbf463f6d,0x3f75be48,0xbf22bec4,0xbe953f7b
.long 0x3ec4bf80,0xbf6d3f35,0x3ec4bf80,0xbf6d3f35,0x3dc93f6d,0x3ef1bf7b,0x3f7fbec4,0xbf62be48,0xbf0ebf35,0x3e483f6d,0x3f0e3f35,0xbe48bf6d,0x3f623ec4,0xbf46bf0e,0xbef13f6d,0x3f22bf55
.long 0x250d8000,0x250d8000,0x250d8000,0x250d8000,0x3f46bf35,0x3f62bf55,0x3f22bf35,0x3ef1bf0e,0xbf7b3f80,0xbf553f6d,0x3f7bbf80,0x3f55bf6d,0x3ef1bf35,0xbdc9be48,0x3f62bf35,0x3f7fbf7b
.long 0x3ec4250d,0x3f6dbf35,0x3ec4250d,0x3f6dbf35,0xbf753f35,0xbf463f7b,0xbe953f35,0x3f22be48,0x3f55bf80,0xbe48bec4,0xbf553f80,0x3e483ec4,0xbdc93f35,0x3f75bf0e,0xbf7f3f35,0xbe953f55
.long 0xbf358000,0xbf353f80,0xbf358000,0xbf353f80,0x3f7fbf35,0xbe95bf0e,0xbdc9bf35,0xbf753f55,0xbf0e3f80,0x3f7bbec4,0x3f0ebf80,0xbf7b3ec4,0xbe95bf35,0xbf223f7b,0x3f75bf35,0xbf46be48
.long 0x3f6d250d,0xbec4bf35,0x3f6d250d,0xbec4bf35,0xbf623f35,0x3f7fbe48,0x3ef13f35,0x3dc9bf7b,0x3e48bf80,0xbf0e3f6d,0xbe483f80,0x3f0ebf6d,0x3f223f35,0xbef1bf55,0xbf463f35,0x3f62bf0e
.long 0x250d8000,0x250d8000,0x250d8000,0x250d8000,0x3f75bf6d,0x3f7fbf7b,0x3e95bec4,0x3dc9be48,0xbf0e3f35,0xbe483ec4,0x3f0ebf35,0x3e48bec4,0xbf223ec4,0xbf753f55,0x3f46bf6d,0x3e95bf0e
.long 0x3f6dbf80,0x3ec4bf35,0x3f6dbf80,0x3ec4bf35,0x3dc93ec4,0x3f62bf0e,0x3f7fbf6d,0x3ef1bf55,0xbf7b3f35,0xbf0e3f6d,0x3f7bbf35,0x3f0ebf6d,0x3ef1bf6d,0xbf463e48,0x3f62bec4,0x3f22bf7b
.long 0x3f35250d,0x3f35bf80,0x3f35250d,0x3f35bf80,0xbf623f6d,0x3f223e48,0x3ef13ec4,0x3f46bf7b,0xbe48bf35,0xbf553f6d,0x3e483f35,0x3f55bf6d,0x3f7fbec4,0xbef1bf0e,0xbdc93f6d,0x3f62bf55
.long 0xbec43f80,0x3f6dbf35,0xbec43f80,0x3f6dbf35,0xbf46bec4,0x3e953f55,0xbf223f6d,0x3f75bf0e,0x3f55bf35,0xbf7b3ec4,0xbf553f35,0x3f7bbec4,0x3e953f6d,0xbdc9bf7b,0xbf753ec4,0x3f7fbe48
.long 0x250d8000,0x250d8000,0x250d8000,0x250d8000,0xbdc98000,0xbe953e48,0xbf7f3f80,0xbf753f7b,0xbe488000,0xbf0e3ec4,0x3e48250d,0x3f0ebec4,0xbe958000,0xbf463f0e,0x3f75bf80,0x3f22bf55
.long 0xbec48000,0xbf6d3f35,0xbec48000,0xbf6d3f35,0xbef18000,0xbf7f3f55,0xbf623f80,0xbdc93f0e,0xbf0e8000,0xbf7b3f6d,0x3f0e250d,0x3f7bbf6d,0xbf228000,0xbf623f7b,0x3f46bf80,0xbef1be48
.long 0xbf358000,0xbf353f80,0xbf358000,0xbf353f80,0xbf468000,0xbef13f7b,0xbf223f80,0x3f62be48,0xbf558000,0xbe483f6d,0x3f55250d,0x3e48bf6d,0xbf628000,0x3dc93f55,0x3ef1bf80,0xbf7f3f0e
.long 0xbf6d8000,0x3ec43f35,0xbf6d8000,0x3ec43f35,0xbf758000,0x3f223f0e,0xbe953f80,0x3f46bf55,0xbf7b8000,0x3f553ec4,0x3f7b250d,0xbf55bec4,0xbf7f8000,0x3f753e48,0x3dc9bf80,0xbe953f7b
.long 0x250d8000,0x250d8000,0x250d8000,0x250d8000,0xbef13ec4,0xbf223f0e,0xbf623f6d,0xbf463f55,0xbf553f35,0xbf7b3f6d,0x3f55bf35,0x3f7bbf6d,0xbf7f3f6d,0xbf623f7b,0x3dc9bec4,0xbef13e48
.long 0xbf6d3f80,0xbec43f35,0xbf6d3f80,0xbec43f35,0xbf223f6d,0x3e953e48,0x3f46bec4,0x3f75bf7b,0xbe483f35,0x3f55bec4,0x3e48bf35,0xbf553ec4,0x3e953ec4,0x3f7fbf55,0xbf753f6d,0x3dc93f0e
.long 0x3f35250d,0x3f35bf80,0x3f35250d,0x3f35bf80,0x3f75bec4,0x3dc9bf55,0x3e95bf6d,0xbf7f3f0e,0x3f7bbf35,0xbf0ebec4,0xbf7b3f35,0x3f0e3ec4,0x3f46bf6d,0xbf753e48,0x3f223ec4,0x3e95bf7b
.long 0x3ec4bf80,0xbf6d3f35,0x3ec4bf80,0xbf6d3f35,0xbdc9bf6d,0xbef13f7b,0xbf7f3ec4,0x3f623e48,0xbf0ebf35,0x3e483f6d,0x3f0e3f35,0xbe48bf6d,0xbf62bec4,0x3f463f0e,0x3ef1bf6d,0xbf223f55
.long 0x250d8000,0x250d8000,0x250d8000,0x250d8000,0xbf463f35,0xbf623f55,0xbf223f35,0xbef13f0e,0xbf7b3f80,0xbf553f6d,0x3f7bbf80,0x3f55bf6d,0xbef13f35,0x3dc93e48,0xbf623f35,0xbf7f3f7b
.long 0x3ec4250d,0x3f6dbf35,0x3ec4250d,0x3f6dbf35,0x3f75bf35,0x3f46bf7b,0x3e95bf35,0xbf223e48,0x3f55bf80,0xbe48bec4,0xbf553f80,0x3e483ec4,0x3dc9bf35,0xbf753f0e,0x3f7fbf35,0x3e95bf55
.long 0xbf358000,0xbf353f80,0xbf358000,0xbf353f80,0xbf7f3f35,0x3e953f0e,0x3dc93f35,0x3f75bf55,0xbf0e3f80,0x3f7bbec4,0x3f0ebf80,0xbf7b3ec4,0x3e953f35,0x3f22bf7b,0xbf753f35,0x3f463e48
.long 0x3f6d250d,0xbec4bf35,0x3f6d250d,0xbec4bf35,0x3f62bf35,0xbf7f3e48,0xbef1bf35,0xbdc93f7b,0x3e48bf80,0xbf0e3f6d,0xbe483f80,0x3f0ebf6d,0xbf22bf35,0x3ef13f55,0x3f46bf35,0xbf623f0e
.long 0x250d8000,0x250d8000,0x250d8000,0x250d8000,0xbf753f6d,0xbf7f3f7b,0xbe953ec4,0xbdc93e48,0xbf0e3f35,0xbe483ec4,0x3f0ebf35,0x3e48bec4,0x3f22bec4,0x3f75bf55,0xbf463f6d,0xbe953f0e
.long 0x3f6dbf80,0x3ec4bf35,0x3f6dbf80,0x3ec4bf35,0xbdc9bec4,0xbf623f0e,0xbf7f3f6d,0xbef13f55,0xbf7b3f35,0xbf0e3f6d,0x3f7bbf35,0x3f0ebf6d,0xbef13f6d,0x3f46be48,0xbf623ec4,0xbf223f7b
.long 0x3f35250d,0x3f35bf80,0x3f35250d,0x3f35bf80,0x3f62bf6d,0xbf22be48,0xbef1bec4,0xbf463f7b,0xbe48bf35,0xbf553f6d,0x3e483f35,0x3f55bf6d,0xbf7f3ec4,0x3ef13f0e,0x3dc9bf6d,0xbf623f55
.long 0xbec43f80,0x3f6dbf35,0xbec43f80,0x3f6dbf35,0x3f463ec4,0xbe95bf55,0x3f22bf6d,0xbf753f0e,0x3f55bf35,0xbf7b3ec4,0xbf553f35,0x3f7bbec4,0xbe95bf6d,0x3dc93f7b,0x3f75bec4,0xbf7f3e48
.long 0xbf808000,0x3f80250d,0xbf808000,0x3f80250d,0x3f7f250d,0xbf753e48,0xbdc9bf80,0x3e953f7b,0xbf7b8000,0x3f55bec4,0x3f7b250d,0xbf553ec4,0x3f75250d,0xbf223f0e,0x3e953f80,0xbf46bf55
.long 0xbf6d8000,0x3ec4bf35,0xbf6d8000,0x3ec4bf35,0x3f62250d,0xbdc93f55,0xbef1bf80,0x3f7f3f0e,0xbf558000,0xbe48bf6d,0x3f55250d,0x3e483f6d,0x3f46250d,0x3ef13f7b,0x3f223f80,0xbf62be48
.long 0xbf358000,0xbf35bf80,0xbf358000,0xbf35bf80,0x3f22250d,0x3f623f7b,0xbf46bf80,0x3ef1be48,0xbf0e8000,0xbf7bbf6d,0x3f0e250d,0x3f7b3f6d,0x3ef1250d,0x3f7f3f55,0x3f623f80,0x3dc93f0e
.long 0xbec48000,0xbf6dbf35,0xbec48000,0xbf6dbf35,0x3e95250d,0x3f463f0e,0xbf75bf80,0xbf22bf55,0xbe488000,0xbf0ebec4,0x3e48250d,0x3f0e3ec4,0x3dc9250d,0x3e953e48,0x3f7f3f80,0x3f753f7b
.long 0xbf808000,0x3f80250d,0xbf808000,0x3f80250d,0x3f62bec4,0xbf463f0e,0xbef1bf6d,0x3f223f55,0xbf0e3f35,0x3e48bf6d,0x3f0ebf35,0xbe483f6d,0x3dc9bf6d,0x3ef13f7b,0x3f7f3ec4,0xbf623e48
.long 0x3ec43f80,0xbf6dbf35,0x3ec43f80,0xbf6dbf35,0xbf46bf6d,0x3f753e48,0xbf223ec4,0xbe95bf7b,0x3f7b3f35,0xbf0e3ec4,0xbf7bbf35,0x3f0ebec4,0xbf75bec4,0xbdc9bf55,0xbe95bf6d,0x3f7f3f0e
.long 0x3f35250d,0x3f353f80,0x3f35250d,0x3f353f80,0xbe953ec4,0xbf7fbf55,0x3f753f6d,0xbdc93f0e,0xbe48bf35,0x3f553ec4,0x3e483f35,0xbf55bec4,0x3f223f6d,0xbe953e48,0xbf46bec4,0xbf75bf7b
.long 0xbf6dbf80,0xbec4bf35,0xbf6dbf80,0xbec4bf35,0x3f7f3f6d,0x3f623f7b,0xbdc9bec4,0x3ef13e48,0xbf55bf35,0xbf7bbf6d,0x3f553f35,0x3f7b3f6d,0x3ef13ec4,0x3f223f0e,0x3f623f6d,0x3f463f55
.long 0xbf808000,0x3f80250d,0xbf808000,0x3f80250d,0x3f22bf35,0xbef13f55,0xbf46bf35,0x3f623f0e,0x3e483f80,0xbf0ebf6d,0xbe48bf80,0x3f0e3f6d,0xbf62bf35,0x3f7f3e48,0x3ef1bf35,0x3dc93f7b
.long 0x3f6d250d,0xbec43f35,0x3f6d250d,0xbec43f35,0xbe953f35,0xbf22bf7b,0x3f753f35,0xbf463e48,0xbf0ebf80,0x3f7b3ec4,0x3f0e3f80,0xbf7bbec4,0x3f7f3f35,0xbe953f0e,0xbdc93f35,0xbf75bf55
.long 0xbf358000,0xbf35bf80,0xbf358000,0xbf35bf80,0xbdc9bf35,0x3f753f0e,0xbf7fbf35,0xbe95bf55,0x3f553f80,0xbe483ec4,0xbf55bf80,0x3e48bec4,0xbf75bf35,0xbf46bf7b,0xbe95bf35,0x3f223e48
.long 0x3ec4250d,0x3f6d3f35,0x3ec4250d,0x3f6d3f35,0x3ef13f35,0xbdc93e48,0x3f623f35,0x3f7f3f7b,0xbf7bbf80,0xbf55bf6d,0x3f7b3f80,0x3f553f6d,0x3f463f35,0x3f623f55,0x3f223f35,0x3ef13f0e
.long 0xbf808000,0x3f80250d,0xbf808000,0x3f80250d,0x3e95bf6d,0xbdc93f7b,0xbf75bec4,0x3f7f3e48,0x3f553f35,0xbf7bbec4,0xbf55bf35,0x3f7b3ec4,0xbf463ec4,0x3e95bf55,0xbf22bf6d,0x3f753f0e
.long 0xbec4bf80,0x3f6d3f35,0xbec4bf80,0x3f6d3f35,0x3f7f3ec4,0xbef13f0e,0xbdc9bf6d,0x3f623f55,0xbe483f35,0xbf55bf6d,0x3e48bf35,0x3f553f6d,0xbf62bf6d,0x3f22be48,0x3ef1bec4,0x3f463f7b
.long 0x3f35250d,0x3f353f80,0x3f35250d,0x3f353f80,0x3ef13f6d,0xbf46be48,0x3f623ec4,0x3f223f7b,0xbf7bbf35,0xbf0ebf6d,0x3f7b3f35,0x3f0e3f6d,0x3dc9bec4,0x3f623f0e,0x3f7f3f6d,0x3ef13f55
.long 0x3f6d3f80,0x3ec43f35,0x3f6d3f80,0x3ec43f35,0xbf22bec4,0xbf75bf55,0x3f463f6d,0x3e953f0e,0xbf0ebf35,0xbe48bec4,0x3f0e3f35,0x3e483ec4,0x3f753f6d,0x3f7f3f7b,0x3e953ec4,0x3dc93e48
.long 0xbf808000,0x3f80250d,0xbf808000,0x3f80250d,0xbf7f8000,0x3f75be48,0x3dc93f80,0xbe95bf7b,0xbf7b8000,0x3f55bec4,0x3f7b250d,0xbf553ec4,0xbf758000,0x3f22bf0e,0xbe95bf80,0x3f463f55
.long 0xbf6d8000,0x3ec4bf35,0xbf6d8000,0x3ec4bf35,0xbf628000,0x3dc9bf55,0x3ef13f80,0xbf7fbf0e,0xbf558000,0xbe48bf6d,0x3f55250d,0x3e483f6d,0xbf468000,0xbef1bf7b,0xbf22bf80,0x3f623e48
.long 0xbf358000,0xbf35bf80,0xbf358000,0xbf35bf80,0xbf228000,0xbf62bf7b,0x3f463f80,0xbef13e48,0xbf0e8000,0xbf7bbf6d,0x3f0e250d,0x3f7b3f6d,0xbef18000,0xbf7fbf55,0xbf62bf80,0xbdc9bf0e
.long 0xbec48000,0xbf6dbf35,0xbec48000,0xbf6dbf35,0xbe958000,0xbf46bf0e,0x3f753f80,0x3f223f55,0xbe488000,0xbf0ebec4,0x3e48250d,0x3f0e3ec4,0xbdc98000,0xbe95be48,0xbf7fbf80,0xbf75bf7b
.long 0xbf808000,0x3f80250d,0xbf808000,0x3f80250d,0xbf623ec4,0x3f46bf0e,0x3ef13f6d,0xbf22bf55,0xbf0e3f35,0x3e48bf6d,0x3f0ebf35,0xbe483f6d,0xbdc93f6d,0xbef1bf7b,0xbf7fbec4,0x3f62be48
.long 0x3ec43f80,0xbf6dbf35,0x3ec43f80,0xbf6dbf35,0x3f463f6d,0xbf75be48,0x3f22bec4,0x3e953f7b,0x3f7b3f35,0xbf0e3ec4,0xbf7bbf35,0x3f0ebec4,0x3f753ec4,0x3dc93f55,0x3e953f6d,0xbf7fbf0e
.long 0x3f35250d,0x3f353f80,0x3f35250d,0x3f353f80,0x3e95bec4,0x3f7f3f55,0xbf75bf6d,0x3dc9bf0e,0xbe48bf35,0x3f553ec4,0x3e483f35,0xbf55bec4,0xbf22bf6d,0x3e95be48,0x3f463ec4,0x3f753f7b
.long 0xbf6dbf80,0xbec4bf35,0xbf6dbf80,0xbec4bf35,0xbf7fbf6d,0xbf62bf7b,0x3dc93ec4,0xbef1be48,0xbf55bf35,0xbf7bbf6d,0x3f553f35,0x3f7b3f6d,0xbef1bec4,0xbf22bf0e,0xbf62bf6d,0xbf46bf55
.long 0xbf808000,0x3f80250d,0xbf808000,0x3f80250d,0xbf223f35,0x3ef1bf55,0x3f463f35,0xbf62bf0e,0x3e483f80,0xbf0ebf6d,0xbe48bf80,0x3f0e3f6d,0x3f623f35,0xbf7fbe48,0xbef13f35,0xbdc9bf7b
.long 0x3f6d250d,0xbec43f35,0x3f6d250d,0xbec43f35,0x3e95bf35,0x3f223f7b,0xbf75bf35,0x3f46be48,0xbf0ebf80,0x3f7b3ec4,0x3f0e3f80,0xbf7bbec4,0xbf7fbf35,0x3e95bf0e,0x3dc9bf35,0x3f753f55
.long 0xbf358000,0xbf35bf80,0xbf358000,0xbf35bf80,0x3dc93f35,0xbf75bf0e,0x3f7f3f35,0x3e953f55,0x3f553f80,0xbe483ec4,0xbf55bf80,0x3e48bec4,0x3f753f35,0x3f463f7b,0x3e953f35,0xbf22be48
.long 0x3ec4250d,0x3f6d3f35,0x3ec4250d,0x3f6d3f35,0xbef1bf35,0x3dc9be48,0xbf62bf35,0xbf7fbf7b,0xbf7bbf80,0xbf55bf6d,0x3f7b3f80,0x3f553f6d,0xbf46bf35,0xbf62bf55,0xbf22bf35,0xbef1bf0e
.long 0xbf808000,0x3f80250d,0xbf808000,0x3f80250d,0xbe953f6d,0x3dc9bf7b,0x3f753ec4,0xbf7fbe48,0x3f553f35,0xbf7bbec4,0xbf55bf35,0x3f7b3ec4,0x3f46bec4,0xbe953f55,0x3f223f6d,0xbf75bf0e
.long 0xbec4bf80,0x3f6d3f35,0xbec4bf80,0x3f6d3f35,0xbf7fbec4,0x3ef1bf0e,0x3dc93f6d,0xbf62bf55,0xbe483f35,0xbf55bf6d,0x3e48bf35,0x3f553f6d,0x3f623f6d,0xbf223e48,0xbef13ec4,0xbf46bf7b
.long 0x3f35250d,0x3f353f80,0x3f35250d,0x3f353f80,0xbef1bf6d,0x3f463e48,0xbf62bec4,0xbf22bf7b,0xbf7bbf35,0xbf0ebf6d,0x3f7b3f35,0x3f0e3f6d,0xbdc93ec4,0xbf62bf0e,0xbf7fbf6d,0xbef1bf55
.long 0x3f6d3f80,0x3ec43f35,0x3f6d3f80,0x3ec43f35,0x3f223ec4,0x3f753f55,0xbf46bf6d,0xbe95bf0e,0xbf0ebf35,0xbe48bec4,0x3f0e3f35,0x3e483ec4,0xbf75bf6d,0xbf7fbf7b,0xbe95bec4,0xbdc9be48
.long 0x80008000,0x80008000,0x80008000,0x80008000,0xbdc9250d,0xbe95be48,0xbf7fbf80,0xbf75bf7b,0x3e488000,0x3f0e3ec4,0xbe48250d,0xbf0ebec4,0xbe95250d,0xbf46bf0e,0x3f753f80,0x3f223f55
.long 0x3ec48000,0x3f6d3f35,0x3ec48000,0x3f6d3f35,0xbef1250d,0xbf7fbf55,0xbf62bf80,0xbdc9bf0e,0x3f0e8000,0x3f7b3f6d,0xbf0e250d,0xbf7bbf6d,0xbf22250d,0xbf62bf7b,0x3f463f80,0xbef13e48
.long 0x3f358000,0x3f353f80,0x3f358000,0x3f353f80,0xbf46250d,0xbef1bf7b,0xbf22bf80,0x3f623e48,0x3f558000,0x3e483f6d,0xbf55250d,0xbe48bf6d,0xbf62250d,0x3dc9bf55,0x3ef13f80,0xbf7fbf0e
.long 0x3f6d8000,0xbec43f35,0x3f6d8000,0xbec43f35,0xbf75250d,0x3f22bf0e,0xbe95bf80,0x3f463f55,0x3f7b8000,0xbf553ec4,0xbf7b250d,0x3f55bec4,0xbf7f250d,0x3f75be48,0x3dc93f80,0xbe95bf7b
.long 0x80008000,0x80008000,0x80008000,0x80008000,0xbef1bec4,0xbf22bf0e,0xbf62bf6d,0xbf46bf55,0x3f553f35,0x3f7b3f6d,0xbf55bf35,0xbf7bbf6d,0xbf7fbf6d,0xbf62bf7b,0x3dc93ec4,0xbef1be48
.long 0x3f6d3f80,0x3ec43f35,0x3f6d3f80,0x3ec43f35,0xbf22bf6d,0x3e95be48,0x3f463ec4,0x3f753f7b,0x3e483f35,0xbf55bec4,0xbe48bf35,0x3f553ec4,0x3e95bec4,0x3f7f3f55,0xbf75bf6d,0x3dc9bf0e
.long 0xbf35250d,0xbf35bf80,0xbf35250d,0xbf35bf80,0x3f753ec4,0x3dc93f55,0x3e953f6d,0xbf7fbf0e,0xbf7bbf35,0x3f0ebec4,0x3f7b3f35,0xbf0e3ec4,0x3f463f6d,0xbf75be48,0x3f22bec4,0x3e953f7b
.long 0xbec4bf80,0x3f6d3f35,0xbec4bf80,0x3f6d3f35,0xbdc93f6d,0xbef1bf7b,0xbf7fbec4,0x3f62be48,0x3f0ebf35,0xbe483f6d,0xbf0e3f35,0x3e48bf6d,0xbf623ec4,0x3f46bf0e,0x3ef13f6d,0xbf22bf55
.long 0x80008000,0x80008000,0x80008000,0x80008000,0xbf46bf35,0xbf62bf55,0xbf22bf35,0xbef1bf0e,0x3f7b3f80,0x3f553f6d,0xbf7bbf80,0xbf55bf6d,0xbef1bf35,0x3dc9be48,0xbf62bf35,0xbf7fbf7b
.long 0xbec4250d,0xbf6dbf35,0xbec4250d,0xbf6dbf35,0x3f753f35,0x3f463f7b,0x3e953f35,0xbf22be48,0xbf55bf80,0x3e48bec4,0x3f553f80,0xbe483ec4,0x3dc93f35,0xbf75bf0e,0x3f7f3f35,0x3e953f55
.long 0x3f358000,0x3f353f80,0x3f358000,0x3f353f80,0xbf7fbf35,0x3e95bf0e,0x3dc9bf35,0x3f753f55,0x3f0e3f80,0xbf7bbec4,0xbf0ebf80,0x3f7b3ec4,0x3e95bf35,0x3f223f7b,0xbf75bf35,0x3f46be48
.long 0xbf6d250d,0x3ec4bf35,0xbf6d250d,0x3ec4bf35,0x3f623f35,0xbf7fbe48,0xbef13f35,0xbdc9bf7b,0xbe48bf80,0x3f0e3f6d,0x3e483f80,0xbf0ebf6d,0xbf223f35,0x3ef1bf55,0x3f463f35,0xbf62bf0e
.long 0x80008000,0x80008000,0x80008000,0x80008000,0xbf75bf6d,0xbf7fbf7b,0xbe95bec4,0xbdc9be48,0x3f0e3f35,0x3e483ec4,0xbf0ebf35,0xbe48bec4,0x3f223ec4,0x3f753f55,0xbf46bf6d,0xbe95bf0e
.long 0xbf6dbf80,0xbec4bf35,0xbf6dbf80,0xbec4bf35,0xbdc93ec4,0xbf62bf0e,0xbf7fbf6d,0xbef1bf55,0x3f7b3f35,0x3f0e3f6d,0xbf7bbf35,0xbf0ebf6d,0xbef1bf6d,0x3f463e48,0xbf62bec4,0xbf22bf7b
.long 0xbf35250d,0xbf35bf80,0xbf35250d,0xbf35bf80,0x3f623f6d,0xbf223e48,0xbef13ec4,0xbf46bf7b,0x3e48bf35,0x3f553f6d,0xbe483f35,0xbf55bf6d,0xbf7fbec4,0x3ef1bf0e,0x3dc93f6d,0xbf62bf55
.long 0x3ec43f80,0xbf6dbf35,0x3ec43f80,0xbf6dbf35,0x3f46bec4,0xbe953f55,0x3f223f6d,0xbf75bf0e,0xbf55bf35,0x3f7b3ec4,0x3f553f35,0xbf7bbec4,0xbe953f6d,0x3dc9bf7b,0x3f753ec4,0xbf7fbe48
.long 0x80008000,0x80008000,0x80008000,0x80008000,0x3dc98000,0x3e953e48,0x3f7f3f80,0x3f753f7b,0x3e488000,0x3f0e3ec4,0xbe48250d,0xbf0ebec4,0x3e958000,0x3f463f0e,0xbf75bf80,0xbf22bf55
.long 0x3ec48000,0x3f6d3f35,0x3ec48000,0x3f6d3f35,0x3ef18000,0x3f7f3f55,0x3f623f80,0x3dc93f0e,0x3f0e8000,0x3f7b3f6d,0xbf0e250d,0xbf7bbf6d,0x3f228000,0x3f623f7b,0xbf46bf80,0x3ef1be48
.long 0x3f358000,0x3f353f80,0x3f358000,0x3f353f80,0x3f468000,0x3ef13f7b,0x3f223f80,0xbf62be48,0x3f558000,0x3e483f6d,0xbf55250d,0xbe48bf6d,0x3f628000,0xbdc93f55,0xbef1bf80,0x3f7f3f0e
.long 0x3f6d8000,0xbec43f35,0x3f6d8000,0xbec43f35,0x3f758000,0xbf223f0e,0x3e953f80,0xbf46bf55,0x3f7b8000,0xbf553ec4,0xbf7b250d,0x3f55bec4,0x3f7f8000,0xbf753e48,0xbdc9bf80,0x3e953f7b
.long 0x80008000,0x80008000,0x80008000,0x80008000,0x3ef13ec4,0x3f223f0e,0x3f623f6d,0x3f463f55,0x3f553f35,0x3f7b3f6d,0xbf55bf35,0xbf7bbf6d,0x3f7f3f6d,0x3f623f7b,0xbdc9bec4,0x3ef13e48
.long 0x3f6d3f80,0x3ec43f35,0x3f6d3f80,0x3ec43f35,0x3f223f6d,0xbe953e48,0xbf46bec4,0xbf75bf7b,0x3e483f35,0xbf55bec4,0xbe48bf35,0x3f553ec4,0xbe953ec4,0xbf7fbf55,0x3f753f6d,0xbdc93f0e
.long 0xbf35250d,0xbf35bf80,0xbf35250d,0xbf35bf80,0xbf75bec4,0xbdc9bf55,0xbe95bf6d,0x3f7f3f0e,0xbf7bbf35,0x3f0ebec4,0x3f7b3f35,0xbf0e3ec4,0xbf46bf6d,0x3f753e48,0xbf223ec4,0xbe95bf7b
.long 0xbec4bf80,0x3f6d3f35,0xbec4bf80,0x3f6d3f35,0x3dc9bf6d,0x3ef13f7b,0x3f7f3ec4,0xbf623e48,0x3f0ebf35,0xbe483f6d,0xbf0e3f35,0x3e48bf6d,0x3f62bec4,0xbf463f0e,0xbef1bf6d,0x3f223f55
.long 0x80008000,0x80008000,0x80008000,0x80008000,0x3f463f35,0x3f623f55,0x3f223f35,0x3ef13f0e,0x3f7b3f80,0x3f553f6d,0xbf7bbf80,0xbf55bf6d,0x3ef13f35,0xbdc93e48,0x3f623f35,0x3f7f3f7b
.long 0xbec4250d,0xbf6dbf35,0xbec4250d,0xbf6dbf35,0xbf75bf35,0xbf46bf7b,0xbe95bf35,0x3f223e48,0xbf55bf80,0x3e48bec4,0x3f553f80,0xbe483ec4,0xbdc9bf35,0x3f753f0e,0xbf7fbf35,0xbe95bf55
.long 0x3f358000,0x3f353f80,0x3f358000,0x3f353f80,0x3f7f3f35,0xbe953f0e,0xbdc93f35,0xbf75bf55,0x3f0e3f80,0xbf7bbec4,0xbf0ebf80,0x3f7b3ec4,0xbe953f35,0xbf22bf7b,0x3f753f35,0xbf463e48
.long 0xbf6d250d,0x3ec4bf35,0xbf6d250d,0x3ec4bf35,0xbf62bf35,0x3f7f3e48,0x3ef1bf35,0x3dc93f7b,0xbe48bf80,0x3f0e3f6d,0x3e483f80,0xbf0ebf6d,0x3f22bf35,0xbef13f55,0xbf46bf35,0x3f623f0e
.long 0x80008000,0x80008000,0x80008000,0x80008000,0x3f753f6d,0x3f7f3f7b,0x3e953ec4,0x3dc93e48,0x3f0e3f35,0x3e483ec4,0xbf0ebf35,0xbe48bec4,0xbf22bec4,0xbf75bf55,0x3f463f6d,0x3e953f0e
.long 0xbf6dbf80,0xbec4bf35,0xbf6dbf80,0xbec4bf35,0x3dc9bec4,0x3f623f0e,0x3f7f3f6d,0x3ef13f55,0x3f7b3f35,0x3f0e3f6d,0xbf7bbf35,0xbf0ebf6d,0x3ef13f6d,0xbf46be48,0x3f623ec4,0x3f223f7b
.long 0xbf35250d,0xbf35bf80,0xbf35250d,0xbf35bf80,0xbf62bf6d,0x3f22be48,0x3ef1bec4,0x3f463f7b,0x3e48bf35,0x3f553f6d,0xbe483f35,0xbf55bf6d,0x3f7f3ec4,0xbef13f0e,0xbdc9bf6d,0x3f623f55
.long 0x3ec43f80,0xbf6dbf35,0x3ec43f80,0xbf6dbf35,0xbf463ec4,0x3e95bf55,0xbf22bf6d,0x3f753f0e,0xbf55bf35,0x3f7b3ec4,0x3f553f35,0xbf7bbec4,0x3e95bf6d,0xbdc93f7b,0xbf75bec4,0x3f7f3e48
.long 0x3f808000,0xbf80250d,0x3f808000,0xbf80250d,0xbf7f250d,0x3f753e48,0x3dc9bf80,0xbe953f7b,0x3f7b8000,0xbf55bec4,0xbf7b250d,0x3f553ec4,0xbf75250d,0x3f223f0e,0xbe953f80,0x3f46bf55
.long 0x3f6d8000,0xbec4bf35,0x3f6d8000,0xbec4bf35,0xbf62250d,0x3dc93f55,0x3ef1bf80,0xbf7f3f0e,0x3f558000,0x3e48bf6d,0xbf55250d,0xbe483f6d,0xbf46250d,0xbef13f7b,0xbf223f80,0x3f62be48
.long 0x3f358000,0x3f35bf80,0x3f358000,0x3f35bf80,0xbf22250d,0xbf623f7b,0x3f46bf80,0xbef1be48,0x3f0e8000,0x3f7bbf6d,0xbf0e250d,0xbf7b3f6d,0xbef1250d,0xbf7f3f55,0xbf623f80,0xbdc93f0e
.long 0x3ec48000,0x3f6dbf35,0x3ec48000,0x3f6dbf35,0xbe95250d,0xbf463f0e,0x3f75bf80,0x3f22bf55,0x3e488000,0x3f0ebec4,0xbe48250d,0xbf0e3ec4,0xbdc9250d,0xbe953e48,0xbf7f3f80,0xbf753f7b
.long 0x3f808000,0xbf80250d,0x3f808000,0xbf80250d,0xbf62bec4,0x3f463f0e,0x3ef1bf6d,0xbf223f55,0x3f0e3f35,0xbe48bf6d,0xbf0ebf35,0x3e483f6d,0xbdc9bf6d,0xbef13f7b,0xbf7f3ec4,0x3f623e48
.long 0xbec43f80,0x3f6dbf35,0xbec43f80,0x3f6dbf35,0x3f46bf6d,0xbf753e48,0x3f223ec4,0x3e95bf7b,0xbf7b3f35,0x3f0e3ec4,0x3f7bbf35,0xbf0ebec4,0x3f75bec4,0x3dc9bf55,0x3e95bf6d,0xbf7f3f0e
.long 0xbf35250d,0xbf353f80,0xbf35250d,0xbf353f80,0x3e953ec4,0x3f7fbf55,0xbf753f6d,0x3dc93f0e,0x3e48bf35,0xbf553ec4,0xbe483f35,0x3f55bec4,0xbf223f6d,0x3e953e48,0x3f46bec4,0x3f75bf7b
.long 0x3f6dbf80,0x3ec4bf35,0x3f6dbf80,0x3ec4bf35,0xbf7f3f6d,0xbf623f7b,0x3dc9bec4,0xbef13e48,0x3f55bf35,0x3f7bbf6d,0xbf553f35,0xbf7b3f6d,0xbef13ec4,0xbf223f0e,0xbf623f6d,0xbf463f55
.long 0x3f808000,0xbf80250d,0x3f808000,0xbf80250d,0xbf22bf35,0x3ef13f55,0x3f46bf35,0xbf623f0e,0xbe483f80,0x3f0ebf6d,0x3e48bf80,0xbf0e3f6d,0x3f62bf35,0xbf7f3e48,0xbef1bf35,0xbdc93f7b
.long 0xbf6d250d,0x3ec43f35,0xbf6d250d,0x3ec43f35,0x3e953f35,0x3f22bf7b,0xbf753f35,0x3f463e48,0x3f0ebf80,0xbf7b3ec4,0xbf0e3f80,0x3f7bbec4,0xbf7f3f35,0x3e953f0e,0x3dc93f35,0x3f75bf55
.long 0x3f358000,0x3f35bf80,0x3f358000,0x3f35bf80,0x3dc9bf35,0xbf753f0e,0x3f7fbf35,0x3e95bf55,0xbf553f80,0x3e483ec4,0x3f55bf80,0xbe48bec4,0x3f75bf35,0x3f46bf7b,0x3e95bf35,0xbf223e48
.long 0xbec4250d,0xbf6d3f35,0xbec4250d,0xbf6d3f35,0xbef13f35,0x3dc93e48,0xbf623f35,0xbf7f3f7b,0x3f7bbf80,0x3f55bf6d,0xbf7b3f80,0xbf553f6d,0xbf463f35,0xbf623f55,0xbf223f35,0xbef13f0e
.long 0x3f808000,0xbf80250d,0x3f808000,0xbf80250d,0xbe95bf6d,0x3dc93f7b,0x3f75bec4,0xbf7f3e48,0xbf553f35,0x3f7bbec4,0x3f55bf35,0xbf7b3ec4,0x3f463ec4,0xbe95bf55,0x3f22bf6d,0xbf753f0e
.long 0x3ec4bf80,0xbf6d3f35,0x3ec4bf80,0xbf6d3f35,0xbf7f3ec4,0x3ef13f0e,0x3dc9bf6d,0xbf623f55,0x3e483f35,0x3f55bf6d,0xbe48bf35,0xbf553f6d,0x3f62bf6d,0xbf22be48,0xbef1bec4,0xbf463f7b
.long 0xbf35250d,0xbf353f80,0xbf35250d,0xbf353f80,0xbef13f6d,0x3f46be48,0xbf623ec4,0xbf223f7b,0x3f7bbf35,0x3f0ebf6d,0xbf7b3f35,0xbf0e3f6d,0xbdc9bec4,0xbf623f0e,0xbf7f3f6d,0xbef13f55
.long 0xbf6d3f80,0xbec43f35,0xbf6d3f80,0xbec43f35,0x3f22bec4,0x3f75bf55,0xbf463f6d,0xbe953f0e,0x3f0ebf35,0x3e48bec4,0xbf0e3f35,0xbe483ec4,0xbf753f6d,0xbf7f3f7b,0xbe953ec4,0xbdc93e48
.long 0x3f808000,0xbf80250d,0x3f808000,0xbf80250d,0x3f7f8000,0xbf75be48,0xbdc93f80,0x3e95bf7b,0x3f7b8000,0xbf55bec4,0xbf7b250d,0x3f553ec4,0x3f758000,0xbf22bf0e,0x3e95bf80,0xbf463f55
.long 0x3f6d8000,0xbec4bf35,0x3f6d8000,0xbec4bf35,0x3f628000,0xbdc9bf55,0xbef13f80,0x3f7fbf0e,0x3f558000,0x3e48bf6d,0xbf55250d,0xbe483f6d,0x3f468000,0x3ef1bf7b,0x3f22bf80,0xbf623e48
.long 0x3f358000,0x3f35bf80,0x3f358000,0x3f35bf80,0x3f228000,0x3f62bf7b,0xbf463f80,0x3ef13e48,0x3f0e8000,0x3f7bbf6d,0xbf0e250d,0xbf7b3f6d,0x3ef18000,0x3f7fbf55,0x3f62bf80,0x3dc9bf0e
.long 0x3ec48000,0x3f6dbf35,0x3ec48000,0x3f6dbf35,0x3e958000,0x3f46bf0e,0xbf753f80,0xbf223f55,0x3e488000,0x3f0ebec4,0xbe48250d,0xbf0e3ec4,0x3dc98000,0x3e95be48,0x3f7fbf80,0x3f75bf7b
.long 0x3f808000,0xbf80250d,0x3f808000,0xbf80250d,0x3f623ec4,0xbf46bf0e,0xbef13f6d,0x3f22bf55,0x3f0e3f35,0xbe48bf6d,0xbf0ebf35,0x3e483f6d,0x3dc93f6d,0x3ef1bf7b,0x3f7fbec4,0xbf62be48
.long 0xbec43f80,0x3f6dbf35,0xbec43f80,0x3f6dbf35,0xbf463f6d,0x3f75be48,0xbf22bec4,0xbe953f7b,0xbf7b3f35,0x3f0e3ec4,0x3f7bbf35,0xbf0ebec4,0xbf753ec4,0xbdc93f55,0xbe953f6d,0x3f7fbf0e
.long 0xbf35250d,0xbf353f80,0xbf35250d,0xbf353f80,0xbe95bec4,0xbf7f3f55,0x3f75bf6d,0xbdc9bf0e,0x3e48bf35,0xbf553ec4,0xbe483f35,0x3f55bec4,0x3f22bf6d,0xbe95be48,0xbf463ec4,0xbf753f7b
.long 0x3f6dbf80,0x3ec4bf35,0x3f6dbf80,0x3ec4bf35,0x3f7fbf6d,0x3f62bf7b,0xbdc93ec4,0x3ef1be48,0x3f55bf35,0x3f7bbf6d,0xbf553f35,0xbf7b3f6d,0x3ef1bec4,0x3f22bf0e,0x3f62bf6d,0x3f46bf55
.long 0x3f808000,0xbf80250d,0x3f808000,0xbf80250d,0x3f223f35,0xbef1bf55,0xbf463f35,0x3f62bf0e,0xbe483f80,0x3f0ebf6d,0x3e48bf80,0xbf0e3f6d,0xbf623f35,0x3f7fbe48,0x3ef13f35,0x3dc9bf7b
.long 0xbf6d250d,0x3ec43f35,0xbf6d250d,0x3ec43f35,0xbe95bf35,0xbf223f7b,0x3f75bf35,0xbf46be48,0x3f0ebf80,0xbf7b3ec4,0xbf0e3f80,0x3f7bbec4,0x3f7fbf35,0xbe95bf0e,0xbdc9bf35,0xbf753f55
.long 0x3f358000,0x3f35bf80,0x3f358000,0x3f35bf80,0xbdc93f35,0x3f75bf0e,0xbf7f3f35,0xbe953f55,0xbf553f80,0x3e483ec4,0x3f55bf80,0xbe48bec4,0xbf753f35,0xbf463f7b,0xbe953f35,0x3f22be48
.long 0xbec4250d,0xbf6d3f35,0xbec4250d,0xbf6d3f35,0x3ef1bf35,0xbdc9be48,0x3f62bf35,0x3f7fbf7b,0x3f7bbf80,0x3f55bf6d,0xbf7b3f80,0xbf553f6d,0x3f46bf35,0x3f62bf55,0x3f22bf35,0x3ef1bf0e
.long 0x3f808000,0xbf80250d,0x3f808000,0xbf80250d,0x3e953f6d,0xbdc9bf7b,0xbf753ec4,0x3f7fbe48,0xbf553f35,0x3f7bbec4,0x3f55bf35,0xbf7b3ec4,0xbf46bec4,0x3e953f55,0xbf223f6d,0x3f75bf0e
.long 0x3ec4bf80,0xbf6d3f35,0x3ec4bf80,0xbf6d3f35,0x3f7fbec4,0xbef1bf0e,0xbdc93f6d,0x3f62bf55,0x3e483f35,0x3f55bf6d,0xbe48bf35,0xbf553f6d,0xbf623f6d,0x3f223e48,0x3ef13ec4,0x3f46bf7b
.long 0xbf35250d,0xbf353f80,0xbf35250d,0xbf353f80,0x3ef1bf6d,0xbf463e48,0x3f62bec4,0x3f22bf7b,0x3f7bbf35,0x3f0ebf6d,0xbf7b3f35,0xbf0e3f6d,0x3dc93ec4,0x3f62bf0e,0x3f7fbf6d,0x3ef1bf55
.long 0xbf6d3f80,0xbec43f35,0xbf6d3f80,0xbec43f35,0xbf223ec4,0xbf753f55,0x3f46bf6d,0x3e95bf0e,0x3f0ebf35,0x3e48bec4,0xbf0e3f35,0xbe483ec4,0x3f75bf6d,0x3f7fbf7b,0x3e95bec4,0x3dc9be48
.long 0xbf803f80,0xbf803f80,0xbf803f80,0xbf803f80,0xbf7b3f80,0xbf553f6d,0xbf0e3f35,0xbe483ec4,0xbf6d3f80,0xbec43f35,0x3ec4248d,0x3f6dbf35,0xbf553f80,0x3e483ec4,0x3f7bbf35,0x3f0ebf6d
.long 0xbf353f80,0x3f35248d,0x3f35bf80,0xbf35a554,0xbf0e3f80,0x3f7bbec4,0xbe48bf35,0xbf553f6d,0xbec43f80,0x3f6dbf35,0xbf6da554,0x3ec43f35,0xbe483f80,0x3f0ebf6d,0xbf553f35,0x3f7bbec4
.long 0xa5543f80,0x248dbf80,0xa5543f80,0x248dbf80,0x3e483f80,0xbf0ebf6d,0x3f553f35,0xbf7bbec4,0x3ec43f80,0xbf6dbf35,0x3f6d248d,0xbec43f35,0x3f0e3f80,0xbf7bbec4,0x3e48bf35,0x3f553f6d
.long 0x3f353f80,0xbf35a554,0xbf35bf80,0x3f35248d,0x3f553f80,0xbe483ec4,0xbf7bbf35,0xbf0ebf6d,0x3f6d3f80,0x3ec43f35,0xbec4a554,0xbf6dbf35,0x3f7b3f80,0x3f553f6d,0x3f0e3f35,0x3e483ec4
.long 0xbf803f80,0xbf803f80,0xbf803f80,0xbf803f80,0x3e48248d,0x3f0ebec4,0x3f55bf35,0x3f7bbf6d,0x3f6dbf80,0x3ec4bf35,0xbec4a554,0xbf6d3f35,0xbf0ea554,0xbf7b3f6d,0xbe483f35,0x3f55bec4
.long 0xbf353f80,0x3f35248d,0x3f35bf80,0xbf35a554,0x3f55248d,0x3e48bf6d,0xbf7b3f35,0x3f0e3ec4,0x3ec4bf80,0xbf6d3f35,0x3f6d248d,0xbec4bf35,0xbf7ba554,0x3f553ec4,0xbf0ebf35,0x3e483f6d
.long 0xa5543f80,0x248dbf80,0xa5543f80,0x248dbf80,0x3f7b248d,0xbf553ec4,0x3f0ebf35,0xbe483f6d,0xbec4bf80,0x3f6d3f35,0xbf6da554,0x3ec4bf35,0xbf55a554,0xbe48bf6d,0x3f7b3f35,0xbf0e3ec4
.long 0x3f353f80,0xbf35a554,0xbf35bf80,0x3f35248d,0x3f0e248d,0x3f7b3f6d,0x3e483f35,0xbf55bec4,0xbf6dbf80,0xbec4bf35,0x3ec4248d,0x3f6d3f35,0xbe48a554,0xbf0ebec4,0xbf55bf35,0xbf7bbf6d
.long 0xbf803f80,0xbf803f80,0xbf803f80,0xbf803f80,0x3f7bbf80,0x3f55bf6d,0x3f0ebf35,0x3e48bec4,0xbf6d3f80,0xbec43f35,0x3ec4248d,0x3f6dbf35,0x3f55bf80,0xbe48bec4,0xbf7b3f35,0xbf0e3f6d
.long 0xbf353f80,0x3f35248d,0x3f35bf80,0xbf35a554,0x3f0ebf80,0xbf7b3ec4,0x3e483f35,0x3f55bf6d,0xbec43f80,0x3f6dbf35,0xbf6da554,0x3ec43f35,0x3e48bf80,0xbf0e3f6d,0x3f55bf35,0xbf7b3ec4
.long 0xa5543f80,0x248dbf80,0xa5543f80,0x248dbf80,0xbe48bf80,0x3f0e3f6d,0xbf55bf35,0x3f7b3ec4,0x3ec43f80,0xbf6dbf35,0x3f6d248d,0xbec43f35,0xbf0ebf80,0x3f7b3ec4,0xbe483f35,0xbf55bf6d
.long 0x3f353f80,0xbf35a554,0xbf35bf80,0x3f35248d,0xbf55bf80,0x3e48bec4,0x3f7b3f35,0x3f0e3f6d,0x3f6d3f80,0x3ec43f35,0xbec4a554,0xbf6dbf35,0xbf7bbf80,0xbf55bf6d,0xbf0ebf35,0xbe48bec4
.long 0xbf803f80,0xbf803f80,0xbf803f80,0xbf803f80,0xbe48a554,0xbf0e3ec4,0xbf553f35,0xbf7b3f6d,0x3f6dbf80,0x3ec4bf35,0xbec4a554,0xbf6d3f35,0x3f0e248d,0x3f7bbf6d,0x3e48bf35,0xbf553ec4
.long 0xbf353f80,0x3f35248d,0x3f35bf80,0xbf35a554,0xbf55a554,0xbe483f6d,0x3f7bbf35,0xbf0ebec4,0x3ec4bf80,0xbf6d3f35,0x3f6d248d,0xbec4bf35,0x3f7b248d,0xbf55bec4,0x3f0e3f35,0xbe48bf6d
.long 0xa5543f80,0x248dbf80,0xa5543f80,0x248dbf80,0xbf7ba554,0x3f55bec4,0xbf0e3f35,0x3e48bf6d,0xbec4bf80,0x3f6d3f35,0xbf6da554,0x3ec4bf35,0x3f55248d,0x3e483f6d,0xbf7bbf35,0x3f0ebec4
.long 0x3f353f80,0xbf35a554,0xbf35bf80,0x3f35248d,0xbf0ea554,0xbf7bbf6d,0xbe48bf35,0x3f553ec4,0xbf6dbf80,0xbec4bf35,0x3ec4248d,0x3f6d3f35,0x3e48248d,0x3f0e3ec4,0x3f553f35,0x3f7b3f6d
.long 0xa50d0000,0xa50d0000,0xa50d0000,0xa50d0000,0x3e480000,0x3f0ebec4,0x3f55bf35,0x3f7bbf6d,0x3ec40000,0x3f6dbf35,0x3f6dbf80,0x3ec4bf35,0x3f0e0000,0x3f7bbf6d,0x3e48bf35,0xbf553ec4
.long 0x3f350000,0x3f35bf80,0xbf35a50d,0xbf353f80,0x3f550000,0x3e48bf6d,0xbf7b3f35,0x3f0e3ec4,0x3f6d0000,0xbec4bf35,0xbec43f80,0x3f6dbf35,0x3f7b0000,0xbf55bec4,0x3f0e3f35,0xbe48bf6d
.long 0x3f800000,0xbf80a50d,0x3f800000,0xbf80a50d,0x3f7b0000,0xbf553ec4,0x3f0ebf35,0xbe483f6d,0x3f6d0000,0xbec43f35,0xbec4bf80,0x3f6d3f35,0x3f550000,0x3e483f6d,0xbf7bbf35,0x3f0ebec4
.long 0x3f350000,0x3f353f80,0xbf35a50d,0xbf35bf80,0x3f0e0000,0x3f7b3f6d,0x3e483f35,0xbf55bec4,0x3ec40000,0x3f6d3f35,0x3f6d3f80,0x3ec43f35,0x3e480000,0x3f0e3ec4,0x3f553f35,0x3f7b3f6d
.long 0xa50d0000,0xa50d0000,0xa50d0000,0xa50d0000,0x3f7bbf80,0x3f55bf6d,0x3f0ebf35,0x3e48bec4,0xbec4a50d,0xbf6d3f35,0xbf6d3f80,0xbec43f35,0xbf553f80,0x3e483ec4,0x3f7bbf35,0x3f0ebf6d
.long 0x3f350000,0x3f35bf80,0xbf35a50d,0xbf353f80,0x3f0ebf80,0xbf7b3ec4,0x3e483f35,0x3f55bf6d,0xbf6da50d,0x3ec43f35,0x3ec4bf80,0xbf6d3f35,0xbe483f80,0x3f0ebf6d,0xbf553f35,0x3f7bbec4
.long 0x3f800000,0xbf80a50d,0x3f800000,0xbf80a50d,0xbe48bf80,0x3f0e3f6d,0xbf55bf35,0x3f7b3ec4,0xbf6da50d,0x3ec4bf35,0x3ec43f80,0xbf6dbf35,0x3f0e3f80,0xbf7bbec4,0x3e48bf35,0x3f553f6d
.long 0x3f350000,0x3f353f80,0xbf35a50d,0xbf35bf80,0xbf55bf80,0x3e48bec4,0x3f7b3f35,0x3f0e3f6d,0xbec4a50d,0xbf6dbf35,0xbf6dbf80,0xbec4bf35,0x3f7b3f80,0x3f553f6d,0x3f0e3f35,0x3e483ec4
.long 0xa50d0000,0xa50d0000,0xa50d0000,0xa50d0000,0xbe48a50d,0xbf0e3ec4,0xbf553f35,0xbf7b3f6d,0x3ec40000,0x3f6dbf35,0x3f6dbf80,0x3ec4bf35,0xbf0ea50d,0xbf7b3f6d,0xbe483f35,0x3f55bec4
.long 0x3f350000,0x3f35bf80,0xbf35a50d,0xbf353f80,0xbf55a50d,0xbe483f6d,0x3f7bbf35,0xbf0ebec4,0x3f6d0000,0xbec4bf35,0xbec43f80,0x3f6dbf35,0xbf7ba50d,0x3f553ec4,0xbf0ebf35,0x3e483f6d
.long 0x3f800000,0xbf80a50d,0x3f800000,0xbf80a50d,0xbf7ba50d,0x3f55bec4,0xbf0e3f35,0x3e48bf6d,0x3f6d0000,0xbec43f35,0xbec4bf80,0x3f6d3f35,0xbf55a50d,0xbe48bf6d,0x3f7b3f35,0xbf0e3ec4
.long 0x3f350000,0x3f353f80,0xbf35a50d,0xbf35bf80,0xbf0ea50d,0xbf7bbf6d,0xbe48bf35,0x3f553ec4,0x3ec40000,0x3f6d3f35,0x3f6d3f80,0x3ec43f35,0xbe48a50d,0xbf0ebec4,0xbf55bf35,0xbf7bbf6d
.long 0xa50d0000,0xa50d0000,0xa50d0000,0xa50d0000,0xbf7b3f80,0xbf553f6d,0xbf0e3f35,0xbe483ec4,0xbec4a50d,0xbf6d3f35,0xbf6d3f80,0xbec43f35,0x3f55bf80,0xbe48bec4,0xbf7b3f35,0xbf0e3f6d
.long 0x3f350000,0x3f35bf80,0xbf35a50d,0xbf353f80,0xbf0e3f80,0x3f7bbec4,0xbe48bf35,0xbf553f6d,0xbf6da50d,0x3ec43f35,0x3ec4bf80,0xbf6d3f35,0x3e48bf80,0xbf0e3f6d,0x3f55bf35,0xbf7b3ec4
.long 0x3f800000,0xbf80a50d,0x3f800000,0xbf80a50d,0x3e483f80,0xbf0ebf6d,0x3f553f35,0xbf7bbec4,0xbf6da50d,0x3ec4bf35,0x3ec43f80,0xbf6dbf35,0xbf0ebf80,0x3f7b3ec4,0xbe483f35,0xbf55bf6d
.long 0x3f350000,0x3f353f80,0xbf35a50d,0xbf35bf80,0x3f553f80,0xbe483ec4,0xbf7bbf35,0xbf0ebf6d,0xbec4a50d,0xbf6dbf35,0xbf6dbf80,0xbec4bf35,0xbf7bbf80,0xbf55bf6d,0xbf0ebf35,0xbe48bec4
.long 0x250d8000,0x250d8000,0x250d8000,0x250d8000,0xbe488000,0xbf0e3ec4,0xbf553f35,0xbf7b3f6d,0xbec48000,0xbf6d3f35,0xbf6d3f80,0xbec43f35,0xbf0e8000,0xbf7b3f6d,0xbe483f35,0x3f55bec4
.long 0xbf358000,0xbf353f80,0x3f35250d,0x3f35bf80,0xbf558000,0xbe483f6d,0x3f7bbf35,0xbf0ebec4,0xbf6d8000,0x3ec43f35,0x3ec4bf80,0xbf6d3f35,0xbf7b8000,0x3f553ec4,0xbf0ebf35,0x3e483f6d
.long 0xbf808000,0x3f80250d,0xbf808000,0x3f80250d,0xbf7b8000,0x3f55bec4,0xbf0e3f35,0x3e48bf6d,0xbf6d8000,0x3ec4bf35,0x3ec43f80,0xbf6dbf35,0xbf558000,0xbe48bf6d,0x3f7b3f35,0xbf0e3ec4
.long 0xbf358000,0xbf35bf80,0x3f35250d,0x3f353f80,0xbf0e8000,0xbf7bbf6d,0xbe48bf35,0x3f553ec4,0xbec48000,0xbf6dbf35,0xbf6dbf80,0xbec4bf35,0xbe488000,0xbf0ebec4,0xbf55bf35,0xbf7bbf6d
.long 0x250d8000,0x250d8000,0x250d8000,0x250d8000,0xbf7b3f80,0xbf553f6d,0xbf0e3f35,0xbe483ec4,0x3ec4250d,0x3f6dbf35,0x3f6dbf80,0x3ec4bf35,0x3f55bf80,0xbe48bec4,0xbf7b3f35,0xbf0e3f6d
.long 0xbf358000,0xbf353f80,0x3f35250d,0x3f35bf80,0xbf0e3f80,0x3f7bbec4,0xbe48bf35,0xbf553f6d,0x3f6d250d,0xbec4bf35,0xbec43f80,0x3f6dbf35,0x3e48bf80,0xbf0e3f6d,0x3f55bf35,0xbf7b3ec4
.long 0xbf808000,0x3f80250d,0xbf808000,0x3f80250d,0x3e483f80,0xbf0ebf6d,0x3f553f35,0xbf7bbec4,0x3f6d250d,0xbec43f35,0xbec4bf80,0x3f6d3f35,0xbf0ebf80,0x3f7b3ec4,0xbe483f35,0xbf55bf6d
.long 0xbf358000,0xbf35bf80,0x3f35250d,0x3f353f80,0x3f553f80,0xbe483ec4,0xbf7bbf35,0xbf0ebf6d,0x3ec4250d,0x3f6d3f35,0x3f6d3f80,0x3ec43f35,0xbf7bbf80,0xbf55bf6d,0xbf0ebf35,0xbe48bec4
.long 0x250d8000,0x250d8000,0x250d8000,0x250d8000,0x3e48250d,0x3f0ebec4,0x3f55bf35,0x3f7bbf6d,0xbec48000,0xbf6d3f35,0xbf6d3f80,0xbec43f35,0x3f0e250d,0x3f7bbf6d,0x3e48bf35,0xbf553ec4
.long 0xbf358000,0xbf353f80,0x3f35250d,0x3f35bf80,0x3f55250d,0x3e48bf6d,0xbf7b3f35,0x3f0e3ec4,0xbf6d8000,0x3ec43f35,0x3ec4bf80,0xbf6d3f35,0x3f7b250d,0xbf55bec4,0x3f0e3f35,0xbe48bf6d
.long 0xbf808000,0x3f80250d,0xbf808000,0x3f80250d,0x3f7b250d,0xbf553ec4,0x3f0ebf35,0xbe483f6d,0xbf6d8000,0x3ec4bf35,0x3ec43f80,0xbf6dbf35,0x3f55250d,0x3e483f6d,0xbf7bbf35,0x3f0ebec4
.long 0xbf358000,0xbf35bf80,0x3f35250d,0x3f353f80,0x3f0e250d,0x3f7b3f6d,0x3e483f35,0xbf55bec4,0xbec48000,0xbf6dbf35,0xbf6dbf80,0xbec4bf35,0x3e48250d,0x3f0e3ec4,0x3f553f35,0x3f7b3f6d
.long 0x250d8000,0x250d8000,0x250d8000,0x250d8000,0x3f7bbf80,0x3f55bf6d,0x3f0ebf35,0x3e48bec4,0x3ec4250d,0x3f6dbf35,0x3f6dbf80,0x3ec4bf35,0xbf553f80,0x3e483ec4,0x3f7bbf35,0x3f0ebf6d
.long 0xbf358000,0xbf353f80,0x3f35250d,0x3f35bf80,0x3f0ebf80,0xbf7b3ec4,0x3e483f35,0x3f55bf6d,0x3f6d250d,0xbec4bf35,0xbec43f80,0x3f6dbf35,0xbe483f80,0x3f0ebf6d,0xbf553f35,0x3f7bbec4
.long 0xbf808000,0x3f80250d,0xbf808000,0x3f80250d,0xbe48bf80,0x3f0e3f6d,0xbf55bf35,0x3f7b3ec4,0x3f6d250d,0xbec43f35,0xbec4bf80,0x3f6d3f35,0x3f0e3f80,0xbf7bbec4,0x3e48bf35,0x3f553f6d
.long 0xbf358000,0xbf35bf80,0x3f35250d,0x3f353f80,0xbf55bf80,0x3e48bec4,0x3f7b3f35,0x3f0e3f6d,0x3ec4250d,0x3f6d3f35,0x3f6d3f80,0x3ec43f35,0x3f7b3f80,0x3f553f6d,0x3f0e3f35,0x3e483ec4
.long 0x248d3132,0xbd48fb30,0xbdc8bd36,0xbe164083,0xbdc8bd36,0xbe195be0,0xbe4dee60,0xbe80f8c0,0xbe47c5c2,0xbe7ee6e1,0xbe9aa086,0xbeb554ec,0xbe94a031,0xbeb0eacb,0xbecc9b8b,0xbee79a5d
.long 0xbec3ef15,0xbee0924f,0xbefc5d27,0xbf0b9a6b,0xbef15aea,0xbf06f686,0xbf14b039,0xbf21cbfb,0xbf0e39da,0xbf1c420c,0xbf299415,0xbf36206c,0xbf226799,0xbf2ff3e6,0xbf3ca003,0xbf485bca
.long 0xbf3504f3,0xbf41d870,0xbf4d9f02,0xbf584853,0xbf45e403,0xbf51c0c2,0xbf5c61c7,0xbf65b710,0xbf54db31,0xbf5f8327,0xbf68bf3c,0xbf708066,0xbf61c598,0xbf6afb8c,0xbf7294f8,0xbf788486
.long 0xbf6c835e,0xbf740bdd,0xbf79c79d,0xbf7dabcc,0xbf74fa0b,0xbf7a9c59,0xbf7e4323,0xbf7fe705,0xbf7b14be,0xbf7e9bc9,0xbf7ffb11,0xbf7f2f9d,0xbf7ec46d,0xbf7fffb1,0xbf7eea9d,0xbf7b87b2
.long 0xbe47c5c2,0xbe78cfcc,0xbe94a031,0xbeac7cd4,0xbe9aa086,0xbeb3dca5,0xbecc9b8b,0xbee4cbfe,0xbecf7bca,0xbee900b7,0xbf00e7e4,0xbf0cead0,0xbf00e7e4,0xbf0d9281,0xbf19c200,0xbf256bcb
.long 0xbf187fc0,0xbf24d225,0xbf3085bb,0xbf3b8f3b,0xbf2e3bde,0xbf39f2ac,0xbf44e3f5,0xbf4f0417,0xbf41d870,0xbf4cae79,0xbf5695e5,0xbf5f8327,0xbf531849,0xbf5cc7d1,0xbf655e0b,0xbf6cd007
.long 0xbf61c598,0xbf6a09a7,0xbf710908,0xbf76ba07,0xbf6db293,0xbf74484b,0xbf796e4e,0xbf7d1cdd,0xbf76ba07,0xbf7b61fc,0xbf7e70b0,0xbf7fe129,0xbf7cbfc9,0xbf7f3f54,0xbf7ffec4,0xbf7efcc9
.long 0xbf7fb10f,0xbf7fd397,0xbf7e1324,0xbf7a7302,0xbf7f84ab,0xbf7d1cdd,0xbf78b47b,0xbf725470,0xbf7c3b28,0xbf772417,0xbf6ff573,0xbf66becc,0xbf75dec6,0xbf6dfcf2,0xbf63f473,0xbf57dc7f
.long 0xbec3ef15,0xbedae880,0xbef15aea,0xbf039c3d,0xbefc5d27,0xbf099f4e,0xbf14b039,0xbf1f599f,0xbf187fc0,0xbf239da9,0xbf2e3bde,0xbf385216,0xbf3085bb,0xbf3b0629,0xbf44e3f5,0xbf4e1689
.long 0xbf45e403,0xbf4f7a1f,0xbf584853,0xbf604621,0xbf584853,0xbf60a6cf,0xbf6816a8,0xbf6e8ff8,0xbf676bd8,0xbf6e46be,0xbf740bdd,0xbf78b47b,0xbf731447,0xbf7822d1,0xbf7bf531,0xbf7e868b
.long 0xbf7b14be,0xbf7e1324,0xbf7fb10f,0xbf7fec43,0xbf7f4e6d,0xbf7fffb1,0xbf7f2f9d,0xbf7cdf6c,0xbf7fb10f,0xbf7de0b1,0xbf7a7302,0xbf756d97,0xbf7c3b28,0xbf77beb7,0xbf718f57,0xbf69b7e4
.long 0xbf74fa0b,0xbf6db293,0xbf64aa59,0xbf59f26a,0xbf6a09a7,0xbf5fe4e9,0xbf53fac3,0xbf466354,0xbf5b941a,0xbf4e8d90,0xbf3fc767,0xbf2f61a5,0xbf49d112,0xbf39f2ac,0xbf286605,0xbf1553b7
.long 0xbf0e39da,0xbf187fc0,0xbf226799,0xbf2beb4a,0xbf299415,0xbf33587a,0xbf3ca003,0xbf456439,0xbf41d870,0xbf4ac77f,0xbf531849,0xbf5ac450,0xbf5695e5,0xbf5e5aa6,0xbf655e0b,0xbf6b99fb
.long 0xbf676bd8,0xbf6db293,0xbf731447,0xbf778bc5,0xbf740bdd,0xbf788486,0xbf7bf531,0xbf7e5a38,0xbf7c3b28,0xbf7e9bc9,0xbf7fd397,0xbf7fe129,0xbf7fd397,0xbf7fdaaf,0xbf7e9bc9,0xbf7c187a
.long 0xbf7ec46d,0xbf7c3b28,0xbf7853f8,0xbf731447,0xbf791298,0xbf73ced9,0xbf6d1c1d,0xbf650479,0xbf6ed89e,0xbf66becc,0xbf5d2d53,0xbf5233c6,0xbf604621,0xbf554aa4,0xbf48d8b3,0xbf3b0629
.long 0xbf4d9f02,0xbf3fc767,0xbf3085bb,0xbf1ff6cb,0xbf373a23,0xbf269de3,0xbf14b039,0xbf019573,0xbf1d7fd1,0xbf0a48ad,0xbeebcbbb,0xbec1071e,0xbf00e7e4,0xbed6a399,0xbea986c4,0xbe75c35a
.long 0xbf800000,0xbf7fb10f,0xbf7ec46d,0xbf7d3aac,0xbf7ec46d,0xbf7d1cdd,0xbf7ac516,0xbf77beb7,0xbf7b14be,0xbf77f110,0xbf740bdd,0xbf6f6830,0xbf74fa0b,0xbf703b37,0xbf6aab7b,0xbf644fac
.long 0xbf6c835e,0xbf660f88,0xbf5ebe05,0xbf5695e5,0xbf61c598,0xbf5988ad,0xbf5064af,0xbf466354,0xbf54db31,0xbf4ac77f,0xbf3fc767,0xbf33e7bc,0xbf45e403,0xbf39f2ac,0xbf2d1469,0xbf1f599f
.long 0xbf3504f3,0xbf273656,0xbf187fc0,0xbf08f59b,0xbf226799,0xbf12c39a,0xbf0242b1,0xbee1fb6a,0xbf0e39da,0xbef9a02d,0xbed53641,0xbeaf713a,0xbef15aea,0xbecb2aae,0xbea395c5,0xbe75c35a
.long 0xbec3ef15,0xbe9aa086,0xbe605c13,0xbe09cf86,0xbe94a031,0xbe5101f1,0xbdee3876,0xbce22a7a,0xbe47c5c2,0xbdd53db9,0xbc490e90,0x3da3308c,0xbdc8bd36,0xbb490fc6,0x3dbc3ac3,0x3e3e853e
.long 0xbf7b14be,0xbf7853f8,0xbf74fa0b,0xbf710908,0xbf740bdd,0xbf6faf1b,0xbf6aab7b,0xbf650479,0xbf6a09a7,0xbf63f473,0xbf5d2d53,0xbf55b993,0xbf5d2d53,0xbf554aa4,0xbf4cae79,0xbf436051
.long 0xbf4d9f02,0xbf43e200,0xbf396842,0xbf2e3bde,0xbf3b8f3b,0xbf2ff3e6,0xbf239da9,0xbf16999f,0xbf273656,0xbf19c200,0xbf0b9a6b,0xbef9a02d,0xbf10d3cd,0xbf019573,0xbee363fa,0xbec27b55
.long 0xbef15aea,0xbecf7bca,0xbeac7cd4,0xbe888e93,0xbebe1d4a,0xbe9920fe,0xbe667c66,0xbe195be0,0xbe888e93,0xbe419b37,0xbde1bc2e,0xbcfb49ba,0xbe22abb6,0xbd9cecf9,0x3bc90f88,0x3db5f8da
.long 0xbd48fb30,0x3d16c32c,0x3dfab273,0x3e541501,0x3d7b2b74,0x3e195be0,0x3e72b651,0x3ea5129f,0x3e2f10a2,0x3e8586ce,0x3eb263ef,0x3eddbe79,0x3e8e9a22,0x3ebca7af,0x3ee900b7,0x3f099f4e
.long 0xbf6c835e,0xbf676bd8,0xbf61c598,0xbf5b941a,0xbf5ebe05,0xbf57dc7f,0xbf5064af,0xbf485bca,0xbf4d9f02,0xbf44e3f5,0xbf3b8f3b,0xbf31a81d,0xbf396842,0xbf2ecef7,0xbf239da9,0xbf17de12
.long 0xbf226799,0xbf15f6d9,0xbf08f59b,0xbef6e0cb,0xbf08f59b,0xbef58035,0xbed8106b,0xbeb9bb1e,0xbedae880,0xbebb31a0,0xbe9aa086,0xbe72b651,0xbea09ae5,0xbe7bdba4,0xbe354098,0xbddb7d37
.long 0xbe47c5c2,0xbdfab273,0xbd48fb30,0x3cc90ab0,0xbd96a905,0x3b490fc6,0x3da3308c,0x3e1f917b,0x3d48fb30,0x3e039502,0x3e541501,0x3e919ddd,0x3e2f10a2,0x3e80f8c0,0x3ea986c4,0x3ed0eb2a
.long 0x3e94a031,0x3ebe1d4a,0x3ee63375,0x3f064b82,0x3ecf7bca,0x3ef840c8,0x3f0f8784,0x3f21cbfb,0x3f039c3d,0x3f173c07,0x3f299415,0x3f3a7ca4,0x3f1d7fd1,0x3f2ff3e6,0x3f40d0da,0x3f4fefa8
.long 0xbf54db31,0xbf4d9f02,0xbf45e403,0xbf3daef9,0xbf3fc767,0xbf36ad7f,0xbf2d1469,0xbf2302d3,0xbf273656,0xbf1c420c,0xbf10d3cd,0xbf04f484,0xbf0b9a6b,0xbefdbabb,0xbee363fa,0xbec8477c
.long 0xbedae880,0xbebe1d4a,0xbea09ae5,0xbe827dc0,0xbe9aa086,0xbe75c35a,0xbe354098,0xbde7fa9a,0xbe2f10a2,0xbdd53db9,0xbd16c32c,0x3cfb49ba,0xbd16c32c,0x3d0a342f,0x3dd53db9,0x3e3228d4
.long 0x3dc8bd36,0x3e2f10a2,0x3e78cfcc,0x3ea09ae5,0x3e6c9a7f,0x3e9c1faf,0x3ec1071e,0x3ee4cbfe,0x3eb8442a,0x3eddbe79,0x3f00e7e4,0x3f121eb0,0x3ef6e0cb,0x3f0d9281,0x3f1ebc12,0x3f2ecef7
.long 0x3f187fc0,0x3f299415,0x3f396842,0x3f47de65,0x3f32c8c9,0x3f425b89,0x3f5064af,0x3f5cc7d1,0x3f49d112,0x3f577026,0x3f633c5a,0x3f6d1c1d,0x3f5d2d53,0x3f686b39,0x3f718f57,0x3f788486
.long 0xbf3504f3,0xbf3daef9,0xbf45e403,0xbf4d9f02,0xbf4d9f02,0xbf554aa4,0xbf5c61c7,0xbf62df7b,0xbf61c598,0xbf6816a8,0xbf6db293,0xbf7294f8,0xbf710908,0xbf75a67b,0xbf796e4e,0xbf7c5d3a
.long 0xbf7b14be,0xbf7dabcc,0xbf7f4e6d,0xbf7ffb11,0xbf7fb10f,0xbf7ff84a,0xbf7f2f9d,0xbf7d57de,0xbf7ec46d,0xbf7c7eb0,0xbf791298,0xbf748422,0xbf7853f8,0xbf73530e,0xbf6d1c1d,0xbf65b710
.long 0xbf6c835e,0xbf64aa59,0xbf5b941a,0xbf514d3d,0xbf5b941a,0xbf50d937,0xbf44e3f5,0xbf37c655,0xbf45e403,0xbf385216,0xbf299415,0xbf19c200,0xbf2beb4a,0xbf1ba299,0xbf0a48ad,0xbeeff7fb
.long 0xbf0e39da,0xbef6e0cb,0xbecf7bca,0xbea68f12,0xbedae880,0xbeb0eacb,0xbe8586ce,0xbe3228d4,0xbe94a031,0xbe4dee60,0xbde1bc2e,0xbc96c9b6,0xbe164083,0xbd55880e,0x3d2fe007,0x3e0cec4a
.long 0xbf54db31,0xbf5b941a,0xbf61c598,0xbf676bd8,0xbf68bf3c,0xbf6dfcf2,0xbf7294f8,0xbf76841b,0xbf76ba07,0xbf7a1e84,0xbf7cbfc9,0xbf7e9bc9,0xbf7e70b0,0xbf7fa6e3,0xbf7ffec4,0xbf7f7808
.long 0xbf7fb10f,0xbf7e70b0,0xbf7c3b28,0xbf791298,0xbf7a7302,0xbf76841b,0xbf718f57,0xbf6b99fb,0xbf6ed89e,0xbf6816a8,0xbf604621,0xbf577026,0xbf5d2d53,0xbf5389c7,0xbf48d8b3,0xbf3d27b8
.long 0xbf45e403,0xbf396842,0xbf2beb4a,0xbf1d7fd1,0xbf299415,0xbf1a6293,0xbf0a48ad,0xbef2bd43,0xbf08f59b,0xbeee9479,0xbec9b953,0xbea395c5,0xbec9b953,0xbea21887,0xbe72b651,0xbe1f917b
.long 0xbe78cfcc,0xbe22abb6,0xbd96a905,0x3c490e90,0xbdafb680,0x3b490fc6,0x3dbc3ac3,0x3e3857ec,0x3d96a905,0x3e28defc,0x3e827dc0,0x3eaf713a,0x3e6c9a7f,0x3ea5129f,0x3ed25a09,0x3efdbabb
.long 0xbf6c835e,0xbf710908,0xbf74fa0b,0xbf7853f8,0xbf79c79d,0xbf7c5d3a,0xbf7e4323,0xbf7f7808,0xbf7fb10f,0xbf7ffec4,0xbf7f84ab,0xbf7e4323,0xbf7e1324,0xbf7bd14d,0xbf78b47b,0xbf74bf62
.long 0xbf74fa0b,0xbf6ff573,0xbf6a09a7,0xbf633c5a,0xbf64aa59,0xbf5cc7d1,0xbf53fac3,0xbf4a4c87,0xbf4d9f02,0xbf42de29,0xbf373a23,0xbf2ac082,0xbf3085bb,0xbf2302d3,0xbf14b039,0xbf05a02c
.long 0xbf0e39da,0xbefc5d27,0xbedae880,0xbeb8442a,0xbecf7bca,0xbeab0201,0xbe8586ce,0xbe3e853e,0xbe78cfcc,0xbe28defc,0xbdafb680,0xbbc90f88,0xbd96a905,0x3c16cb58,0x3dbc3ac3,0x3e3228d4
.long 0x3dc8bd36,0x3e3b6ecf,0x3e888e93,0x3eb263ef,0x3e888e93,0x3eb3dca5,0x3eddbe79,0x3f02ef9f,0x3edae880,0x3f0242b1,0x3f15f6d9,0x3f286605,0x3f13682a,0x3f269de3,0x3f385216,0x3f485bca
.long 0xbf7b14be,0xbf7d3aac,0xbf7ec46d,0xbf7fb10f,0xbf7ffb11,0xbf7fcbe2,0xbf7eea9d,0xbf7d57de,0xbf7c3b28,0xbf796e4e,0xbf75dec6,0xbf718f57,0xbf6ff573,0xbf6a5ad9,0xbf63f473,0xbf5cc7d1
.long 0xbf5b941a,0xbf531849,0xbf49d112,0xbf3fc767,0xbf3fc767,0xbf34768f,0xbf286605,0xbf1ba299,0xbf1d7fd1,0xbf0f8784,0xbf00e7e4,0xbee363fa,0xbeebcbbb,0xbecb2aae,0xbea986c4,0xbe870ada
.long 0xbe94a031,0xbe605c13,0xbe164083,0xbd96a905,0xbde1bc2e,0xbd0a342f,0x3d2fe007,0x3df475c0,0x3d96a905,0x3e1c76de,0x3e6c9a7f,0x3e9d9e78,0x3e827dc0,0x3eab0201,0x3ed25a09,0x3ef840c8
.long 0x3edae880,0x3f00e7e4,0x3f13682a,0x3f24d225,0x3f15f6d9,0x3f27ce61,0x3f385216,0x3f476085,0x3f396842,0x3f48d8b3,0x3f5695e5,0x3f628210,0x3f5695e5,0x3f62df7b,0x3f6d1c1d,0x3f75341d
.long 0xbf3504f3,0xbf2beb4a,0xbf226799,0xbf187fc0,0xbf187fc0,0xbf0d9281,0xbf0242b1,0xbeed3063,0xbef15aea,0xbed8106b,0xbebe1d4a,0xbea395c5,0xbeac7cd4,0xbe901c2c,0xbe667c66,0xbe2bf804
.long 0xbe47c5c2,0xbe09cf86,0xbd96a905,0xbc490e90,0xbd48fb30,0x3c7b514b,0x3da3308c,0x3e1324ca,0x3dc8bd36,0x3e28defc,0x3e6c9a7f,0x3e97a117,0x3e78cfcc,0x3e9f1cdf,0x3ec1071e,0x3ee1fb6a
.long 0x3ec3ef15,0x3ee63375,0x3f039c3d,0x3f13682a,0x3f039c3d,0x3f140c5f,0x3f239da9,0x3f3238aa,0x3f226799,0x3f31a81d,0x3f3fc767,0x3f4cae79,0x3f3daef9,0x3f4b41fa,0x3f577026,0x3f62241a
.long 0x3f54db31,0x3f604621,0x3f6a09a7,0x3f721352,0x3f676bd8,0x3f703b37,0x3f772417,0x3f7c187a,0x3f74fa0b,0x3f7ac516,0x3f7e70b0,0x3f7ff4e6,0x3f7d3aac,0x3f7fa6e3,0x3f7fc38f,0x3f7d906e
.long 0xbf0e39da,0xbf039c3d,0xbef15aea,0xbedae880,0xbed53641,0xbebca7af,0xbea395c5,0xbe8a11f7,0xbe888e93,0xbe5a3997,0xbe22abb6,0xbdd53db9,0xbde1bc2e,0xbd55880e,0x3bc90f88,0x3d83db0a
.long 0x3d48fb30,0x3de1bc2e,0x3e2f10a2,0x3e6c9a7f,0x3e541501,0x3e8a11f7,0x3ea986c4,0x3ec8477c,0x3eb8442a,0x3ed8106b,0x3ef6e0cb,0x3f0a48ad,0x3f00e7e4,0x3f102dd5,0x3f1ebc12,0x3f2c800f
.long 0x3f226799,0x3f3085bb,0x3f3daef9,0x3f49d112,0x3f3fc767,0x3f4c3578,0x3f577026,0x3f61668a,0x3f584853,0x3f628210,0x3f6b4b0c,0x3f7294f8,0x3f6b4b0c,0x3f72d4eb,0x3f78b47b,0x3f7cdf6c
.long 0x3f7853f8,0x3f7cbfc9,0x3f7f4e6d,0x3f7ffb11,0x3f7f0e58,0x3f7fffb1,0x3f7eea9d,0x3f7bd14d,0x3f7f4e6d,0x3f7c7eb0,0x3f778bc5,0x3f708066,0x3f791298,0x3f725470,0x3f696591,0x3f5e5aa6
.long 0xbec3ef15,0xbeac7cd4,0xbe94a031,0xbe78cfcc,0xbe605c13,0xbe2bf804,0xbdee3876,0xbd83db0a,0xbd48fb30,0x3bc90f88,0x3d7b2b74,0x3dee3876,0x3dfab273,0x3e3857ec,0x3e72b651,0x3e9620d2
.long 0x3e94a031,0x3eb263ef,0x3ecf7bca,0x3eebcbbb,0x3ee63375,0x3f019573,0x3f0f8784,0x3f1ce11f,0x3f187fc0,0x3f26050a,0x3f32c8c9,0x3f3ebc1b,0x3f396842,0x3f456439,0x3f5064af,0x3f5a5ba0
.long 0x3f54db31,0x3f5ebe05,0x3f676bd8,0x3f6ed89e,0x3f6a09a7,0x3f714c7a,0x3f772417,0x3f7b87b2,0x3f7853f8,0x3f7c7eb0,0x3f7f0e58,0x3f7ffec4,0x3f7f4e6d,0x3f7ffd39,0x3f7eea9d,0x3f7c187a
.long 0x3f7ec46d,0x3f7baccd,0x3f76ba07,0x3f6ff573,0x3f76ba07,0x3f6faf1b,0x3f66becc,0x3f5bfb34,0x3f676bd8,0x3f5c61c7,0x3f4f7a1f,0x3f40d0da,0x3f514d3d,0x3f425b89,0x3f31a81d,0x3f1f599f
.long 0xbe47c5c2,0xbe164083,0xbdc8bd36,0xbd48fb30,0xbc490e90,0x3d2351cb,0x3dbc3ac3,0x3e1324ca,0x3e2f10a2,0x3e667c66,0x3e8e9a22,0x3ea986c4,0x3eb263ef,0x3ece0bea,0x3ee900b7,0x3f019573
.long 0x3f039c3d,0x3f10d3cd,0x3f1d7fd1,0x3f299415,0x3f299415,0x3f3592e7,0x3f40d0da,0x3f4b41fa,0x3f49d112,0x3f53fac3,0x3f5d2d53,0x3f655e0b,0x3f633c5a,0x3f6afb8c,0x3f718f57,0x3f76ef5b
.long 0x3f74fa0b,0x3f79c79d,0x3f7d3aac,0x3f7f4e6d,0x3f7e70b0,0x3f7fdaaf,0x3f7fc38f,0x3f7e2b72,0x3f7f4e6d,0x3f7cfe73,0x3f791298,0x3f73913f,0x3f778bc5,0x3f714c7a,0x3f696591,0x3f5fe4e9
.long 0x3f676bd8,0x3f5d2d53,0x3f514d3d,0x3f43e200,0x3f4f7a1f,0x3f4154e1,0x3f31a81d,0x3f209393,0x3f3085bb,0x3f1ebc12,0x3f0b9a6b,0x3eee9479,0x3f0b9a6b,0x3eed3063,0x3ec1071e,0x3e931f35
.long 0x3f800000,0x3f7fb10f,0x3f7ec46d,0x3f7d3aac,0x3f800000,0x3f7fa6e3,0x3f7e9bc9,0x3f7cdf6c,0x3f800000,0x3f7f9c18,0x3f7e70b0,0x3f7c7eb0,0x3f800000,0x3f7f90b1,0x3f7e4323,0x3f7c187a
.long 0x3f800000,0x3f7f84ab,0x3f7e1324,0x3f7baccd,0x3f800000,0x3f7f7808,0x3f7de0b1,0x3f7b3bab,0x3f800000,0x3f7f6ac7,0x3f7dabcc,0x3f7ac516,0x3f800000,0x3f7f5ce9,0x3f7d7474,0x3f7a4910
.long 0x3f800000,0x3f7f4e6d,0x3f7d3aac,0x3f79c79d,0x3f800000,0x3f7f3f54,0x3f7cfe73,0x3f7940c0,0x3f800000,0x3f7f2f9d,0x3f7cbfc9,0x3f78b47b,0x3f800000,0x3f7f1f49,0x3f7c7eb0,0x3f7822d1
.long 0x3f800000,0x3f7f0e58,0x3f7c3b28,0x3f778bc5,0x3f800000,0x3f7efcc9,0x3f7bf531,0x3f76ef5b,0x3f800000,0x3f7eea9d,0x3f7baccd,0x3f764d97,0x3f800000,0x3f7ed7d4,0x3f7b61fc,0x3f75a67b
.long 0x3f7b14be,0x3f7853f8,0x3f74fa0b,0x3f710908,0x3f7a7302,0x3f77583a,0x3f73913f,0x3f6f20b0,0x3f79c79d,0x3f764d97,0x3f721352,0x3f6d1c1d,0x3f791298,0x3f75341d,0x3f708066,0x3f6afb8c
.long 0x3f7853f8,0x3f740bdd,0x3f6ed89e,0x3f68bf3c,0x3f778bc5,0x3f72d4eb,0x3f6d1c1d,0x3f666771,0x3f76ba07,0x3f718f57,0x3f6b4b0c,0x3f63f473,0x3f75dec6,0x3f703b37,0x3f696591,0x3f61668a
.long 0x3f74fa0b,0x3f6ed89e,0x3f676bd8,0x3f5ebe05,0x3f740bdd,0x3f6d67a1,0x3f655e0b,0x3f5bfb34,0x3f731447,0x3f6be858,0x3f633c5a,0x3f591e6a,0x3f721352,0x3f6a5ad9,0x3f6106f2,0x3f5627fe
.long 0x3f710908,0x3f68bf3c,0x3f5ebe05,0x3f531849,0x3f6ff573,0x3f671599,0x3f5c61c7,0x3f4fefa8,0x3f6ed89e,0x3f655e0b,0x3f59f26a,0x3f4cae79,0x3f6db293,0x3f6398ac,0x3f577026,0x3f495521
.long 0x3f6c835e,0x3f676bd8,0x3f61c598,0x3f5b941a,0x3f6a09a7,0x3f644fac,0x3f5df6be,0x3f570348,0x3f676bd8,0x3f6106f2,0x3f59f26a,0x3f5233c6,0x3f64aa59,0x3f5d924d,0x3f55b993,0x3f4d26fd
.long 0x3f61c598,0x3f59f26a,0x3f514d3d,0x3f47de65,0x3f5ebe05,0x3f5627fe,0x3f4cae79,0x3f425b89,0x3f5b941a,0x3f5233c6,0x3f47de65,0x3f3ca003,0x3f584853,0x3f4e1689,0x3f42de29,0x3f36ad7f
.long 0x3f54db31,0x3f49d112,0x3f3daef9,0x3f3085bb,0x3f514d3d,0x3f456439,0x3f385216,0x3f2a2a80,0x3f4d9f02,0x3f40d0da,0x3f32c8c9,0x3f239da9,0x3f49d112,0x3f3c17d9,0x3f2d1469,0x3f1ce11f
.long 0x3f45e403,0x3f373a23,0x3f273656,0x3f15f6d9,0x3f41d870,0x3f3238aa,0x3f212ff9,0x3f0ee0db,0x3f3daef9,0x3f2d1469,0x3f1b02c6,0x3f07a136,0x3f396842,0x3f27ce61,0x3f14b039,0x3f003a06
.long 0x3f54db31,0x3f4d9f02,0x3f45e403,0x3f3daef9,0x3f4f7a1f,0x3f476085,0x3f3ebc1b,0x3f3592e7,0x3f49d112,0x3f40d0da,0x3f373a23,0x3f2d1469,0x3f43e200,0x3f39f2ac,0x3f2f61a5,0x3f24381a
.long 0x3f3daef9,0x3f32c8c9,0x3f273656,0x3f1b02c6,0x3f373a23,0x3f2b561b,0x3f1ebc12,0x3f11796b,0x3f3085bb,0x3f239da9,0x3f15f6d9,0x3f07a136,0x3f299415,0x3f1ba299,0x3f0cead0,0x3efafef7
.long 0x3f226799,0x3f13682a,0x3f039c3d,0x3ee63375,0x3f1b02c6,0x3f0af1b7,0x3ef41f07,0x3ed0eb2a,0x3f13682a,0x3f0242b1,0x3ee0924f,0x3ebb31a0,0x3f0b9a6b,0x3ef2bd43,0x3ecc9b8b,0x3ea5129f
.long 0x3f039c3d,0x3ee0924f,0x3eb8442a,0x3e8e9a22,0x3ef6e0cb,0x3ece0bea,0x3ea395c5,0x3e6fa8b2,0x3ee63375,0x3ebb31a0,0x3e8e9a22,0x3e419b37,0x3ed53641,0x3ea80b1f,0x3e72b651,0x3e1324ca
.long 0x0,0xbd48fb30,0xbdc8bd36,0xbe164083,0x0,0xbd55880e,0xbdd53db9,0xbe1f917b,0x0,0xbd621469,0xbde1bc2e,0xbe28defc,0x0,0xbd6ea038,0xbdee3876,0xbe3228d4
.long 0x0,0xbd7b2b74,0xbdfab273,0xbe3b6ecf,0x0,0xbd83db0a,0xbe039502,0xbe44b0b9,0x0,0xbd8a200a,0xbe09cf86,0xbe4dee60,0x0,0xbd9064b4,0xbe1008b7,0xbe57278f
.long 0x0,0xbd96a905,0xbe164083,0xbe605c13,0x0,0xbd9cecf9,0xbe1c76de,0xbe698bba,0x0,0xbda3308c,0xbe22abb6,0xbe72b651,0x0,0xbda973ba,0xbe28defc,0xbe7bdba4
.long 0x0,0xbdafb680,0xbe2f10a2,0xbe827dc0,0x0,0xbdb5f8da,0xbe354098,0xbe870ada,0x0,0xbdbc3ac3,0xbe3b6ecf,0xbe8b9507,0x0,0xbdc27c39,0xbe419b37,0xbe901c2c
.long 0xbe47c5c2,0xbe78cfcc,0xbe94a031,0xbeac7cd4,0xbe541501,0xbe840270,0xbe9d9e78,0xbeb6ccc3,0xbe605c13,0xbe8b9507,0xbea68f12,0xbec1071e,0xbe6c9a7f,0xbe931f35,0xbeaf713a,0xbecb2aae
.long 0xbe78cfcc,0xbe9aa086,0xbeb8442a,0xbed53641,0xbe827dc0,0xbea21887,0xbec1071e,0xbedf28a9,0xbe888e93,0xbea986c4,0xbec9b953,0xbee900b7,0xbe8e9a22,0xbeb0eacb,0xbed25a09,0xbef2bd43
.long 0xbe94a031,0xbeb8442a,0xbedae880,0xbefc5d27,0xbe9aa086,0xbebf926f,0xbee363fa,0xbf02ef9f,0xbea09ae5,0xbec6d529,0xbeebcbbb,0xbf07a136,0xbea68f12,0xbece0bea,0xbef41f07,0xbf0c42c9
.long 0xbeac7cd4,0xbed53641,0xbefc5d27,0xbf10d3cd,0xbeb263ef,0xbedc53c1,0xbf0242b1,0xbf1553b7,0xbeb8442a,0xbee363fa,0xbf064b82,0xbf19c200,0xbebe1d4a,0xbeea6681,0xbf0a48ad,0xbf1e1e22
.long 0xbec3ef15,0xbedae880,0xbef15aea,0xbf039c3d,0xbecf7bca,0xbee79a5d,0xbeff17b2,0xbf0af1b7,0xbedae880,0xbef41f07,0xbf064b82,0xbf121eb0,0xbee63375,0xbf003a06,0xbf0cead0,0xbf19210f
.long 0xbef15aea,0xbf064b82,0xbf13682a,0xbf1ff6cb,0xbefc5d27,0xbf0c42c9,0xbf19c200,0xbf269de3,0xbf039c3d,0xbf121eb0,0xbf1ff6cb,0xbf2d1469,0xbf08f59b,0xbf17de12,0xbf26050a,0xbf33587a
.long 0xbf0e39da,0xbf1d7fd1,0xbf2beb4a,0xbf396842,0xbf13682a,0xbf2302d3,0xbf31a81d,0xbf3f41fc,0xbf187fc0,0xbf286605,0xbf373a23,0xbf44e3f5,0xbf1d7fd1,0xbf2da859,0xbf3ca003,0xbf4a4c87
.long 0xbf226799,0xbf32c8c9,0xbf41d870,0xbf4f7a1f,0xbf273656,0xbf37c655,0xbf46e22a,0xbf546b3b,0xbf2beb4a,0xbf3ca003,0xbf4bbbf8,0xbf591e6a,0xbf3085bb,0xbf4154e1,0xbf5064af,0xbf5d924d
.long 0xbf0e39da,0xbf187fc0,0xbf226799,0xbf2beb4a,0xbf15f6d9,0xbf209393,0xbf2ac082,0xbf34768f,0xbf1d7fd1,0xbf286605,0xbf32c8c9,0xbf3ca003,0xbf24d225,0xbf2ff3e6,0xbf3a7ca4,0xbf446337
.long 0xbf2beb4a,0xbf373a23,0xbf41d870,0xbf4bbbf8,0xbf32c8c9,0xbf3e35c5,0xbf48d8b3,0xbf52a649,0xbf396842,0xbf44e3f5,0xbf4f7a1f,0xbf591e6a,0xbf3fc767,0xbf4b41fa,0xbf55b993,0xbf5f20db
.long 0xbf45e403,0xbf514d3d,0xbf5b941a,0xbf64aa59,0xbf4bbbf8,0xbf570348,0xbf6106f2,0xbf69b7e4,0xbf514d3d,0xbf5c61c7,0xbf660f88,0xbf6e46be,0xbf5695e5,0xbf61668a,0xbf6aab7b,0xbf725470
.long 0xbf5b941a,0xbf660f88,0xbf6ed89e,0xbf75dec6,0xbf604621,0xbf6a5ad9,0xbf7294f8,0xbf78e3d6,0xbf64aa59,0xbf6e46be,0xbf75dec6,0xbf7b61fc,0xbf68bf3c,0xbf71d19f,0xbf78b47b,0xbf7d57de
.long 0x3f3504f3,0x3f2beb4a,0x3f226799,0x3f187fc0,0x3f2beb4a,0x3f21cbfb,0x3f173c07,0x3f0c42c9,0x3f226799,0x3f173c07,0x3f0b9a6b,0x3eff17b2,0x3f187fc0,0x3f0c42c9,0x3eff17b2,0x3ee4cbfe
.long 0x3f0e39da,0x3f00e7e4,0x3ee63375,0x3ec9b953,0x3f039c3d,0x3eea6681,0x3ecc9b8b,0x3eadf73c,0x3ef15aea,0x3ed25a09,0x3eb263ef,0x3e919ddd,0x3edae880,0x3eb9bb1e,0x3e97a117,0x3e698bba
.long 0x3ec3ef15,0x3ea09ae5,0x3e78cfcc,0x3e2f10a2,0x3eac7cd4,0x3e870ada,0x3e419b37,0x3de7fa9a,0x3e94a031,0x3e5a3997,0x3e09cf86,0x3d621469,0x3e78cfcc,0x3e25c58c,0x3da3308c,0xbb490fc6
.long 0x3e47c5c2,0x3de1bc2e,0x3cc90ab0,0xbd7b2b74,0x3e164083,0x3d6ea038,0xbcfb49ba,0xbdf475c0,0x3dc8bd36,0x3bc90f88,0xbdafb680,0xbe354098,0x3d48fb30,0xbd3c6dd5,0xbe1008b7,0xbe6fa8b2
.long 0x3f0e39da,0x3f039c3d,0x3ef15aea,0x3edae880,0x3f00e7e4,0x3eea6681,0x3ed25a09,0x3eb9bb1e,0x3ee63375,0x3ecc9b8b,0x3eb263ef,0x3e97a117,0x3ec9b953,0x3eadf73c,0x3e919ddd,0x3e698bba
.long 0x3eac7cd4,0x3e8e9a22,0x3e605c13,0x3e22abb6,0x3e8e9a22,0x3e5d4b1a,0x3e1c76de,0x3db5f8da,0x3e605c13,0x3e1c76de,0x3dafb680,0x3c96c9b6,0x3e22abb6,0x3db5f8da,0x3c96c9b6,0xbd55880e
.long 0x3dc8bd36,0x3cc90ab0,0xbd48fb30,0xbdfab273,0x3d16c32c,0xbd2351cb,0xbdee3876,0xbe44b0b9,0xbcc90ab0,0xbdd53db9,0xbe3b6ecf,0xbe8586ce,0xbdafb680,0xbe2bf804,0xbe7ee6e1,0xbea80b1f
.long 0xbe164083,0xbe6c9a7f,0xbea09ae5,0xbec9b953,0xbe541501,0xbe9620d2,0xbec1071e,0xbeea6681,0xbe888e93,0xbeb554ec,0xbee0924f,0xbf04f484,0xbea68f12,0xbed3c867,0xbeff17b2,0xbf140c5f
.long 0x3ec3ef15,0x3eac7cd4,0x3e94a031,0x3e78cfcc,0x3ea09ae5,0x3e870ada,0x3e5a3997,0x3e25c58c,0x3e78cfcc,0x3e419b37,0x3e09cf86,0x3da3308c,0x3e2f10a2,0x3de7fa9a,0x3d621469,0xbb490fc6
.long 0x3dc8bd36,0x3d16c32c,0xbcc90ab0,0xbdafb680,0x3cc90ab0,0xbd2351cb,0xbdd53db9,0xbe2bf804,0xbd48fb30,0xbdee3876,0xbe3b6ecf,0xbe7ee6e1,0xbdfab273,0xbe44b0b9,0xbe8586ce,0xbea80b1f
.long 0xbe47c5c2,0xbe888e93,0xbeac7cd4,0xbecf7bca,0xbe888e93,0xbeadf73c,0xbed25a09,0xbef58035,0xbeac7cd4,0xbed25a09,0xbef6e0cb,0xbf0cead0,0xbecf7bca,0xbef58035,0xbf0cead0,0xbf1e1e22
.long 0xbef15aea,0xbf0b9a6b,0xbf1d7fd1,0xbf2e3bde,0xbf08f59b,0xbf1ba299,0xbf2d1469,0xbf3d27b8,0xbf187fc0,0xbf2ac082,0xbf3b8f3b,0xbf4ac77f,0xbf273656,0xbf38dd65,0xbf48d8b3,0xbf570348
.long 0x3e47c5c2,0x3e164083,0x3dc8bd36,0x3d48fb30,0x3de1bc2e,0x3d6ea038,0x3bc90f88,0xbd3c6dd5,0x3cc90ab0,0xbcfb49ba,0xbdafb680,0xbe1008b7,0xbd7b2b74,0xbdf475c0,0xbe354098,0xbe6fa8b2
.long 0xbe164083,0xbe541501,0xbe888e93,0xbea68f12,0xbe6c9a7f,0xbe9620d2,0xbeb554ec,0xbed3c867,0xbea09ae5,0xbec1071e,0xbee0924f,0xbeff17b2,0xbec9b953,0xbeea6681,0xbf04f484,0xbf140c5f
.long 0xbef15aea,0xbf08f59b,0xbf187fc0,0xbf273656,0xbf0b9a6b,0xbf1ba299,0xbf2ac082,0xbf38dd65,0xbf1d7fd1,0xbf2d1469,0xbf3b8f3b,0xbf48d8b3,0xbf2e3bde,0xbf3d27b8,0xbf4ac77f,0xbf570348
.long 0xbf3daef9,0xbf4bbbf8,0xbf584853,0xbf633c5a,0xbf4bbbf8,0xbf58b3a1,0xbf63f473,0xbf6d67a1,0xbf584853,0xbf63f473,0xbf6db293,0xbf756d97,0xbf633c5a,0xbf6d67a1,0xbf756d97,0xbf7b3bab
.long 0xbf3504f3,0xbf3daef9,0xbf45e403,0xbf4d9f02,0xbf3daef9,0xbf466354,0xbf4e8d90,0xbf5627fe,0xbf45e403,0xbf4e8d90,0xbf5695e5,0xbf5df6be,0xbf4d9f02,0xbf5627fe,0xbf5df6be,0xbf650479
.long 0xbf54db31,0xbf5d2d53,0xbf64aa59,0xbf6b4b0c,0xbf5b941a,0xbf6398ac,0xbf6aab7b,0xbf70c501,0xbf61c598,0xbf696591,0xbf6ff573,0xbf756d97,0xbf676bd8,0xbf6e8ff8,0xbf748422,0xbf7940c0
.long 0xbf6c835e,0xbf731447,0xbf7853f8,0xbf7c3b28,0xbf710908,0xbf76ef5b,0xbf7b61fc,0xbf7e5a38,0xbf74fa0b,0xbf7a1e84,0xbf7dabcc,0xbf7f9c18,0xbf7853f8,0xbf7c9f8a,0xbf7f2f9d,0xbf7fffb1
.long 0xbf7b14be,0xbf7e70b0,0xbf7fec43,0xbf7f84ab,0xbf7d3aac,0xbf7f90b1,0xbf7fe129,0xbf7e2b72,0xbf7ec46d,0xbf7ffec4,0xbf7f0e58,0xbf7bf531,0xbf7fb10f,0xbf7fba9e,0xbf7d7474,0xbf78e3d6
.long 0xbf54db31,0xbf5b941a,0xbf61c598,0xbf676bd8,0xbf5d2d53,0xbf6398ac,0xbf696591,0xbf6e8ff8,0xbf64aa59,0xbf6aab7b,0xbf6ff573,0xbf748422,0xbf6b4b0c,0xbf70c501,0xbf756d97,0xbf7940c0
.long 0xbf710908,0xbf75dec6,0xbf79c79d,0xbf7cbfc9,0xbf75dec6,0xbf79f35e,0xbf7cfe73,0xbf7efcc9,0xbf79c79d,0xbf7cfe73,0xbf7f0e58,0xbf7ff4e6,0xbf7cbfc9,0xbf7efcc9,0xbf7ff4e6,0xbf7fa6e3
.long 0xbf7ec46d,0xbf7fec43,0xbf7fb10f,0xbf7e1324,0xbf7fd397,0xbf7fcbe2,0xbf7e4323,0xbf7b3bab,0xbf7fec43,0xbf7e9bc9,0xbf7baccd,0xbf772417,0xbf7f0e58,0xbf7c5d3a,0xbf77f110,0xbf71d19f
.long 0xbf7d3aac,0xbf791298,0xbf731447,0xbf6b4b0c,0xbf7a7302,0xbf74bf62,0xbf6d1c1d,0xbf6398ac,0xbf76ba07,0xbf6f6830,0xbf660f88,0xbf5ac450,0xbf721352,0xbf6912ae,0xbf5df6be,0xbf50d937
.long 0xbf6c835e,0xbf710908,0xbf74fa0b,0xbf7853f8,0xbf731447,0xbf76ef5b,0xbf7a1e84,0xbf7c9f8a,0xbf7853f8,0xbf7b61fc,0xbf7dabcc,0xbf7f2f9d,0xbf7c3b28,0xbf7e5a38,0xbf7f9c18,0xbf7fffb1
.long 0xbf7ec46d,0xbf7fd397,0xbf7fec43,0xbf7f0e58,0xbf7fec43,0xbf7fcbe2,0xbf7e9bc9,0xbf7c5d3a,0xbf7fb10f,0xbf7e4323,0xbf7baccd,0xbf77f110,0xbf7e1324,0xbf7b3bab,0xbf772417,0xbf71d19f
.long 0xbf7b14be,0xbf76ba07,0xbf710908,0xbf6a09a7,0xbf76ba07,0xbf70c501,0xbf696591,0xbf60a6cf,0xbf710908,0xbf696591,0xbf604621,0xbf55b993,0xbf6a09a7,0xbf60a6cf,0xbf55b993,0xbf495521
.long 0xbf61c598,0xbf5695e5,0xbf49d112,0xbf3b8f3b,0xbf584853,0xbf4b41fa,0xbf3ca003,0xbf2c800f,0xbf4d9f02,0xbf3ebc1b,0xbf2e3bde,0xbf1c420c,0xbf41d870,0xbf311722,0xbf1ebc12,0xbf0af1b7
.long 0xbf7b14be,0xbf7d3aac,0xbf7ec46d,0xbf7fb10f,0xbf7e70b0,0xbf7f90b1,0xbf7ffec4,0xbf7fba9e,0xbf7fec43,0xbf7fe129,0xbf7f0e58,0xbf7d7474,0xbf7f84ab,0xbf7e2b72,0xbf7bf531,0xbf78e3d6
.long 0xbf7d3aac,0xbf7a7302,0xbf76ba07,0xbf721352,0xbf791298,0xbf74bf62,0xbf6f6830,0xbf6912ae,0xbf731447,0xbf6d1c1d,0xbf660f88,0xbf5df6be,0xbf6b4b0c,0xbf6398ac,0xbf5ac450,0xbf50d937
.long 0xbf61c598,0xbf584853,0xbf4d9f02,0xbf41d870,0xbf5695e5,0xbf4b41fa,0xbf3ebc1b,0xbf311722,0xbf49d112,0xbf3ca003,0xbf2e3bde,0xbf1ebc12,0xbf3b8f3b,0xbf2c800f,0xbf1c420c,0xbf0af1b7
.long 0xbf2beb4a,0xbf1b02c6,0xbf08f59b,0xbeebcbbb,0xbf1b02c6,0xbf084b92,0xbee900b7,0xbebf926f,0xbf08f59b,0xbee900b7,0xbebe1d4a,0xbe919ddd,0xbeebcbbb,0xbebf926f,0xbe919ddd,0xbe44b0b9
.long 0x248d3132,0xbdc8bd36,0xbe47c5c2,0xbe94a031,0xbd48fb30,0xbe195be0,0xbe7ee6e1,0xbeb0eacb,0xbdc8bd36,0xbe4dee60,0xbe9aa086,0xbecc9b8b,0xbe164083,0xbe80f8c0,0xbeb554ec,0xbee79a5d
.long 0xbe47c5c2,0xbe9aa086,0xbecf7bca,0xbf00e7e4,0xbe78cfcc,0xbeb3dca5,0xbee900b7,0xbf0d9281,0xbe94a031,0xbecc9b8b,0xbf00e7e4,0xbf19c200,0xbeac7cd4,0xbee4cbfe,0xbf0cead0,0xbf256bcb
.long 0xbec3ef15,0xbefc5d27,0xbf187fc0,0xbf3085bb,0xbedae880,0xbf099f4e,0xbf239da9,0xbf3b0629,0xbef15aea,0xbf14b039,0xbf2e3bde,0xbf44e3f5,0xbf039c3d,0xbf1f599f,0xbf385216,0xbf4e1689
.long 0xbf0e39da,0xbf299415,0xbf41d870,0xbf5695e5,0xbf187fc0,0xbf33587a,0xbf4ac77f,0xbf5e5aa6,0xbf226799,0xbf3ca003,0xbf531849,0xbf655e0b,0xbf2beb4a,0xbf456439,0xbf5ac450,0xbf6b99fb
.long 0xbec3ef15,0xbef15aea,0xbf0e39da,0xbf226799,0xbee0924f,0xbf06f686,0xbf1c420c,0xbf2ff3e6,0xbefc5d27,0xbf14b039,0xbf299415,0xbf3ca003,0xbf0b9a6b,0xbf21cbfb,0xbf36206c,0xbf485bca
.long 0xbf187fc0,0xbf2e3bde,0xbf41d870,0xbf531849,0xbf24d225,0xbf39f2ac,0xbf4cae79,0xbf5cc7d1,0xbf3085bb,0xbf44e3f5,0xbf5695e5,0xbf655e0b,0xbf3b8f3b,0xbf4f0417,0xbf5f8327,0xbf6cd007
.long 0xbf45e403,0xbf584853,0xbf676bd8,0xbf731447,0xbf4f7a1f,0xbf60a6cf,0xbf6e46be,0xbf7822d1,0xbf584853,0xbf6816a8,0xbf740bdd,0xbf7bf531,0xbf604621,0xbf6e8ff8,0xbf78b47b,0xbf7e868b
.long 0xbf676bd8,0xbf740bdd,0xbf7c3b28,0xbf7fd397,0xbf6db293,0xbf788486,0xbf7e9bc9,0xbf7fdaaf,0xbf731447,0xbf7bf531,0xbf7fd397,0xbf7e9bc9,0xbf778bc5,0xbf7e5a38,0xbf7fe129,0xbf7c187a
.long 0xbf3504f3,0xbf45e403,0xbf54db31,0xbf61c598,0xbf41d870,0xbf51c0c2,0xbf5f8327,0xbf6afb8c,0xbf4d9f02,0xbf5c61c7,0xbf68bf3c,0xbf7294f8,0xbf584853,0xbf65b710,0xbf708066,0xbf788486
.long 0xbf61c598,0xbf6db293,0xbf76ba07,0xbf7cbfc9,0xbf6a09a7,0xbf74484b,0xbf7b61fc,0xbf7f3f54,0xbf710908,0xbf796e4e,0xbf7e70b0,0xbf7ffec4,0xbf76ba07,0xbf7d1cdd,0xbf7fe129,0xbf7efcc9
.long 0xbf7b14be,0xbf7f4e6d,0xbf7fb10f,0xbf7c3b28,0xbf7e1324,0xbf7fffb1,0xbf7de0b1,0xbf77beb7,0xbf7fb10f,0xbf7f2f9d,0xbf7a7302,0xbf718f57,0xbf7fec43,0xbf7cdf6c,0xbf756d97,0xbf69b7e4
.long 0xbf7ec46d,0xbf791298,0xbf6ed89e,0xbf604621,0xbf7c3b28,0xbf73ced9,0xbf66becc,0xbf554aa4,0xbf7853f8,0xbf6d1c1d,0xbf5d2d53,0xbf48d8b3,0xbf731447,0xbf650479,0xbf5233c6,0xbf3b0629
.long 0xbf6c835e,0xbf74fa0b,0xbf7b14be,0xbf7ec46d,0xbf740bdd,0xbf7a9c59,0xbf7e9bc9,0xbf7fffb1,0xbf79c79d,0xbf7e4323,0xbf7ffb11,0xbf7eea9d,0xbf7dabcc,0xbf7fe705,0xbf7f2f9d,0xbf7b87b2
.long 0xbf7fb10f,0xbf7f84ab,0xbf7c3b28,0xbf75dec6,0xbf7fd397,0xbf7d1cdd,0xbf772417,0xbf6dfcf2,0xbf7e1324,0xbf78b47b,0xbf6ff573,0xbf63f473,0xbf7a7302,0xbf725470,0xbf66becc,0xbf57dc7f
.long 0xbf74fa0b,0xbf6a09a7,0xbf5b941a,0xbf49d112,0xbf6db293,0xbf5fe4e9,0xbf4e8d90,0xbf39f2ac,0xbf64aa59,0xbf53fac3,0xbf3fc767,0xbf286605,0xbf59f26a,0xbf466354,0xbf2f61a5,0xbf1553b7
.long 0xbf4d9f02,0xbf373a23,0xbf1d7fd1,0xbf00e7e4,0xbf3fc767,0xbf269de3,0xbf0a48ad,0xbed6a399,0xbf3085bb,0xbf14b039,0xbeebcbbb,0xbea986c4,0xbf1ff6cb,0xbf019573,0xbec1071e,0xbe75c35a
.long 0x3f800000,0x3f7ec46d,0x3f7b14be,0x3f74fa0b,0x3f7fb10f,0x3f7d1cdd,0x3f77f110,0x3f703b37,0x3f7ec46d,0x3f7ac516,0x3f740bdd,0x3f6aab7b,0x3f7d3aac,0x3f77beb7,0x3f6f6830,0x3f644fac
.long 0x3f7b14be,0x3f740bdd,0x3f6a09a7,0x3f5d2d53,0x3f7853f8,0x3f6faf1b,0x3f63f473,0x3f554aa4,0x3f74fa0b,0x3f6aab7b,0x3f5d2d53,0x3f4cae79,0x3f710908,0x3f650479,0x3f55b993,0x3f436051
.long 0x3f6c835e,0x3f5ebe05,0x3f4d9f02,0x3f396842,0x3f676bd8,0x3f57dc7f,0x3f44e3f5,0x3f2ecef7,0x3f61c598,0x3f5064af,0x3f3b8f3b,0x3f239da9,0x3f5b941a,0x3f485bca,0x3f31a81d,0x3f17de12
.long 0x3f54db31,0x3f3fc767,0x3f273656,0x3f0b9a6b,0x3f4d9f02,0x3f36ad7f,0x3f1c420c,0x3efdbabb,0x3f45e403,0x3f2d1469,0x3f10d3cd,0x3ee363fa,0x3f3daef9,0x3f2302d3,0x3f04f484,0x3ec8477c
.long 0x3f6c835e,0x3f61c598,0x3f54db31,0x3f45e403,0x3f660f88,0x3f5988ad,0x3f4ac77f,0x3f39f2ac,0x3f5ebe05,0x3f5064af,0x3f3fc767,0x3f2d1469,0x3f5695e5,0x3f466354,0x3f33e7bc,0x3f1f599f
.long 0x3f4d9f02,0x3f3b8f3b,0x3f273656,0x3f10d3cd,0x3f43e200,0x3f2ff3e6,0x3f19c200,0x3f019573,0x3f396842,0x3f239da9,0x3f0b9a6b,0x3ee363fa,0x3f2e3bde,0x3f16999f,0x3ef9a02d,0x3ec27b55
.long 0x3f226799,0x3f08f59b,0x3edae880,0x3ea09ae5,0x3f15f6d9,0x3ef58035,0x3ebb31a0,0x3e7bdba4,0x3f08f59b,0x3ed8106b,0x3e9aa086,0x3e354098,0x3ef6e0cb,0x3eb9bb1e,0x3e72b651,0x3ddb7d37
.long 0x3edae880,0x3e9aa086,0x3e2f10a2,0x3d16c32c,0x3ebe1d4a,0x3e75c35a,0x3dd53db9,0xbd0a342f,0x3ea09ae5,0x3e354098,0x3d16c32c,0xbdd53db9,0x3e827dc0,0x3de7fa9a,0xbcfb49ba,0xbe3228d4
.long 0x3f3504f3,0x3f226799,0x3f0e39da,0x3ef15aea,0x3f273656,0x3f12c39a,0x3ef9a02d,0x3ecb2aae,0x3f187fc0,0x3f0242b1,0x3ed53641,0x3ea395c5,0x3f08f59b,0x3ee1fb6a,0x3eaf713a,0x3e75c35a
.long 0x3ef15aea,0x3ebe1d4a,0x3e888e93,0x3e22abb6,0x3ecf7bca,0x3e9920fe,0x3e419b37,0x3d9cecf9,0x3eac7cd4,0x3e667c66,0x3de1bc2e,0xbbc90f88,0x3e888e93,0x3e195be0,0x3cfb49ba,0xbdb5f8da
.long 0x3e47c5c2,0x3d96a905,0xbd48fb30,0xbe2f10a2,0x3dfab273,0xbb490fc6,0xbe039502,0xbe80f8c0,0x3d48fb30,0xbda3308c,0xbe541501,0xbea986c4,0xbcc90ab0,0xbe1f917b,0xbe919ddd,0xbed0eb2a
.long 0xbdc8bd36,0xbe6c9a7f,0xbeb8442a,0xbef6e0cb,0xbe2f10a2,0xbe9c1faf,0xbeddbe79,0xbf0d9281,0xbe78cfcc,0xbec1071e,0xbf00e7e4,0xbf1ebc12,0xbea09ae5,0xbee4cbfe,0xbf121eb0,0xbf2ecef7
.long 0x3ec3ef15,0x3e94a031,0x3e47c5c2,0x3dc8bd36,0x3e9aa086,0x3e5101f1,0x3dd53db9,0x3b490fc6,0x3e605c13,0x3dee3876,0x3c490e90,0xbdbc3ac3,0x3e09cf86,0x3ce22a7a,0xbda3308c,0xbe3e853e
.long 0x3d48fb30,0xbd7b2b74,0xbe2f10a2,0xbe8e9a22,0xbd16c32c,0xbe195be0,0xbe8586ce,0xbebca7af,0xbdfab273,0xbe72b651,0xbeb263ef,0xbee900b7,0xbe541501,0xbea5129f,0xbeddbe79,0xbf099f4e
.long 0xbe94a031,0xbecf7bca,0xbf039c3d,0xbf1d7fd1,0xbebe1d4a,0xbef840c8,0xbf173c07,0xbf2ff3e6,0xbee63375,0xbf0f8784,0xbf299415,0xbf40d0da,0xbf064b82,0xbf21cbfb,0xbf3a7ca4,0xbf4fefa8
.long 0xbf187fc0,0xbf32c8c9,0xbf49d112,0xbf5d2d53,0xbf299415,0xbf425b89,0xbf577026,0xbf686b39,0xbf396842,0xbf5064af,0xbf633c5a,0xbf718f57,0xbf47de65,0xbf5cc7d1,0xbf6d1c1d,0xbf788486
.long 0xbf3504f3,0xbf4d9f02,0xbf61c598,0xbf710908,0xbf3daef9,0xbf554aa4,0xbf6816a8,0xbf75a67b,0xbf45e403,0xbf5c61c7,0xbf6db293,0xbf796e4e,0xbf4d9f02,0xbf62df7b,0xbf7294f8,0xbf7c5d3a
.long 0xbf54db31,0xbf68bf3c,0xbf76ba07,0xbf7e70b0,0xbf5b941a,0xbf6dfcf2,0xbf7a1e84,0xbf7fa6e3,0xbf61c598,0xbf7294f8,0xbf7cbfc9,0xbf7ffec4,0xbf676bd8,0xbf76841b,0xbf7e9bc9,0xbf7f7808
.long 0xbf6c835e,0xbf79c79d,0xbf7fb10f,0xbf7e1324,0xbf710908,0xbf7c5d3a,0xbf7ffec4,0xbf7bd14d,0xbf74fa0b,0xbf7e4323,0xbf7f84ab,0xbf78b47b,0xbf7853f8,0xbf7f7808,0xbf7e4323,0xbf74bf62
.long 0xbf7b14be,0xbf7ffb11,0xbf7c3b28,0xbf6ff573,0xbf7d3aac,0xbf7fcbe2,0xbf796e4e,0xbf6a5ad9,0xbf7ec46d,0xbf7eea9d,0xbf75dec6,0xbf63f473,0xbf7fb10f,0xbf7d57de,0xbf718f57,0xbf5cc7d1
.long 0xbf7b14be,0xbf7fb10f,0xbf7ec46d,0xbf7853f8,0xbf7dabcc,0xbf7ff84a,0xbf7c7eb0,0xbf73530e,0xbf7f4e6d,0xbf7f2f9d,0xbf791298,0xbf6d1c1d,0xbf7ffb11,0xbf7d57de,0xbf748422,0xbf65b710
.long 0xbf7fb10f,0xbf7a7302,0xbf6ed89e,0xbf5d2d53,0xbf7e70b0,0xbf76841b,0xbf6816a8,0xbf5389c7,0xbf7c3b28,0xbf718f57,0xbf604621,0xbf48d8b3,0xbf791298,0xbf6b99fb,0xbf577026,0xbf3d27b8
.long 0xbf74fa0b,0xbf64aa59,0xbf4d9f02,0xbf3085bb,0xbf6ff573,0xbf5cc7d1,0xbf42de29,0xbf2302d3,0xbf6a09a7,0xbf53fac3,0xbf373a23,0xbf14b039,0xbf633c5a,0xbf4a4c87,0xbf2ac082,0xbf05a02c
.long 0xbf5b941a,0xbf3fc767,0xbf1d7fd1,0xbeebcbbb,0xbf531849,0xbf34768f,0xbf0f8784,0xbecb2aae,0xbf49d112,0xbf286605,0xbf00e7e4,0xbea986c4,0xbf3fc767,0xbf1ba299,0xbee363fa,0xbe870ada
.long 0xbf6c835e,0xbf5b941a,0xbf45e403,0xbf2beb4a,0xbf64aa59,0xbf50d937,0xbf385216,0xbf1ba299,0xbf5b941a,0xbf44e3f5,0xbf299415,0xbf0a48ad,0xbf514d3d,0xbf37c655,0xbf19c200,0xbeeff7fb
.long 0xbf45e403,0xbf299415,0xbf08f59b,0xbec9b953,0xbf396842,0xbf1a6293,0xbeee9479,0xbea21887,0xbf2beb4a,0xbf0a48ad,0xbec9b953,0xbe72b651,0xbf1d7fd1,0xbef2bd43,0xbea395c5,0xbe1f917b
.long 0xbf0e39da,0xbecf7bca,0xbe78cfcc,0xbd96a905,0xbefc5d27,0xbeab0201,0xbe28defc,0x3c16cb58,0xbedae880,0xbe8586ce,0xbdafb680,0x3dbc3ac3,0xbeb8442a,0xbe3e853e,0xbbc90f88,0x3e3228d4
.long 0xbe94a031,0xbde1bc2e,0x3d96a905,0x3e827dc0,0xbe605c13,0xbd0a342f,0x3e1c76de,0x3eab0201,0xbe164083,0x3d2fe007,0x3e6c9a7f,0x3ed25a09,0xbd96a905,0x3df475c0,0x3e9d9e78,0x3ef840c8
.long 0xbf0e39da,0xbedae880,0xbe94a031,0xbe164083,0xbef6e0cb,0xbeb0eacb,0xbe4dee60,0xbd55880e,0xbecf7bca,0xbe8586ce,0xbde1bc2e,0x3d2fe007,0xbea68f12,0xbe3228d4,0xbc96c9b6,0x3e0cec4a
.long 0xbe78cfcc,0xbdafb680,0x3d96a905,0x3e6c9a7f,0xbe22abb6,0x3b490fc6,0x3e28defc,0x3ea5129f,0xbd96a905,0x3dbc3ac3,0x3e827dc0,0x3ed25a09,0x3c490e90,0x3e3857ec,0x3eaf713a,0x3efdbabb
.long 0x3dc8bd36,0x3e888e93,0x3edae880,0x3f13682a,0x3e3b6ecf,0x3eb3dca5,0x3f0242b1,0x3f269de3,0x3e888e93,0x3eddbe79,0x3f15f6d9,0x3f385216,0x3eb263ef,0x3f02ef9f,0x3f286605,0x3f485bca
.long 0x3edae880,0x3f15f6d9,0x3f396842,0x3f5695e5,0x3f00e7e4,0x3f27ce61,0x3f48d8b3,0x3f62df7b,0x3f13682a,0x3f385216,0x3f5695e5,0x3f6d1c1d,0x3f24d225,0x3f476085,0x3f628210,0x3f75341d
.long 0x3f3504f3,0x3f187fc0,0x3ef15aea,0x3eac7cd4,0x3f2beb4a,0x3f0d9281,0x3ed8106b,0x3e901c2c,0x3f226799,0x3f0242b1,0x3ebe1d4a,0x3e667c66,0x3f187fc0,0x3eed3063,0x3ea395c5,0x3e2bf804
.long 0x3f0e39da,0x3ed53641,0x3e888e93,0x3de1bc2e,0x3f039c3d,0x3ebca7af,0x3e5a3997,0x3d55880e,0x3ef15aea,0x3ea395c5,0x3e22abb6,0xbbc90f88,0x3edae880,0x3e8a11f7,0x3dd53db9,0xbd83db0a
.long 0x3ec3ef15,0x3e605c13,0x3d48fb30,0xbdfab273,0x3eac7cd4,0x3e2bf804,0xbbc90f88,0xbe3857ec,0x3e94a031,0x3dee3876,0xbd7b2b74,0xbe72b651,0x3e78cfcc,0x3d83db0a,0xbdee3876,0xbe9620d2
.long 0x3e47c5c2,0x3c490e90,0xbe2f10a2,0xbeb263ef,0x3e164083,0xbd2351cb,0xbe667c66,0xbece0bea,0x3dc8bd36,0xbdbc3ac3,0xbe8e9a22,0xbee900b7,0x3d48fb30,0xbe1324ca,0xbea986c4,0xbf019573
.long 0x3e47c5c2,0x3d48fb30,0xbdc8bd36,0xbe78cfcc,0x3e09cf86,0xbc7b514b,0xbe28defc,0xbe9f1cdf,0x3d96a905,0xbda3308c,0xbe6c9a7f,0xbec1071e,0x3c490e90,0xbe1324ca,0xbe97a117,0xbee1fb6a
.long 0xbd48fb30,0xbe541501,0xbeb8442a,0xbf00e7e4,0xbde1bc2e,0xbe8a11f7,0xbed8106b,0xbf102dd5,0xbe2f10a2,0xbea986c4,0xbef6e0cb,0xbf1ebc12,0xbe6c9a7f,0xbec8477c,0xbf0a48ad,0xbf2c800f
.long 0xbe94a031,0xbee63375,0xbf187fc0,0xbf396842,0xbeb263ef,0xbf019573,0xbf26050a,0xbf456439,0xbecf7bca,0xbf0f8784,0xbf32c8c9,0xbf5064af,0xbeebcbbb,0xbf1ce11f,0xbf3ebc1b,0xbf5a5ba0
.long 0xbf039c3d,0xbf299415,0xbf49d112,0xbf633c5a,0xbf10d3cd,0xbf3592e7,0xbf53fac3,0xbf6afb8c,0xbf1d7fd1,0xbf40d0da,0xbf5d2d53,0xbf718f57,0xbf299415,0xbf4b41fa,0xbf655e0b,0xbf76ef5b
.long 0xbec3ef15,0xbf039c3d,0xbf226799,0xbf3daef9,0xbee63375,0xbf140c5f,0xbf31a81d,0xbf4b41fa,0xbf039c3d,0xbf239da9,0xbf3fc767,0xbf577026,0xbf13682a,0xbf3238aa,0xbf4cae79,0xbf62241a
.long 0xbf226799,0xbf3fc767,0xbf584853,0xbf6b4b0c,0xbf3085bb,0xbf4c3578,0xbf628210,0xbf72d4eb,0xbf3daef9,0xbf577026,0xbf6b4b0c,0xbf78b47b,0xbf49d112,0xbf61668a,0xbf7294f8,0xbf7cdf6c
.long 0xbf54db31,0xbf6a09a7,0xbf7853f8,0xbf7f4e6d,0xbf5ebe05,0xbf714c7a,0xbf7c7eb0,0xbf7ffd39,0xbf676bd8,0xbf772417,0xbf7f0e58,0xbf7eea9d,0xbf6ed89e,0xbf7b87b2,0xbf7ffec4,0xbf7c187a
.long 0xbf74fa0b,0xbf7e70b0,0xbf7f4e6d,0xbf778bc5,0xbf79c79d,0xbf7fdaaf,0xbf7cfe73,0xbf714c7a,0xbf7d3aac,0xbf7fc38f,0xbf791298,0xbf696591,0xbf7f4e6d,0xbf7e2b72,0xbf73913f,0xbf5fe4e9
.long 0xbf54db31,0xbf676bd8,0xbf74fa0b,0xbf7d3aac,0xbf604621,0xbf703b37,0xbf7ac516,0xbf7fa6e3,0xbf6a09a7,0xbf772417,0xbf7e70b0,0xbf7fc38f,0xbf721352,0xbf7c187a,0xbf7ff4e6,0xbf7d906e
.long 0xbf7853f8,0xbf7f0e58,0xbf7f4e6d,0xbf791298,0xbf7cbfc9,0xbf7fffb1,0xbf7c7eb0,0xbf725470,0xbf7f4e6d,0xbf7eea9d,0xbf778bc5,0xbf696591,0xbf7ffb11,0xbf7bd14d,0xbf708066,0xbf5e5aa6
.long 0xbf7ec46d,0xbf76ba07,0xbf676bd8,0xbf514d3d,0xbf7baccd,0xbf6faf1b,0xbf5c61c7,0xbf425b89,0xbf76ba07,0xbf66becc,0xbf4f7a1f,0xbf31a81d,0xbf6ff573,0xbf5bfb34,0xbf40d0da,0xbf1f599f
.long 0xbf676bd8,0xbf4f7a1f,0xbf3085bb,0xbf0b9a6b,0xbf5d2d53,0xbf4154e1,0xbf1ebc12,0xbeed3063,0xbf514d3d,0xbf31a81d,0xbf0b9a6b,0xbec1071e,0xbf43e200,0xbf209393,0xbeee9479,0xbe931f35
.long 0x3f800000,0x3f800000,0x3f800000,0x3f800000,0x3f7fb10f,0x3f7fa6e3,0x3f7f9c18,0x3f7f90b1,0x3f7ec46d,0x3f7e9bc9,0x3f7e70b0,0x3f7e4323,0x3f7d3aac,0x3f7cdf6c,0x3f7c7eb0,0x3f7c187a
.long 0x3f7b14be,0x3f7a7302,0x3f79c79d,0x3f791298,0x3f7853f8,0x3f77583a,0x3f764d97,0x3f75341d,0x3f74fa0b,0x3f73913f,0x3f721352,0x3f708066,0x3f710908,0x3f6f20b0,0x3f6d1c1d,0x3f6afb8c
.long 0x3f6c835e,0x3f6a09a7,0x3f676bd8,0x3f64aa59,0x3f676bd8,0x3f644fac,0x3f6106f2,0x3f5d924d,0x3f61c598,0x3f5df6be,0x3f59f26a,0x3f55b993,0x3f5b941a,0x3f570348,0x3f5233c6,0x3f4d26fd
.long 0x3f54db31,0x3f4f7a1f,0x3f49d112,0x3f43e200,0x3f4d9f02,0x3f476085,0x3f40d0da,0x3f39f2ac,0x3f45e403,0x3f3ebc1b,0x3f373a23,0x3f2f61a5,0x3f3daef9,0x3f3592e7,0x3f2d1469,0x3f24381a
.long 0x3f800000,0x3f800000,0x3f800000,0x3f800000,0x3f7f84ab,0x3f7f7808,0x3f7f6ac7,0x3f7f5ce9,0x3f7e1324,0x3f7de0b1,0x3f7dabcc,0x3f7d7474,0x3f7baccd,0x3f7b3bab,0x3f7ac516,0x3f7a4910
.long 0x3f7853f8,0x3f778bc5,0x3f76ba07,0x3f75dec6,0x3f740bdd,0x3f72d4eb,0x3f718f57,0x3f703b37,0x3f6ed89e,0x3f6d1c1d,0x3f6b4b0c,0x3f696591,0x3f68bf3c,0x3f666771,0x3f63f473,0x3f61668a
.long 0x3f61c598,0x3f5ebe05,0x3f5b941a,0x3f584853,0x3f59f26a,0x3f5627fe,0x3f5233c6,0x3f4e1689,0x3f514d3d,0x3f4cae79,0x3f47de65,0x3f42de29,0x3f47de65,0x3f425b89,0x3f3ca003,0x3f36ad7f
.long 0x3f3daef9,0x3f373a23,0x3f3085bb,0x3f299415,0x3f32c8c9,0x3f2b561b,0x3f239da9,0x3f1ba299,0x3f273656,0x3f1ebc12,0x3f15f6d9,0x3f0cead0,0x3f1b02c6,0x3f11796b,0x3f07a136,0x3efafef7
.long 0x3f800000,0x3f800000,0x3f800000,0x3f800000,0x3f7f4e6d,0x3f7f3f54,0x3f7f2f9d,0x3f7f1f49,0x3f7d3aac,0x3f7cfe73,0x3f7cbfc9,0x3f7c7eb0,0x3f79c79d,0x3f7940c0,0x3f78b47b,0x3f7822d1
.long 0x3f74fa0b,0x3f740bdd,0x3f731447,0x3f721352,0x3f6ed89e,0x3f6d67a1,0x3f6be858,0x3f6a5ad9,0x3f676bd8,0x3f655e0b,0x3f633c5a,0x3f6106f2,0x3f5ebe05,0x3f5bfb34,0x3f591e6a,0x3f5627fe
.long 0x3f54db31,0x3f514d3d,0x3f4d9f02,0x3f49d112,0x3f49d112,0x3f456439,0x3f40d0da,0x3f3c17d9,0x3f3daef9,0x3f385216,0x3f32c8c9,0x3f2d1469,0x3f3085bb,0x3f2a2a80,0x3f239da9,0x3f1ce11f
.long 0x3f226799,0x3f1b02c6,0x3f13682a,0x3f0b9a6b,0x3f13682a,0x3f0af1b7,0x3f0242b1,0x3ef2bd43,0x3f039c3d,0x3ef41f07,0x3ee0924f,0x3ecc9b8b,0x3ee63375,0x3ed0eb2a,0x3ebb31a0,0x3ea5129f
.long 0x3f800000,0x3f800000,0x3f800000,0x3f800000,0x3f7f0e58,0x3f7efcc9,0x3f7eea9d,0x3f7ed7d4,0x3f7c3b28,0x3f7bf531,0x3f7baccd,0x3f7b61fc,0x3f778bc5,0x3f76ef5b,0x3f764d97,0x3f75a67b
.long 0x3f710908,0x3f6ff573,0x3f6ed89e,0x3f6db293,0x3f68bf3c,0x3f671599,0x3f655e0b,0x3f6398ac,0x3f5ebe05,0x3f5c61c7,0x3f59f26a,0x3f577026,0x3f531849,0x3f4fefa8,0x3f4cae79,0x3f495521
.long 0x3f45e403,0x3f41d870,0x3f3daef9,0x3f396842,0x3f373a23,0x3f3238aa,0x3f2d1469,0x3f27ce61,0x3f273656,0x3f212ff9,0x3f1b02c6,0x3f14b039,0x3f15f6d9,0x3f0ee0db,0x3f07a136,0x3f003a06
.long 0x3f039c3d,0x3ef6e0cb,0x3ee63375,0x3ed53641,0x3ee0924f,0x3ece0bea,0x3ebb31a0,0x3ea80b1f,0x3eb8442a,0x3ea395c5,0x3e8e9a22,0x3e72b651,0x3e8e9a22,0x3e6fa8b2,0x3e419b37,0x3e1324ca
.long 0x80000000,0x80000000,0x80000000,0x80000000,0x3d48fb30,0x3d55880e,0x3d621469,0x3d6ea038,0x3dc8bd36,0x3dd53db9,0x3de1bc2e,0x3dee3876,0x3e164083,0x3e1f917b,0x3e28defc,0x3e3228d4
.long 0x3e47c5c2,0x3e541501,0x3e605c13,0x3e6c9a7f,0x3e78cfcc,0x3e840270,0x3e8b9507,0x3e931f35,0x3e94a031,0x3e9d9e78,0x3ea68f12,0x3eaf713a,0x3eac7cd4,0x3eb6ccc3,0x3ec1071e,0x3ecb2aae
.long 0x3ec3ef15,0x3ecf7bca,0x3edae880,0x3ee63375,0x3edae880,0x3ee79a5d,0x3ef41f07,0x3f003a06,0x3ef15aea,0x3eff17b2,0x3f064b82,0x3f0cead0,0x3f039c3d,0x3f0af1b7,0x3f121eb0,0x3f19210f
.long 0x3f0e39da,0x3f15f6d9,0x3f1d7fd1,0x3f24d225,0x3f187fc0,0x3f209393,0x3f286605,0x3f2ff3e6,0x3f226799,0x3f2ac082,0x3f32c8c9,0x3f3a7ca4,0x3f2beb4a,0x3f34768f,0x3f3ca003,0x3f446337
.long 0x80000000,0x80000000,0x80000000,0x80000000,0x3d7b2b74,0x3d83db0a,0x3d8a200a,0x3d9064b4,0x3dfab273,0x3e039502,0x3e09cf86,0x3e1008b7,0x3e3b6ecf,0x3e44b0b9,0x3e4dee60,0x3e57278f
.long 0x3e78cfcc,0x3e827dc0,0x3e888e93,0x3e8e9a22,0x3e9aa086,0x3ea21887,0x3ea986c4,0x3eb0eacb,0x3eb8442a,0x3ec1071e,0x3ec9b953,0x3ed25a09,0x3ed53641,0x3edf28a9,0x3ee900b7,0x3ef2bd43
.long 0x3ef15aea,0x3efc5d27,0x3f039c3d,0x3f08f59b,0x3f064b82,0x3f0c42c9,0x3f121eb0,0x3f17de12,0x3f13682a,0x3f19c200,0x3f1ff6cb,0x3f26050a,0x3f1ff6cb,0x3f269de3,0x3f2d1469,0x3f33587a
.long 0x3f2beb4a,0x3f32c8c9,0x3f396842,0x3f3fc767,0x3f373a23,0x3f3e35c5,0x3f44e3f5,0x3f4b41fa,0x3f41d870,0x3f48d8b3,0x3f4f7a1f,0x3f55b993,0x3f4bbbf8,0x3f52a649,0x3f591e6a,0x3f5f20db
.long 0x80000000,0x80000000,0x80000000,0x80000000,0x3d96a905,0x3d9cecf9,0x3da3308c,0x3da973ba,0x3e164083,0x3e1c76de,0x3e22abb6,0x3e28defc,0x3e605c13,0x3e698bba,0x3e72b651,0x3e7bdba4
.long 0x3e94a031,0x3e9aa086,0x3ea09ae5,0x3ea68f12,0x3eb8442a,0x3ebf926f,0x3ec6d529,0x3ece0bea,0x3edae880,0x3ee363fa,0x3eebcbbb,0x3ef41f07,0x3efc5d27,0x3f02ef9f,0x3f07a136,0x3f0c42c9
.long 0x3f0e39da,0x3f13682a,0x3f187fc0,0x3f1d7fd1,0x3f1d7fd1,0x3f2302d3,0x3f286605,0x3f2da859,0x3f2beb4a,0x3f31a81d,0x3f373a23,0x3f3ca003,0x3f396842,0x3f3f41fc,0x3f44e3f5,0x3f4a4c87
.long 0x3f45e403,0x3f4bbbf8,0x3f514d3d,0x3f5695e5,0x3f514d3d,0x3f570348,0x3f5c61c7,0x3f61668a,0x3f5b941a,0x3f6106f2,0x3f660f88,0x3f6aab7b,0x3f64aa59,0x3f69b7e4,0x3f6e46be,0x3f725470
.long 0x80000000,0x80000000,0x80000000,0x80000000,0x3dafb680,0x3db5f8da,0x3dbc3ac3,0x3dc27c39,0x3e2f10a2,0x3e354098,0x3e3b6ecf,0x3e419b37,0x3e827dc0,0x3e870ada,0x3e8b9507,0x3e901c2c
.long 0x3eac7cd4,0x3eb263ef,0x3eb8442a,0x3ebe1d4a,0x3ed53641,0x3edc53c1,0x3ee363fa,0x3eea6681,0x3efc5d27,0x3f0242b1,0x3f064b82,0x3f0a48ad,0x3f10d3cd,0x3f1553b7,0x3f19c200,0x3f1e1e22
.long 0x3f226799,0x3f273656,0x3f2beb4a,0x3f3085bb,0x3f32c8c9,0x3f37c655,0x3f3ca003,0x3f4154e1,0x3f41d870,0x3f46e22a,0x3f4bbbf8,0x3f5064af,0x3f4f7a1f,0x3f546b3b,0x3f591e6a,0x3f5d924d
.long 0x3f5b941a,0x3f604621,0x3f64aa59,0x3f68bf3c,0x3f660f88,0x3f6a5ad9,0x3f6e46be,0x3f71d19f,0x3f6ed89e,0x3f7294f8,0x3f75dec6,0x3f78b47b,0x3f75dec6,0x3f78e3d6,0x3f7b61fc,0x3f7d57de
.long 0x3f3504f3,0x3f2beb4a,0x3f226799,0x3f187fc0,0x3f2beb4a,0x3f21cbfb,0x3f173c07,0x3f0c42c9,0x3f226799,0x3f173c07,0x3f0b9a6b,0x3eff17b2,0x3f187fc0,0x3f0c42c9,0x3eff17b2,0x3ee4cbfe
.long 0x3f0e39da,0x3f00e7e4,0x3ee63375,0x3ec9b953,0x3f039c3d,0x3eea6681,0x3ecc9b8b,0x3eadf73c,0x3ef15aea,0x3ed25a09,0x3eb263ef,0x3e919ddd,0x3edae880,0x3eb9bb1e,0x3e97a117,0x3e698bba
.long 0x3ec3ef15,0x3ea09ae5,0x3e78cfcc,0x3e2f10a2,0x3eac7cd4,0x3e870ada,0x3e419b37,0x3de7fa9a,0x3e94a031,0x3e5a3997,0x3e09cf86,0x3d621469,0x3e78cfcc,0x3e25c58c,0x3da3308c,0xbb490fc6
.long 0x3e47c5c2,0x3de1bc2e,0x3cc90ab0,0xbd7b2b74,0x3e164083,0x3d6ea038,0xbcfb49ba,0xbdf475c0,0x3dc8bd36,0x3bc90f88,0xbdafb680,0xbe354098,0x3d48fb30,0xbd3c6dd5,0xbe1008b7,0xbe6fa8b2
.long 0x3f0e39da,0x3f039c3d,0x3ef15aea,0x3edae880,0x3f00e7e4,0x3eea6681,0x3ed25a09,0x3eb9bb1e,0x3ee63375,0x3ecc9b8b,0x3eb263ef,0x3e97a117,0x3ec9b953,0x3eadf73c,0x3e919ddd,0x3e698bba
.long 0x3eac7cd4,0x3e8e9a22,0x3e605c13,0x3e22abb6,0x3e8e9a22,0x3e5d4b1a,0x3e1c76de,0x3db5f8da,0x3e605c13,0x3e1c76de,0x3dafb680,0x3c96c9b6,0x3e22abb6,0x3db5f8da,0x3c96c9b6,0xbd55880e
.long 0x3dc8bd36,0x3cc90ab0,0xbd48fb30,0xbdfab273,0x3d16c32c,0xbd2351cb,0xbdee3876,0xbe44b0b9,0xbcc90ab0,0xbdd53db9,0xbe3b6ecf,0xbe8586ce,0xbdafb680,0xbe2bf804,0xbe7ee6e1,0xbea80b1f
.long 0xbe164083,0xbe6c9a7f,0xbea09ae5,0xbec9b953,0xbe541501,0xbe9620d2,0xbec1071e,0xbeea6681,0xbe888e93,0xbeb554ec,0xbee0924f,0xbf04f484,0xbea68f12,0xbed3c867,0xbeff17b2,0xbf140c5f
.long 0x3ec3ef15,0x3eac7cd4,0x3e94a031,0x3e78cfcc,0x3ea09ae5,0x3e870ada,0x3e5a3997,0x3e25c58c,0x3e78cfcc,0x3e419b37,0x3e09cf86,0x3da3308c,0x3e2f10a2,0x3de7fa9a,0x3d621469,0xbb490fc6
.long 0x3dc8bd36,0x3d16c32c,0xbcc90ab0,0xbdafb680,0x3cc90ab0,0xbd2351cb,0xbdd53db9,0xbe2bf804,0xbd48fb30,0xbdee3876,0xbe3b6ecf,0xbe7ee6e1,0xbdfab273,0xbe44b0b9,0xbe8586ce,0xbea80b1f
.long 0xbe47c5c2,0xbe888e93,0xbeac7cd4,0xbecf7bca,0xbe888e93,0xbeadf73c,0xbed25a09,0xbef58035,0xbeac7cd4,0xbed25a09,0xbef6e0cb,0xbf0cead0,0xbecf7bca,0xbef58035,0xbf0cead0,0xbf1e1e22
.long 0xbef15aea,0xbf0b9a6b,0xbf1d7fd1,0xbf2e3bde,0xbf08f59b,0xbf1ba299,0xbf2d1469,0xbf3d27b8,0xbf187fc0,0xbf2ac082,0xbf3b8f3b,0xbf4ac77f,0xbf273656,0xbf38dd65,0xbf48d8b3,0xbf570348
.long 0x3e47c5c2,0x3e164083,0x3dc8bd36,0x3d48fb30,0x3de1bc2e,0x3d6ea038,0x3bc90f88,0xbd3c6dd5,0x3cc90ab0,0xbcfb49ba,0xbdafb680,0xbe1008b7,0xbd7b2b74,0xbdf475c0,0xbe354098,0xbe6fa8b2
.long 0xbe164083,0xbe541501,0xbe888e93,0xbea68f12,0xbe6c9a7f,0xbe9620d2,0xbeb554ec,0xbed3c867,0xbea09ae5,0xbec1071e,0xbee0924f,0xbeff17b2,0xbec9b953,0xbeea6681,0xbf04f484,0xbf140c5f
.long 0xbef15aea,0xbf08f59b,0xbf187fc0,0xbf273656,0xbf0b9a6b,0xbf1ba299,0xbf2ac082,0xbf38dd65,0xbf1d7fd1,0xbf2d1469,0xbf3b8f3b,0xbf48d8b3,0xbf2e3bde,0xbf3d27b8,0xbf4ac77f,0xbf570348
.long 0xbf3daef9,0xbf4bbbf8,0xbf584853,0xbf633c5a,0xbf4bbbf8,0xbf58b3a1,0xbf63f473,0xbf6d67a1,0xbf584853,0xbf63f473,0xbf6db293,0xbf756d97,0xbf633c5a,0xbf6d67a1,0xbf756d97,0xbf7b3bab
.long 0x3f3504f3,0x3f3daef9,0x3f45e403,0x3f4d9f02,0x3f3daef9,0x3f466354,0x3f4e8d90,0x3f5627fe,0x3f45e403,0x3f4e8d90,0x3f5695e5,0x3f5df6be,0x3f4d9f02,0x3f5627fe,0x3f5df6be,0x3f650479
.long 0x3f54db31,0x3f5d2d53,0x3f64aa59,0x3f6b4b0c,0x3f5b941a,0x3f6398ac,0x3f6aab7b,0x3f70c501,0x3f61c598,0x3f696591,0x3f6ff573,0x3f756d97,0x3f676bd8,0x3f6e8ff8,0x3f748422,0x3f7940c0
.long 0x3f6c835e,0x3f731447,0x3f7853f8,0x3f7c3b28,0x3f710908,0x3f76ef5b,0x3f7b61fc,0x3f7e5a38,0x3f74fa0b,0x3f7a1e84,0x3f7dabcc,0x3f7f9c18,0x3f7853f8,0x3f7c9f8a,0x3f7f2f9d,0x3f7fffb1
.long 0x3f7b14be,0x3f7e70b0,0x3f7fec43,0x3f7f84ab,0x3f7d3aac,0x3f7f90b1,0x3f7fe129,0x3f7e2b72,0x3f7ec46d,0x3f7ffec4,0x3f7f0e58,0x3f7bf531,0x3f7fb10f,0x3f7fba9e,0x3f7d7474,0x3f78e3d6
.long 0x3f54db31,0x3f5b941a,0x3f61c598,0x3f676bd8,0x3f5d2d53,0x3f6398ac,0x3f696591,0x3f6e8ff8,0x3f64aa59,0x3f6aab7b,0x3f6ff573,0x3f748422,0x3f6b4b0c,0x3f70c501,0x3f756d97,0x3f7940c0
.long 0x3f710908,0x3f75dec6,0x3f79c79d,0x3f7cbfc9,0x3f75dec6,0x3f79f35e,0x3f7cfe73,0x3f7efcc9,0x3f79c79d,0x3f7cfe73,0x3f7f0e58,0x3f7ff4e6,0x3f7cbfc9,0x3f7efcc9,0x3f7ff4e6,0x3f7fa6e3
.long 0x3f7ec46d,0x3f7fec43,0x3f7fb10f,0x3f7e1324,0x3f7fd397,0x3f7fcbe2,0x3f7e4323,0x3f7b3bab,0x3f7fec43,0x3f7e9bc9,0x3f7baccd,0x3f772417,0x3f7f0e58,0x3f7c5d3a,0x3f77f110,0x3f71d19f
.long 0x3f7d3aac,0x3f791298,0x3f731447,0x3f6b4b0c,0x3f7a7302,0x3f74bf62,0x3f6d1c1d,0x3f6398ac,0x3f76ba07,0x3f6f6830,0x3f660f88,0x3f5ac450,0x3f721352,0x3f6912ae,0x3f5df6be,0x3f50d937
.long 0x3f6c835e,0x3f710908,0x3f74fa0b,0x3f7853f8,0x3f731447,0x3f76ef5b,0x3f7a1e84,0x3f7c9f8a,0x3f7853f8,0x3f7b61fc,0x3f7dabcc,0x3f7f2f9d,0x3f7c3b28,0x3f7e5a38,0x3f7f9c18,0x3f7fffb1
.long 0x3f7ec46d,0x3f7fd397,0x3f7fec43,0x3f7f0e58,0x3f7fec43,0x3f7fcbe2,0x3f7e9bc9,0x3f7c5d3a,0x3f7fb10f,0x3f7e4323,0x3f7baccd,0x3f77f110,0x3f7e1324,0x3f7b3bab,0x3f772417,0x3f71d19f
.long 0x3f7b14be,0x3f76ba07,0x3f710908,0x3f6a09a7,0x3f76ba07,0x3f70c501,0x3f696591,0x3f60a6cf,0x3f710908,0x3f696591,0x3f604621,0x3f55b993,0x3f6a09a7,0x3f60a6cf,0x3f55b993,0x3f495521
.long 0x3f61c598,0x3f5695e5,0x3f49d112,0x3f3b8f3b,0x3f584853,0x3f4b41fa,0x3f3ca003,0x3f2c800f,0x3f4d9f02,0x3f3ebc1b,0x3f2e3bde,0x3f1c420c,0x3f41d870,0x3f311722,0x3f1ebc12,0x3f0af1b7
.long 0x3f7b14be,0x3f7d3aac,0x3f7ec46d,0x3f7fb10f,0x3f7e70b0,0x3f7f90b1,0x3f7ffec4,0x3f7fba9e,0x3f7fec43,0x3f7fe129,0x3f7f0e58,0x3f7d7474,0x3f7f84ab,0x3f7e2b72,0x3f7bf531,0x3f78e3d6
.long 0x3f7d3aac,0x3f7a7302,0x3f76ba07,0x3f721352,0x3f791298,0x3f74bf62,0x3f6f6830,0x3f6912ae,0x3f731447,0x3f6d1c1d,0x3f660f88,0x3f5df6be,0x3f6b4b0c,0x3f6398ac,0x3f5ac450,0x3f50d937
.long 0x3f61c598,0x3f584853,0x3f4d9f02,0x3f41d870,0x3f5695e5,0x3f4b41fa,0x3f3ebc1b,0x3f311722,0x3f49d112,0x3f3ca003,0x3f2e3bde,0x3f1ebc12,0x3f3b8f3b,0x3f2c800f,0x3f1c420c,0x3f0af1b7
.long 0x3f2beb4a,0x3f1b02c6,0x3f08f59b,0x3eebcbbb,0x3f1b02c6,0x3f084b92,0x3ee900b7,0x3ebf926f,0x3f08f59b,0x3ee900b7,0x3ebe1d4a,0x3e919ddd,0x3eebcbbb,0x3ebf926f,0x3e919ddd,0x3e44b0b9
.long 0x3f803f80,0x3f803f80,0x3f803f80,0x3f803f80,0xbf7bbf80,0xbf55bf6d,0x3f7b3f80,0x3f553f6d,0x3f6d3f80,0x3ec43f35,0x3f6d3f80,0x3ec43f35,0xbf55bf80,0x3e48bec4,0x3f553f80,0xbe483ec4
.long 0x248d3f80,0xa554bf80,0x248d3f80,0xa554bf80,0x3e48bf80,0xbf0e3f6d,0xbe483f80,0x3f0ebf6d,0xbec43f80,0x3f6dbf35,0xbec43f80,0x3f6dbf35,0x3f0ebf80,0xbf7b3ec4,0xbf0e3f80,0x3f7bbec4
.long 0xbf803f80,0xbf803f80,0xbf803f80,0xbf803f80,0x3f7bbf80,0x3f55bf6d,0xbf7b3f80,0xbf553f6d,0xbf6d3f80,0xbec43f35,0xbf6d3f80,0xbec43f35,0x3f55bf80,0xbe48bec4,0xbf553f80,0x3e483ec4
.long 0xa5543f80,0x248dbf80,0xa5543f80,0x248dbf80,0xbe48bf80,0x3f0e3f6d,0x3e483f80,0xbf0ebf6d,0x3ec43f80,0xbf6dbf35,0x3ec43f80,0xbf6dbf35,0xbf0ebf80,0x3f7b3ec4,0x3f0e3f80,0xbf7bbec4
.long 0x3f803f80,0x3f803f80,0x3f803f80,0x3f803f80,0xbf0ebf35,0xbe48bec4,0x3f0e3f35,0x3e483ec4,0xbec4248d,0xbf6dbf35,0xbec4248d,0xbf6dbf35,0x3f7b3f35,0x3f0e3f6d,0xbf7bbf35,0xbf0ebf6d
.long 0x248d3f80,0xa554bf80,0x248d3f80,0xa554bf80,0x3f55bf35,0xbf7b3ec4,0xbf553f35,0x3f7bbec4,0xbf6d248d,0x3ec43f35,0xbf6d248d,0x3ec43f35,0x3e483f35,0x3f55bf6d,0xbe48bf35,0xbf553f6d
.long 0xbf803f80,0xbf803f80,0xbf803f80,0xbf803f80,0x3f0ebf35,0x3e48bec4,0xbf0e3f35,0xbe483ec4,0x3ec4248d,0x3f6dbf35,0x3ec4248d,0x3f6dbf35,0xbf7b3f35,0xbf0e3f6d,0x3f7bbf35,0x3f0ebf6d
.long 0xa5543f80,0x248dbf80,0xa5543f80,0x248dbf80,0xbf55bf35,0x3f7b3ec4,0x3f553f35,0xbf7bbec4,0x3f6d248d,0xbec43f35,0x3f6d248d,0xbec43f35,0xbe483f35,0xbf55bf6d,0x3e48bf35,0x3f553f6d
.long 0x3f803f80,0x3f803f80,0x3f803f80,0x3f803f80,0x3e48a554,0x3f0e3ec4,0xbe48248d,0xbf0ebec4,0xbf6dbf80,0xbec4bf35,0xbf6dbf80,0xbec4bf35,0xbf0e248d,0xbf7bbf6d,0x3f0ea554,0x3f7b3f6d
.long 0x248d3f80,0xa554bf80,0x248d3f80,0xa554bf80,0x3f7ba554,0xbf55bec4,0xbf7b248d,0x3f553ec4,0x3ec4bf80,0xbf6d3f35,0x3ec4bf80,0xbf6d3f35,0xbf55248d,0xbe483f6d,0x3f55a554,0x3e48bf6d
.long 0xbf803f80,0xbf803f80,0xbf803f80,0xbf803f80,0xbe48a554,0xbf0e3ec4,0x3e48248d,0x3f0ebec4,0x3f6dbf80,0x3ec4bf35,0x3f6dbf80,0x3ec4bf35,0x3f0e248d,0x3f7bbf6d,0xbf0ea554,0xbf7b3f6d
.long 0xa5543f80,0x248dbf80,0xa5543f80,0x248dbf80,0xbf7ba554,0x3f55bec4,0x3f7b248d,0xbf553ec4,0xbec4bf80,0x3f6d3f35,0xbec4bf80,0x3f6d3f35,0x3f55248d,0x3e483f6d,0xbf55a554,0xbe48bf6d
.long 0x3f803f80,0x3f803f80,0x3f803f80,0x3f803f80,0x3f553f35,0x3f7b3f6d,0xbf55bf35,0xbf7bbf6d,0x3ec4a554,0x3f6d3f35,0x3ec4a554,0x3f6d3f35,0xbe48bf35,0x3f553ec4,0x3e483f35,0xbf55bec4
.long 0x248d3f80,0xa554bf80,0x248d3f80,0xa554bf80,0x3f0e3f35,0xbe48bf6d,0xbf0ebf35,0x3e483f6d,0x3f6da554,0xbec4bf35,0x3f6da554,0xbec4bf35,0x3f7bbf35,0xbf0ebec4,0xbf7b3f35,0x3f0e3ec4
.long 0xbf803f80,0xbf803f80,0xbf803f80,0xbf803f80,0xbf553f35,0xbf7b3f6d,0x3f55bf35,0x3f7bbf6d,0xbec4a554,0xbf6d3f35,0xbec4a554,0xbf6d3f35,0x3e48bf35,0xbf553ec4,0xbe483f35,0x3f55bec4
.long 0xa5543f80,0x248dbf80,0xa5543f80,0x248dbf80,0xbf0e3f35,0x3e48bf6d,0x3f0ebf35,0xbe483f6d,0xbf6da554,0x3ec4bf35,0xbf6da554,0x3ec4bf35,0xbf7bbf35,0x3f0ebec4,0x3f7b3f35,0xbf0e3ec4
.long 0x3f353f80,0xbf35248d,0x3f353f80,0xbf35248d,0xbf0ebf80,0x3f7b3ec4,0x3f0e3f80,0xbf7bbec4,0x3ec43f80,0xbf6dbf35,0x3ec43f80,0xbf6dbf35,0xbe48bf80,0x3f0e3f6d,0x3e483f80,0xbf0ebf6d
.long 0xbf353f80,0x3f35a554,0xbf353f80,0x3f35a554,0x3f55bf80,0xbe48bec4,0xbf553f80,0x3e483ec4,0xbf6d3f80,0xbec43f35,0xbf6d3f80,0xbec43f35,0x3f7bbf80,0x3f55bf6d,0xbf7b3f80,0xbf553f6d
.long 0xbf353f80,0x3f35248d,0xbf353f80,0x3f35248d,0x3f0ebf80,0xbf7b3ec4,0xbf0e3f80,0x3f7bbec4,0xbec43f80,0x3f6dbf35,0xbec43f80,0x3f6dbf35,0x3e48bf80,0xbf0e3f6d,0xbe483f80,0x3f0ebf6d
.long 0x3f353f80,0xbf35a554,0x3f353f80,0xbf35a554,0xbf55bf80,0x3e48bec4,0x3f553f80,0xbe483ec4,0x3f6d3f80,0x3ec43f35,0x3f6d3f80,0x3ec43f35,0xbf7bbf80,0xbf55bf6d,0x3f7b3f80,0x3f553f6d
.long 0xbf35bf80,0x3f35a554,0xbf35bf80,0x3f35a554,0xbe483f35,0xbf55bf6d,0x3e48bf35,0x3f553f6d,0x3f6da554,0xbec43f35,0x3f6da554,0xbec43f35,0xbf55bf35,0x3f7b3ec4,0x3f553f35,0xbf7bbec4
.long 0x3f35bf80,0xbf35248d,0x3f35bf80,0xbf35248d,0xbf7b3f35,0xbf0e3f6d,0x3f7bbf35,0x3f0ebf6d,0x3ec4a554,0x3f6dbf35,0x3ec4a554,0x3f6dbf35,0x3f0ebf35,0x3e48bec4,0xbf0e3f35,0xbe483ec4
.long 0x3f35bf80,0xbf35a554,0x3f35bf80,0xbf35a554,0x3e483f35,0x3f55bf6d,0xbe48bf35,0xbf553f6d,0xbf6da554,0x3ec43f35,0xbf6da554,0x3ec43f35,0x3f55bf35,0xbf7b3ec4,0xbf553f35,0x3f7bbec4
.long 0xbf35bf80,0x3f35248d,0xbf35bf80,0x3f35248d,0x3f7b3f35,0x3f0e3f6d,0xbf7bbf35,0xbf0ebf6d,0xbec4a554,0xbf6dbf35,0xbec4a554,0xbf6dbf35,0xbf0ebf35,0xbe48bec4,0x3f0e3f35,0x3e483ec4
.long 0x3f353f80,0xbf35248d,0x3f353f80,0xbf35248d,0x3f55a554,0x3e483f6d,0xbf55248d,0xbe48bf6d,0xbec4bf80,0x3f6d3f35,0xbec4bf80,0x3f6d3f35,0xbf7b248d,0x3f55bec4,0x3f7ba554,0xbf553ec4
.long 0xbf353f80,0x3f35a554,0xbf353f80,0x3f35a554,0x3f0ea554,0x3f7bbf6d,0xbf0e248d,0xbf7b3f6d,0x3f6dbf80,0x3ec4bf35,0x3f6dbf80,0x3ec4bf35,0xbe48248d,0xbf0e3ec4,0x3e48a554,0x3f0ebec4
.long 0xbf353f80,0x3f35248d,0xbf353f80,0x3f35248d,0xbf55a554,0xbe483f6d,0x3f55248d,0x3e48bf6d,0x3ec4bf80,0xbf6d3f35,0x3ec4bf80,0xbf6d3f35,0x3f7b248d,0xbf55bec4,0xbf7ba554,0x3f553ec4
.long 0x3f353f80,0xbf35a554,0x3f353f80,0xbf35a554,0xbf0ea554,0xbf7bbf6d,0x3f0e248d,0x3f7b3f6d,0xbf6dbf80,0xbec4bf35,0xbf6dbf80,0xbec4bf35,0x3e48248d,0x3f0e3ec4,0xbe48a554,0xbf0ebec4
.long 0xbf35bf80,0x3f35a554,0xbf35bf80,0x3f35a554,0xbf7bbf35,0x3f0ebec4,0x3f7b3f35,0xbf0e3ec4,0xbf6d248d,0x3ec4bf35,0xbf6d248d,0x3ec4bf35,0xbf0e3f35,0x3e48bf6d,0x3f0ebf35,0xbe483f6d
.long 0x3f35bf80,0xbf35248d,0x3f35bf80,0xbf35248d,0x3e48bf35,0xbf553ec4,0xbe483f35,0x3f55bec4,0xbec4248d,0xbf6d3f35,0xbec4248d,0xbf6d3f35,0xbf553f35,0xbf7b3f6d,0x3f55bf35,0x3f7bbf6d
.long 0x3f35bf80,0xbf35a554,0x3f35bf80,0xbf35a554,0x3f7bbf35,0xbf0ebec4,0xbf7b3f35,0x3f0e3ec4,0x3f6d248d,0xbec4bf35,0x3f6d248d,0xbec4bf35,0x3f0e3f35,0xbe48bf6d,0xbf0ebf35,0x3e483f6d
.long 0xbf35bf80,0x3f35248d,0xbf35bf80,0x3f35248d,0xbe48bf35,0x3f553ec4,0x3e483f35,0xbf55bec4,0x3ec4248d,0x3f6d3f35,0x3ec4248d,0x3f6d3f35,0x3f553f35,0x3f7b3f6d,0xbf55bf35,0xbf7bbf6d
.long 0x0,0x0,0x0,0x0,0x3e48a50d,0x3f0e3ec4,0xbe480000,0xbf0ebec4,0xbec40000,0xbf6dbf35,0xbec40000,0xbf6dbf35,0x3f0ea50d,0x3f7b3f6d,0xbf0e0000,0xbf7bbf6d
.long 0xbf800000,0x3f80a50d,0xbf800000,0x3f80a50d,0x3f7ba50d,0xbf55bec4,0xbf7b0000,0x3f553ec4,0xbf6d0000,0x3ec43f35,0xbf6d0000,0x3ec43f35,0x3f55a50d,0x3e48bf6d,0xbf550000,0xbe483f6d
.long 0xa50d0000,0xa50d0000,0xa50d0000,0xa50d0000,0xbe48a50d,0xbf0e3ec4,0x3e480000,0x3f0ebec4,0x3ec40000,0x3f6dbf35,0x3ec40000,0x3f6dbf35,0xbf0ea50d,0xbf7b3f6d,0x3f0e0000,0x3f7bbf6d
.long 0x3f800000,0xbf80a50d,0x3f800000,0xbf80a50d,0xbf7ba50d,0x3f55bec4,0x3f7b0000,0xbf553ec4,0x3f6d0000,0xbec43f35,0x3f6d0000,0xbec43f35,0xbf55a50d,0xbe48bf6d,0x3f550000,0x3e483f6d
.long 0x0,0x0,0x0,0x0,0x3f553f35,0x3f7b3f6d,0xbf55bf35,0xbf7bbf6d,0xbf6dbf80,0xbec4bf35,0xbf6dbf80,0xbec4bf35,0x3e483f35,0xbf55bec4,0xbe48bf35,0x3f553ec4
.long 0xbf800000,0x3f80a50d,0xbf800000,0x3f80a50d,0x3f0e3f35,0xbe48bf6d,0xbf0ebf35,0x3e483f6d,0x3ec4bf80,0xbf6d3f35,0x3ec4bf80,0xbf6d3f35,0xbf7b3f35,0x3f0e3ec4,0x3f7bbf35,0xbf0ebec4
.long 0xa50d0000,0xa50d0000,0xa50d0000,0xa50d0000,0xbf553f35,0xbf7b3f6d,0x3f55bf35,0x3f7bbf6d,0x3f6dbf80,0x3ec4bf35,0x3f6dbf80,0x3ec4bf35,0xbe483f35,0x3f55bec4,0x3e48bf35,0xbf553ec4
.long 0x3f800000,0xbf80a50d,0x3f800000,0xbf80a50d,0xbf0e3f35,0x3e48bf6d,0x3f0ebf35,0xbe483f6d,0xbec4bf80,0x3f6d3f35,0xbec4bf80,0x3f6d3f35,0x3f7b3f35,0xbf0e3ec4,0xbf7bbf35,0x3f0ebec4
.long 0x0,0x0,0x0,0x0,0x3f7b3f80,0x3f553f6d,0xbf7bbf80,0xbf55bf6d,0x3ec4a50d,0x3f6d3f35,0x3ec4a50d,0x3f6d3f35,0xbf55bf80,0x3e48bec4,0x3f553f80,0xbe483ec4
.long 0xbf800000,0x3f80a50d,0xbf800000,0x3f80a50d,0xbe483f80,0x3f0ebf6d,0x3e48bf80,0xbf0e3f6d,0x3f6da50d,0xbec4bf35,0x3f6da50d,0xbec4bf35,0x3f0ebf80,0xbf7b3ec4,0xbf0e3f80,0x3f7bbec4
.long 0xa50d0000,0xa50d0000,0xa50d0000,0xa50d0000,0xbf7b3f80,0xbf553f6d,0x3f7bbf80,0x3f55bf6d,0xbec4a50d,0xbf6d3f35,0xbec4a50d,0xbf6d3f35,0x3f55bf80,0xbe48bec4,0xbf553f80,0x3e483ec4
.long 0x3f800000,0xbf80a50d,0x3f800000,0xbf80a50d,0x3e483f80,0xbf0ebf6d,0xbe48bf80,0x3f0e3f6d,0xbf6da50d,0x3ec4bf35,0xbf6da50d,0x3ec4bf35,0xbf0ebf80,0x3f7b3ec4,0x3f0e3f80,0xbf7bbec4
.long 0x0,0x0,0x0,0x0,0x3f0e3f35,0x3e483ec4,0xbf0ebf35,0xbe48bec4,0x3f6d3f80,0x3ec43f35,0x3f6d3f80,0x3ec43f35,0x3f7b3f35,0x3f0e3f6d,0xbf7bbf35,0xbf0ebf6d
.long 0xbf800000,0x3f80a50d,0xbf800000,0x3f80a50d,0xbf553f35,0x3f7bbec4,0x3f55bf35,0xbf7b3ec4,0xbec43f80,0x3f6dbf35,0xbec43f80,0x3f6dbf35,0x3e483f35,0x3f55bf6d,0xbe48bf35,0xbf553f6d
.long 0xa50d0000,0xa50d0000,0xa50d0000,0xa50d0000,0xbf0e3f35,0xbe483ec4,0x3f0ebf35,0x3e48bec4,0xbf6d3f80,0xbec43f35,0xbf6d3f80,0xbec43f35,0xbf7b3f35,0xbf0e3f6d,0x3f7bbf35,0x3f0ebf6d
.long 0x3f800000,0xbf80a50d,0x3f800000,0xbf80a50d,0x3f553f35,0xbf7bbec4,0xbf55bf35,0x3f7b3ec4,0x3ec43f80,0xbf6dbf35,0x3ec43f80,0xbf6dbf35,0xbe483f35,0xbf55bf6d,0x3e48bf35,0x3f553f6d
.long 0xbf350000,0xbf35bf80,0xbf350000,0xbf35bf80,0x3f55a50d,0x3e483f6d,0xbf550000,0xbe48bf6d,0xbf6d0000,0x3ec4bf35,0xbf6d0000,0x3ec4bf35,0x3f7ba50d,0xbf553ec4,0xbf7b0000,0x3f55bec4
.long 0xbf350000,0xbf353f80,0xbf350000,0xbf353f80,0x3f0ea50d,0x3f7bbf6d,0xbf0e0000,0xbf7b3f6d,0xbec40000,0xbf6d3f35,0xbec40000,0xbf6d3f35,0x3e48a50d,0x3f0ebec4,0xbe480000,0xbf0e3ec4
.long 0x3f350000,0x3f35bf80,0x3f350000,0x3f35bf80,0xbf55a50d,0xbe483f6d,0x3f550000,0x3e48bf6d,0x3f6d0000,0xbec4bf35,0x3f6d0000,0xbec4bf35,0xbf7ba50d,0x3f553ec4,0x3f7b0000,0xbf55bec4
.long 0x3f350000,0x3f353f80,0x3f350000,0x3f353f80,0xbf0ea50d,0xbf7bbf6d,0x3f0e0000,0x3f7b3f6d,0x3ec40000,0x3f6d3f35,0x3ec40000,0x3f6d3f35,0xbe48a50d,0xbf0ebec4,0x3e480000,0x3f0e3ec4
.long 0x3f35a50d,0x3f353f80,0x3f35a50d,0x3f353f80,0xbf7bbf35,0x3f0ebec4,0x3f7b3f35,0xbf0e3ec4,0x3ec43f80,0xbf6dbf35,0x3ec43f80,0xbf6dbf35,0x3f0ebf35,0xbe483f6d,0xbf0e3f35,0x3e48bf6d
.long 0x3f35a50d,0x3f35bf80,0x3f35a50d,0x3f35bf80,0x3e48bf35,0xbf553ec4,0xbe483f35,0x3f55bec4,0xbf6d3f80,0xbec43f35,0xbf6d3f80,0xbec43f35,0x3f55bf35,0x3f7bbf6d,0xbf553f35,0xbf7b3f6d
.long 0xbf35a50d,0xbf353f80,0xbf35a50d,0xbf353f80,0x3f7bbf35,0xbf0ebec4,0xbf7b3f35,0x3f0e3ec4,0xbec43f80,0x3f6dbf35,0xbec43f80,0x3f6dbf35,0xbf0ebf35,0x3e483f6d,0x3f0e3f35,0xbe48bf6d
.long 0xbf35a50d,0xbf35bf80,0xbf35a50d,0xbf35bf80,0xbe48bf35,0x3f553ec4,0x3e483f35,0xbf55bec4,0x3f6d3f80,0x3ec43f35,0x3f6d3f80,0x3ec43f35,0xbf55bf35,0xbf7bbf6d,0x3f553f35,0x3f7b3f6d
.long 0xbf350000,0xbf35bf80,0xbf350000,0xbf35bf80,0x3f0e3f80,0xbf7bbec4,0xbf0ebf80,0x3f7b3ec4,0x3f6da50d,0xbec43f35,0x3f6da50d,0xbec43f35,0xbe48bf80,0x3f0e3f6d,0x3e483f80,0xbf0ebf6d
.long 0xbf350000,0xbf353f80,0xbf350000,0xbf353f80,0xbf553f80,0x3e483ec4,0x3f55bf80,0xbe48bec4,0x3ec4a50d,0x3f6dbf35,0x3ec4a50d,0x3f6dbf35,0x3f7bbf80,0x3f55bf6d,0xbf7b3f80,0xbf553f6d
.long 0x3f350000,0x3f35bf80,0x3f350000,0x3f35bf80,0xbf0e3f80,0x3f7bbec4,0x3f0ebf80,0xbf7b3ec4,0xbf6da50d,0x3ec43f35,0xbf6da50d,0x3ec43f35,0x3e48bf80,0xbf0e3f6d,0xbe483f80,0x3f0ebf6d
.long 0x3f350000,0x3f353f80,0x3f350000,0x3f353f80,0x3f553f80,0xbe483ec4,0xbf55bf80,0x3e48bec4,0xbec4a50d,0xbf6dbf35,0xbec4a50d,0xbf6dbf35,0xbf7bbf80,0xbf55bf6d,0x3f7b3f80,0x3f553f6d
.long 0x3f35a50d,0x3f353f80,0x3f35a50d,0x3f353f80,0x3e48bf35,0x3f553f6d,0xbe483f35,0xbf55bf6d,0xbec4bf80,0x3f6d3f35,0xbec4bf80,0x3f6d3f35,0xbf55bf35,0x3f7b3ec4,0x3f553f35,0xbf7bbec4
.long 0x3f35a50d,0x3f35bf80,0x3f35a50d,0x3f35bf80,0x3f7bbf35,0x3f0ebf6d,0xbf7b3f35,0xbf0e3f6d,0x3f6dbf80,0x3ec4bf35,0x3f6dbf80,0x3ec4bf35,0x3f0ebf35,0x3e48bec4,0xbf0e3f35,0xbe483ec4
.long 0xbf35a50d,0xbf353f80,0xbf35a50d,0xbf353f80,0xbe48bf35,0xbf553f6d,0x3e483f35,0x3f55bf6d,0x3ec4bf80,0xbf6d3f35,0x3ec4bf80,0xbf6d3f35,0x3f55bf35,0xbf7b3ec4,0xbf553f35,0x3f7bbec4
.long 0xbf35a50d,0xbf35bf80,0xbf35a50d,0xbf35bf80,0xbf7bbf35,0xbf0ebf6d,0x3f7b3f35,0x3f0e3f6d,0xbf6dbf80,0xbec4bf35,0xbf6dbf80,0xbec4bf35,0xbf0ebf35,0xbe48bec4,0x3f0e3f35,0x3e483ec4
.long 0x80008000,0x80008000,0x80008000,0x80008000,0xbe48250d,0xbf0ebec4,0x3e488000,0x3f0e3ec4,0x3ec48000,0x3f6d3f35,0x3ec48000,0x3f6d3f35,0xbf0e250d,0xbf7bbf6d,0x3f0e8000,0x3f7b3f6d
.long 0x3f808000,0xbf80250d,0x3f808000,0xbf80250d,0xbf7b250d,0x3f553ec4,0x3f7b8000,0xbf55bec4,0x3f6d8000,0xbec4bf35,0x3f6d8000,0xbec4bf35,0xbf55250d,0xbe483f6d,0x3f558000,0x3e48bf6d
.long 0x250d8000,0x250d8000,0x250d8000,0x250d8000,0x3e48250d,0x3f0ebec4,0xbe488000,0xbf0e3ec4,0xbec48000,0xbf6d3f35,0xbec48000,0xbf6d3f35,0x3f0e250d,0x3f7bbf6d,0xbf0e8000,0xbf7b3f6d
.long 0xbf808000,0x3f80250d,0xbf808000,0x3f80250d,0x3f7b250d,0xbf553ec4,0xbf7b8000,0x3f55bec4,0xbf6d8000,0x3ec4bf35,0xbf6d8000,0x3ec4bf35,0x3f55250d,0x3e483f6d,0xbf558000,0xbe48bf6d
.long 0x80008000,0x80008000,0x80008000,0x80008000,0xbf55bf35,0xbf7bbf6d,0x3f553f35,0x3f7b3f6d,0x3f6d3f80,0x3ec43f35,0x3f6d3f80,0x3ec43f35,0xbe48bf35,0x3f553ec4,0x3e483f35,0xbf55bec4
.long 0x3f808000,0xbf80250d,0x3f808000,0xbf80250d,0xbf0ebf35,0x3e483f6d,0x3f0e3f35,0xbe48bf6d,0xbec43f80,0x3f6dbf35,0xbec43f80,0x3f6dbf35,0x3f7bbf35,0xbf0ebec4,0xbf7b3f35,0x3f0e3ec4
.long 0x250d8000,0x250d8000,0x250d8000,0x250d8000,0x3f55bf35,0x3f7bbf6d,0xbf553f35,0xbf7b3f6d,0xbf6d3f80,0xbec43f35,0xbf6d3f80,0xbec43f35,0x3e48bf35,0xbf553ec4,0xbe483f35,0x3f55bec4
.long 0xbf808000,0x3f80250d,0xbf808000,0x3f80250d,0x3f0ebf35,0xbe483f6d,0xbf0e3f35,0x3e48bf6d,0x3ec43f80,0xbf6dbf35,0x3ec43f80,0xbf6dbf35,0xbf7bbf35,0x3f0ebec4,0x3f7b3f35,0xbf0e3ec4
.long 0x80008000,0x80008000,0x80008000,0x80008000,0xbf7bbf80,0xbf55bf6d,0x3f7b3f80,0x3f553f6d,0xbec4250d,0xbf6dbf35,0xbec4250d,0xbf6dbf35,0x3f553f80,0xbe483ec4,0xbf55bf80,0x3e48bec4
.long 0x3f808000,0xbf80250d,0x3f808000,0xbf80250d,0x3e48bf80,0xbf0e3f6d,0xbe483f80,0x3f0ebf6d,0xbf6d250d,0x3ec43f35,0xbf6d250d,0x3ec43f35,0xbf0e3f80,0x3f7bbec4,0x3f0ebf80,0xbf7b3ec4
.long 0x250d8000,0x250d8000,0x250d8000,0x250d8000,0x3f7bbf80,0x3f55bf6d,0xbf7b3f80,0xbf553f6d,0x3ec4250d,0x3f6dbf35,0x3ec4250d,0x3f6dbf35,0xbf553f80,0x3e483ec4,0x3f55bf80,0xbe48bec4
.long 0xbf808000,0x3f80250d,0xbf808000,0x3f80250d,0xbe48bf80,0x3f0e3f6d,0x3e483f80,0xbf0ebf6d,0x3f6d250d,0xbec43f35,0x3f6d250d,0xbec43f35,0x3f0e3f80,0xbf7bbec4,0xbf0ebf80,0x3f7b3ec4
.long 0x80008000,0x80008000,0x80008000,0x80008000,0xbf0ebf35,0xbe48bec4,0x3f0e3f35,0x3e483ec4,0xbf6dbf80,0xbec4bf35,0xbf6dbf80,0xbec4bf35,0xbf7bbf35,0xbf0ebf6d,0x3f7b3f35,0x3f0e3f6d
.long 0x3f808000,0xbf80250d,0x3f808000,0xbf80250d,0x3f55bf35,0xbf7b3ec4,0xbf553f35,0x3f7bbec4,0x3ec4bf80,0xbf6d3f35,0x3ec4bf80,0xbf6d3f35,0xbe48bf35,0xbf553f6d,0x3e483f35,0x3f55bf6d
.long 0x250d8000,0x250d8000,0x250d8000,0x250d8000,0x3f0ebf35,0x3e48bec4,0xbf0e3f35,0xbe483ec4,0x3f6dbf80,0x3ec4bf35,0x3f6dbf80,0x3ec4bf35,0x3f7bbf35,0x3f0ebf6d,0xbf7b3f35,0xbf0e3f6d
.long 0xbf808000,0x3f80250d,0xbf808000,0x3f80250d,0xbf55bf35,0x3f7b3ec4,0x3f553f35,0xbf7bbec4,0xbec4bf80,0x3f6d3f35,0xbec4bf80,0x3f6d3f35,0x3e48bf35,0x3f553f6d,0xbe483f35,0xbf55bf6d
.long 0x3f358000,0x3f353f80,0x3f358000,0x3f353f80,0xbf55250d,0xbe48bf6d,0x3f558000,0x3e483f6d,0x3f6d8000,0xbec43f35,0x3f6d8000,0xbec43f35,0xbf7b250d,0x3f55bec4,0x3f7b8000,0xbf553ec4
.long 0x3f358000,0x3f35bf80,0x3f358000,0x3f35bf80,0xbf0e250d,0xbf7b3f6d,0x3f0e8000,0x3f7bbf6d,0x3ec48000,0x3f6dbf35,0x3ec48000,0x3f6dbf35,0xbe48250d,0xbf0e3ec4,0x3e488000,0x3f0ebec4
.long 0xbf358000,0xbf353f80,0xbf358000,0xbf353f80,0x3f55250d,0x3e48bf6d,0xbf558000,0xbe483f6d,0xbf6d8000,0x3ec43f35,0xbf6d8000,0x3ec43f35,0x3f7b250d,0xbf55bec4,0xbf7b8000,0x3f553ec4
.long 0xbf358000,0xbf35bf80,0xbf358000,0xbf35bf80,0x3f0e250d,0x3f7b3f6d,0xbf0e8000,0xbf7bbf6d,0xbec48000,0xbf6dbf35,0xbec48000,0xbf6dbf35,0x3e48250d,0x3f0e3ec4,0xbe488000,0xbf0ebec4
.long 0xbf35250d,0xbf35bf80,0xbf35250d,0xbf35bf80,0x3f7b3f35,0xbf0e3ec4,0xbf7bbf35,0x3f0ebec4,0xbec4bf80,0x3f6d3f35,0xbec4bf80,0x3f6d3f35,0xbf0e3f35,0x3e48bf6d,0x3f0ebf35,0xbe483f6d
.long 0xbf35250d,0xbf353f80,0xbf35250d,0xbf353f80,0xbe483f35,0x3f55bec4,0x3e48bf35,0xbf553ec4,0x3f6dbf80,0x3ec4bf35,0x3f6dbf80,0x3ec4bf35,0xbf553f35,0xbf7b3f6d,0x3f55bf35,0x3f7bbf6d
.long 0x3f35250d,0x3f35bf80,0x3f35250d,0x3f35bf80,0xbf7b3f35,0x3f0e3ec4,0x3f7bbf35,0xbf0ebec4,0x3ec4bf80,0xbf6d3f35,0x3ec4bf80,0xbf6d3f35,0x3f0e3f35,0xbe48bf6d,0xbf0ebf35,0x3e483f6d
.long 0x3f35250d,0x3f353f80,0x3f35250d,0x3f353f80,0x3e483f35,0xbf55bec4,0xbe48bf35,0x3f553ec4,0xbf6dbf80,0xbec4bf35,0xbf6dbf80,0xbec4bf35,0x3f553f35,0x3f7b3f6d,0xbf55bf35,0xbf7bbf6d
.long 0x3f358000,0x3f353f80,0x3f358000,0x3f353f80,0xbf0ebf80,0x3f7b3ec4,0x3f0e3f80,0xbf7bbec4,0xbf6d250d,0x3ec4bf35,0xbf6d250d,0x3ec4bf35,0x3e483f80,0xbf0ebf6d,0xbe48bf80,0x3f0e3f6d
.long 0x3f358000,0x3f35bf80,0x3f358000,0x3f35bf80,0x3f55bf80,0xbe48bec4,0xbf553f80,0x3e483ec4,0xbec4250d,0xbf6d3f35,0xbec4250d,0xbf6d3f35,0xbf7b3f80,0xbf553f6d,0x3f7bbf80,0x3f55bf6d
.long 0xbf358000,0xbf353f80,0xbf358000,0xbf353f80,0x3f0ebf80,0xbf7b3ec4,0xbf0e3f80,0x3f7bbec4,0x3f6d250d,0xbec4bf35,0x3f6d250d,0xbec4bf35,0xbe483f80,0x3f0ebf6d,0x3e48bf80,0xbf0e3f6d
.long 0xbf358000,0xbf35bf80,0xbf358000,0xbf35bf80,0xbf55bf80,0x3e48bec4,0x3f553f80,0xbe483ec4,0x3ec4250d,0x3f6d3f35,0x3ec4250d,0x3f6d3f35,0x3f7b3f80,0x3f553f6d,0xbf7bbf80,0xbf55bf6d
.long 0xbf35250d,0xbf35bf80,0xbf35250d,0xbf35bf80,0xbe483f35,0xbf55bf6d,0x3e48bf35,0x3f553f6d,0x3ec43f80,0xbf6dbf35,0x3ec43f80,0xbf6dbf35,0x3f553f35,0xbf7bbec4,0xbf55bf35,0x3f7b3ec4
.long 0xbf35250d,0xbf353f80,0xbf35250d,0xbf353f80,0xbf7b3f35,0xbf0e3f6d,0x3f7bbf35,0x3f0ebf6d,0xbf6d3f80,0xbec43f35,0xbf6d3f80,0xbec43f35,0xbf0e3f35,0xbe483ec4,0x3f0ebf35,0x3e48bec4
.long 0x3f35250d,0x3f35bf80,0x3f35250d,0x3f35bf80,0x3e483f35,0x3f55bf6d,0xbe48bf35,0xbf553f6d,0xbec43f80,0x3f6dbf35,0xbec43f80,0x3f6dbf35,0xbf553f35,0x3f7bbec4,0x3f55bf35,0xbf7b3ec4
.long 0x3f35250d,0x3f353f80,0x3f35250d,0x3f353f80,0x3f7b3f35,0x3f0e3f6d,0xbf7bbf35,0xbf0ebf6d,0x3f6d3f80,0x3ec43f35,0x3f6d3f80,0x3ec43f35,0x3f0e3f35,0x3e483ec4,0xbf0ebf35,0xbe48bec4
.size spectral_tables, 100352
.p2align 6
.amdhsa_kernel gated_mix__spectral_gfnet__grouped_kv_mqa__prompt_kernel
  .amdhsa_next_free_vgpr 256
  .amdhsa_next_free_sgpr 102
  .amdhsa_accum_offset 256
  .amdhsa_group_segment_fixed_size 0
  .amdhsa_kernarg_size 96
  .amdhsa_user_sgpr_count 2
  .amdhsa_user_sgpr_kernarg_segment_ptr 1
  .amdhsa_system_sgpr_workgroup_id_x 1
.end_amdhsa_kernel
```
